```python
import torch

def _softmax(x, axis=-1):
    return torch.softmax(x, dim=axis)
def _gelu(x):
    return torch.nn.functional.gelu(x, approximate="tanh")
def _silu(x):
    return torch.nn.functional.silu(x)
def _sigmoid(x):
    return torch.sigmoid(x)
def _layernorm(x, axis=-1, eps=1e-5):
    m = x.mean(dim=axis, keepdim=True)
    v = x.var(dim=axis, keepdim=True, unbiased=False)
    return (x - m) / torch.sqrt(v + eps)
def _scatter_add(tgt, idx, src, axis=0):
    return tgt.clone().index_add_(axis, idx, src)
def _segment_sum(src, seg, n):
    out = torch.zeros((n,) + src.shape[1:], dtype=src.dtype)
    return out.index_add_(0, seg, src)
def _pad(x, pw):
    flat = tuple(v for pair in reversed(pw) for v in pair)
    return torch.nn.functional.pad(x, flat)

kernel_name = 'concat_heads__mha_block_cached__gqa_block_cached__near_ridge'

def setup_inputs():

    _w = (lambda a: (lambda t: t.to(torch.bfloat16) if t.is_floating_point() else t)(torch.as_tensor(a)))
    def _A_setup():
        B, Sq, D = 16, 192, 640
        H, Sk, Dh = 32, 512, 128
        return {
            "x": _w((lambda *s: torch.randn(*s, dtype=torch.bfloat16) * 0.8)(B, Sq, D)),
            "k_cache": _w((lambda *s: torch.randn(*s, dtype=torch.bfloat16) * 0.8)(B, H, Sk, Dh)),
            "v_cache": _w((lambda *s: torch.randn(*s, dtype=torch.bfloat16) * 0.05)(B, H, Sk, Dh)),
            "wq": _w((lambda *s: torch.randn(*s, dtype=torch.bfloat16) * 0.8)(D, H * Dh) * (D ** -0.5)),
            "wo": _w((lambda *s: torch.randn(*s, dtype=torch.bfloat16) * 0.05)(H * Dh, D) * ((H * Dh) ** -0.5)),
        }
    _A_in = _A_setup()

    def _B_setup():
        B, Sq, D = 16, 192, 640
        Hq, Hkv, Sk, Dh = 32, 32, 512, 128
        assert Hq % Hkv == 0, (Hq, Hkv)
        return {
            "x": _w((lambda *s: torch.randn(*s, dtype=torch.bfloat16) * 0.8)(B, Sq, D)),
            "k_cache": _w((lambda *s: torch.randn(*s, dtype=torch.bfloat16) * 0.8)(B, Hkv, Sk, Dh)),
            "v_cache": _w((lambda *s: torch.randn(*s, dtype=torch.bfloat16) * 0.05)(B, Hkv, Sk, Dh)),
            "wq": _w((lambda *s: torch.randn(*s, dtype=torch.bfloat16) * 0.8)(D, Hq * Dh) * (D ** -0.5)),
            "wo": _w((lambda *s: torch.randn(*s, dtype=torch.bfloat16) * 0.05)(Hq * Dh, D) * ((Hq * Dh) ** -0.5)),
        }
    _B_in = _B_setup()

    return {
        "A_x": _A_in["x"],
        "A_k_cache": _A_in["k_cache"],
        "A_v_cache": _A_in["v_cache"],
        "A_wq": _A_in["wq"],
        "A_wo": _A_in["wo"],
        "B_x": _B_in["x"],
        "B_k_cache": _B_in["k_cache"],
        "B_v_cache": _B_in["v_cache"],
        "B_wq": _B_in["wq"],
        "B_wo": _B_in["wo"],
    }

def reference(A_x, A_k_cache, A_v_cache, A_wq, A_wo, B_x, B_k_cache, B_v_cache, B_wq, B_wo):
    def _A_ref(x, k_cache, v_cache, wq, wo):
        B, Sq, D = x.shape
        H, Dh = 32, 128
        q = (lambda x, *d: x.permute(*d))((x @ wq).reshape(B, Sq, H, Dh), 0, 2, 1, 3)
        scores = torch.einsum("bhqd,bhkd->bhqk", q, k_cache) * (Dh ** -0.5)
        p = _softmax(scores, axis=-1)
        o = torch.einsum("bhqk,bhkd->bhqd", p, v_cache)
        return (lambda x, *d: x.permute(*d))(o, 0, 2, 1, 3).reshape(B, Sq, H * Dh) @ wo

    def _B_ref(x, k_cache, v_cache, wq, wo):
        B, Sq, D = x.shape
        Hq, Dh = 32, 128
        Hkv = k_cache.shape[1]
        rep = Hq // Hkv
        q = (lambda x, *d: x.permute(*d))((x @ wq).reshape(B, Sq, Hq, Dh), 0, 2, 1, 3)
        k = (lambda x, n, axis: torch.repeat_interleave(x, n, dim=axis))(k_cache, rep, axis=1)
        v = (lambda x, n, axis: torch.repeat_interleave(x, n, dim=axis))(v_cache, rep, axis=1)
        scores = torch.einsum("bhqd,bhkd->bhqk", q, k) * (Dh ** -0.5)
        p = _softmax(scores, axis=-1)
        o = torch.einsum("bhqk,bhkd->bhqd", p, v)
        return (lambda x, *d: x.permute(*d))(o, 0, 2, 1, 3).reshape(B, Sq, Hq * Dh) @ wo

    a = _A_ref(A_x, A_k_cache, A_v_cache, A_wq, A_wo)
    b = _B_ref(B_x, B_k_cache, B_v_cache, B_wq, B_wo)
    return torch.concatenate([a, b], axis=-1)
```

```asm
; @launch grid=(256,1,1) block=(256,1,1) lds=163840
.amdgcn_target "amdgcn-amd-amdhsa--gfx950"
.text
.globl concat_heads__mha_block_cached__gqa_block_cached__near_ridge_kernel
.p2align 8
.type concat_heads__mha_block_cached__gqa_block_cached__near_ridge_kernel,@function
concat_heads__mha_block_cached__gqa_block_cached__near_ridge_kernel:
    s_load_dwordx16 s[48:63], s[0:1], 0
    s_load_dwordx8 s[92:99], s[0:1], 64
    s_load_dwordx2 s[64:65], s[0:1], 96
    s_memrealtime s[40:41]
    s_cmp_ge_u32 s2, 256
    s_cbranch_scc1 K_END
    v_lshrrev_b32 v32, 6, v0
    v_and_b32 v0, 63, v0
    v_readfirstlane_b32 s43, v32
    s_and_b32 s70, s2, 7
    s_lshr_b32 s3, s2, 3
    s_lshr_b32 s4, s70, 2
    s_and_b32 s5, s70, 1
    s_lshl_b32 s5, s5, 3
    s_lshr_b32 s72, s3, 2
    s_add_u32 s5, s5, s72
    s_and_b32 s6, s70, 2
    s_lshl_b32 s6, s6, 1
    s_and_b32 s73, s3, 3
    s_add_u32 s6, s6, s73
    v_lshrrev_b32 v32, 3, v0
    v_and_b32 v33, 4, v32
    v_and_b32 v34, 1, v32
    v_lshl_add_u32 v33, v34, 1, v33
    v_bfe_u32 v34, v32, 1, 1
    v_add_u32 v33, v33, v34
    v_lshlrev_b32 v33, 3, v33
    s_lshl_b32 s71, s43, 1
    v_add_u32 v33, s71, v33
    v_mul_u32_u24 v33, 1280, v33
    v_and_b32 v34, 7, v0
    v_lshl_add_u32 v1, v34, 4, v33
    v_lshrrev_b32 v32, 5, v0
    v_lshlrev_b32 v32, 15, v32
    s_lshl_b32 s71, s43, 16
    v_add_u32 v32, s71, v32
    v_and_b32 v33, 31, v0
    v_lshl_add_u32 v2, v33, 4, v32
    s_mul_i32 s28, s43, 6208
    s_mul_i32 s29, s43, 4360
    s_xor_b32 s31, s2, s3
    s_and_b32 s31, s31, 1
    s_add_u32 s75, s72, s73
    s_and_b32 s75, s75, 1
    s_mul_i32 s71, s5, 245760
    s_lshl_b32 s72, s6, 10
    s_mov_b32 s10, 245760
    s_mov_b32 s11, 0x20000
    s_sub_u32 s14, 5242880, s72
    s_mov_b32 s15, 0x20000
    s_waitcnt lgkmcnt(0)
    s_cmp_eq_u32 s4, 0
    s_cselect_b64 s[54:55], s[54:55], s[92:93]
    s_cselect_b64 s[48:49], s[48:49], s[58:59]
    s_cselect_b64 s[50:51], s[50:51], s[60:61]
    s_cselect_b64 s[52:53], s[52:53], s[62:63]
    s_cselect_b64 s[66:67], s[56:57], s[94:95]
    s_add_u32 s12, s54, s72
    s_addc_u32 s13, s55, 0
    s_add_u32 s8, s48, s71
    s_addc_u32 s9, s49, 0
    s_lshl_b32 s60, s75, 7
    s_lshl_b32 s61, s75, 10
    s_or_b32 s61, s61, s31
    s_lshl_b32 s61, s61, 9
    s_mov_b32 s62, 5242880
    s_add_u32 m0, s29, 24832
    s_xor_b32 s35, s61, 0
    s_nop 0
    buffer_load_dwordx4 v2, s[12:15], s35 offen lds
    s_add_u32 m0, s29, 25920
    s_xor_b32 s35, s61, 8192
    buffer_load_dwordx4 v2, s[12:15], s35 offen lds
    s_add_u32 m0, s29, 27008
    s_xor_b32 s35, s61, 16384
    buffer_load_dwordx4 v2, s[12:15], s35 offen lds
    s_add_u32 m0, s29, 28096
    s_xor_b32 s35, s61, 24576
    buffer_load_dwordx4 v2, s[12:15], s35 offen lds
    s_add_u32 m0, s28, 136864
    s_xor_b32 s35, s60, 0
    buffer_load_dwordx4 v1, s[8:11], s35 offen offset:0 lds
    s_add_u32 m0, s28, 138688
    s_nop 0
    buffer_load_dwordx4 v1, s[8:11], s35 offen offset:1280 lds
    s_add_u32 m0, s28, 137888
    s_xor_b32 s35, s60, 81920
    buffer_load_dwordx4 v1, s[8:11], s35 offen offset:0 lds
    s_add_u32 m0, s28, 139712
    s_nop 0
    buffer_load_dwordx4 v1, s[8:11], s35 offen offset:1280 lds
    s_add_u32 m0, s28, 138912
    s_xor_b32 s35, s60, 163840
    buffer_load_dwordx4 v1, s[8:11], s35 offen offset:0 lds
    s_add_u32 m0, s28, 140736
    s_nop 0
    buffer_load_dwordx4 v1, s[8:11], s35 offen offset:1280 lds
    s_mov_b64 s[76:77], s[96:97]
    s_mov_b64 s[78:79], s[98:99]
    s_lshr_b32 s44, s43, 1
    s_and_b32 s45, s43, 1
    v_mov_b32 v47, 0x7ffff000
    v_lshlrev_b32 v4, 4, v0
    s_getpc_b64 s[56:57]
K1_PC:
    s_mov_b32 s58, TEXT_END-K1_PC
    s_mov_b32 s59, 0x20000
    s_lshl_b32 s71, s3, 2
    s_add_u32 s71, s71, s43
    s_mul_i32 s71, s71, 640
    v_lshlrev_b32 v33, 7, v0
    v_cmp_gt_u32 vcc, 5, v0
    s_nop 1
    v_cndmask_b32 v32, v47, v33, vcc
    buffer_load_dword v13, v32, s[56:59], s71 offen
    s_add_u32 m0, s29, 42272
    s_xor_b32 s35, s61, 262144
    buffer_load_dwordx4 v2, s[12:15], s35 offen lds
    s_add_u32 m0, s29, 43360
    s_xor_b32 s35, s61, 270336
    buffer_load_dwordx4 v2, s[12:15], s35 offen lds
    s_add_u32 m0, s29, 44448
    s_xor_b32 s35, s61, 278528
    buffer_load_dwordx4 v2, s[12:15], s35 offen lds
    s_add_u32 m0, s29, 45536
    s_xor_b32 s35, s61, 286720
    buffer_load_dwordx4 v2, s[12:15], s35 offen lds
    v_lshrrev_b32 v35, 4, v0
    v_lshlrev_b32 v32, 11, v35
    s_lshl_b32 s71, s45, 10
    v_add_u32 v32, s71, v32
    v_and_b32 v39, 15, v0
    v_lshl_add_u32 v3, v39, 4, v32
    v_and_b32 v36, 7, v0
    v_bfe_u32 v37, v0, 3, 1
    v_lshlrev_b32 v38, 4, v35
    v_lshl_add_u32 v38, v37, 8, v38
    v_mul_u32_u24 v32, 3104, v36
    v_add_u32 v32, v32, v38
    s_mul_i32 s71, s45, 1536
    v_add_u32 v5, s71, v32
    v_add_u32 v6, 136864, v5
    v_mul_u32_u24 v32, 1056, v36
    v_add_u32 v32, v32, v38
    s_mul_i32 s72, s44, 8448
    v_add_u32 v9, s72, v32
    v_bfe_u32 v36, v0, 2, 2
    v_and_b32 v37, 3, v0
    v_mul_u32_u24 v32, 4360, v35
    v_mul_u32_u24 v33, 1088, v36
    v_add_u32 v32, v32, v33
    v_lshl_add_u32 v32, v37, 4, v32
    s_lshl_b32 s71, s44, 8
    s_add_u32 s71, s71, 24832
    v_add_u32 v7, s71, v32
    v_add_u32 v8, 77152, v7
    v_and_b32 v32, 1, v35
    v_lshl_add_u32 v32, v32, 2, v36
    v_mul_u32_u24 v32, 1056, v32
    v_lshrrev_b32 v33, 1, v35
    v_lshl_add_u32 v32, v33, 8, v32
    v_lshl_add_u32 v32, v37, 3, v32
    v_add_u32 v10, s72, v32
    v_lshrrev_b32 v32, 4, v0
    v_xor_b32 v32, v32, v0
    v_and_b32 v32, 2, v32
    v_cmp_eq_u32 vcc, 0, v32
    v_mov_b32 v33, 0x3f803f80
    s_nop 0
    v_cndmask_b32 v32, 0, v33, vcc
    v_accvgpr_write_b32 a216, v32
    v_accvgpr_write_b32 a217, v32
    v_accvgpr_write_b32 a218, v32
    v_accvgpr_write_b32 a219, v32
    v_accvgpr_write_b32 a192, 1.0
    v_accvgpr_write_b32 a193, 1.0
    v_accvgpr_write_b32 a194, 1.0
    v_accvgpr_write_b32 a195, 1.0
    v_accvgpr_write_b32 a196, 1.0
    v_accvgpr_write_b32 a197, 1.0
    v_accvgpr_write_b32 a198, 1.0
    v_accvgpr_write_b32 a199, 1.0
    v_accvgpr_write_b32 a200, 1.0
    v_accvgpr_write_b32 a201, 1.0
    v_accvgpr_write_b32 a202, 1.0
    v_accvgpr_write_b32 a203, 1.0
    v_mov_b32 v28, 0
    s_mul_i32 s71, s45, 4224
    s_add_u32 s30, s72, s71
    s_mov_b32 s38, 0x3e0293ee
    s_mov_b32 s39, s38
    s_mov_b32 s46, 0x39800000
    s_mov_b32 s47, 0x15000000
    s_mov_b32 s42, 0
    s_mov_b32 s86, 0
    s_mov_b32 s37, 0
    s_lshl_b32 s71, s5, 5
    s_lshl_b32 s72, s6, 2
    s_add_u32 s72, s72, s44
    s_add_u32 s71, s71, s72
    s_lshl_b32 s71, s71, 17
    s_add_u32 s16, s50, s71
    s_addc_u32 s17, s51, 0
    s_mov_b32 s18, 393216
    s_mov_b32 s19, 0x20000
    s_add_u32 s20, s52, s71
    s_addc_u32 s21, s53, 0
    s_mov_b32 s22, 393216
    s_mov_b32 s23, 0x20000
    s_lshl_b32 s71, s4, 7
    s_lshl_b32 s72, s72, 2
    s_add_u32 s71, s71, s72
    s_mul_i32 s71, s71, 192
    s_mul_i32 s72, s5, 12
    s_add_u32 s71, s71, s72
    s_mul_i32 s72, s45, 6
    s_add_u32 s71, s71, s72
    s_lshl_b32 s71, s71, 10
    s_add_u32 s24, s64, s71
    s_addc_u32 s25, s65, 0
    s_mov_b32 s26, 0
    s_mov_b32 s27, 0x20000
    s_mov_b32 s34, 0
    s_lshl_b32 s71, s5, 3
    s_add_u32 s71, s71, s6
    s_lshl_b32 s71, s71, 2
    s_add_u32 s71, s71, s43
    s_mul_i32 s71, s71, 10240
    s_add_u32 s98, s66, s71
    s_addc_u32 s99, s67, 0
    s_and_b32 s74, s70, 1
    s_mul_i32 s73, s74, 30
    s_add_u32 s73, s73, s3
    s_mul_i32 s72, s73, 205
    s_lshr_b32 s72, s72, 10
    s_mul_i32 s71, s72, 5
    s_sub_u32 s73, s73, s71
    s_and_b32 s71, s70, 2
    s_mul_i32 s71, s71, 6
    s_add_u32 s72, s72, s71
    s_mul_i32 s74, s74, 0
    s_add_u32 s74, s74, s3
    s_cmp_ge_u32 s74, 30
    s_cselect_b32 s63, 1, 0
    s_cselect_b32 s72, 0, s72
    s_cselect_b32 s75, 0, -1
    s_lshl_b32 s71, s4, 7
    s_lshl_b32 s74, s44, 6
    s_add_u32 s71, s71, s74
    s_mul_i32 s71, s71, 192
    s_lshl_b32 s74, s72, 3
    s_add_u32 s71, s71, s74
    s_lshl_b32 s74, s45, 2
    s_add_u32 s71, s71, s74
    s_lshl_b32 s71, s71, 10
    s_add_u32 s48, s64, s71
    s_addc_u32 s49, s65, 0
    s_and_b32 s50, s75, 12390400
    s_mov_b32 s51, 0x20000
    s_mul_i32 s71, s44, 2621440
    s_lshl_b32 s74, s73, 8
    s_add_u32 s71, s71, s74
    s_add_u32 s52, s66, s71
    s_addc_u32 s53, s67, 0
    s_and_b32 s54, s75, 2620416
    s_mov_b32 s55, 0x20000
    s_lshl_b32 s71, s72, 2
    s_lshl_b32 s85, s45, 1
    s_add_u32 s71, s71, s85
    s_add_u32 s71, s71, s44
    s_mul_i32 s71, s71, 81920
    s_mul_i32 s85, s4, 1280
    s_add_u32 s71, s71, s85
    s_add_u32 s71, s71, s74
    s_add_u32 s56, s76, s71
    s_addc_u32 s57, s77, 0
    s_and_b32 s58, s75, 79616
    s_mov_b32 s59, 0x20000
    s_add_u32 s68, s64, 67108864
    s_addc_u32 s69, s65, 0
    s_mov_b64 s[64:65], s[78:79]
    s_mov_b32 s66, 256
    s_mov_b32 s67, 0x20000
    s_lshl_b32 s74, s4, 4
    s_add_u32 s85, s74, s5
    s_lshl_b32 s85, s85, 1
    s_lshr_b32 s36, s6, 2
    s_add_u32 s85, s85, s36
    s_lshl_b32 s85, s85, 6
    s_and_b32 s36, s6, 3
    s_add_u32 s85, s85, s36
    s_lshl_b32 s85, s85, 2
    s_cmp_eq_u32 s43, 0
    s_cselect_b32 s85, s85, 0x7ffff000
    v_mov_b32 v32, s85
    v_cmp_eq_u32 vcc, 0, v0
    s_nop 1
    v_cndmask_b32 v20, v47, v32, vcc
    s_or_b32 s85, s2, s43
    v_or_b32 v32, s85, v0
    v_lshlrev_b32 v58, 8, v32
    s_or_b32 s85, s40, 1
    v_mov_b32 v21, s85
    buffer_store_dword v21, v58, s[64:67], 0 offen sc1
    s_lshl_b32 s85, s72, 1
    s_add_u32 s85, s85, s45
    s_mul_i32 s85, s85, 43
    s_lshr_b32 s85, s85, 7
    s_add_u32 s85, s85, s74
    s_lshl_b32 s85, s85, 1
    s_add_u32 s85, s85, s44
    s_lshl_b32 s85, s85, 6
    v_and_or_b32 v32, v0, 3, s85
    v_lshlrev_b32 v17, 2, v32
    s_mov_b32 s70, 0
    s_mov_b32 s71, 0x20000
    s_mul_i32 s85, s72, 3
    s_mul_i32 s36, s73, 2
    s_add_u32 s85, s85, s36
    s_mul_i32 s36, s44, 0
    s_add_u32 s85, s85, s36
    s_bfe_u32 s36, s85, 3
    s_mul_i32 s36, s36, 0x18
    s_and_b32 s72, s85, 7
    s_and_b32 s85, s2, 3
    s_lshl_b32 s85, s85, 4
    s_or_b32 s72, s72, s85
    s_lshr_b32 s85, s2, 1
    s_xor_b32 s85, s85, s2
    s_and_b32 s85, s85, 1
    s_lshl_b32 s85, s85, 3
    s_or_b32 s72, s72, s85
    s_xor_b32 s72, s72, s36
    s_lshl_b32 s85, s44, 11
    v_add_u32 v14, s85, v4
    v_xor_b32 v15, 2048, v14
    v_mul_u32_u24 v33, 10240, v35
    s_mul_i32 s85, s45, 5120
    v_add_u32 v33, s85, v33
    v_lshl_add_u32 v16, v39, 4, v33
    s_mov_b64 s[76:77], s[98:99]
    s_mov_b32 s78, 10240
    s_mov_b32 s79, 0x20000
    s_mov_b32 s100, 5120
    s_mov_b64 s[98:99], s[64:65]
    s_lshl_b32 s75, s31, 18
    s_lshr_b32 s101, s2, 3
    s_xor_b32 s101, s101, s2
    s_lshl_b32 s85, s44, 3
    s_xor_b32 s101, s101, s85
    s_and_b32 s101, s101, 15
    s_lshl_b32 s101, s101, 13
    s_lshr_b32 s80, s2, 7
    s_and_b32 s85, s2, 0
    s_lshl_b32 s85, s85, 1
    s_or_b32 s80, s80, s85
    s_lshl_b32 s85, s44, 1
    s_or_b32 s80, s80, s85
    s_and_b32 s85, s2, 4
    s_or_b32 s80, s80, s85
    s_lshl_b32 s80, s80, 14
    s_add_u32 s80, s80, 8192
    s_mov_b32 s73, -512
    s_mov_b32 s74, 14784
    s_mov_b64 s[92:93], s[16:17]
    s_mov_b32 s94, 393216
    s_mov_b32 s95, 0x20000
    v_lshlrev_b32 v32, 7, v0
    v_cmp_gt_u32 vcc, 40, v0
    s_nop 1
    v_cndmask_b32 v29, v47, v32, vcc
    v_lshlrev_b32 v57, 17, v0
    s_cmp_eq_u32 s45, 0
    s_cselect_b64 s[92:93], s[16:17], s[20:21]
    buffer_load_dword v13, v57, s[92:95], 0 offen nt
    s_add_u32 m0, s28, 0
    s_xor_b32 s35, s60, 128
    buffer_load_dwordx4 v1, s[8:11], s35 offen offset:0 lds
    s_add_u32 m0, s28, 1824
    s_nop 0
    buffer_load_dwordx4 v1, s[8:11], s35 offen offset:1280 lds
    s_add_u32 m0, s28, 1024
    s_xor_b32 s35, s60, 82048
    buffer_load_dwordx4 v1, s[8:11], s35 offen offset:0 lds
    s_add_u32 m0, s28, 2848
    s_nop 0
    buffer_load_dwordx4 v1, s[8:11], s35 offen offset:1280 lds
    s_add_u32 m0, s28, 2048
    s_xor_b32 s35, s60, 163968
    buffer_load_dwordx4 v1, s[8:11], s35 offen offset:0 lds
    s_add_u32 m0, s28, 3872
    s_nop 0
    s_nop 0
    buffer_load_dwordx4 v1, s[8:11], s35 offen offset:1280 lds
    s_add_u32 m0, s29, 84544
    s_xor_b32 s35, s61, 524288
    buffer_load_dwordx4 v2, s[12:15], s35 offen lds
    s_add_u32 m0, s29, 85632
    s_xor_b32 s35, s61, 532480
    buffer_load_dwordx4 v2, s[12:15], s35 offen lds
    s_add_u32 m0, s29, 86720
    s_xor_b32 s35, s61, 540672
    buffer_load_dwordx4 v2, s[12:15], s35 offen lds
    s_add_u32 m0, s29, 87808
    s_xor_b32 s35, s61, 548864
    buffer_load_dwordx4 v2, s[12:15], s35 offen lds
    s_waitcnt vmcnt(17) lgkmcnt(0)
    s_barrier
    ds_read_b64_tr_b16 a[220:221], v7 offset:0
    ds_read_b64_tr_b16 a[222:223], v7 offset:512
    ds_read_b64_tr_b16 a[224:225], v7 offset:8
    ds_read_b64_tr_b16 a[226:227], v7 offset:520
    ds_read_b64_tr_b16 a[228:229], v7 offset:64
    ds_read_b64_tr_b16 a[230:231], v7 offset:576
    ds_read_b64_tr_b16 a[232:233], v7 offset:72
    ds_read_b64_tr_b16 a[234:235], v7 offset:584
    ds_read_b64_tr_b16 a[236:237], v7 offset:128
    ds_read_b64_tr_b16 a[238:239], v7 offset:640
    ds_read_b64_tr_b16 a[240:241], v7 offset:136
    ds_read_b64_tr_b16 a[242:243], v7 offset:648
    ds_read_b64_tr_b16 a[244:245], v7 offset:192
    ds_read_b64_tr_b16 a[246:247], v7 offset:704
    ds_read_b64_tr_b16 a[248:249], v7 offset:200
    ds_read_b64_tr_b16 a[250:251], v7 offset:712
    ds_read_b128 v[32:35], v6 offset:0
    ds_read_b128 v[36:39], v6 offset:128
    ds_read_b128 v[40:43], v6 offset:512
    ds_read_b128 v[44:47], v6 offset:640
    ds_read_b128 v[48:51], v6 offset:1024
    ds_read_b128 v[52:55], v6 offset:1152
    s_waitcnt vmcnt(12) lgkmcnt(0)
    s_barrier
    v_mfma_f32_16x16x32_bf16 v[64:67], a[220:223], v[32:35], 0
    ds_read_b64_tr_b16 a[0:1], v7 offset:17440
    v_accvgpr_write_b32 a192, 0
    v_mfma_f32_16x16x32_bf16 v[68:71], a[224:227], v[32:35], 0
    ds_read_b64_tr_b16 a[2:3], v7 offset:17952
    v_accvgpr_write_b32 a193, 0
    v_mfma_f32_16x16x32_bf16 v[72:75], a[228:231], v[32:35], 0
    s_add_u32 m0, s29, 101984
    s_xor_b32 s35, s61, 786432
    ds_read_b64_tr_b16 a[4:5], v7 offset:17448
    v_mfma_f32_16x16x32_bf16 v[76:79], a[232:235], v[32:35], 0
    buffer_load_dwordx4 v2, s[12:15], s35 offen lds
    v_mfma_f32_16x16x32_bf16 v[80:83], a[236:239], v[32:35], 0
    v_accvgpr_write_b32 a194, 0
    v_accvgpr_write_b32 a195, 0
    v_mfma_f32_16x16x32_bf16 v[84:87], a[240:243], v[32:35], 0
    ds_read_b64_tr_b16 a[6:7], v7 offset:17960
    v_accvgpr_write_b32 a196, 0
    v_mfma_f32_16x16x32_bf16 v[88:91], a[244:247], v[32:35], 0
    s_add_u32 m0, s29, 103072
    s_xor_b32 s35, s61, 794624
    ds_read_b64_tr_b16 a[8:9], v7 offset:17504
    v_mfma_f32_16x16x32_bf16 v[92:95], a[248:251], v[32:35], 0
    buffer_load_dwordx4 v2, s[12:15], s35 offen lds
    v_mfma_f32_16x16x32_bf16 v[124:127], a[248:251], v[36:39], 0
    v_accvgpr_write_b32 a197, 0
    v_accvgpr_write_b32 a198, 0
    v_mfma_f32_16x16x32_bf16 v[120:123], a[244:247], v[36:39], 0
    ds_read_b64_tr_b16 a[10:11], v7 offset:18016
    v_accvgpr_write_b32 a199, 0
    v_mfma_f32_16x16x32_bf16 v[116:119], a[240:243], v[36:39], 0
    s_add_u32 m0, s29, 104160
    s_xor_b32 s35, s61, 802816
    ds_read_b64_tr_b16 a[12:13], v7 offset:17512
    v_mfma_f32_16x16x32_bf16 v[112:115], a[236:239], v[36:39], 0
    buffer_load_dwordx4 v2, s[12:15], s35 offen lds
    v_mfma_f32_16x16x32_bf16 v[108:111], a[232:235], v[36:39], 0
    ds_read_b64_tr_b16 a[14:15], v7 offset:18024
    v_accvgpr_write_b32 a200, 0
    v_mfma_f32_16x16x32_bf16 v[104:107], a[228:231], v[36:39], 0
    v_accvgpr_write_b32 a201, 0
    v_accvgpr_write_b32 a202, 0
    v_mfma_f32_16x16x32_bf16 v[100:103], a[224:227], v[36:39], 0
    s_add_u32 m0, s29, 105248
    s_xor_b32 s35, s61, 811008
    ds_read_b64_tr_b16 a[16:17], v7 offset:17568
    v_mfma_f32_16x16x32_bf16 v[96:99], a[220:223], v[36:39], 0
    buffer_load_dwordx4 v2, s[12:15], s35 offen lds
    v_mfma_f32_16x16x32_bf16 v[128:131], a[220:223], v[40:43], 0
    ds_read_b64_tr_b16 a[18:19], v7 offset:18080
    v_accvgpr_write_b32 a203, 0
    v_mfma_f32_16x16x32_bf16 v[132:135], a[224:227], v[40:43], 0
    v_mfma_f32_16x16x32_bf16 v[136:139], a[228:231], v[40:43], 0
    s_add_u32 m0, s28, 59712
    s_xor_b32 s35, s60, 256
    ds_read_b64_tr_b16 a[20:21], v7 offset:17576
    v_mfma_f32_16x16x32_bf16 v[140:143], a[232:235], v[40:43], 0
    buffer_load_dwordx4 v1, s[8:11], s35 offen offset:0 lds
    v_mfma_f32_16x16x32_bf16 v[144:147], a[236:239], v[40:43], 0
    ds_read_b64_tr_b16 a[22:23], v7 offset:18088
    v_mfma_f32_16x16x32_bf16 v[148:151], a[240:243], v[40:43], 0
    ds_read_b64_tr_b16 a[24:25], v7 offset:17632
    v_mfma_f32_16x16x32_bf16 v[152:155], a[244:247], v[40:43], 0
    s_add_u32 m0, s28, 61536
    v_mfma_f32_16x16x32_bf16 v[156:159], a[248:251], v[40:43], 0
    buffer_load_dwordx4 v1, s[8:11], s35 offen offset:1280 lds
    v_mfma_f32_16x16x32_bf16 v[188:191], a[248:251], v[44:47], 0
    ds_read_b64_tr_b16 a[26:27], v7 offset:18144
    v_mfma_f32_16x16x32_bf16 v[184:187], a[244:247], v[44:47], 0
    ds_read_b64_tr_b16 a[28:29], v7 offset:17640
    v_mfma_f32_16x16x32_bf16 v[180:183], a[240:243], v[44:47], 0
    s_add_u32 m0, s28, 60736
    s_xor_b32 s35, s60, 82176
    v_mfma_f32_16x16x32_bf16 v[176:179], a[236:239], v[44:47], 0
    buffer_load_dwordx4 v1, s[8:11], s35 offen offset:0 lds
    v_mfma_f32_16x16x32_bf16 v[172:175], a[232:235], v[44:47], 0
    ds_read_b64_tr_b16 a[30:31], v7 offset:18152
    v_mfma_f32_16x16x32_bf16 v[168:171], a[228:231], v[44:47], 0
    ds_read_b128 a[32:35], v6 offset:64
    v_mfma_f32_16x16x32_bf16 v[164:167], a[224:227], v[44:47], 0
    s_add_u32 m0, s28, 62560
    ds_read_b128 a[36:39], v6 offset:192
    v_mfma_f32_16x16x32_bf16 v[160:163], a[220:223], v[44:47], 0
    buffer_load_dwordx4 v1, s[8:11], s35 offen offset:1280 lds
    v_mfma_f32_16x16x32_bf16 v[192:195], a[220:223], v[48:51], 0
    v_mfma_f32_16x16x32_bf16 v[196:199], a[224:227], v[48:51], 0
    ds_read_b128 a[40:43], v6 offset:576
    v_mfma_f32_16x16x32_bf16 v[200:203], a[228:231], v[48:51], 0
    s_add_u32 m0, s28, 61760
    s_xor_b32 s35, s60, 164096
    ds_read_b128 a[44:47], v6 offset:704
    v_mfma_f32_16x16x32_bf16 v[204:207], a[232:235], v[48:51], 0
    buffer_load_dwordx4 v1, s[8:11], s35 offen offset:0 lds
    v_mfma_f32_16x16x32_bf16 v[208:211], a[236:239], v[48:51], 0
    v_mfma_f32_16x16x32_bf16 v[212:215], a[240:243], v[48:51], 0
    ds_read_b128 a[48:51], v6 offset:1088
    v_mfma_f32_16x16x32_bf16 v[216:219], a[244:247], v[48:51], 0
    s_add_u32 m0, s28, 63584
    ds_read_b128 a[52:55], v6 offset:1216
    v_mfma_f32_16x16x32_bf16 v[220:223], a[248:251], v[48:51], 0
    buffer_load_dwordx4 v1, s[8:11], s35 offen offset:1280 lds
    v_mfma_f32_16x16x32_bf16 v[252:255], a[248:251], v[52:55], 0
    v_mfma_f32_16x16x32_bf16 v[248:251], a[244:247], v[52:55], 0
    v_mfma_f32_16x16x32_bf16 v[244:247], a[240:243], v[52:55], 0
    v_mfma_f32_16x16x32_bf16 v[240:243], a[236:239], v[52:55], 0
    v_mfma_f32_16x16x32_bf16 v[236:239], a[232:235], v[52:55], 0
    v_mfma_f32_16x16x32_bf16 v[232:235], a[228:231], v[52:55], 0
    v_mfma_f32_16x16x32_bf16 v[228:231], a[224:227], v[52:55], 0
    v_mfma_f32_16x16x32_bf16 v[224:227], a[220:223], v[52:55], 0
    s_waitcnt vmcnt(10) lgkmcnt(0)
    s_barrier
    v_mfma_f32_16x16x32_bf16 v[64:67], a[0:3], a[32:35], v[64:67]
    ds_read_b64_tr_b16 a[220:221], v7 offset:59712
    v_mfma_f32_16x16x32_bf16 v[68:71], a[4:7], a[32:35], v[68:71]
    ds_read_b64_tr_b16 a[222:223], v7 offset:60224
    v_mfma_f32_16x16x32_bf16 v[72:75], a[8:11], a[32:35], v[72:75]
    s_add_u32 m0, s29, 119424
    s_xor_b32 s35, s61, 1048576
    v_mfma_f32_16x16x32_bf16 v[76:79], a[12:15], a[32:35], v[76:79]
    buffer_load_dwordx4 v2, s[12:15], s35 offen lds
    v_mfma_f32_16x16x32_bf16 v[80:83], a[16:19], a[32:35], v[80:83]
    ds_read_b64_tr_b16 a[224:225], v7 offset:59720
    v_mfma_f32_16x16x32_bf16 v[84:87], a[20:23], a[32:35], v[84:87]
    ds_read_b64_tr_b16 a[226:227], v7 offset:60232
    v_mfma_f32_16x16x32_bf16 v[88:91], a[24:27], a[32:35], v[88:91]
    v_mfma_f32_16x16x32_bf16 v[92:95], a[28:31], a[32:35], v[92:95]
    s_add_u32 m0, s29, 120512
    s_xor_b32 s35, s61, 1056768
    ds_read_b64_tr_b16 a[228:229], v7 offset:59776
    v_mfma_f32_16x16x32_bf16 v[124:127], a[28:31], a[36:39], v[124:127]
    buffer_load_dwordx4 v2, s[12:15], s35 offen lds
    v_mfma_f32_16x16x32_bf16 v[120:123], a[24:27], a[36:39], v[120:123]
    ds_read_b64_tr_b16 a[230:231], v7 offset:60288
    v_mfma_f32_16x16x32_bf16 v[116:119], a[20:23], a[36:39], v[116:119]
    v_mfma_f32_16x16x32_bf16 v[112:115], a[16:19], a[36:39], v[112:115]
    ds_read_b64_tr_b16 a[232:233], v7 offset:59784
    v_mfma_f32_16x16x32_bf16 v[108:111], a[12:15], a[36:39], v[108:111]
    s_add_u32 m0, s29, 121600
    s_xor_b32 s35, s61, 1064960
    ds_read_b64_tr_b16 a[234:235], v7 offset:60296
    v_mfma_f32_16x16x32_bf16 v[104:107], a[8:11], a[36:39], v[104:107]
    buffer_load_dwordx4 v2, s[12:15], s35 offen lds
    v_mfma_f32_16x16x32_bf16 v[100:103], a[4:7], a[36:39], v[100:103]
    v_mfma_f32_16x16x32_bf16 v[96:99], a[0:3], a[36:39], v[96:99]
    ds_read_b64_tr_b16 a[236:237], v7 offset:59840
    v_mfma_f32_16x16x32_bf16 v[128:131], a[0:3], a[40:43], v[128:131]
    ds_read_b64_tr_b16 a[238:239], v7 offset:60352
    v_mfma_f32_16x16x32_bf16 v[132:135], a[4:7], a[40:43], v[132:135]
    s_add_u32 m0, s29, 122688
    s_xor_b32 s35, s61, 1073152
    v_mfma_f32_16x16x32_bf16 v[136:139], a[8:11], a[40:43], v[136:139]
    buffer_load_dwordx4 v2, s[12:15], s35 offen lds
    v_mfma_f32_16x16x32_bf16 v[140:143], a[12:15], a[40:43], v[140:143]
    ds_read_b64_tr_b16 a[240:241], v7 offset:59848
    v_mfma_f32_16x16x32_bf16 v[144:147], a[16:19], a[40:43], v[144:147]
    ds_read_b64_tr_b16 a[242:243], v7 offset:60360
    v_mfma_f32_16x16x32_bf16 v[148:151], a[20:23], a[40:43], v[148:151]
    v_mfma_f32_16x16x32_bf16 v[152:155], a[24:27], a[40:43], v[152:155]
    s_add_u32 m0, s29, 24832
    s_xor_b32 s35, s61, 1310720
    ds_read_b64_tr_b16 a[244:245], v7 offset:59904
    v_mfma_f32_16x16x32_bf16 v[156:159], a[28:31], a[40:43], v[156:159]
    buffer_load_dwordx4 v2, s[12:15], s35 offen lds
    v_mfma_f32_16x16x32_bf16 v[188:191], a[28:31], a[44:47], v[188:191]
    ds_read_b64_tr_b16 a[246:247], v7 offset:60416
    v_mfma_f32_16x16x32_bf16 v[184:187], a[24:27], a[44:47], v[184:187]
    v_mfma_f32_16x16x32_bf16 v[180:183], a[20:23], a[44:47], v[180:183]
    ds_read_b64_tr_b16 a[248:249], v7 offset:59912
    v_mfma_f32_16x16x32_bf16 v[176:179], a[16:19], a[44:47], v[176:179]
    s_add_u32 m0, s29, 25920
    s_xor_b32 s35, s61, 1318912
    ds_read_b64_tr_b16 a[250:251], v7 offset:60424
    v_mfma_f32_16x16x32_bf16 v[172:175], a[12:15], a[44:47], v[172:175]
    buffer_load_dwordx4 v2, s[12:15], s35 offen lds
    v_mfma_f32_16x16x32_bf16 v[168:171], a[8:11], a[44:47], v[168:171]
    v_mfma_f32_16x16x32_bf16 v[164:167], a[4:7], a[44:47], v[164:167]
    ds_read_b128 v[32:35], v5 offset:0
    v_mfma_f32_16x16x32_bf16 v[160:163], a[0:3], a[44:47], v[160:163]
    ds_read_b128 v[36:39], v5 offset:128
    v_mfma_f32_16x16x32_bf16 v[192:195], a[0:3], a[48:51], v[192:195]
    s_add_u32 m0, s29, 27008
    s_xor_b32 s35, s61, 1327104
    v_mfma_f32_16x16x32_bf16 v[196:199], a[4:7], a[48:51], v[196:199]
    buffer_load_dwordx4 v2, s[12:15], s35 offen lds
    v_mfma_f32_16x16x32_bf16 v[200:203], a[8:11], a[48:51], v[200:203]
    ds_read_b128 v[40:43], v5 offset:512
    v_mfma_f32_16x16x32_bf16 v[204:207], a[12:15], a[48:51], v[204:207]
    ds_read_b128 v[44:47], v5 offset:640
    v_mfma_f32_16x16x32_bf16 v[208:211], a[16:19], a[48:51], v[208:211]
    v_mfma_f32_16x16x32_bf16 v[212:215], a[20:23], a[48:51], v[212:215]
    s_add_u32 m0, s29, 28096
    s_xor_b32 s35, s61, 1335296
    ds_read_b128 v[48:51], v5 offset:1024
    v_mfma_f32_16x16x32_bf16 v[216:219], a[24:27], a[48:51], v[216:219]
    buffer_load_dwordx4 v2, s[12:15], s35 offen lds
    v_mfma_f32_16x16x32_bf16 v[220:223], a[28:31], a[48:51], v[220:223]
    ds_read_b128 v[52:55], v5 offset:1152
    v_mfma_f32_16x16x32_bf16 v[252:255], a[28:31], a[52:55], v[252:255]
    v_mfma_f32_16x16x32_bf16 v[248:251], a[24:27], a[52:55], v[248:251]
    v_mfma_f32_16x16x32_bf16 v[244:247], a[20:23], a[52:55], v[244:247]
    v_mfma_f32_16x16x32_bf16 v[240:243], a[16:19], a[52:55], v[240:243]
    v_mfma_f32_16x16x32_bf16 v[236:239], a[12:15], a[52:55], v[236:239]
    v_mfma_f32_16x16x32_bf16 v[232:235], a[8:11], a[52:55], v[232:235]
    v_mfma_f32_16x16x32_bf16 v[228:231], a[4:7], a[52:55], v[228:231]
    v_mfma_f32_16x16x32_bf16 v[224:227], a[0:3], a[52:55], v[224:227]
    s_waitcnt vmcnt(14) lgkmcnt(0)
    s_barrier
    v_mfma_f32_16x16x32_bf16 v[64:67], a[220:223], v[32:35], v[64:67]
    ds_read_b64_tr_b16 a[0:1], v8 offset:0
    v_mfma_f32_16x16x32_bf16 v[68:71], a[224:227], v[32:35], v[68:71]
    ds_read_b64_tr_b16 a[2:3], v8 offset:512
    v_mfma_f32_16x16x32_bf16 v[72:75], a[228:231], v[32:35], v[72:75]
    s_add_u32 m0, s28, 136864
    s_xor_b32 s35, s60, 384
    ds_read_b64_tr_b16 a[4:5], v8 offset:8
    v_mfma_f32_16x16x32_bf16 v[76:79], a[232:235], v[32:35], v[76:79]
    buffer_load_dwordx4 v1, s[8:11], s35 offen offset:0 lds
    v_mfma_f32_16x16x32_bf16 v[80:83], a[236:239], v[32:35], v[80:83]
    v_mfma_f32_16x16x32_bf16 v[84:87], a[240:243], v[32:35], v[84:87]
    ds_read_b64_tr_b16 a[6:7], v8 offset:520
    v_mfma_f32_16x16x32_bf16 v[88:91], a[244:247], v[32:35], v[88:91]
    s_add_u32 m0, s28, 138688
    ds_read_b64_tr_b16 a[8:9], v8 offset:64
    v_mfma_f32_16x16x32_bf16 v[92:95], a[248:251], v[32:35], v[92:95]
    buffer_load_dwordx4 v1, s[8:11], s35 offen offset:1280 lds
    v_mfma_f32_16x16x32_bf16 v[124:127], a[248:251], v[36:39], v[124:127]
    v_mfma_f32_16x16x32_bf16 v[120:123], a[244:247], v[36:39], v[120:123]
    ds_read_b64_tr_b16 a[10:11], v8 offset:576
    v_mfma_f32_16x16x32_bf16 v[116:119], a[240:243], v[36:39], v[116:119]
    s_add_u32 m0, s28, 137888
    s_xor_b32 s35, s60, 82304
    ds_read_b64_tr_b16 a[12:13], v8 offset:72
    v_mfma_f32_16x16x32_bf16 v[112:115], a[236:239], v[36:39], v[112:115]
    buffer_load_dwordx4 v1, s[8:11], s35 offen offset:0 lds
    v_mfma_f32_16x16x32_bf16 v[108:111], a[232:235], v[36:39], v[108:111]
    ds_read_b64_tr_b16 a[14:15], v8 offset:584
    v_mfma_f32_16x16x32_bf16 v[104:107], a[228:231], v[36:39], v[104:107]
    v_mfma_f32_16x16x32_bf16 v[100:103], a[224:227], v[36:39], v[100:103]
    s_add_u32 m0, s28, 139712
    ds_read_b64_tr_b16 a[16:17], v8 offset:128
    v_mfma_f32_16x16x32_bf16 v[96:99], a[220:223], v[36:39], v[96:99]
    buffer_load_dwordx4 v1, s[8:11], s35 offen offset:1280 lds
    v_mfma_f32_16x16x32_bf16 v[128:131], a[220:223], v[40:43], v[128:131]
    ds_read_b64_tr_b16 a[18:19], v8 offset:640
    v_mfma_f32_16x16x32_bf16 v[132:135], a[224:227], v[40:43], v[132:135]
    v_mfma_f32_16x16x32_bf16 v[136:139], a[228:231], v[40:43], v[136:139]
    s_add_u32 m0, s28, 138912
    s_xor_b32 s35, s60, 164224
    ds_read_b64_tr_b16 a[20:21], v8 offset:136
    v_mfma_f32_16x16x32_bf16 v[140:143], a[232:235], v[40:43], v[140:143]
    buffer_load_dwordx4 v1, s[8:11], s35 offen offset:0 lds
    v_mfma_f32_16x16x32_bf16 v[144:147], a[236:239], v[40:43], v[144:147]
    ds_read_b64_tr_b16 a[22:23], v8 offset:648
    v_mfma_f32_16x16x32_bf16 v[148:151], a[240:243], v[40:43], v[148:151]
    ds_read_b64_tr_b16 a[24:25], v8 offset:192
    v_mfma_f32_16x16x32_bf16 v[152:155], a[244:247], v[40:43], v[152:155]
    s_add_u32 m0, s28, 140736
    v_mfma_f32_16x16x32_bf16 v[156:159], a[248:251], v[40:43], v[156:159]
    buffer_load_dwordx4 v1, s[8:11], s35 offen offset:1280 lds
    v_mfma_f32_16x16x32_bf16 v[188:191], a[248:251], v[44:47], v[188:191]
    ds_read_b64_tr_b16 a[26:27], v8 offset:704
    v_mfma_f32_16x16x32_bf16 v[184:187], a[244:247], v[44:47], v[184:187]
    ds_read_b64_tr_b16 a[28:29], v8 offset:200
    v_mfma_f32_16x16x32_bf16 v[180:183], a[240:243], v[44:47], v[180:183]
    s_add_u32 m0, s29, 42272
    s_xor_b32 s35, s61, 1572864
    v_mfma_f32_16x16x32_bf16 v[176:179], a[236:239], v[44:47], v[176:179]
    buffer_load_dwordx4 v2, s[12:15], s35 offen lds
    v_mfma_f32_16x16x32_bf16 v[172:175], a[232:235], v[44:47], v[172:175]
    ds_read_b64_tr_b16 a[30:31], v8 offset:712
    v_mfma_f32_16x16x32_bf16 v[168:171], a[228:231], v[44:47], v[168:171]
    ds_read_b128 a[32:35], v5 offset:64
    v_mfma_f32_16x16x32_bf16 v[164:167], a[224:227], v[44:47], v[164:167]
    s_add_u32 m0, s29, 43360
    s_xor_b32 s35, s61, 1581056
    ds_read_b128 a[36:39], v5 offset:192
    v_mfma_f32_16x16x32_bf16 v[160:163], a[220:223], v[44:47], v[160:163]
    buffer_load_dwordx4 v2, s[12:15], s35 offen lds
    v_mfma_f32_16x16x32_bf16 v[192:195], a[220:223], v[48:51], v[192:195]
    v_mfma_f32_16x16x32_bf16 v[196:199], a[224:227], v[48:51], v[196:199]
    ds_read_b128 a[40:43], v5 offset:576
    v_mfma_f32_16x16x32_bf16 v[200:203], a[228:231], v[48:51], v[200:203]
    s_add_u32 m0, s29, 44448
    s_xor_b32 s35, s61, 1589248
    ds_read_b128 a[44:47], v5 offset:704
    v_mfma_f32_16x16x32_bf16 v[204:207], a[232:235], v[48:51], v[204:207]
    buffer_load_dwordx4 v2, s[12:15], s35 offen lds
    v_mfma_f32_16x16x32_bf16 v[208:211], a[236:239], v[48:51], v[208:211]
    v_mfma_f32_16x16x32_bf16 v[212:215], a[240:243], v[48:51], v[212:215]
    ds_read_b128 a[48:51], v5 offset:1088
    v_mfma_f32_16x16x32_bf16 v[216:219], a[244:247], v[48:51], v[216:219]
    s_add_u32 m0, s29, 45536
    s_xor_b32 s35, s61, 1597440
    ds_read_b128 a[52:55], v5 offset:1216
    v_mfma_f32_16x16x32_bf16 v[220:223], a[248:251], v[48:51], v[220:223]
    buffer_load_dwordx4 v2, s[12:15], s35 offen lds
    v_mfma_f32_16x16x32_bf16 v[252:255], a[248:251], v[52:55], v[252:255]
    v_mfma_f32_16x16x32_bf16 v[248:251], a[244:247], v[52:55], v[248:251]
    v_mfma_f32_16x16x32_bf16 v[244:247], a[240:243], v[52:55], v[244:247]
    v_mfma_f32_16x16x32_bf16 v[240:243], a[236:239], v[52:55], v[240:243]
    v_mfma_f32_16x16x32_bf16 v[236:239], a[232:235], v[52:55], v[236:239]
    v_mfma_f32_16x16x32_bf16 v[232:235], a[228:231], v[52:55], v[232:235]
    v_mfma_f32_16x16x32_bf16 v[228:231], a[224:227], v[52:55], v[228:231]
    v_mfma_f32_16x16x32_bf16 v[224:227], a[220:223], v[52:55], v[224:227]
    s_waitcnt vmcnt(14) lgkmcnt(0)
    s_barrier
    v_mfma_f32_16x16x32_bf16 v[64:67], a[0:3], a[32:35], v[64:67]
    ds_read_b64_tr_b16 a[220:221], v8 offset:17440
    v_mfma_f32_16x16x32_bf16 v[68:71], a[4:7], a[32:35], v[68:71]
    ds_read_b64_tr_b16 a[222:223], v8 offset:17952
    v_mfma_f32_16x16x32_bf16 v[72:75], a[8:11], a[32:35], v[72:75]
    s_add_u32 m0, s29, 84544
    s_xor_b32 s35, s61, 1835008
    ds_read_b64_tr_b16 a[224:225], v8 offset:17448
    v_mfma_f32_16x16x32_bf16 v[76:79], a[12:15], a[32:35], v[76:79]
    buffer_load_dwordx4 v2, s[12:15], s35 offen lds
    v_mfma_f32_16x16x32_bf16 v[80:83], a[16:19], a[32:35], v[80:83]
    v_mfma_f32_16x16x32_bf16 v[84:87], a[20:23], a[32:35], v[84:87]
    ds_read_b64_tr_b16 a[226:227], v8 offset:17960
    v_mfma_f32_16x16x32_bf16 v[88:91], a[24:27], a[32:35], v[88:91]
    s_add_u32 m0, s29, 85632
    s_xor_b32 s35, s61, 1843200
    ds_read_b64_tr_b16 a[228:229], v8 offset:17504
    v_mfma_f32_16x16x32_bf16 v[92:95], a[28:31], a[32:35], v[92:95]
    buffer_load_dwordx4 v2, s[12:15], s35 offen lds
    v_mfma_f32_16x16x32_bf16 v[124:127], a[28:31], a[36:39], v[124:127]
    v_mfma_f32_16x16x32_bf16 v[120:123], a[24:27], a[36:39], v[120:123]
    ds_read_b64_tr_b16 a[230:231], v8 offset:18016
    v_mfma_f32_16x16x32_bf16 v[116:119], a[20:23], a[36:39], v[116:119]
    s_add_u32 m0, s29, 86720
    s_xor_b32 s35, s61, 1851392
    ds_read_b64_tr_b16 a[232:233], v8 offset:17512
    v_mfma_f32_16x16x32_bf16 v[112:115], a[16:19], a[36:39], v[112:115]
    buffer_load_dwordx4 v2, s[12:15], s35 offen lds
    v_mfma_f32_16x16x32_bf16 v[108:111], a[12:15], a[36:39], v[108:111]
    ds_read_b64_tr_b16 a[234:235], v8 offset:18024
    v_mfma_f32_16x16x32_bf16 v[104:107], a[8:11], a[36:39], v[104:107]
    v_mfma_f32_16x16x32_bf16 v[100:103], a[4:7], a[36:39], v[100:103]
    s_add_u32 m0, s29, 87808
    s_xor_b32 s35, s61, 1859584
    ds_read_b64_tr_b16 a[236:237], v8 offset:17568
    v_mfma_f32_16x16x32_bf16 v[96:99], a[0:3], a[36:39], v[96:99]
    buffer_load_dwordx4 v2, s[12:15], s35 offen lds
    v_mfma_f32_16x16x32_bf16 v[128:131], a[0:3], a[40:43], v[128:131]
    ds_read_b64_tr_b16 a[238:239], v8 offset:18080
    v_mfma_f32_16x16x32_bf16 v[132:135], a[4:7], a[40:43], v[132:135]
    v_mfma_f32_16x16x32_bf16 v[136:139], a[8:11], a[40:43], v[136:139]
    s_add_u32 m0, s28, 0
    s_xor_b32 s35, s60, 512
    ds_read_b64_tr_b16 a[240:241], v8 offset:17576
    v_mfma_f32_16x16x32_bf16 v[140:143], a[12:15], a[40:43], v[140:143]
    buffer_load_dwordx4 v1, s[8:11], s35 offen offset:0 lds
    v_mfma_f32_16x16x32_bf16 v[144:147], a[16:19], a[40:43], v[144:147]
    ds_read_b64_tr_b16 a[242:243], v8 offset:18088
    v_mfma_f32_16x16x32_bf16 v[148:151], a[20:23], a[40:43], v[148:151]
    ds_read_b64_tr_b16 a[244:245], v8 offset:17632
    v_mfma_f32_16x16x32_bf16 v[152:155], a[24:27], a[40:43], v[152:155]
    s_add_u32 m0, s28, 1824
    v_mfma_f32_16x16x32_bf16 v[156:159], a[28:31], a[40:43], v[156:159]
    buffer_load_dwordx4 v1, s[8:11], s35 offen offset:1280 lds
    v_mfma_f32_16x16x32_bf16 v[188:191], a[28:31], a[44:47], v[188:191]
    ds_read_b64_tr_b16 a[246:247], v8 offset:18144
    v_mfma_f32_16x16x32_bf16 v[184:187], a[24:27], a[44:47], v[184:187]
    ds_read_b64_tr_b16 a[248:249], v8 offset:17640
    v_mfma_f32_16x16x32_bf16 v[180:183], a[20:23], a[44:47], v[180:183]
    s_add_u32 m0, s28, 1024
    s_xor_b32 s35, s60, 82432
    v_mfma_f32_16x16x32_bf16 v[176:179], a[16:19], a[44:47], v[176:179]
    buffer_load_dwordx4 v1, s[8:11], s35 offen offset:0 lds
    v_mfma_f32_16x16x32_bf16 v[172:175], a[12:15], a[44:47], v[172:175]
    ds_read_b64_tr_b16 a[250:251], v8 offset:18152
    v_mfma_f32_16x16x32_bf16 v[168:171], a[8:11], a[44:47], v[168:171]
    ds_read_b128 v[32:35], v5 offset:59712
    v_mfma_f32_16x16x32_bf16 v[164:167], a[4:7], a[44:47], v[164:167]
    s_add_u32 m0, s28, 2848
    ds_read_b128 v[36:39], v5 offset:59840
    v_mfma_f32_16x16x32_bf16 v[160:163], a[0:3], a[44:47], v[160:163]
    buffer_load_dwordx4 v1, s[8:11], s35 offen offset:1280 lds
    v_mfma_f32_16x16x32_bf16 v[192:195], a[0:3], a[48:51], v[192:195]
    v_mfma_f32_16x16x32_bf16 v[196:199], a[4:7], a[48:51], v[196:199]
    ds_read_b128 v[40:43], v5 offset:60224
    v_mfma_f32_16x16x32_bf16 v[200:203], a[8:11], a[48:51], v[200:203]
    s_add_u32 m0, s28, 2048
    s_xor_b32 s35, s60, 164352
    ds_read_b128 v[44:47], v5 offset:60352
    v_mfma_f32_16x16x32_bf16 v[204:207], a[12:15], a[48:51], v[204:207]
    buffer_load_dwordx4 v1, s[8:11], s35 offen offset:0 lds
    v_mfma_f32_16x16x32_bf16 v[208:211], a[16:19], a[48:51], v[208:211]
    v_mfma_f32_16x16x32_bf16 v[212:215], a[20:23], a[48:51], v[212:215]
    ds_read_b128 v[48:51], v5 offset:60736
    v_mfma_f32_16x16x32_bf16 v[216:219], a[24:27], a[48:51], v[216:219]
    s_add_u32 m0, s28, 3872
    ds_read_b128 v[52:55], v5 offset:60864
    v_mfma_f32_16x16x32_bf16 v[220:223], a[28:31], a[48:51], v[220:223]
    buffer_load_dwordx4 v1, s[8:11], s35 offen offset:1280 lds
    v_mfma_f32_16x16x32_bf16 v[252:255], a[28:31], a[52:55], v[252:255]
    v_mfma_f32_16x16x32_bf16 v[248:251], a[24:27], a[52:55], v[248:251]
    v_mfma_f32_16x16x32_bf16 v[244:247], a[20:23], a[52:55], v[244:247]
    v_mfma_f32_16x16x32_bf16 v[240:243], a[16:19], a[52:55], v[240:243]
    v_mfma_f32_16x16x32_bf16 v[236:239], a[12:15], a[52:55], v[236:239]
    v_mfma_f32_16x16x32_bf16 v[232:235], a[8:11], a[52:55], v[232:235]
    v_mfma_f32_16x16x32_bf16 v[228:231], a[4:7], a[52:55], v[228:231]
    v_mfma_f32_16x16x32_bf16 v[224:227], a[0:3], a[52:55], v[224:227]
    s_waitcnt vmcnt(14) lgkmcnt(0)
    s_barrier
    v_mfma_f32_16x16x32_bf16 v[64:67], a[220:223], v[32:35], v[64:67]
    ds_read_b64_tr_b16 a[0:1], v7 offset:0
    v_mfma_f32_16x16x32_bf16 v[68:71], a[224:227], v[32:35], v[68:71]
    ds_read_b64_tr_b16 a[2:3], v7 offset:512
    v_mfma_f32_16x16x32_bf16 v[72:75], a[228:231], v[32:35], v[72:75]
    s_add_u32 m0, s29, 101984
    s_xor_b32 s35, s61, 2097152
    ds_read_b64_tr_b16 a[4:5], v7 offset:8
    v_mfma_f32_16x16x32_bf16 v[76:79], a[232:235], v[32:35], v[76:79]
    buffer_load_dwordx4 v2, s[12:15], s35 offen lds
    v_mfma_f32_16x16x32_bf16 v[80:83], a[236:239], v[32:35], v[80:83]
    ds_read_b64_tr_b16 a[6:7], v7 offset:520
    v_mfma_f32_16x16x32_bf16 v[84:87], a[240:243], v[32:35], v[84:87]
    ds_read_b64_tr_b16 a[8:9], v7 offset:64
    v_mfma_f32_16x16x32_bf16 v[88:91], a[244:247], v[32:35], v[88:91]
    s_add_u32 m0, s29, 103072
    s_xor_b32 s35, s61, 2105344
    ds_read_b64_tr_b16 a[10:11], v7 offset:576
    v_mfma_f32_16x16x32_bf16 v[92:95], a[248:251], v[32:35], v[92:95]
    buffer_load_dwordx4 v2, s[12:15], s35 offen lds
    v_mfma_f32_16x16x32_bf16 v[124:127], a[248:251], v[36:39], v[124:127]
    ds_read_b64_tr_b16 a[12:13], v7 offset:72
    v_mfma_f32_16x16x32_bf16 v[120:123], a[244:247], v[36:39], v[120:123]
    v_mfma_f32_16x16x32_bf16 v[116:119], a[240:243], v[36:39], v[116:119]
    s_add_u32 m0, s29, 104160
    s_xor_b32 s35, s61, 2113536
    ds_read_b64_tr_b16 a[14:15], v7 offset:584
    v_mfma_f32_16x16x32_bf16 v[112:115], a[236:239], v[36:39], v[112:115]
    buffer_load_dwordx4 v2, s[12:15], s35 offen lds
    v_mfma_f32_16x16x32_bf16 v[108:111], a[232:235], v[36:39], v[108:111]
    ds_read_b64_tr_b16 a[16:17], v7 offset:128
    v_mfma_f32_16x16x32_bf16 v[104:107], a[228:231], v[36:39], v[104:107]
    ds_read_b64_tr_b16 a[18:19], v7 offset:640
    v_mfma_f32_16x16x32_bf16 v[100:103], a[224:227], v[36:39], v[100:103]
    s_add_u32 m0, s29, 105248
    s_xor_b32 s35, s61, 2121728
    ds_read_b64_tr_b16 a[20:21], v7 offset:136
    v_mfma_f32_16x16x32_bf16 v[96:99], a[220:223], v[36:39], v[96:99]
    buffer_load_dwordx4 v2, s[12:15], s35 offen lds
    v_mfma_f32_16x16x32_bf16 v[128:131], a[220:223], v[40:43], v[128:131]
    ds_read_b64_tr_b16 a[22:23], v7 offset:648
    v_mfma_f32_16x16x32_bf16 v[132:135], a[224:227], v[40:43], v[132:135]
    ds_read_b64_tr_b16 a[24:25], v7 offset:192
    v_mfma_f32_16x16x32_bf16 v[136:139], a[228:231], v[40:43], v[136:139]
    s_add_u32 m0, s29, 119424
    s_xor_b32 s35, s61, 2359296
    ds_read_b64_tr_b16 a[26:27], v7 offset:704
    v_mfma_f32_16x16x32_bf16 v[140:143], a[232:235], v[40:43], v[140:143]
    buffer_load_dwordx4 v2, s[12:15], s35 offen lds
    v_mfma_f32_16x16x32_bf16 v[144:147], a[236:239], v[40:43], v[144:147]
    v_mfma_f32_16x16x32_bf16 v[148:151], a[240:243], v[40:43], v[148:151]
    ds_read_b64_tr_b16 a[28:29], v7 offset:200
    v_mfma_f32_16x16x32_bf16 v[152:155], a[244:247], v[40:43], v[152:155]
    s_add_u32 m0, s29, 120512
    s_xor_b32 s35, s61, 2367488
    ds_read_b64_tr_b16 a[30:31], v7 offset:712
    v_mfma_f32_16x16x32_bf16 v[156:159], a[248:251], v[40:43], v[156:159]
    buffer_load_dwordx4 v2, s[12:15], s35 offen lds
    v_mfma_f32_16x16x32_bf16 v[188:191], a[248:251], v[44:47], v[188:191]
    ds_read_b128 a[32:35], v5 offset:59776
    v_mfma_f32_16x16x32_bf16 v[184:187], a[244:247], v[44:47], v[184:187]
    ds_read_b128 a[36:39], v5 offset:59904
    v_mfma_f32_16x16x32_bf16 v[180:183], a[240:243], v[44:47], v[180:183]
    s_add_u32 m0, s29, 121600
    s_xor_b32 s35, s61, 2375680
    ds_read_b128 a[40:43], v5 offset:60288
    v_mfma_f32_16x16x32_bf16 v[176:179], a[236:239], v[44:47], v[176:179]
    buffer_load_dwordx4 v2, s[12:15], s35 offen lds
    v_mfma_f32_16x16x32_bf16 v[172:175], a[232:235], v[44:47], v[172:175]
    ds_read_b128 a[44:47], v5 offset:60416
    v_mfma_f32_16x16x32_bf16 v[168:171], a[228:231], v[44:47], v[168:171]
    ds_read_b128 a[48:51], v5 offset:60800
    v_mfma_f32_16x16x32_bf16 v[164:167], a[224:227], v[44:47], v[164:167]
    s_add_u32 m0, s29, 122688
    s_xor_b32 s35, s61, 2383872
    v_mfma_f32_16x16x32_bf16 v[160:163], a[220:223], v[44:47], v[160:163]
    buffer_load_dwordx4 v2, s[12:15], s35 offen lds
    v_mfma_f32_16x16x32_bf16 v[192:195], a[220:223], v[48:51], v[192:195]
    ds_read_b128 a[52:55], v5 offset:60928
    v_mfma_f32_16x16x32_bf16 v[196:199], a[224:227], v[48:51], v[196:199]
    s_bfe_u32 s36, s3, 131075
    ds_read_b128 a[96:99], v6 offset:0
    v_mfma_f32_16x16x32_bf16 v[200:203], a[228:231], v[48:51], v[200:203]
    s_cmp_eq_u32 s36, 0
    s_cselect_b32 s36, 0, 0x40000000
    ds_read_b128 a[100:103], v6 offset:128
    v_mfma_f32_16x16x32_bf16 v[204:207], a[232:235], v[48:51], v[204:207]
    buffer_load_dword v13, v29, s[76:79], s36 offen
    v_mfma_f32_16x16x32_bf16 v[208:211], a[236:239], v[48:51], v[208:211]
    ds_read_b128 a[104:107], v6 offset:512
    v_mfma_f32_16x16x32_bf16 v[212:215], a[240:243], v[48:51], v[212:215]
    ds_read_b128 a[108:111], v6 offset:640
    v_mfma_f32_16x16x32_bf16 v[216:219], a[244:247], v[48:51], v[216:219]
    ds_read_b128 a[112:115], v6 offset:1024
    v_mfma_f32_16x16x32_bf16 v[220:223], a[248:251], v[48:51], v[220:223]
    ds_read_b128 a[116:119], v6 offset:1152
    v_mfma_f32_16x16x32_bf16 v[252:255], a[248:251], v[52:55], v[252:255]
    v_mfma_f32_16x16x32_bf16 v[248:251], a[244:247], v[52:55], v[248:251]
    v_mfma_f32_16x16x32_bf16 v[244:247], a[240:243], v[52:55], v[244:247]
    v_mfma_f32_16x16x32_bf16 v[240:243], a[236:239], v[52:55], v[240:243]
    v_mfma_f32_16x16x32_bf16 v[236:239], a[232:235], v[52:55], v[236:239]
    v_mfma_f32_16x16x32_bf16 v[232:235], a[228:231], v[52:55], v[232:235]
    v_mfma_f32_16x16x32_bf16 v[228:231], a[224:227], v[52:55], v[228:231]
    v_mfma_f32_16x16x32_bf16 v[224:227], a[220:223], v[52:55], v[224:227]
    s_waitcnt vmcnt(15) lgkmcnt(0)
    s_barrier
    v_mfma_f32_16x16x32_bf16 v[64:67], a[0:3], a[32:35], v[64:67]
    ds_read_b64_tr_b16 a[220:221], v7 offset:17440
    v_mfma_f32_16x16x32_bf16 v[68:71], a[4:7], a[32:35], v[68:71]
    ds_read_b64_tr_b16 a[222:223], v7 offset:17952
    v_mfma_f32_16x16x32_bf16 v[72:75], a[8:11], a[32:35], v[72:75]
    s_add_u32 m0, s28, 59712
    s_xor_b32 s35, s60, 640
    ds_read_b64_tr_b16 a[224:225], v7 offset:17448
    v_mfma_f32_16x16x32_bf16 v[76:79], a[12:15], a[32:35], v[76:79]
    buffer_load_dwordx4 v1, s[8:11], s35 offen offset:0 lds
    v_mfma_f32_16x16x32_bf16 v[80:83], a[16:19], a[32:35], v[80:83]
    ds_read_b64_tr_b16 a[226:227], v7 offset:17960
    v_mfma_f32_16x16x32_bf16 v[84:87], a[20:23], a[32:35], v[84:87]
    ds_read_b64_tr_b16 a[228:229], v7 offset:17504
    v_mfma_f32_16x16x32_bf16 v[88:91], a[24:27], a[32:35], v[88:91]
    s_add_u32 m0, s28, 61536
    ds_read_b64_tr_b16 a[230:231], v7 offset:18016
    v_mfma_f32_16x16x32_bf16 v[92:95], a[28:31], a[32:35], v[92:95]
    buffer_load_dwordx4 v1, s[8:11], s35 offen offset:1280 lds
    v_mfma_f32_16x16x32_bf16 v[124:127], a[28:31], a[36:39], v[124:127]
    v_mfma_f32_16x16x32_bf16 v[120:123], a[24:27], a[36:39], v[120:123]
    ds_read_b64_tr_b16 a[232:233], v7 offset:17512
    v_mfma_f32_16x16x32_bf16 v[116:119], a[20:23], a[36:39], v[116:119]
    s_add_u32 m0, s28, 60736
    s_xor_b32 s35, s60, 82560
    ds_read_b64_tr_b16 a[234:235], v7 offset:18024
    v_mfma_f32_16x16x32_bf16 v[112:115], a[16:19], a[36:39], v[112:115]
    buffer_load_dwordx4 v1, s[8:11], s35 offen offset:0 lds
    v_mfma_f32_16x16x32_bf16 v[108:111], a[12:15], a[36:39], v[108:111]
    ds_read_b64_tr_b16 a[236:237], v7 offset:17568
    v_mfma_f32_16x16x32_bf16 v[104:107], a[8:11], a[36:39], v[104:107]
    ds_read_b64_tr_b16 a[238:239], v7 offset:18080
    v_mfma_f32_16x16x32_bf16 v[100:103], a[4:7], a[36:39], v[100:103]
    s_add_u32 m0, s28, 62560
    ds_read_b64_tr_b16 a[240:241], v7 offset:17576
    v_mfma_f32_16x16x32_bf16 v[96:99], a[0:3], a[36:39], v[96:99]
    buffer_load_dwordx4 v1, s[8:11], s35 offen offset:1280 lds
    v_mfma_f32_16x16x32_bf16 v[128:131], a[0:3], a[40:43], v[128:131]
    v_mfma_f32_16x16x32_bf16 v[132:135], a[4:7], a[40:43], v[132:135]
    ds_read_b64_tr_b16 a[242:243], v7 offset:18088
    v_mfma_f32_16x16x32_bf16 v[136:139], a[8:11], a[40:43], v[136:139]
    s_add_u32 m0, s28, 61760
    s_xor_b32 s35, s60, 164480
    ds_read_b64_tr_b16 a[244:245], v7 offset:17632
    v_mfma_f32_16x16x32_bf16 v[140:143], a[12:15], a[40:43], v[140:143]
    buffer_load_dwordx4 v1, s[8:11], s35 offen offset:0 lds
    v_mfma_f32_16x16x32_bf16 v[144:147], a[16:19], a[40:43], v[144:147]
    ds_read_b64_tr_b16 a[246:247], v7 offset:18144
    v_mfma_f32_16x16x32_bf16 v[148:151], a[20:23], a[40:43], v[148:151]
    ds_read_b64_tr_b16 a[248:249], v7 offset:17640
    v_mfma_f32_16x16x32_bf16 v[152:155], a[24:27], a[40:43], v[152:155]
    s_add_u32 m0, s28, 63584
    ds_read_b64_tr_b16 a[250:251], v7 offset:18152
    v_mfma_f32_16x16x32_bf16 v[156:159], a[28:31], a[40:43], v[156:159]
    buffer_load_dwordx4 v1, s[8:11], s35 offen offset:1280 lds
    v_mfma_f32_16x16x32_bf16 v[188:191], a[28:31], a[44:47], v[188:191]
    v_mfma_f32_16x16x32_bf16 v[184:187], a[24:27], a[44:47], v[184:187]
    ds_read_b128 v[32:35], v6 offset:64
    v_mfma_f32_16x16x32_bf16 v[180:183], a[20:23], a[44:47], v[180:183]
    s_add_u32 m0, s29, 24832
    s_xor_b32 s35, s61, 2621440
    ds_read_b128 v[36:39], v6 offset:192
    v_mfma_f32_16x16x32_bf16 v[176:179], a[16:19], a[44:47], v[176:179]
    buffer_load_dwordx4 v2, s[12:15], s35 offen lds
    v_mfma_f32_16x16x32_bf16 v[172:175], a[12:15], a[44:47], v[172:175]
    ds_read_b128 v[40:43], v6 offset:576
    v_mfma_f32_16x16x32_bf16 v[168:171], a[8:11], a[44:47], v[168:171]
    ds_read_b128 v[44:47], v6 offset:704
    v_mfma_f32_16x16x32_bf16 v[164:167], a[4:7], a[44:47], v[164:167]
    s_add_u32 m0, s29, 25920
    s_xor_b32 s35, s61, 2629632
    ds_read_b128 v[48:51], v6 offset:1088
    v_mfma_f32_16x16x32_bf16 v[160:163], a[0:3], a[44:47], v[160:163]
    buffer_load_dwordx4 v2, s[12:15], s35 offen lds
    v_mfma_f32_16x16x32_bf16 v[192:195], a[0:3], a[48:51], v[192:195]
    v_mfma_f32_16x16x32_bf16 v[196:199], a[4:7], a[48:51], v[196:199]
    ds_read_b128 v[52:55], v6 offset:1216
    v_mfma_f32_16x16x32_bf16 v[200:203], a[8:11], a[48:51], v[200:203]
    s_add_u32 m0, s29, 27008
    s_xor_b32 s35, s61, 2637824
    ds_read_b64_tr_b16 a[64:65], v7 offset:59712
    v_mfma_f32_16x16x32_bf16 v[204:207], a[12:15], a[48:51], v[204:207]
    buffer_load_dwordx4 v2, s[12:15], s35 offen lds
    v_mfma_f32_16x16x32_bf16 v[208:211], a[16:19], a[48:51], v[208:211]
    ds_read_b64_tr_b16 a[66:67], v7 offset:60224
    v_mfma_f32_16x16x32_bf16 v[212:215], a[20:23], a[48:51], v[212:215]
    ds_read_b64_tr_b16 a[68:69], v7 offset:59720
    v_mfma_f32_16x16x32_bf16 v[216:219], a[24:27], a[48:51], v[216:219]
    s_add_u32 m0, s29, 28096
    s_xor_b32 s35, s61, 2646016
    ds_read_b64_tr_b16 a[70:71], v7 offset:60232
    v_mfma_f32_16x16x32_bf16 v[220:223], a[28:31], a[48:51], v[220:223]
    buffer_load_dwordx4 v2, s[12:15], s35 offen lds
    v_mfma_f32_16x16x32_bf16 v[252:255], a[28:31], a[52:55], v[252:255]
    v_mfma_f32_16x16x32_bf16 v[248:251], a[24:27], a[52:55], v[248:251]
    v_mfma_f32_16x16x32_bf16 v[244:247], a[20:23], a[52:55], v[244:247]
    s_bfe_u32 s36, s3, 131075
    s_cmp_eq_u32 s36, 1
    s_cselect_b32 s36, 0, 0x40000000
    v_mfma_f32_16x16x32_bf16 v[240:243], a[16:19], a[52:55], v[240:243]
    buffer_load_dword v13, v29, s[76:79], s36 offen
    v_mfma_f32_16x16x32_bf16 v[236:239], a[12:15], a[52:55], v[236:239]
    v_mfma_f32_16x16x32_bf16 v[232:235], a[8:11], a[52:55], v[232:235]
    v_mfma_f32_16x16x32_bf16 v[228:231], a[4:7], a[52:55], v[228:231]
    v_mfma_f32_16x16x32_bf16 v[224:227], a[0:3], a[52:55], v[224:227]
    s_waitcnt vmcnt(16) lgkmcnt(0)
    s_barrier
    v_mfma_f32_16x16x32_bf16 v[64:67], a[220:223], a[96:99], v[64:67]
    ds_read_b64_tr_b16 a[72:73], v7 offset:59776
    v_mfma_f32_16x16x32_bf16 v[68:71], a[224:227], a[96:99], v[68:71]
    ds_read_b64_tr_b16 a[74:75], v7 offset:60288
    v_mfma_f32_16x16x32_bf16 v[72:75], a[228:231], a[96:99], v[72:75]
    s_add_u32 m0, s29, 42272
    s_xor_b32 s35, s61, 2883584
    ds_read_b64_tr_b16 a[76:77], v7 offset:59784
    v_mfma_f32_16x16x32_bf16 v[76:79], a[232:235], a[96:99], v[76:79]
    buffer_load_dwordx4 v2, s[12:15], s35 offen lds
    v_mfma_f32_16x16x32_bf16 v[80:83], a[236:239], a[96:99], v[80:83]
    ds_read_b64_tr_b16 a[78:79], v7 offset:60296
    v_mfma_f32_16x16x32_bf16 v[84:87], a[240:243], a[96:99], v[84:87]
    ds_read_b64_tr_b16 a[80:81], v7 offset:59840
    v_mfma_f32_16x16x32_bf16 v[88:91], a[244:247], a[96:99], v[88:91]
    s_add_u32 m0, s29, 43360
    s_xor_b32 s35, s61, 2891776
    ds_read_b64_tr_b16 a[82:83], v7 offset:60352
    v_mfma_f32_16x16x32_bf16 v[92:95], a[248:251], a[96:99], v[92:95]
    buffer_load_dwordx4 v2, s[12:15], s35 offen lds
    v_mfma_f32_16x16x32_bf16 v[124:127], a[248:251], a[100:103], v[124:127]
    ds_read_b64_tr_b16 a[84:85], v7 offset:59848
    v_mfma_f32_16x16x32_bf16 v[120:123], a[244:247], a[100:103], v[120:123]
    ds_read_b64_tr_b16 a[86:87], v7 offset:60360
    v_mfma_f32_16x16x32_bf16 v[116:119], a[240:243], a[100:103], v[116:119]
    s_add_u32 m0, s29, 44448
    s_xor_b32 s35, s61, 2899968
    ds_read_b64_tr_b16 a[88:89], v7 offset:59904
    v_mfma_f32_16x16x32_bf16 v[112:115], a[236:239], a[100:103], v[112:115]
    buffer_load_dwordx4 v2, s[12:15], s35 offen lds
    v_mfma_f32_16x16x32_bf16 v[108:111], a[232:235], a[100:103], v[108:111]
    ds_read_b64_tr_b16 a[90:91], v7 offset:60416
    v_mfma_f32_16x16x32_bf16 v[104:107], a[228:231], a[100:103], v[104:107]
    v_mfma_f32_16x16x32_bf16 v[100:103], a[224:227], a[100:103], v[100:103]
    s_add_u32 m0, s29, 45536
    s_xor_b32 s35, s61, 2908160
    ds_read_b64_tr_b16 a[92:93], v7 offset:59912
    v_mfma_f32_16x16x32_bf16 v[96:99], a[220:223], a[100:103], v[96:99]
    buffer_load_dwordx4 v2, s[12:15], s35 offen lds
    v_mfma_f32_16x16x32_bf16 v[128:131], a[220:223], a[104:107], v[128:131]
    ds_read_b64_tr_b16 a[94:95], v7 offset:60424
    v_mfma_f32_16x16x32_bf16 v[132:135], a[224:227], a[104:107], v[132:135]
    ds_read_b128 a[32:35], v5 offset:0
    v_mfma_f32_16x16x32_bf16 v[136:139], a[228:231], a[104:107], v[136:139]
    s_add_u32 m0, s28, 136864
    s_xor_b32 s35, s60, 768
    ds_read_b128 a[36:39], v5 offset:128
    v_mfma_f32_16x16x32_bf16 v[140:143], a[232:235], a[104:107], v[140:143]
    buffer_load_dwordx4 v1, s[8:11], s35 offen offset:0 lds
    v_mfma_f32_16x16x32_bf16 v[144:147], a[236:239], a[104:107], v[144:147]
    ds_read_b128 a[40:43], v5 offset:512
    v_mfma_f32_16x16x32_bf16 v[148:151], a[240:243], a[104:107], v[148:151]
    ds_read_b128 a[44:47], v5 offset:640
    v_mfma_f32_16x16x32_bf16 v[152:155], a[244:247], a[104:107], v[152:155]
    s_add_u32 m0, s28, 138688
    ds_read_b128 a[48:51], v5 offset:1024
    v_mfma_f32_16x16x32_bf16 v[156:159], a[248:251], a[104:107], v[156:159]
    buffer_load_dwordx4 v1, s[8:11], s35 offen offset:1280 lds
    v_mfma_f32_16x16x32_bf16 v[188:191], a[248:251], a[108:111], v[188:191]
    ds_read_b128 a[52:55], v5 offset:1152
    v_mfma_f32_16x16x32_bf16 v[184:187], a[244:247], a[108:111], v[184:187]
    ds_read_b128 a[160:163], v5 offset:64
    v_mfma_f32_16x16x32_bf16 v[180:183], a[240:243], a[108:111], v[180:183]
    s_add_u32 m0, s28, 137888
    s_xor_b32 s35, s60, 82688
    v_mfma_f32_16x16x32_bf16 v[176:179], a[236:239], a[108:111], v[176:179]
    buffer_load_dwordx4 v1, s[8:11], s35 offen offset:0 lds
    v_mfma_f32_16x16x32_bf16 v[172:175], a[232:235], a[108:111], v[172:175]
    ds_read_b128 a[164:167], v5 offset:192
    v_mfma_f32_16x16x32_bf16 v[168:171], a[228:231], a[108:111], v[168:171]
    ds_read_b128 a[168:171], v5 offset:576
    v_mfma_f32_16x16x32_bf16 v[164:167], a[224:227], a[108:111], v[164:167]
    s_add_u32 m0, s28, 139712
    ds_read_b128 a[172:175], v5 offset:704
    v_mfma_f32_16x16x32_bf16 v[160:163], a[220:223], a[108:111], v[160:163]
    buffer_load_dwordx4 v1, s[8:11], s35 offen offset:1280 lds
    v_mfma_f32_16x16x32_bf16 v[192:195], a[220:223], a[112:115], v[192:195]
    ds_read_b128 a[176:179], v5 offset:1088
    v_mfma_f32_16x16x32_bf16 v[196:199], a[224:227], a[112:115], v[196:199]
    ds_read_b128 a[180:183], v5 offset:1216
    v_mfma_f32_16x16x32_bf16 v[200:203], a[228:231], a[112:115], v[200:203]
    s_add_u32 m0, s28, 138912
    s_xor_b32 s35, s60, 164608
    ds_read_b64_tr_b16 a[0:1], v8 offset:0
    v_mfma_f32_16x16x32_bf16 v[204:207], a[232:235], a[112:115], v[204:207]
    buffer_load_dwordx4 v1, s[8:11], s35 offen offset:0 lds
    v_mfma_f32_16x16x32_bf16 v[208:211], a[236:239], a[112:115], v[208:211]
    ds_read_b64_tr_b16 a[2:3], v8 offset:512
    v_mfma_f32_16x16x32_bf16 v[212:215], a[240:243], a[112:115], v[212:215]
    ds_read_b64_tr_b16 a[4:5], v8 offset:8
    v_mfma_f32_16x16x32_bf16 v[216:219], a[244:247], a[112:115], v[216:219]
    s_add_u32 m0, s28, 140736
    ds_read_b64_tr_b16 a[6:7], v8 offset:520
    v_mfma_f32_16x16x32_bf16 v[220:223], a[248:251], a[112:115], v[220:223]
    buffer_load_dwordx4 v1, s[8:11], s35 offen offset:1280 lds
    v_mfma_f32_16x16x32_bf16 v[252:255], a[248:251], a[116:119], v[252:255]
    v_mfma_f32_16x16x32_bf16 v[248:251], a[244:247], a[116:119], v[248:251]
    v_mfma_f32_16x16x32_bf16 v[244:247], a[240:243], a[116:119], v[244:247]
    s_bfe_u32 s36, s3, 131075
    s_cmp_eq_u32 s36, 2
    s_cselect_b32 s36, 0, 0x40000000
    v_mfma_f32_16x16x32_bf16 v[240:243], a[236:239], a[116:119], v[240:243]
    buffer_load_dword v13, v29, s[76:79], s36 offen
    v_mfma_f32_16x16x32_bf16 v[236:239], a[232:235], a[116:119], v[236:239]
    v_mfma_f32_16x16x32_bf16 v[232:235], a[228:231], a[116:119], v[232:235]
    v_mfma_f32_16x16x32_bf16 v[228:231], a[224:227], a[116:119], v[228:231]
    v_mfma_f32_16x16x32_bf16 v[224:227], a[220:223], a[116:119], v[224:227]
    s_waitcnt vmcnt(16) lgkmcnt(0)
    s_barrier
    v_mfma_f32_16x16x32_bf16 v[64:67], a[64:67], v[32:35], v[64:67]
    ds_read_b64_tr_b16 a[8:9], v8 offset:64
    v_mfma_f32_16x16x32_bf16 v[68:71], a[68:71], v[32:35], v[68:71]
    ds_read_b64_tr_b16 a[10:11], v8 offset:576
    v_mfma_f32_16x16x32_bf16 v[72:75], a[72:75], v[32:35], v[72:75]
    s_add_u32 m0, s29, 84544
    s_xor_b32 s35, s61, 3145728
    ds_read_b64_tr_b16 a[12:13], v8 offset:72
    v_mfma_f32_16x16x32_bf16 v[76:79], a[76:79], v[32:35], v[76:79]
    buffer_load_dwordx4 v2, s[12:15], s35 offen lds
    v_mfma_f32_16x16x32_bf16 v[80:83], a[80:83], v[32:35], v[80:83]
    ds_read_b64_tr_b16 a[14:15], v8 offset:584
    v_mfma_f32_16x16x32_bf16 v[84:87], a[84:87], v[32:35], v[84:87]
    ds_read_b64_tr_b16 a[16:17], v8 offset:128
    v_mfma_f32_16x16x32_bf16 v[88:91], a[88:91], v[32:35], v[88:91]
    s_add_u32 m0, s29, 85632
    s_xor_b32 s35, s61, 3153920
    ds_read_b64_tr_b16 a[18:19], v8 offset:640
    v_mfma_f32_16x16x32_bf16 v[92:95], a[92:95], v[32:35], v[92:95]
    buffer_load_dwordx4 v2, s[12:15], s35 offen lds
    v_mfma_f32_16x16x32_bf16 v[124:127], a[92:95], v[36:39], v[124:127]
    v_mfma_f32_16x16x32_bf16 v[120:123], a[88:91], v[36:39], v[120:123]
    ds_read_b64_tr_b16 a[20:21], v8 offset:136
    v_mfma_f32_16x16x32_bf16 v[116:119], a[84:87], v[36:39], v[116:119]
    s_add_u32 m0, s29, 86720
    s_xor_b32 s35, s61, 3162112
    ds_read_b64_tr_b16 a[22:23], v8 offset:648
    v_mfma_f32_16x16x32_bf16 v[112:115], a[80:83], v[36:39], v[112:115]
    buffer_load_dwordx4 v2, s[12:15], s35 offen lds
    v_mfma_f32_16x16x32_bf16 v[108:111], a[76:79], v[36:39], v[108:111]
    ds_read_b64_tr_b16 a[24:25], v8 offset:192
    v_mfma_f32_16x16x32_bf16 v[104:107], a[72:75], v[36:39], v[104:107]
    ds_read_b64_tr_b16 a[26:27], v8 offset:704
    v_mfma_f32_16x16x32_bf16 v[100:103], a[68:71], v[36:39], v[100:103]
    s_add_u32 m0, s29, 87808
    s_xor_b32 s35, s61, 3170304
    ds_read_b64_tr_b16 a[28:29], v8 offset:200
    v_mfma_f32_16x16x32_bf16 v[96:99], a[64:67], v[36:39], v[96:99]
    buffer_load_dwordx4 v2, s[12:15], s35 offen lds
    v_mfma_f32_16x16x32_bf16 v[128:131], a[64:67], v[40:43], v[128:131]
    v_mfma_f32_16x16x32_bf16 v[132:135], a[68:71], v[40:43], v[132:135]
    ds_read_b64_tr_b16 a[30:31], v8 offset:712
    v_mfma_f32_16x16x32_bf16 v[136:139], a[72:75], v[40:43], v[136:139]
    s_add_u32 m0, s28, 0
    s_xor_b32 s35, s60, 896
    ds_read_b64_tr_b16 a[220:221], v8 offset:17440
    v_mfma_f32_16x16x32_bf16 v[140:143], a[76:79], v[40:43], v[140:143]
    buffer_load_dwordx4 v1, s[8:11], s35 offen offset:0 lds
    v_mfma_f32_16x16x32_bf16 v[144:147], a[80:83], v[40:43], v[144:147]
    ds_read_b64_tr_b16 a[222:223], v8 offset:17952
    v_mfma_f32_16x16x32_bf16 v[148:151], a[84:87], v[40:43], v[148:151]
    ds_read_b64_tr_b16 a[224:225], v8 offset:17448
    v_mfma_f32_16x16x32_bf16 v[152:155], a[88:91], v[40:43], v[152:155]
    s_add_u32 m0, s28, 1824
    ds_read_b64_tr_b16 a[226:227], v8 offset:17960
    v_mfma_f32_16x16x32_bf16 v[156:159], a[92:95], v[40:43], v[156:159]
    buffer_load_dwordx4 v1, s[8:11], s35 offen offset:1280 lds
    v_mfma_f32_16x16x32_bf16 v[188:191], a[92:95], v[44:47], v[188:191]
    v_mfma_f32_16x16x32_bf16 v[184:187], a[88:91], v[44:47], v[184:187]
    ds_read_b128 a[96:99], v5 offset:59712
    v_mfma_f32_16x16x32_bf16 v[180:183], a[84:87], v[44:47], v[180:183]
    s_add_u32 m0, s28, 1024
    s_xor_b32 s35, s60, 82816
    ds_read_b128 a[100:103], v5 offset:59840
    v_mfma_f32_16x16x32_bf16 v[176:179], a[80:83], v[44:47], v[176:179]
    buffer_load_dwordx4 v1, s[8:11], s35 offen offset:0 lds
    v_mfma_f32_16x16x32_bf16 v[172:175], a[76:79], v[44:47], v[172:175]
    ds_read_b128 a[104:107], v5 offset:60224
    v_mfma_f32_16x16x32_bf16 v[168:171], a[72:75], v[44:47], v[168:171]
    ds_read_b128 a[108:111], v5 offset:60352
    v_mfma_f32_16x16x32_bf16 v[164:167], a[68:71], v[44:47], v[164:167]
    s_add_u32 m0, s28, 2848
    ds_read_b128 a[112:115], v5 offset:60736
    v_mfma_f32_16x16x32_bf16 v[160:163], a[64:67], v[44:47], v[160:163]
    buffer_load_dwordx4 v1, s[8:11], s35 offen offset:1280 lds
    v_mfma_f32_16x16x32_bf16 v[192:195], a[64:67], v[48:51], v[192:195]
    v_mfma_f32_16x16x32_bf16 v[196:199], a[68:71], v[48:51], v[196:199]
    ds_read_b128 a[116:119], v5 offset:60864
    v_mfma_f32_16x16x32_bf16 v[200:203], a[72:75], v[48:51], v[200:203]
    s_add_u32 m0, s28, 2048
    s_xor_b32 s35, s60, 164736
    ds_read_b64_tr_b16 a[228:229], v8 offset:17504
    v_mfma_f32_16x16x32_bf16 v[204:207], a[76:79], v[48:51], v[204:207]
    buffer_load_dwordx4 v1, s[8:11], s35 offen offset:0 lds
    v_mfma_f32_16x16x32_bf16 v[208:211], a[80:83], v[48:51], v[208:211]
    ds_read_b64_tr_b16 a[230:231], v8 offset:18016
    v_mfma_f32_16x16x32_bf16 v[212:215], a[84:87], v[48:51], v[212:215]
    ds_read_b64_tr_b16 a[232:233], v8 offset:17512
    v_mfma_f32_16x16x32_bf16 v[216:219], a[88:91], v[48:51], v[216:219]
    s_add_u32 m0, s28, 3872
    ds_read_b64_tr_b16 a[234:235], v8 offset:18024
    v_mfma_f32_16x16x32_bf16 v[220:223], a[92:95], v[48:51], v[220:223]
    buffer_load_dwordx4 v1, s[8:11], s35 offen offset:1280 lds
    v_mfma_f32_16x16x32_bf16 v[252:255], a[92:95], v[52:55], v[252:255]
    v_mfma_f32_16x16x32_bf16 v[248:251], a[88:91], v[52:55], v[248:251]
    v_mfma_f32_16x16x32_bf16 v[244:247], a[84:87], v[52:55], v[244:247]
    s_bfe_u32 s36, s3, 131075
    s_cmp_eq_u32 s36, 3
    s_cselect_b32 s36, 0, 0x40000000
    v_mfma_f32_16x16x32_bf16 v[240:243], a[80:83], v[52:55], v[240:243]
    buffer_load_dword v13, v29, s[76:79], s36 offen
    v_mfma_f32_16x16x32_bf16 v[236:239], a[76:79], v[52:55], v[236:239]
    v_mfma_f32_16x16x32_bf16 v[232:235], a[72:75], v[52:55], v[232:235]
    v_mfma_f32_16x16x32_bf16 v[228:231], a[68:71], v[52:55], v[228:231]
    v_mfma_f32_16x16x32_bf16 v[224:227], a[64:67], v[52:55], v[224:227]
    s_waitcnt vmcnt(23) lgkmcnt(0)
    s_barrier
    v_mfma_f32_16x16x32_bf16 v[64:67], a[0:3], a[32:35], v[64:67]
    ds_read_b64_tr_b16 a[236:237], v8 offset:17568
    v_mfma_f32_16x16x32_bf16 v[68:71], a[4:7], a[32:35], v[68:71]
    ds_read_b64_tr_b16 a[238:239], v8 offset:18080
    v_mfma_f32_16x16x32_bf16 v[72:75], a[8:11], a[32:35], v[72:75]
    s_add_u32 m0, s29, 101984
    s_xor_b32 s35, s61, 3407872
    ds_read_b64_tr_b16 a[240:241], v8 offset:17576
    v_mfma_f32_16x16x32_bf16 v[76:79], a[12:15], a[32:35], v[76:79]
    buffer_load_dwordx4 v2, s[12:15], s35 offen lds
    v_mfma_f32_16x16x32_bf16 v[80:83], a[16:19], a[32:35], v[80:83]
    v_mfma_f32_16x16x32_bf16 v[84:87], a[20:23], a[32:35], v[84:87]
    ds_read_b64_tr_b16 a[242:243], v8 offset:18088
    v_mfma_f32_16x16x32_bf16 v[88:91], a[24:27], a[32:35], v[88:91]
    ds_read_b64_tr_b16 a[244:245], v8 offset:17632
    v_mfma_f32_16x16x32_bf16 v[92:95], a[28:31], a[32:35], v[92:95]
    ds_read_b64_tr_b16 a[246:247], v8 offset:18144
    v_mfma_f32_16x16x32_bf16 v[124:127], a[28:31], a[36:39], v[124:127]
    v_mfma_f32_16x16x32_bf16 v[120:123], a[24:27], a[36:39], v[120:123]
    ds_read_b64_tr_b16 a[248:249], v8 offset:17640
    v_mfma_f32_16x16x32_bf16 v[116:119], a[20:23], a[36:39], v[116:119]
    s_add_u32 m0, s29, 103072
    s_xor_b32 s35, s61, 3416064
    ds_read_b64_tr_b16 a[250:251], v8 offset:18152
    v_mfma_f32_16x16x32_bf16 v[112:115], a[16:19], a[36:39], v[112:115]
    buffer_load_dwordx4 v2, s[12:15], s35 offen lds
    v_mfma_f32_16x16x32_bf16 v[108:111], a[12:15], a[36:39], v[108:111]
    v_mfma_f32_16x16x32_bf16 v[104:107], a[8:11], a[36:39], v[104:107]
    ds_read_b128 v[32:35], v5 offset:59776
    v_mfma_f32_16x16x32_bf16 v[100:103], a[4:7], a[36:39], v[100:103]
    ds_read_b128 v[36:39], v5 offset:59904
    v_mfma_f32_16x16x32_bf16 v[96:99], a[0:3], a[36:39], v[96:99]
    ds_read_b128 v[40:43], v5 offset:60288
    v_mfma_f32_16x16x32_bf16 v[128:131], a[0:3], a[40:43], v[128:131]
    v_mfma_f32_16x16x32_bf16 v[132:135], a[4:7], a[40:43], v[132:135]
    ds_read_b128 v[44:47], v5 offset:60416
    v_mfma_f32_16x16x32_bf16 v[136:139], a[8:11], a[40:43], v[136:139]
    s_add_u32 m0, s29, 104160
    s_xor_b32 s35, s61, 3424256
    ds_read_b128 v[48:51], v5 offset:60800
    v_mfma_f32_16x16x32_bf16 v[140:143], a[12:15], a[40:43], v[140:143]
    buffer_load_dwordx4 v2, s[12:15], s35 offen lds
    v_mfma_f32_16x16x32_bf16 v[144:147], a[16:19], a[40:43], v[144:147]
    v_mfma_f32_16x16x32_bf16 v[148:151], a[20:23], a[40:43], v[148:151]
    ds_read_b128 v[52:55], v5 offset:60928
    v_mfma_f32_16x16x32_bf16 v[152:155], a[24:27], a[40:43], v[152:155]
    ds_read_b64_tr_b16 a[64:65], v7 offset:0
    v_mfma_f32_16x16x32_bf16 v[156:159], a[28:31], a[40:43], v[156:159]
    ds_read_b64_tr_b16 a[66:67], v7 offset:512
    v_mfma_f32_16x16x32_bf16 v[188:191], a[28:31], a[44:47], v[188:191]
    v_mfma_f32_16x16x32_bf16 v[184:187], a[24:27], a[44:47], v[184:187]
    ds_read_b64_tr_b16 a[68:69], v7 offset:8
    v_mfma_f32_16x16x32_bf16 v[180:183], a[20:23], a[44:47], v[180:183]
    s_add_u32 m0, s29, 105248
    s_xor_b32 s35, s61, 3432448
    ds_read_b64_tr_b16 a[70:71], v7 offset:520
    v_mfma_f32_16x16x32_bf16 v[176:179], a[16:19], a[44:47], v[176:179]
    buffer_load_dwordx4 v2, s[12:15], s35 offen lds
    v_mfma_f32_16x16x32_bf16 v[172:175], a[12:15], a[44:47], v[172:175]
    ds_read_b64_tr_b16 a[72:73], v7 offset:64
    v_mfma_f32_16x16x32_bf16 v[168:171], a[8:11], a[44:47], v[168:171]
    v_mfma_f32_16x16x32_bf16 v[164:167], a[4:7], a[44:47], v[164:167]
    ds_read_b64_tr_b16 a[74:75], v7 offset:576
    v_mfma_f32_16x16x32_bf16 v[160:163], a[0:3], a[44:47], v[160:163]
    ds_read_b64_tr_b16 a[76:77], v7 offset:72
    v_mfma_f32_16x16x32_bf16 v[192:195], a[0:3], a[48:51], v[192:195]
    v_mfma_f32_16x16x32_bf16 v[196:199], a[4:7], a[48:51], v[196:199]
    s_bfe_u32 s36, s3, 131075
    ds_read_b64_tr_b16 a[78:79], v7 offset:584
    v_mfma_f32_16x16x32_bf16 v[200:203], a[8:11], a[48:51], v[200:203]
    s_cmp_eq_u32 s36, 0
    s_cselect_b32 s36, s100, 0x40000000
    ds_read_b64_tr_b16 a[80:81], v7 offset:128
    v_mfma_f32_16x16x32_bf16 v[204:207], a[12:15], a[48:51], v[204:207]
    buffer_load_dword v13, v29, s[76:79], s36 offen
    v_mfma_f32_16x16x32_bf16 v[208:211], a[16:19], a[48:51], v[208:211]
    ds_read_b64_tr_b16 a[82:83], v7 offset:640
    v_mfma_f32_16x16x32_bf16 v[212:215], a[20:23], a[48:51], v[212:215]
    v_mfma_f32_16x16x32_bf16 v[216:219], a[24:27], a[48:51], v[216:219]
    ds_read_b64_tr_b16 a[84:85], v7 offset:136
    v_mfma_f32_16x16x32_bf16 v[220:223], a[28:31], a[48:51], v[220:223]
    ds_read_b64_tr_b16 a[86:87], v7 offset:648
    v_mfma_f32_16x16x32_bf16 v[252:255], a[28:31], a[52:55], v[252:255]
    v_mfma_f32_16x16x32_bf16 v[248:251], a[24:27], a[52:55], v[248:251]
    v_mfma_f32_16x16x32_bf16 v[244:247], a[20:23], a[52:55], v[244:247]
    v_mfma_f32_16x16x32_bf16 v[240:243], a[16:19], a[52:55], v[240:243]
    v_mfma_f32_16x16x32_bf16 v[236:239], a[12:15], a[52:55], v[236:239]
    v_mfma_f32_16x16x32_bf16 v[232:235], a[8:11], a[52:55], v[232:235]
    v_mfma_f32_16x16x32_bf16 v[228:231], a[4:7], a[52:55], v[228:231]
    v_mfma_f32_16x16x32_bf16 v[224:227], a[0:3], a[52:55], v[224:227]
    s_waitcnt vmcnt(17) lgkmcnt(0)
    s_barrier
    v_mfma_f32_16x16x32_bf16 v[64:67], a[220:223], a[160:163], v[64:67]
    ds_read_b64_tr_b16 a[88:89], v7 offset:192
    v_mfma_f32_16x16x32_bf16 v[68:71], a[224:227], a[160:163], v[68:71]
    ds_read_b64_tr_b16 a[90:91], v7 offset:704
    v_mfma_f32_16x16x32_bf16 v[72:75], a[228:231], a[160:163], v[72:75]
    s_add_u32 m0, s29, 119424
    s_xor_b32 s35, s61, 3670016
    ds_read_b64_tr_b16 a[92:93], v7 offset:200
    v_mfma_f32_16x16x32_bf16 v[76:79], a[232:235], a[160:163], v[76:79]
    buffer_load_dwordx4 v2, s[12:15], s35 offen lds
    v_mfma_f32_16x16x32_bf16 v[80:83], a[236:239], a[160:163], v[80:83]
    ds_read_b64_tr_b16 a[94:95], v7 offset:712
    v_mfma_f32_16x16x32_bf16 v[84:87], a[240:243], a[160:163], v[84:87]
    ds_read_b64_tr_b16 a[0:1], v7 offset:17440
    v_mfma_f32_16x16x32_bf16 v[88:91], a[244:247], a[160:163], v[88:91]
    s_add_u32 m0, s29, 120512
    s_xor_b32 s35, s61, 3678208
    ds_read_b64_tr_b16 a[2:3], v7 offset:17952
    v_mfma_f32_16x16x32_bf16 v[92:95], a[248:251], a[160:163], v[92:95]
    buffer_load_dwordx4 v2, s[12:15], s35 offen lds
    v_mfma_f32_16x16x32_bf16 v[124:127], a[248:251], a[164:167], v[124:127]
    v_mfma_f32_16x16x32_bf16 v[120:123], a[244:247], a[164:167], v[120:123]
    ds_read_b64_tr_b16 a[4:5], v7 offset:17448
    v_mfma_f32_16x16x32_bf16 v[116:119], a[240:243], a[164:167], v[116:119]
    s_add_u32 m0, s29, 121600
    s_xor_b32 s35, s61, 3686400
    ds_read_b64_tr_b16 a[6:7], v7 offset:17960
    v_mfma_f32_16x16x32_bf16 v[112:115], a[236:239], a[164:167], v[112:115]
    buffer_load_dwordx4 v2, s[12:15], s35 offen lds
    v_mfma_f32_16x16x32_bf16 v[108:111], a[232:235], a[164:167], v[108:111]
    ds_read_b128 a[32:35], v6 offset:0
    v_mfma_f32_16x16x32_bf16 v[104:107], a[228:231], a[164:167], v[104:107]
    ds_read_b128 a[36:39], v6 offset:128
    v_mfma_f32_16x16x32_bf16 v[100:103], a[224:227], a[164:167], v[100:103]
    s_add_u32 m0, s29, 122688
    s_xor_b32 s35, s61, 3694592
    ds_read_b128 a[40:43], v6 offset:512
    v_mfma_f32_16x16x32_bf16 v[96:99], a[220:223], a[164:167], v[96:99]
    buffer_load_dwordx4 v2, s[12:15], s35 offen lds
    v_mfma_f32_16x16x32_bf16 v[128:131], a[220:223], a[168:171], v[128:131]
    v_mfma_f32_16x16x32_bf16 v[132:135], a[224:227], a[168:171], v[132:135]
    ds_read_b128 a[44:47], v6 offset:640
    v_mfma_f32_16x16x32_bf16 v[136:139], a[228:231], a[168:171], v[136:139]
    s_add_u32 m0, s28, 59712
    s_xor_b32 s35, s60, 1024
    ds_read_b128 a[48:51], v6 offset:1024
    v_mfma_f32_16x16x32_bf16 v[140:143], a[232:235], a[168:171], v[140:143]
    buffer_load_dwordx4 v1, s[8:11], s35 offen offset:0 lds
    v_mfma_f32_16x16x32_bf16 v[144:147], a[236:239], a[168:171], v[144:147]
    ds_read_b128 a[52:55], v6 offset:1152
    v_mfma_f32_16x16x32_bf16 v[148:151], a[240:243], a[168:171], v[148:151]
    ds_read_b64_tr_b16 a[8:9], v7 offset:17504
    v_mfma_f32_16x16x32_bf16 v[152:155], a[244:247], a[168:171], v[152:155]
    s_add_u32 m0, s28, 61536
    ds_read_b64_tr_b16 a[10:11], v7 offset:18016
    v_mfma_f32_16x16x32_bf16 v[156:159], a[248:251], a[168:171], v[156:159]
    buffer_load_dwordx4 v1, s[8:11], s35 offen offset:1280 lds
    v_mfma_f32_16x16x32_bf16 v[188:191], a[248:251], a[172:175], v[188:191]
    v_mfma_f32_16x16x32_bf16 v[184:187], a[244:247], a[172:175], v[184:187]
    ds_read_b64_tr_b16 a[12:13], v7 offset:17512
    v_mfma_f32_16x16x32_bf16 v[180:183], a[240:243], a[172:175], v[180:183]
    s_add_u32 m0, s28, 60736
    s_xor_b32 s35, s60, 82944
    ds_read_b64_tr_b16 a[14:15], v7 offset:18024
    v_mfma_f32_16x16x32_bf16 v[176:179], a[236:239], a[172:175], v[176:179]
    buffer_load_dwordx4 v1, s[8:11], s35 offen offset:0 lds
    v_mfma_f32_16x16x32_bf16 v[172:175], a[232:235], a[172:175], v[172:175]
    ds_read_b64_tr_b16 a[16:17], v7 offset:17568
    v_mfma_f32_16x16x32_bf16 v[168:171], a[228:231], a[172:175], v[168:171]
    ds_read_b64_tr_b16 a[18:19], v7 offset:18080
    v_mfma_f32_16x16x32_bf16 v[164:167], a[224:227], a[172:175], v[164:167]
    s_add_u32 m0, s28, 62560
    ds_read_b64_tr_b16 a[20:21], v7 offset:17576
    v_mfma_f32_16x16x32_bf16 v[160:163], a[220:223], a[172:175], v[160:163]
    buffer_load_dwordx4 v1, s[8:11], s35 offen offset:1280 lds
    v_mfma_f32_16x16x32_bf16 v[192:195], a[220:223], a[176:179], v[192:195]
    v_mfma_f32_16x16x32_bf16 v[196:199], a[224:227], a[176:179], v[196:199]
    ds_read_b64_tr_b16 a[22:23], v7 offset:18088
    v_mfma_f32_16x16x32_bf16 v[200:203], a[228:231], a[176:179], v[200:203]
    s_add_u32 m0, s28, 61760
    s_xor_b32 s35, s60, 164864
    ds_read_b64_tr_b16 a[24:25], v7 offset:17632
    v_mfma_f32_16x16x32_bf16 v[204:207], a[232:235], a[176:179], v[204:207]
    buffer_load_dwordx4 v1, s[8:11], s35 offen offset:0 lds
    v_mfma_f32_16x16x32_bf16 v[208:211], a[236:239], a[176:179], v[208:211]
    ds_read_b64_tr_b16 a[26:27], v7 offset:18144
    v_mfma_f32_16x16x32_bf16 v[212:215], a[240:243], a[176:179], v[212:215]
    ds_read_b64_tr_b16 a[28:29], v7 offset:17640
    v_mfma_f32_16x16x32_bf16 v[216:219], a[244:247], a[176:179], v[216:219]
    s_add_u32 m0, s28, 63584
    ds_read_b64_tr_b16 a[30:31], v7 offset:18152
    v_mfma_f32_16x16x32_bf16 v[220:223], a[248:251], a[176:179], v[220:223]
    buffer_load_dwordx4 v1, s[8:11], s35 offen offset:1280 lds
    v_mfma_f32_16x16x32_bf16 v[252:255], a[248:251], a[180:183], v[252:255]
    v_mfma_f32_16x16x32_bf16 v[248:251], a[244:247], a[180:183], v[248:251]
    v_mfma_f32_16x16x32_bf16 v[244:247], a[240:243], a[180:183], v[244:247]
    s_bfe_u32 s36, s3, 131075
    s_cmp_eq_u32 s36, 1
    s_cselect_b32 s36, s100, 0x40000000
    v_mfma_f32_16x16x32_bf16 v[240:243], a[236:239], a[180:183], v[240:243]
    buffer_load_dword v13, v29, s[76:79], s36 offen
    v_mfma_f32_16x16x32_bf16 v[236:239], a[232:235], a[180:183], v[236:239]
    v_mfma_f32_16x16x32_bf16 v[232:235], a[228:231], a[180:183], v[232:235]
    v_mfma_f32_16x16x32_bf16 v[228:231], a[224:227], a[180:183], v[228:231]
    v_mfma_f32_16x16x32_bf16 v[224:227], a[220:223], a[180:183], v[224:227]
    s_waitcnt vmcnt(12) lgkmcnt(0)
    s_barrier
    v_mfma_f32_16x16x32_bf16 v[64:67], a[64:67], a[96:99], v[64:67]
    ds_read_b128 a[160:163], v6 offset:64
    v_mfma_f32_16x16x32_bf16 v[68:71], a[68:71], a[96:99], v[68:71]
    ds_read_b128 a[164:167], v6 offset:192
    v_mfma_f32_16x16x32_bf16 v[72:75], a[72:75], a[96:99], v[72:75]
    s_add_u32 m0, s29, 24832
    s_xor_b32 s35, s61, 3932160
    ds_read_b128 a[168:171], v6 offset:576
    v_mfma_f32_16x16x32_bf16 v[76:79], a[76:79], a[96:99], v[76:79]
    buffer_load_dwordx4 v2, s[12:15], s35 offen lds
    v_mfma_f32_16x16x32_bf16 v[80:83], a[80:83], a[96:99], v[80:83]
    ds_read_b128 a[172:175], v6 offset:704
    v_mfma_f32_16x16x32_bf16 v[84:87], a[84:87], a[96:99], v[84:87]
    ds_read_b128 a[176:179], v6 offset:1088
    v_mfma_f32_16x16x32_bf16 v[88:91], a[88:91], a[96:99], v[88:91]
    s_add_u32 m0, s29, 25920
    s_xor_b32 s35, s61, 3940352
    v_mfma_f32_16x16x32_bf16 v[92:95], a[92:95], a[96:99], v[92:95]
    buffer_load_dwordx4 v2, s[12:15], s35 offen lds
    v_mfma_f32_16x16x32_bf16 v[124:127], a[92:95], a[100:103], v[124:127]
    ds_read_b128 a[180:183], v6 offset:1216
    v_mfma_f32_16x16x32_bf16 v[120:123], a[88:91], a[100:103], v[120:123]
    ds_read_b64_tr_b16 a[220:221], v7 offset:59712
    v_mfma_f32_16x16x32_bf16 v[116:119], a[84:87], a[100:103], v[116:119]
    s_add_u32 m0, s29, 27008
    s_xor_b32 s35, s61, 3948544
    ds_read_b64_tr_b16 a[222:223], v7 offset:60224
    v_mfma_f32_16x16x32_bf16 v[112:115], a[80:83], a[100:103], v[112:115]
    buffer_load_dwordx4 v2, s[12:15], s35 offen lds
    v_mfma_f32_16x16x32_bf16 v[108:111], a[76:79], a[100:103], v[108:111]
    ds_read_b64_tr_b16 a[224:225], v7 offset:59720
    v_mfma_f32_16x16x32_bf16 v[104:107], a[72:75], a[100:103], v[104:107]
    v_mfma_f32_16x16x32_bf16 v[100:103], a[68:71], a[100:103], v[100:103]
    s_add_u32 m0, s29, 28096
    s_xor_b32 s35, s61, 3956736
    ds_read_b64_tr_b16 a[226:227], v7 offset:60232
    v_mfma_f32_16x16x32_bf16 v[96:99], a[64:67], a[100:103], v[96:99]
    buffer_load_dwordx4 v2, s[12:15], s35 offen lds
    v_mfma_f32_16x16x32_bf16 v[128:131], a[64:67], a[104:107], v[128:131]
    ds_read_b64_tr_b16 a[228:229], v7 offset:59776
    v_mfma_f32_16x16x32_bf16 v[132:135], a[68:71], a[104:107], v[132:135]
    ds_read_b64_tr_b16 a[230:231], v7 offset:60288
    v_mfma_f32_16x16x32_bf16 v[136:139], a[72:75], a[104:107], v[136:139]
    s_add_u32 m0, s29, 42272
    s_xor_b32 s35, s61, 4194304
    ds_read_b64_tr_b16 a[232:233], v7 offset:59784
    v_mfma_f32_16x16x32_bf16 v[140:143], a[76:79], a[104:107], v[140:143]
    buffer_load_dwordx4 v2, s[12:15], s35 offen lds
    v_mfma_f32_16x16x32_bf16 v[144:147], a[80:83], a[104:107], v[144:147]
    v_mfma_f32_16x16x32_bf16 v[148:151], a[84:87], a[104:107], v[148:151]
    ds_read_b64_tr_b16 a[234:235], v7 offset:60296
    v_mfma_f32_16x16x32_bf16 v[152:155], a[88:91], a[104:107], v[152:155]
    s_add_u32 m0, s29, 43360
    s_xor_b32 s35, s61, 4202496
    ds_read_b64_tr_b16 a[236:237], v7 offset:59840
    v_mfma_f32_16x16x32_bf16 v[156:159], a[92:95], a[104:107], v[156:159]
    buffer_load_dwordx4 v2, s[12:15], s35 offen lds
    v_mfma_f32_16x16x32_bf16 v[188:191], a[92:95], a[108:111], v[188:191]
    ds_read_b64_tr_b16 a[238:239], v7 offset:60352
    v_mfma_f32_16x16x32_bf16 v[184:187], a[88:91], a[108:111], v[184:187]
    ds_read_b64_tr_b16 a[240:241], v7 offset:59848
    v_mfma_f32_16x16x32_bf16 v[180:183], a[84:87], a[108:111], v[180:183]
    s_add_u32 m0, s29, 44448
    s_xor_b32 s35, s61, 4210688
    ds_read_b64_tr_b16 a[242:243], v7 offset:60360
    v_mfma_f32_16x16x32_bf16 v[176:179], a[80:83], a[108:111], v[176:179]
    buffer_load_dwordx4 v2, s[12:15], s35 offen lds
    v_mfma_f32_16x16x32_bf16 v[172:175], a[76:79], a[108:111], v[172:175]
    v_mfma_f32_16x16x32_bf16 v[168:171], a[72:75], a[108:111], v[168:171]
    ds_read_b64_tr_b16 a[244:245], v7 offset:59904
    v_mfma_f32_16x16x32_bf16 v[164:167], a[68:71], a[108:111], v[164:167]
    s_add_u32 m0, s29, 45536
    s_xor_b32 s35, s61, 4218880
    ds_read_b64_tr_b16 a[246:247], v7 offset:60416
    v_mfma_f32_16x16x32_bf16 v[160:163], a[64:67], a[108:111], v[160:163]
    buffer_load_dwordx4 v2, s[12:15], s35 offen lds
    v_mfma_f32_16x16x32_bf16 v[192:195], a[64:67], a[112:115], v[192:195]
    ds_read_b64_tr_b16 a[248:249], v7 offset:59912
    v_mfma_f32_16x16x32_bf16 v[196:199], a[68:71], a[112:115], v[196:199]
    ds_read_b64_tr_b16 a[250:251], v7 offset:60424
    v_mfma_f32_16x16x32_bf16 v[200:203], a[72:75], a[112:115], v[200:203]
    s_bfe_u32 s36, s3, 131075
    s_cmp_eq_u32 s36, 2
    s_cselect_b32 s36, s100, 0x40000000
    v_mfma_f32_16x16x32_bf16 v[204:207], a[76:79], a[112:115], v[204:207]
    buffer_load_dword v13, v29, s[76:79], s36 offen
    v_mfma_f32_16x16x32_bf16 v[208:211], a[80:83], a[112:115], v[208:211]
    ds_read_b64_tr_b16 a[128:129], v8 offset:0
    v_mfma_f32_16x16x32_bf16 v[212:215], a[84:87], a[112:115], v[212:215]
    ds_read_b64_tr_b16 a[130:131], v8 offset:512
    v_mfma_f32_16x16x32_bf16 v[216:219], a[88:91], a[112:115], v[216:219]
    ds_read_b64_tr_b16 a[132:133], v8 offset:8
    v_mfma_f32_16x16x32_bf16 v[220:223], a[92:95], a[112:115], v[220:223]
    ds_read_b64_tr_b16 a[134:135], v8 offset:520
    v_mfma_f32_16x16x32_bf16 v[252:255], a[92:95], a[116:119], v[252:255]
    v_mfma_f32_16x16x32_bf16 v[248:251], a[88:91], a[116:119], v[248:251]
    v_mfma_f32_16x16x32_bf16 v[244:247], a[84:87], a[116:119], v[244:247]
    v_mfma_f32_16x16x32_bf16 v[240:243], a[80:83], a[116:119], v[240:243]
    v_mfma_f32_16x16x32_bf16 v[236:239], a[76:79], a[116:119], v[236:239]
    v_mfma_f32_16x16x32_bf16 v[232:235], a[72:75], a[116:119], v[232:235]
    v_mfma_f32_16x16x32_bf16 v[228:231], a[68:71], a[116:119], v[228:231]
    v_mfma_f32_16x16x32_bf16 v[224:227], a[64:67], a[116:119], v[224:227]
    s_waitcnt vmcnt(16) lgkmcnt(0)
    s_barrier
    v_mfma_f32_16x16x32_bf16 v[64:67], a[0:3], v[32:35], v[64:67]
    ds_read_b128 a[96:99], v5 offset:0
    v_mfma_f32_16x16x32_bf16 v[68:71], a[4:7], v[32:35], v[68:71]
    ds_read_b128 a[100:103], v5 offset:128
    v_mfma_f32_16x16x32_bf16 v[72:75], a[8:11], v[32:35], v[72:75]
    s_add_u32 m0, s29, 84544
    s_xor_b32 s35, s61, 4456448
    ds_read_b128 a[104:107], v5 offset:512
    v_mfma_f32_16x16x32_bf16 v[76:79], a[12:15], v[32:35], v[76:79]
    buffer_load_dwordx4 v2, s[12:15], s35 offen lds
    v_mfma_f32_16x16x32_bf16 v[80:83], a[16:19], v[32:35], v[80:83]
    ds_read_b128 a[108:111], v5 offset:640
    v_mfma_f32_16x16x32_bf16 v[84:87], a[20:23], v[32:35], v[84:87]
    ds_read_b128 a[112:115], v5 offset:1024
    v_mfma_f32_16x16x32_bf16 v[88:91], a[24:27], v[32:35], v[88:91]
    s_add_u32 m0, s29, 85632
    s_xor_b32 s35, s61, 4464640
    ds_read_b128 a[116:119], v5 offset:1152
    v_mfma_f32_16x16x32_bf16 v[92:95], a[28:31], v[32:35], v[92:95]
    buffer_load_dwordx4 v2, s[12:15], s35 offen lds
    v_mfma_f32_16x16x32_bf16 v[124:127], a[28:31], v[36:39], v[124:127]
    v_mfma_f32_16x16x32_bf16 v[120:123], a[24:27], v[36:39], v[120:123]
    ds_read_b64_tr_b16 a[136:137], v8 offset:64
    v_mfma_f32_16x16x32_bf16 v[116:119], a[20:23], v[36:39], v[116:119]
    s_add_u32 m0, s29, 86720
    s_xor_b32 s35, s61, 4472832
    ds_read_b64_tr_b16 a[138:139], v8 offset:576
    v_mfma_f32_16x16x32_bf16 v[112:115], a[16:19], v[36:39], v[112:115]
    buffer_load_dwordx4 v2, s[12:15], s35 offen lds
    v_mfma_f32_16x16x32_bf16 v[108:111], a[12:15], v[36:39], v[108:111]
    ds_read_b64_tr_b16 a[140:141], v8 offset:72
    v_mfma_f32_16x16x32_bf16 v[104:107], a[8:11], v[36:39], v[104:107]
    ds_read_b64_tr_b16 a[142:143], v8 offset:584
    v_mfma_f32_16x16x32_bf16 v[100:103], a[4:7], v[36:39], v[100:103]
    s_add_u32 m0, s29, 87808
    s_xor_b32 s35, s61, 4481024
    ds_read_b64_tr_b16 a[144:145], v8 offset:128
    v_mfma_f32_16x16x32_bf16 v[96:99], a[0:3], v[36:39], v[96:99]
    buffer_load_dwordx4 v2, s[12:15], s35 offen lds
    v_mfma_f32_16x16x32_bf16 v[128:131], a[0:3], v[40:43], v[128:131]
    v_mfma_f32_16x16x32_bf16 v[132:135], a[4:7], v[40:43], v[132:135]
    ds_read_b64_tr_b16 a[146:147], v8 offset:640
    v_mfma_f32_16x16x32_bf16 v[136:139], a[8:11], v[40:43], v[136:139]
    s_add_u32 m0, s28, 136864
    s_xor_b32 s35, s60, 1152
    ds_read_b64_tr_b16 a[148:149], v8 offset:136
    v_mfma_f32_16x16x32_bf16 v[140:143], a[12:15], v[40:43], v[140:143]
    buffer_load_dwordx4 v1, s[8:11], s35 offen offset:0 lds
    v_mfma_f32_16x16x32_bf16 v[144:147], a[16:19], v[40:43], v[144:147]
    ds_read_b64_tr_b16 a[150:151], v8 offset:648
    v_mfma_f32_16x16x32_bf16 v[148:151], a[20:23], v[40:43], v[148:151]
    ds_read_b64_tr_b16 a[152:153], v8 offset:192
    v_mfma_f32_16x16x32_bf16 v[152:155], a[24:27], v[40:43], v[152:155]
    s_add_u32 m0, s28, 138688
    ds_read_b64_tr_b16 a[154:155], v8 offset:704
    v_mfma_f32_16x16x32_bf16 v[156:159], a[28:31], v[40:43], v[156:159]
    buffer_load_dwordx4 v1, s[8:11], s35 offen offset:1280 lds
    v_mfma_f32_16x16x32_bf16 v[188:191], a[28:31], v[44:47], v[188:191]
    v_mfma_f32_16x16x32_bf16 v[184:187], a[24:27], v[44:47], v[184:187]
    ds_read_b64_tr_b16 a[156:157], v8 offset:200
    v_mfma_f32_16x16x32_bf16 v[180:183], a[20:23], v[44:47], v[180:183]
    s_add_u32 m0, s28, 137888
    s_xor_b32 s35, s60, 83072
    ds_read_b64_tr_b16 a[158:159], v8 offset:712
    v_mfma_f32_16x16x32_bf16 v[176:179], a[16:19], v[44:47], v[176:179]
    buffer_load_dwordx4 v1, s[8:11], s35 offen offset:0 lds
    v_mfma_f32_16x16x32_bf16 v[172:175], a[12:15], v[44:47], v[172:175]
    ds_read_b64_tr_b16 a[64:65], v8 offset:17440
    v_mfma_f32_16x16x32_bf16 v[168:171], a[8:11], v[44:47], v[168:171]
    ds_read_b64_tr_b16 a[66:67], v8 offset:17952
    v_mfma_f32_16x16x32_bf16 v[164:167], a[4:7], v[44:47], v[164:167]
    s_add_u32 m0, s28, 139712
    ds_read_b64_tr_b16 a[68:69], v8 offset:17448
    v_mfma_f32_16x16x32_bf16 v[160:163], a[0:3], v[44:47], v[160:163]
    buffer_load_dwordx4 v1, s[8:11], s35 offen offset:1280 lds
    v_mfma_f32_16x16x32_bf16 v[192:195], a[0:3], v[48:51], v[192:195]
    v_mfma_f32_16x16x32_bf16 v[196:199], a[4:7], v[48:51], v[196:199]
    ds_read_b64_tr_b16 a[70:71], v8 offset:17960
    v_mfma_f32_16x16x32_bf16 v[200:203], a[8:11], v[48:51], v[200:203]
    s_add_u32 m0, s28, 138912
    s_xor_b32 s35, s60, 164992
    ds_read_b64_tr_b16 a[72:73], v8 offset:17504
    v_mfma_f32_16x16x32_bf16 v[204:207], a[12:15], v[48:51], v[204:207]
    buffer_load_dwordx4 v1, s[8:11], s35 offen offset:0 lds
    v_mfma_f32_16x16x32_bf16 v[208:211], a[16:19], v[48:51], v[208:211]
    ds_read_b64_tr_b16 a[74:75], v8 offset:18016
    v_mfma_f32_16x16x32_bf16 v[212:215], a[20:23], v[48:51], v[212:215]
    ds_read_b64_tr_b16 a[76:77], v8 offset:17512
    v_mfma_f32_16x16x32_bf16 v[216:219], a[24:27], v[48:51], v[216:219]
    s_add_u32 m0, s28, 140736
    ds_read_b64_tr_b16 a[78:79], v8 offset:18024
    v_mfma_f32_16x16x32_bf16 v[220:223], a[28:31], v[48:51], v[220:223]
    buffer_load_dwordx4 v1, s[8:11], s35 offen offset:1280 lds
    v_mfma_f32_16x16x32_bf16 v[252:255], a[28:31], v[52:55], v[252:255]
    v_mfma_f32_16x16x32_bf16 v[248:251], a[24:27], v[52:55], v[248:251]
    v_mfma_f32_16x16x32_bf16 v[244:247], a[20:23], v[52:55], v[244:247]
    s_bfe_u32 s36, s3, 131075
    s_cmp_eq_u32 s36, 3
    s_cselect_b32 s36, s100, 0x40000000
    v_mfma_f32_16x16x32_bf16 v[240:243], a[16:19], v[52:55], v[240:243]
    buffer_load_dword v13, v29, s[76:79], s36 offen
    v_mfma_f32_16x16x32_bf16 v[236:239], a[12:15], v[52:55], v[236:239]
    v_mfma_f32_16x16x32_bf16 v[232:235], a[8:11], v[52:55], v[232:235]
    v_mfma_f32_16x16x32_bf16 v[228:231], a[4:7], v[52:55], v[228:231]
    v_mfma_f32_16x16x32_bf16 v[224:227], a[0:3], v[52:55], v[224:227]
    s_waitcnt vmcnt(16) lgkmcnt(0)
    s_barrier
    v_mfma_f32_16x16x32_bf16 v[64:67], a[220:223], a[32:35], v[64:67]
    ds_read_b128 v[32:35], v5 offset:64
    v_mfma_f32_16x16x32_bf16 v[68:71], a[224:227], a[32:35], v[68:71]
    ds_read_b128 v[36:39], v5 offset:192
    v_mfma_f32_16x16x32_bf16 v[72:75], a[228:231], a[32:35], v[72:75]
    s_add_u32 m0, s29, 101984
    s_xor_b32 s35, s61, 4718592
    ds_read_b128 v[40:43], v5 offset:576
    v_mfma_f32_16x16x32_bf16 v[76:79], a[232:235], a[32:35], v[76:79]
    buffer_load_dwordx4 v2, s[12:15], s35 offen lds
    v_mfma_f32_16x16x32_bf16 v[80:83], a[236:239], a[32:35], v[80:83]
    v_mfma_f32_16x16x32_bf16 v[84:87], a[240:243], a[32:35], v[84:87]
    ds_read_b128 v[44:47], v5 offset:704
    v_mfma_f32_16x16x32_bf16 v[88:91], a[244:247], a[32:35], v[88:91]
    ds_read_b128 v[48:51], v5 offset:1088
    v_mfma_f32_16x16x32_bf16 v[92:95], a[248:251], a[32:35], v[92:95]
    v_mfma_f32_16x16x32_bf16 v[124:127], a[248:251], a[36:39], v[124:127]
    ds_read_b128 v[52:55], v5 offset:1216
    v_mfma_f32_16x16x32_bf16 v[120:123], a[244:247], a[36:39], v[120:123]
    ds_read_b64_tr_b16 a[80:81], v8 offset:17568
    v_mfma_f32_16x16x32_bf16 v[116:119], a[240:243], a[36:39], v[116:119]
    s_add_u32 m0, s29, 103072
    s_xor_b32 s35, s61, 4726784
    ds_read_b64_tr_b16 a[82:83], v8 offset:18080
    v_mfma_f32_16x16x32_bf16 v[112:115], a[236:239], a[36:39], v[112:115]
    buffer_load_dwordx4 v2, s[12:15], s35 offen lds
    v_mfma_f32_16x16x32_bf16 v[108:111], a[232:235], a[36:39], v[108:111]
    v_mfma_f32_16x16x32_bf16 v[104:107], a[228:231], a[36:39], v[104:107]
    ds_read_b64_tr_b16 a[84:85], v8 offset:17576
    v_mfma_f32_16x16x32_bf16 v[100:103], a[224:227], a[36:39], v[100:103]
    ds_read_b64_tr_b16 a[86:87], v8 offset:18088
    v_mfma_f32_16x16x32_bf16 v[96:99], a[220:223], a[36:39], v[96:99]
    v_mfma_f32_16x16x32_bf16 v[128:131], a[220:223], a[40:43], v[128:131]
    ds_read_b64_tr_b16 a[88:89], v8 offset:17632
    v_mfma_f32_16x16x32_bf16 v[132:135], a[224:227], a[40:43], v[132:135]
    ds_read_b64_tr_b16 a[90:91], v8 offset:18144
    v_mfma_f32_16x16x32_bf16 v[136:139], a[228:231], a[40:43], v[136:139]
    s_add_u32 m0, s29, 104160
    s_xor_b32 s35, s61, 4734976
    v_mfma_f32_16x16x32_bf16 v[140:143], a[232:235], a[40:43], v[140:143]
    buffer_load_dwordx4 v2, s[12:15], s35 offen lds
    v_mfma_f32_16x16x32_bf16 v[144:147], a[236:239], a[40:43], v[144:147]
    ds_read_b64_tr_b16 a[92:93], v8 offset:17640
    v_mfma_f32_16x16x32_bf16 v[148:151], a[240:243], a[40:43], v[148:151]
    ds_read_b64_tr_b16 a[94:95], v8 offset:18152
    v_mfma_f32_16x16x32_bf16 v[152:155], a[244:247], a[40:43], v[152:155]
    ds_read_b64_tr_b16 a[0:1], v7 offset:0
    v_mfma_f32_16x16x32_bf16 v[156:159], a[248:251], a[40:43], v[156:159]
    v_mfma_f32_16x16x32_bf16 v[188:191], a[248:251], a[44:47], v[188:191]
    ds_read_b64_tr_b16 a[2:3], v7 offset:512
    v_mfma_f32_16x16x32_bf16 v[184:187], a[244:247], a[44:47], v[184:187]
    ds_read_b64_tr_b16 a[4:5], v7 offset:8
    v_mfma_f32_16x16x32_bf16 v[180:183], a[240:243], a[44:47], v[180:183]
    s_add_u32 m0, s29, 105248
    s_xor_b32 s35, s61, 4743168
    v_mfma_f32_16x16x32_bf16 v[176:179], a[236:239], a[44:47], v[176:179]
    buffer_load_dwordx4 v2, s[12:15], s35 offen lds
    v_mfma_f32_16x16x32_bf16 v[172:175], a[232:235], a[44:47], v[172:175]
    ds_read_b64_tr_b16 a[6:7], v7 offset:520
    v_mfma_f32_16x16x32_bf16 v[168:171], a[228:231], a[44:47], v[168:171]
    ds_read_b64_tr_b16 a[8:9], v7 offset:64
    v_mfma_f32_16x16x32_bf16 v[164:167], a[224:227], a[44:47], v[164:167]
    v_mfma_f32_16x16x32_bf16 v[160:163], a[220:223], a[44:47], v[160:163]
    ds_read_b64_tr_b16 a[10:11], v7 offset:576
    v_mfma_f32_16x16x32_bf16 v[192:195], a[220:223], a[48:51], v[192:195]
    ds_read_b64_tr_b16 a[12:13], v7 offset:72
    v_mfma_f32_16x16x32_bf16 v[196:199], a[224:227], a[48:51], v[196:199]
    ds_read_b64_tr_b16 a[14:15], v7 offset:584
    v_mfma_f32_16x16x32_bf16 v[200:203], a[228:231], a[48:51], v[200:203]
    v_mfma_f32_16x16x32_bf16 v[204:207], a[232:235], a[48:51], v[204:207]
    ds_read_b64_tr_b16 a[16:17], v7 offset:128
    v_mfma_f32_16x16x32_bf16 v[208:211], a[236:239], a[48:51], v[208:211]
    ds_read_b64_tr_b16 a[18:19], v7 offset:640
    v_mfma_f32_16x16x32_bf16 v[212:215], a[240:243], a[48:51], v[212:215]
    v_mfma_f32_16x16x32_bf16 v[216:219], a[244:247], a[48:51], v[216:219]
    ds_read_b64_tr_b16 a[20:21], v7 offset:136
    v_mfma_f32_16x16x32_bf16 v[220:223], a[248:251], a[48:51], v[220:223]
    ds_read_b64_tr_b16 a[22:23], v7 offset:648
    v_mfma_f32_16x16x32_bf16 v[252:255], a[248:251], a[52:55], v[252:255]
    v_mfma_f32_16x16x32_bf16 v[248:251], a[244:247], a[52:55], v[248:251]
    v_mfma_f32_16x16x32_bf16 v[244:247], a[240:243], a[52:55], v[244:247]
    v_mfma_f32_16x16x32_bf16 v[240:243], a[236:239], a[52:55], v[240:243]
    v_mfma_f32_16x16x32_bf16 v[236:239], a[232:235], a[52:55], v[236:239]
    v_mfma_f32_16x16x32_bf16 v[232:235], a[228:231], a[52:55], v[232:235]
    v_mfma_f32_16x16x32_bf16 v[228:231], a[224:227], a[52:55], v[228:231]
    v_mfma_f32_16x16x32_bf16 v[224:227], a[220:223], a[52:55], v[224:227]
    s_waitcnt vmcnt(16) lgkmcnt(0)
    s_barrier
    v_mfma_f32_16x16x32_bf16 v[64:67], a[128:131], a[160:163], v[64:67]
    ds_read_b128 a[32:35], v5 offset:59712
    v_mfma_f32_16x16x32_bf16 v[68:71], a[132:135], a[160:163], v[68:71]
    ds_read_b128 a[36:39], v5 offset:59840
    v_mfma_f32_16x16x32_bf16 v[72:75], a[136:139], a[160:163], v[72:75]
    s_add_u32 m0, s29, 119424
    s_xor_b32 s35, s61, 4980736
    ds_read_b128 a[40:43], v5 offset:60224
    v_mfma_f32_16x16x32_bf16 v[76:79], a[140:143], a[160:163], v[76:79]
    buffer_load_dwordx4 v2, s[12:15], s35 offen lds
    v_mfma_f32_16x16x32_bf16 v[80:83], a[144:147], a[160:163], v[80:83]
    ds_read_b128 a[44:47], v5 offset:60352
    v_mfma_f32_16x16x32_bf16 v[84:87], a[148:151], a[160:163], v[84:87]
    v_mfma_f32_16x16x32_bf16 v[88:91], a[152:155], a[160:163], v[88:91]
    ds_read_b128 a[48:51], v5 offset:60736
    v_mfma_f32_16x16x32_bf16 v[92:95], a[156:159], a[160:163], v[92:95]
    s_add_u32 m0, s29, 120512
    s_xor_b32 s35, s61, 4988928
    ds_read_b128 a[52:55], v5 offset:60864
    v_mfma_f32_16x16x32_bf16 v[124:127], a[156:159], a[164:167], v[124:127]
    buffer_load_dwordx4 v2, s[12:15], s35 offen lds
    v_mfma_f32_16x16x32_bf16 v[120:123], a[152:155], a[164:167], v[120:123]
    ds_read_b64_tr_b16 a[24:25], v7 offset:192
    v_mfma_f32_16x16x32_bf16 v[116:119], a[148:151], a[164:167], v[116:119]
    ds_read_b64_tr_b16 a[26:27], v7 offset:704
    v_mfma_f32_16x16x32_bf16 v[112:115], a[144:147], a[164:167], v[112:115]
    v_mfma_f32_16x16x32_bf16 v[108:111], a[140:143], a[164:167], v[108:111]
    s_add_u32 m0, s29, 121600
    s_xor_b32 s35, s61, 4997120
    ds_read_b64_tr_b16 a[28:29], v7 offset:200
    v_mfma_f32_16x16x32_bf16 v[104:107], a[136:139], a[164:167], v[104:107]
    buffer_load_dwordx4 v2, s[12:15], s35 offen lds
    v_mfma_f32_16x16x32_bf16 v[100:103], a[132:135], a[164:167], v[100:103]
    ds_read_b64_tr_b16 a[30:31], v7 offset:712
    v_mfma_f32_16x16x32_bf16 v[96:99], a[128:131], a[164:167], v[96:99]
    ds_read_b64_tr_b16 a[220:221], v7 offset:17440
    v_mfma_f32_16x16x32_bf16 v[128:131], a[128:131], a[168:171], v[128:131]
    ds_read_b64_tr_b16 a[222:223], v7 offset:17952
    v_mfma_f32_16x16x32_bf16 v[132:135], a[132:135], a[168:171], v[132:135]
    s_add_u32 m0, s29, 122688
    s_xor_b32 s35, s61, 5005312
    v_mfma_f32_16x16x32_bf16 v[136:139], a[136:139], a[168:171], v[136:139]
    buffer_load_dwordx4 v2, s[12:15], s35 offen lds
    v_mfma_f32_16x16x32_bf16 v[140:143], a[140:143], a[168:171], v[140:143]
    ds_read_b64_tr_b16 a[224:225], v7 offset:17448
    v_mfma_f32_16x16x32_bf16 v[144:147], a[144:147], a[168:171], v[144:147]
    ds_read_b64_tr_b16 a[226:227], v7 offset:17960
    v_mfma_f32_16x16x32_bf16 v[148:151], a[148:151], a[168:171], v[148:151]
    s_add_u32 m0, s30, 0
    s_mul_i32 s35, s80, 0
    ds_read_b64_tr_b16 a[228:229], v7 offset:17504
    v_mfma_f32_16x16x32_bf16 v[152:155], a[152:155], a[168:171], v[152:155]
    s_add_u32 s35, s35, s101
    s_and_b32 s35, s35, 0x1e000
    s_or_b32 s35, s35, s75
    v_mfma_f32_16x16x32_bf16 v[156:159], a[156:159], a[168:171], v[156:159]
    buffer_load_dwordx4 v3, s[16:19], s35 offen offset:0 nt lds
    v_mfma_f32_16x16x32_bf16 v[188:191], a[156:159], a[172:175], v[188:191]
    ds_read_b64_tr_b16 a[230:231], v7 offset:18016
    v_mfma_f32_16x16x32_bf16 v[184:187], a[152:155], a[172:175], v[184:187]
    ds_read_b64_tr_b16 a[232:233], v7 offset:17512
    v_mfma_f32_16x16x32_bf16 v[180:183], a[148:151], a[172:175], v[180:183]
    ds_read_b64_tr_b16 a[234:235], v7 offset:18024
    v_mfma_f32_16x16x32_bf16 v[176:179], a[144:147], a[172:175], v[176:179]
    s_add_u32 m0, s30, 800
    ds_read_b64_tr_b16 a[236:237], v7 offset:17568
    v_mfma_f32_16x16x32_bf16 v[172:175], a[140:143], a[172:175], v[172:175]
    buffer_load_dwordx4 v3, s[16:19], s35 offen offset:256 nt lds
    v_mfma_f32_16x16x32_bf16 v[168:171], a[136:139], a[172:175], v[168:171]
    v_mfma_f32_16x16x32_bf16 v[164:167], a[132:135], a[172:175], v[164:167]
    ds_read_b64_tr_b16 a[238:239], v7 offset:18080
    v_mfma_f32_16x16x32_bf16 v[160:163], a[128:131], a[172:175], v[160:163]
    ds_read_b64_tr_b16 a[240:241], v7 offset:17576
    v_mfma_f32_16x16x32_bf16 v[192:195], a[128:131], a[176:179], v[192:195]
    s_add_u32 m0, s30, 1600
    ds_read_b64_tr_b16 a[242:243], v7 offset:18088
    v_mfma_f32_16x16x32_bf16 v[196:199], a[132:135], a[176:179], v[196:199]
    buffer_load_dwordx4 v3, s[16:19], s35 offen offset:512 nt lds
    v_mfma_f32_16x16x32_bf16 v[200:203], a[136:139], a[176:179], v[200:203]
    ds_read_b64_tr_b16 a[244:245], v7 offset:17632
    v_mfma_f32_16x16x32_bf16 v[204:207], a[140:143], a[176:179], v[204:207]
    v_mfma_f32_16x16x32_bf16 v[208:211], a[144:147], a[176:179], v[208:211]
    ds_read_b64_tr_b16 a[246:247], v7 offset:18144
    v_mfma_f32_16x16x32_bf16 v[212:215], a[148:151], a[176:179], v[212:215]
    s_add_u32 m0, s30, 2400
    ds_read_b64_tr_b16 a[248:249], v7 offset:17640
    v_mfma_f32_16x16x32_bf16 v[216:219], a[152:155], a[176:179], v[216:219]
    buffer_load_dwordx4 v3, s[16:19], s35 offen offset:768 nt lds
    v_mfma_f32_16x16x32_bf16 v[220:223], a[156:159], a[176:179], v[220:223]
    ds_read_b64_tr_b16 a[250:251], v7 offset:18152
    v_mfma_f32_16x16x32_bf16 v[252:255], a[156:159], a[180:183], v[252:255]
    v_mfma_f32_16x16x32_bf16 v[248:251], a[152:155], a[180:183], v[248:251]
    v_mfma_f32_16x16x32_bf16 v[244:247], a[148:151], a[180:183], v[244:247]
    v_mfma_f32_16x16x32_bf16 v[240:243], a[144:147], a[180:183], v[240:243]
    v_mfma_f32_16x16x32_bf16 v[236:239], a[140:143], a[180:183], v[236:239]
    v_mfma_f32_16x16x32_bf16 v[232:235], a[136:139], a[180:183], v[232:235]
    v_mfma_f32_16x16x32_bf16 v[228:231], a[132:135], a[180:183], v[228:231]
    v_mfma_f32_16x16x32_bf16 v[224:227], a[128:131], a[180:183], v[224:227]
    s_waitcnt vmcnt(19) lgkmcnt(0)
    s_barrier
    v_mfma_f32_16x16x32_bf16 v[64:67], a[64:67], a[96:99], v[64:67]
    ds_read_b128 a[160:163], v5 offset:59776
    v_mfma_f32_16x16x32_bf16 v[68:71], a[68:71], a[96:99], v[68:71]
    s_add_u32 m0, s30, 16896
    s_mul_i32 s35, s80, 0
    ds_read_b128 a[164:167], v5 offset:59904
    v_mfma_f32_16x16x32_bf16 v[72:75], a[72:75], a[96:99], v[72:75]
    s_add_u32 s35, s35, s101
    s_and_b32 s35, s35, 0x1e000
    s_or_b32 s35, s35, s75
    v_mfma_f32_16x16x32_bf16 v[76:79], a[76:79], a[96:99], v[76:79]
    buffer_load_dwordx4 v3, s[20:23], s35 offen offset:0 nt lds
    v_mfma_f32_16x16x32_bf16 v[80:83], a[80:83], a[96:99], v[80:83]
    ds_read_b128 a[168:171], v5 offset:60288
    v_mfma_f32_16x16x32_bf16 v[84:87], a[84:87], a[96:99], v[84:87]
    ds_read_b128 a[172:175], v5 offset:60416
    v_mfma_f32_16x16x32_bf16 v[88:91], a[88:91], a[96:99], v[88:91]
    v_mfma_f32_16x16x32_bf16 v[92:95], a[92:95], a[96:99], v[92:95]
    s_add_u32 m0, s30, 17696
    ds_read_b128 a[176:179], v5 offset:60800
    v_mfma_f32_16x16x32_bf16 v[124:127], a[92:95], a[100:103], v[124:127]
    buffer_load_dwordx4 v3, s[20:23], s35 offen offset:256 nt lds
    v_mfma_f32_16x16x32_bf16 v[120:123], a[88:91], a[100:103], v[120:123]
    ds_read_b128 a[180:183], v5 offset:60928
    v_mfma_f32_16x16x32_bf16 v[116:119], a[84:87], a[100:103], v[116:119]
    v_mfma_f32_16x16x32_bf16 v[112:115], a[80:83], a[100:103], v[112:115]
    ds_read_b64_tr_b16 a[128:129], v7 offset:59712
    v_mfma_f32_16x16x32_bf16 v[108:111], a[76:79], a[100:103], v[108:111]
    s_add_u32 m0, s30, 18496
    ds_read_b64_tr_b16 a[130:131], v7 offset:60224
    v_mfma_f32_16x16x32_bf16 v[104:107], a[72:75], a[100:103], v[104:107]
    buffer_load_dwordx4 v3, s[20:23], s35 offen offset:512 nt lds
    v_mfma_f32_16x16x32_bf16 v[100:103], a[68:71], a[100:103], v[100:103]
    v_mfma_f32_16x16x32_bf16 v[96:99], a[64:67], a[100:103], v[96:99]
    ds_read_b64_tr_b16 a[132:133], v7 offset:59720
    v_mfma_f32_16x16x32_bf16 v[128:131], a[64:67], a[104:107], v[128:131]
    ds_read_b64_tr_b16 a[134:135], v7 offset:60232
    v_mfma_f32_16x16x32_bf16 v[132:135], a[68:71], a[104:107], v[132:135]
    s_add_u32 m0, s30, 19296
    v_mfma_f32_16x16x32_bf16 v[136:139], a[72:75], a[104:107], v[136:139]
    buffer_load_dwordx4 v3, s[20:23], s35 offen offset:768 nt lds
    v_mfma_f32_16x16x32_bf16 v[140:143], a[76:79], a[104:107], v[140:143]
    ds_read_b64_tr_b16 a[136:137], v7 offset:59776
    v_mfma_f32_16x16x32_bf16 v[144:147], a[80:83], a[104:107], v[144:147]
    ds_read_b64_tr_b16 a[138:139], v7 offset:60288
    v_mfma_f32_16x16x32_bf16 v[148:151], a[84:87], a[104:107], v[148:151]
    s_add_u32 m0, s30, 33792
    s_mul_i32 s35, s80, 1
    s_add_u32 s35, s35, s101
    v_mfma_f32_16x16x32_bf16 v[152:155], a[88:91], a[104:107], v[152:155]
    s_and_b32 s35, s35, 0x1e000
    s_or_b32 s35, s35, s75
    ds_read_b64_tr_b16 a[140:141], v7 offset:59784
    v_mfma_f32_16x16x32_bf16 v[156:159], a[92:95], a[104:107], v[156:159]
    buffer_load_dwordx4 v3, s[16:19], s35 offen offset:0 nt lds
    v_mfma_f32_16x16x32_bf16 v[188:191], a[92:95], a[108:111], v[188:191]
    ds_read_b64_tr_b16 a[142:143], v7 offset:60296
    v_mfma_f32_16x16x32_bf16 v[184:187], a[88:91], a[108:111], v[184:187]
    v_mfma_f32_16x16x32_bf16 v[180:183], a[84:87], a[108:111], v[180:183]
    ds_read_b64_tr_b16 a[144:145], v7 offset:59840
    v_mfma_f32_16x16x32_bf16 v[176:179], a[80:83], a[108:111], v[176:179]
    s_add_u32 m0, s30, 34592
    ds_read_b64_tr_b16 a[146:147], v7 offset:60352
    v_mfma_f32_16x16x32_bf16 v[172:175], a[76:79], a[108:111], v[172:175]
    buffer_load_dwordx4 v3, s[16:19], s35 offen offset:256 nt lds
    v_mfma_f32_16x16x32_bf16 v[168:171], a[72:75], a[108:111], v[168:171]
    v_mfma_f32_16x16x32_bf16 v[164:167], a[68:71], a[108:111], v[164:167]
    ds_read_b64_tr_b16 a[148:149], v7 offset:59848
    v_mfma_f32_16x16x32_bf16 v[160:163], a[64:67], a[108:111], v[160:163]
    ds_read_b64_tr_b16 a[150:151], v7 offset:60360
    v_mfma_f32_16x16x32_bf16 v[192:195], a[64:67], a[112:115], v[192:195]
    s_add_u32 m0, s30, 35392
    v_mfma_f32_16x16x32_bf16 v[196:199], a[68:71], a[112:115], v[196:199]
    buffer_load_dwordx4 v3, s[16:19], s35 offen offset:512 nt lds
    v_mfma_f32_16x16x32_bf16 v[200:203], a[72:75], a[112:115], v[200:203]
    ds_read_b64_tr_b16 a[152:153], v7 offset:59904
    v_mfma_f32_16x16x32_bf16 v[204:207], a[76:79], a[112:115], v[204:207]
    ds_read_b64_tr_b16 a[154:155], v7 offset:60416
    v_mfma_f32_16x16x32_bf16 v[208:211], a[80:83], a[112:115], v[208:211]
    v_mfma_f32_16x16x32_bf16 v[212:215], a[84:87], a[112:115], v[212:215]
    s_add_u32 m0, s30, 36192
    ds_read_b64_tr_b16 a[156:157], v7 offset:59912
    v_mfma_f32_16x16x32_bf16 v[216:219], a[88:91], a[112:115], v[216:219]
    buffer_load_dwordx4 v3, s[16:19], s35 offen offset:768 nt lds
    v_mfma_f32_16x16x32_bf16 v[220:223], a[92:95], a[112:115], v[220:223]
    ds_read_b64_tr_b16 a[158:159], v7 offset:60424
    v_mfma_f32_16x16x32_bf16 v[252:255], a[92:95], a[116:119], v[252:255]
    v_mfma_f32_16x16x32_bf16 v[248:251], a[88:91], a[116:119], v[248:251]
    v_mfma_f32_16x16x32_bf16 v[244:247], a[84:87], a[116:119], v[244:247]
    v_mfma_f32_16x16x32_bf16 v[240:243], a[80:83], a[116:119], v[240:243]
    v_mfma_f32_16x16x32_bf16 v[236:239], a[76:79], a[116:119], v[236:239]
    v_mfma_f32_16x16x32_bf16 v[232:235], a[72:75], a[116:119], v[232:235]
    v_mfma_f32_16x16x32_bf16 v[228:231], a[68:71], a[116:119], v[228:231]
    v_mfma_f32_16x16x32_bf16 v[224:227], a[64:67], a[116:119], v[224:227]
    s_waitcnt vmcnt(16) lgkmcnt(0)
    s_barrier
    v_mfma_f32_16x16x32_bf16 v[64:67], a[0:3], v[32:35], v[64:67]
    ds_read_b128 a[96:99], v6 offset:0
    v_mfma_f32_16x16x32_bf16 v[68:71], a[4:7], v[32:35], v[68:71]
    s_add_u32 m0, s30, 50688
    s_mul_i32 s35, s80, 1
    ds_read_b128 a[100:103], v6 offset:128
    v_mfma_f32_16x16x32_bf16 v[72:75], a[8:11], v[32:35], v[72:75]
    s_add_u32 s35, s35, s101
    s_and_b32 s35, s35, 0x1e000
    s_or_b32 s35, s35, s75
    v_mfma_f32_16x16x32_bf16 v[76:79], a[12:15], v[32:35], v[76:79]
    buffer_load_dwordx4 v3, s[20:23], s35 offen offset:0 nt lds
    v_mfma_f32_16x16x32_bf16 v[80:83], a[16:19], v[32:35], v[80:83]
    ds_read_b128 a[104:107], v6 offset:512
    v_mfma_f32_16x16x32_bf16 v[84:87], a[20:23], v[32:35], v[84:87]
    v_mfma_f32_16x16x32_bf16 v[88:91], a[24:27], v[32:35], v[88:91]
    ds_read_b128 a[108:111], v6 offset:640
    v_mfma_f32_16x16x32_bf16 v[92:95], a[28:31], v[32:35], v[92:95]
    ds_read_b128 a[112:115], v6 offset:1024
    v_mfma_f32_16x16x32_bf16 v[124:127], a[28:31], v[36:39], v[124:127]
    v_mfma_f32_16x16x32_bf16 v[120:123], a[24:27], v[36:39], v[120:123]
    ds_read_b128 a[116:119], v6 offset:1152
    v_mfma_f32_16x16x32_bf16 v[116:119], a[20:23], v[36:39], v[116:119]
    v_mfma_f32_16x16x32_bf16 v[112:115], a[16:19], v[36:39], v[112:115]
    ds_read_b64_tr_b16 a[64:65], v8 offset:0
    v_mfma_f32_16x16x32_bf16 v[108:111], a[12:15], v[36:39], v[108:111]
    ds_read_b64_tr_b16 a[66:67], v8 offset:512
    v_mfma_f32_16x16x32_bf16 v[104:107], a[8:11], v[36:39], v[104:107]
    s_add_u32 m0, s30, 51488
    v_mfma_f32_16x16x32_bf16 v[100:103], a[4:7], v[36:39], v[100:103]
    buffer_load_dwordx4 v3, s[20:23], s35 offen offset:256 nt lds
    v_mfma_f32_16x16x32_bf16 v[96:99], a[0:3], v[36:39], v[96:99]
    ds_read_b64_tr_b16 a[68:69], v8 offset:8
    v_mfma_f32_16x16x32_bf16 v[128:131], a[0:3], v[40:43], v[128:131]
    v_mfma_f32_16x16x32_bf16 v[132:135], a[4:7], v[40:43], v[132:135]
    ds_read_b64_tr_b16 a[70:71], v8 offset:520
    v_mfma_f32_16x16x32_bf16 v[136:139], a[8:11], v[40:43], v[136:139]
    ds_read_b64_tr_b16 a[72:73], v8 offset:64
    v_mfma_f32_16x16x32_bf16 v[140:143], a[12:15], v[40:43], v[140:143]
    v_mfma_f32_16x16x32_bf16 v[144:147], a[16:19], v[40:43], v[144:147]
    ds_read_b64_tr_b16 a[74:75], v8 offset:576
    v_mfma_f32_16x16x32_bf16 v[148:151], a[20:23], v[40:43], v[148:151]
    v_mfma_f32_16x16x32_bf16 v[152:155], a[24:27], v[40:43], v[152:155]
    ds_read_b64_tr_b16 a[76:77], v8 offset:72
    v_mfma_f32_16x16x32_bf16 v[156:159], a[28:31], v[40:43], v[156:159]
    ds_read_b64_tr_b16 a[78:79], v8 offset:584
    v_mfma_f32_16x16x32_bf16 v[188:191], a[28:31], v[44:47], v[188:191]
    s_add_u32 m0, s30, 52288
    v_mfma_f32_16x16x32_bf16 v[184:187], a[24:27], v[44:47], v[184:187]
    buffer_load_dwordx4 v3, s[20:23], s35 offen offset:512 nt lds
    v_mfma_f32_16x16x32_bf16 v[180:183], a[20:23], v[44:47], v[180:183]
    ds_read_b64_tr_b16 a[80:81], v8 offset:128
    v_mfma_f32_16x16x32_bf16 v[176:179], a[16:19], v[44:47], v[176:179]
    v_mfma_f32_16x16x32_bf16 v[172:175], a[12:15], v[44:47], v[172:175]
    ds_read_b64_tr_b16 a[82:83], v8 offset:640
    v_mfma_f32_16x16x32_bf16 v[168:171], a[8:11], v[44:47], v[168:171]
    ds_read_b64_tr_b16 a[84:85], v8 offset:136
    v_mfma_f32_16x16x32_bf16 v[164:167], a[4:7], v[44:47], v[164:167]
    v_mfma_f32_16x16x32_bf16 v[160:163], a[0:3], v[44:47], v[160:163]
    ds_read_b64_tr_b16 a[86:87], v8 offset:648
    v_mfma_f32_16x16x32_bf16 v[192:195], a[0:3], v[48:51], v[192:195]
    v_mfma_f32_16x16x32_bf16 v[196:199], a[4:7], v[48:51], v[196:199]
    ds_read_b64_tr_b16 a[88:89], v8 offset:192
    v_mfma_f32_16x16x32_bf16 v[200:203], a[8:11], v[48:51], v[200:203]
    ds_read_b64_tr_b16 a[90:91], v8 offset:704
    v_mfma_f32_16x16x32_bf16 v[204:207], a[12:15], v[48:51], v[204:207]
    s_add_u32 m0, s30, 53088
    v_mfma_f32_16x16x32_bf16 v[208:211], a[16:19], v[48:51], v[208:211]
    buffer_load_dwordx4 v3, s[20:23], s35 offen offset:768 nt lds
    v_mfma_f32_16x16x32_bf16 v[212:215], a[20:23], v[48:51], v[212:215]
    ds_read_b64_tr_b16 a[92:93], v8 offset:200
    v_mfma_f32_16x16x32_bf16 v[216:219], a[24:27], v[48:51], v[216:219]
    v_mfma_f32_16x16x32_bf16 v[220:223], a[28:31], v[48:51], v[220:223]
    ds_read_b64_tr_b16 a[94:95], v8 offset:712
    v_mfma_f32_16x16x32_bf16 v[252:255], a[28:31], v[52:55], v[252:255]
    v_mfma_f32_16x16x32_bf16 v[248:251], a[24:27], v[52:55], v[248:251]
    v_mfma_f32_16x16x32_bf16 v[244:247], a[20:23], v[52:55], v[244:247]
    v_mfma_f32_16x16x32_bf16 v[240:243], a[16:19], v[52:55], v[240:243]
    v_mfma_f32_16x16x32_bf16 v[236:239], a[12:15], v[52:55], v[236:239]
    v_mfma_f32_16x16x32_bf16 v[232:235], a[8:11], v[52:55], v[232:235]
    v_mfma_f32_16x16x32_bf16 v[228:231], a[4:7], v[52:55], v[228:231]
    v_mfma_f32_16x16x32_bf16 v[224:227], a[0:3], v[52:55], v[224:227]
    s_waitcnt vmcnt(16) lgkmcnt(0)
    s_barrier
    v_mfma_f32_16x16x32_bf16 v[64:67], a[220:223], a[32:35], v[64:67]
    ds_read_b128 v[32:35], v6 offset:64
    v_mfma_f32_16x16x32_bf16 v[68:71], a[224:227], a[32:35], v[68:71]
    s_add_u32 m0, s30, 67584
    s_mul_i32 s35, s80, 2
    ds_read_b128 v[36:39], v6 offset:192
    v_mfma_f32_16x16x32_bf16 v[72:75], a[228:231], a[32:35], v[72:75]
    s_add_u32 s35, s35, s101
    s_and_b32 s35, s35, 0x1e000
    s_or_b32 s35, s35, s75
    v_mfma_f32_16x16x32_bf16 v[76:79], a[232:235], a[32:35], v[76:79]
    buffer_load_dwordx4 v3, s[16:19], s35 offen offset:0 nt lds
    v_mfma_f32_16x16x32_bf16 v[80:83], a[236:239], a[32:35], v[80:83]
    ds_read_b128 v[40:43], v6 offset:576
    v_mfma_f32_16x16x32_bf16 v[84:87], a[240:243], a[32:35], v[84:87]
    v_mfma_f32_16x16x32_bf16 v[88:91], a[244:247], a[32:35], v[88:91]
    ds_read_b128 v[44:47], v6 offset:704
    v_mfma_f32_16x16x32_bf16 v[92:95], a[248:251], a[32:35], v[92:95]
    ds_read_b128 v[48:51], v6 offset:1088
    v_mfma_f32_16x16x32_bf16 v[124:127], a[248:251], a[36:39], v[124:127]
    v_mfma_f32_16x16x32_bf16 v[120:123], a[244:247], a[36:39], v[120:123]
    ds_read_b128 v[52:55], v6 offset:1216
    v_mfma_f32_16x16x32_bf16 v[116:119], a[240:243], a[36:39], v[116:119]
    v_mfma_f32_16x16x32_bf16 v[112:115], a[236:239], a[36:39], v[112:115]
    ds_read_b64_tr_b16 a[0:1], v8 offset:17440
    v_mfma_f32_16x16x32_bf16 v[108:111], a[232:235], a[36:39], v[108:111]
    ds_read_b64_tr_b16 a[2:3], v8 offset:17952
    v_mfma_f32_16x16x32_bf16 v[104:107], a[228:231], a[36:39], v[104:107]
    s_add_u32 m0, s30, 68384
    v_mfma_f32_16x16x32_bf16 v[100:103], a[224:227], a[36:39], v[100:103]
    buffer_load_dwordx4 v3, s[16:19], s35 offen offset:256 nt lds
    v_mfma_f32_16x16x32_bf16 v[96:99], a[220:223], a[36:39], v[96:99]
    ds_read_b64_tr_b16 a[4:5], v8 offset:17448
    v_mfma_f32_16x16x32_bf16 v[128:131], a[220:223], a[40:43], v[128:131]
    v_mfma_f32_16x16x32_bf16 v[132:135], a[224:227], a[40:43], v[132:135]
    ds_read_b64_tr_b16 a[6:7], v8 offset:17960
    v_mfma_f32_16x16x32_bf16 v[136:139], a[228:231], a[40:43], v[136:139]
    ds_read_b64_tr_b16 a[8:9], v8 offset:17504
    v_mfma_f32_16x16x32_bf16 v[140:143], a[232:235], a[40:43], v[140:143]
    v_mfma_f32_16x16x32_bf16 v[144:147], a[236:239], a[40:43], v[144:147]
    ds_read_b64_tr_b16 a[10:11], v8 offset:18016
    v_mfma_f32_16x16x32_bf16 v[148:151], a[240:243], a[40:43], v[148:151]
    v_mfma_f32_16x16x32_bf16 v[152:155], a[244:247], a[40:43], v[152:155]
    ds_read_b64_tr_b16 a[12:13], v8 offset:17512
    v_mfma_f32_16x16x32_bf16 v[156:159], a[248:251], a[40:43], v[156:159]
    ds_read_b64_tr_b16 a[14:15], v8 offset:18024
    v_mfma_f32_16x16x32_bf16 v[188:191], a[248:251], a[44:47], v[188:191]
    s_add_u32 m0, s30, 69184
    v_mfma_f32_16x16x32_bf16 v[184:187], a[244:247], a[44:47], v[184:187]
    buffer_load_dwordx4 v3, s[16:19], s35 offen offset:512 nt lds
    v_mfma_f32_16x16x32_bf16 v[180:183], a[240:243], a[44:47], v[180:183]
    ds_read_b64_tr_b16 a[16:17], v8 offset:17568
    v_mfma_f32_16x16x32_bf16 v[176:179], a[236:239], a[44:47], v[176:179]
    v_mfma_f32_16x16x32_bf16 v[172:175], a[232:235], a[44:47], v[172:175]
    ds_read_b64_tr_b16 a[18:19], v8 offset:18080
    v_mfma_f32_16x16x32_bf16 v[168:171], a[228:231], a[44:47], v[168:171]
    ds_read_b64_tr_b16 a[20:21], v8 offset:17576
    v_mfma_f32_16x16x32_bf16 v[164:167], a[224:227], a[44:47], v[164:167]
    v_mfma_f32_16x16x32_bf16 v[160:163], a[220:223], a[44:47], v[160:163]
    ds_read_b64_tr_b16 a[22:23], v8 offset:18088
    v_mfma_f32_16x16x32_bf16 v[192:195], a[220:223], a[48:51], v[192:195]
    v_mfma_f32_16x16x32_bf16 v[196:199], a[224:227], a[48:51], v[196:199]
    ds_read_b64_tr_b16 a[24:25], v8 offset:17632
    v_mfma_f32_16x16x32_bf16 v[200:203], a[228:231], a[48:51], v[200:203]
    ds_read_b64_tr_b16 a[26:27], v8 offset:18144
    v_mfma_f32_16x16x32_bf16 v[204:207], a[232:235], a[48:51], v[204:207]
    s_add_u32 m0, s30, 69984
    v_mfma_f32_16x16x32_bf16 v[208:211], a[236:239], a[48:51], v[208:211]
    buffer_load_dwordx4 v3, s[16:19], s35 offen offset:768 nt lds
    v_mfma_f32_16x16x32_bf16 v[212:215], a[240:243], a[48:51], v[212:215]
    ds_read_b64_tr_b16 a[28:29], v8 offset:17640
    v_mfma_f32_16x16x32_bf16 v[216:219], a[244:247], a[48:51], v[216:219]
    v_mfma_f32_16x16x32_bf16 v[220:223], a[248:251], a[48:51], v[220:223]
    ds_read_b64_tr_b16 a[30:31], v8 offset:18152
    v_mfma_f32_16x16x32_bf16 v[252:255], a[248:251], a[52:55], v[252:255]
    v_mfma_f32_16x16x32_bf16 v[248:251], a[244:247], a[52:55], v[248:251]
    v_mfma_f32_16x16x32_bf16 v[244:247], a[240:243], a[52:55], v[244:247]
    v_mfma_f32_16x16x32_bf16 v[240:243], a[236:239], a[52:55], v[240:243]
    v_mfma_f32_16x16x32_bf16 v[236:239], a[232:235], a[52:55], v[236:239]
    v_mfma_f32_16x16x32_bf16 v[232:235], a[228:231], a[52:55], v[232:235]
    v_mfma_f32_16x16x32_bf16 v[228:231], a[224:227], a[52:55], v[228:231]
    v_mfma_f32_16x16x32_bf16 v[224:227], a[220:223], a[52:55], v[224:227]
    s_waitcnt vmcnt(63) lgkmcnt(0)
    s_barrier
    v_mfma_f32_16x16x32_bf16 v[64:67], a[128:131], a[160:163], v[64:67]
    v_mfma_f32_16x16x32_bf16 v[68:71], a[132:135], a[160:163], v[68:71]
    s_add_u32 m0, s30, 84480
    s_mul_i32 s35, s80, 2
    v_mfma_f32_16x16x32_bf16 v[72:75], a[136:139], a[160:163], v[72:75]
    s_add_u32 s35, s35, s101
    s_and_b32 s35, s35, 0x1e000
    s_or_b32 s35, s35, s75
    v_mfma_f32_16x16x32_bf16 v[76:79], a[140:143], a[160:163], v[76:79]
    buffer_load_dwordx4 v3, s[20:23], s35 offen offset:0 nt lds
    v_mfma_f32_16x16x32_bf16 v[80:83], a[144:147], a[160:163], v[80:83]
    v_lshlrev_b32 v56, 14, v0
    v_mfma_f32_16x16x32_bf16 v[84:87], a[148:151], a[160:163], v[84:87]
    s_getpc_b64 s[76:77]
CT_B:
    s_add_u32 s76, s76, K1_ATT-CT_B
    s_addc_u32 s77, s77, 0
    v_mfma_f32_16x16x32_bf16 v[88:91], a[152:155], a[160:163], v[88:91]
    s_mov_b32 s78, K1_AEXIT-K1_ATT
    s_lshl_b32 s36, s3, 2
    s_add_u32 s36, s36, s43
    v_mfma_f32_16x16x32_bf16 v[92:95], a[156:159], a[160:163], v[92:95]
    s_lshl_b32 s36, s36, 7
    v_mfma_f32_16x16x32_bf16 v[124:127], a[156:159], a[164:167], v[124:127]
    buffer_load_dword v13, v56, s[76:79], s36 offen
    v_mfma_f32_16x16x32_bf16 v[120:123], a[152:155], a[164:167], v[120:123]
    v_mfma_f32_16x16x32_bf16 v[116:119], a[148:151], a[164:167], v[116:119]
    v_mfma_f32_16x16x32_bf16 v[112:115], a[144:147], a[164:167], v[112:115]
    v_mfma_f32_16x16x32_bf16 v[108:111], a[140:143], a[164:167], v[108:111]
    v_mfma_f32_16x16x32_bf16 v[104:107], a[136:139], a[164:167], v[104:107]
    s_add_u32 m0, s30, 85280
    v_mfma_f32_16x16x32_bf16 v[100:103], a[132:135], a[164:167], v[100:103]
    buffer_load_dwordx4 v3, s[20:23], s35 offen offset:256 nt lds
    v_mfma_f32_16x16x32_bf16 v[96:99], a[128:131], a[164:167], v[96:99]
    v_mfma_f32_16x16x32_bf16 v[128:131], a[128:131], a[168:171], v[128:131]
    v_mfma_f32_16x16x32_bf16 v[132:135], a[132:135], a[168:171], v[132:135]
    v_mfma_f32_16x16x32_bf16 v[136:139], a[136:139], a[168:171], v[136:139]
    v_mfma_f32_16x16x32_bf16 v[140:143], a[140:143], a[168:171], v[140:143]
    v_mfma_f32_16x16x32_bf16 v[144:147], a[144:147], a[168:171], v[144:147]
    v_mfma_f32_16x16x32_bf16 v[148:151], a[148:151], a[168:171], v[148:151]
    v_mfma_f32_16x16x32_bf16 v[152:155], a[152:155], a[168:171], v[152:155]
    v_mfma_f32_16x16x32_bf16 v[156:159], a[156:159], a[168:171], v[156:159]
    v_mfma_f32_16x16x32_bf16 v[188:191], a[156:159], a[172:175], v[188:191]
    s_add_u32 m0, s30, 86080
    v_mfma_f32_16x16x32_bf16 v[184:187], a[152:155], a[172:175], v[184:187]
    buffer_load_dwordx4 v3, s[20:23], s35 offen offset:512 nt lds
    v_mfma_f32_16x16x32_bf16 v[180:183], a[148:151], a[172:175], v[180:183]
    v_mfma_f32_16x16x32_bf16 v[176:179], a[144:147], a[172:175], v[176:179]
    v_mfma_f32_16x16x32_bf16 v[172:175], a[140:143], a[172:175], v[172:175]
    v_mfma_f32_16x16x32_bf16 v[168:171], a[136:139], a[172:175], v[168:171]
    v_mfma_f32_16x16x32_bf16 v[164:167], a[132:135], a[172:175], v[164:167]
    v_mfma_f32_16x16x32_bf16 v[160:163], a[128:131], a[172:175], v[160:163]
    v_mfma_f32_16x16x32_bf16 v[192:195], a[128:131], a[176:179], v[192:195]
    v_mfma_f32_16x16x32_bf16 v[196:199], a[132:135], a[176:179], v[196:199]
    v_mfma_f32_16x16x32_bf16 v[200:203], a[136:139], a[176:179], v[200:203]
    v_mfma_f32_16x16x32_bf16 v[204:207], a[140:143], a[176:179], v[204:207]
    s_add_u32 m0, s30, 86880
    v_mfma_f32_16x16x32_bf16 v[208:211], a[144:147], a[176:179], v[208:211]
    buffer_load_dwordx4 v3, s[20:23], s35 offen offset:768 nt lds
    v_mfma_f32_16x16x32_bf16 v[212:215], a[148:151], a[176:179], v[212:215]
    v_mfma_f32_16x16x32_bf16 v[216:219], a[152:155], a[176:179], v[216:219]
    v_mfma_f32_16x16x32_bf16 v[220:223], a[156:159], a[176:179], v[220:223]
    v_mfma_f32_16x16x32_bf16 v[252:255], a[156:159], a[180:183], v[252:255]
    v_mfma_f32_16x16x32_bf16 v[248:251], a[152:155], a[180:183], v[248:251]
    v_mfma_f32_16x16x32_bf16 v[244:247], a[148:151], a[180:183], v[244:247]
    v_mfma_f32_16x16x32_bf16 v[240:243], a[144:147], a[180:183], v[240:243]
    v_mfma_f32_16x16x32_bf16 v[236:239], a[140:143], a[180:183], v[236:239]
    v_mfma_f32_16x16x32_bf16 v[232:235], a[136:139], a[180:183], v[232:235]
    v_mfma_f32_16x16x32_bf16 v[228:231], a[132:135], a[180:183], v[228:231]
    v_mfma_f32_16x16x32_bf16 v[224:227], a[128:131], a[180:183], v[224:227]
    s_waitcnt vmcnt(63) lgkmcnt(0)
    s_barrier
    v_mfma_f32_16x16x32_bf16 v[64:67], a[64:67], a[96:99], v[64:67]
    v_and_b32 v29, 1, v0
    v_mul_u32_u24 v29, 0xaaaa, v29
    v_mfma_f32_16x16x32_bf16 v[68:71], a[68:71], a[96:99], v[68:71]
    s_add_u32 m0, s30, 101376
    s_mul_i32 s35, s80, 3
    v_add_u32 v29, 0x4444, v29
    v_mfma_f32_16x16x32_bf16 v[72:75], a[72:75], a[96:99], v[72:75]
    s_add_u32 s35, s35, s101
    s_and_b32 s35, s35, 0x1e000
    s_or_b32 s35, s35, s75
    v_mfma_f32_16x16x32_bf16 v[76:79], a[76:79], a[96:99], v[76:79]
    buffer_load_dwordx4 v3, s[16:19], s35 offen offset:0 nt lds
    v_mfma_f32_16x16x32_bf16 v[80:83], a[80:83], a[96:99], v[80:83]
    v_mfma_f32_16x16x32_bf16 v[84:87], a[84:87], a[96:99], v[84:87]
    v_mfma_f32_16x16x32_bf16 v[88:91], a[88:91], a[96:99], v[88:91]
    v_mfma_f32_16x16x32_bf16 v[92:95], a[92:95], a[96:99], v[92:95]
    v_mfma_f32_16x16x32_bf16 v[124:127], a[92:95], a[100:103], v[124:127]
    v_mfma_f32_16x16x32_bf16 v[120:123], a[88:91], a[100:103], v[120:123]
    v_mfma_f32_16x16x32_bf16 v[116:119], a[84:87], a[100:103], v[116:119]
    v_mfma_f32_16x16x32_bf16 v[112:115], a[80:83], a[100:103], v[112:115]
    v_mfma_f32_16x16x32_bf16 v[108:111], a[76:79], a[100:103], v[108:111]
    v_mfma_f32_16x16x32_bf16 v[104:107], a[72:75], a[100:103], v[104:107]
    s_add_u32 m0, s30, 102176
    v_mfma_f32_16x16x32_bf16 v[100:103], a[68:71], a[100:103], v[100:103]
    buffer_load_dwordx4 v3, s[16:19], s35 offen offset:256 nt lds
    v_mfma_f32_16x16x32_bf16 v[96:99], a[64:67], a[100:103], v[96:99]
    v_mfma_f32_16x16x32_bf16 v[128:131], a[64:67], a[104:107], v[128:131]
    v_mfma_f32_16x16x32_bf16 v[132:135], a[68:71], a[104:107], v[132:135]
    v_mfma_f32_16x16x32_bf16 v[136:139], a[72:75], a[104:107], v[136:139]
    v_mfma_f32_16x16x32_bf16 v[140:143], a[76:79], a[104:107], v[140:143]
    v_mfma_f32_16x16x32_bf16 v[144:147], a[80:83], a[104:107], v[144:147]
    v_mfma_f32_16x16x32_bf16 v[148:151], a[84:87], a[104:107], v[148:151]
    v_mfma_f32_16x16x32_bf16 v[152:155], a[88:91], a[104:107], v[152:155]
    v_mfma_f32_16x16x32_bf16 v[156:159], a[92:95], a[104:107], v[156:159]
    v_mfma_f32_16x16x32_bf16 v[188:191], a[92:95], a[108:111], v[188:191]
    s_add_u32 m0, s30, 102976
    v_mfma_f32_16x16x32_bf16 v[184:187], a[88:91], a[108:111], v[184:187]
    buffer_load_dwordx4 v3, s[16:19], s35 offen offset:512 nt lds
    v_mfma_f32_16x16x32_bf16 v[180:183], a[84:87], a[108:111], v[180:183]
    v_mfma_f32_16x16x32_bf16 v[176:179], a[80:83], a[108:111], v[176:179]
    v_mfma_f32_16x16x32_bf16 v[172:175], a[76:79], a[108:111], v[172:175]
    v_mfma_f32_16x16x32_bf16 v[168:171], a[72:75], a[108:111], v[168:171]
    v_mfma_f32_16x16x32_bf16 v[164:167], a[68:71], a[108:111], v[164:167]
    v_mfma_f32_16x16x32_bf16 v[160:163], a[64:67], a[108:111], v[160:163]
    v_mfma_f32_16x16x32_bf16 v[192:195], a[64:67], a[112:115], v[192:195]
    v_mfma_f32_16x16x32_bf16 v[196:199], a[68:71], a[112:115], v[196:199]
    v_mfma_f32_16x16x32_bf16 v[200:203], a[72:75], a[112:115], v[200:203]
    v_mfma_f32_16x16x32_bf16 v[204:207], a[76:79], a[112:115], v[204:207]
    s_add_u32 m0, s30, 103776
    v_mfma_f32_16x16x32_bf16 v[208:211], a[80:83], a[112:115], v[208:211]
    buffer_load_dwordx4 v3, s[16:19], s35 offen offset:768 nt lds
    v_mfma_f32_16x16x32_bf16 v[212:215], a[84:87], a[112:115], v[212:215]
    v_mfma_f32_16x16x32_bf16 v[216:219], a[88:91], a[112:115], v[216:219]
    v_mfma_f32_16x16x32_bf16 v[220:223], a[92:95], a[112:115], v[220:223]
    v_mfma_f32_16x16x32_bf16 v[252:255], a[92:95], a[116:119], v[252:255]
    v_mfma_f32_16x16x32_bf16 v[248:251], a[88:91], a[116:119], v[248:251]
    v_mfma_f32_16x16x32_bf16 v[244:247], a[84:87], a[116:119], v[244:247]
    v_mfma_f32_16x16x32_bf16 v[240:243], a[80:83], a[116:119], v[240:243]
    v_mfma_f32_16x16x32_bf16 v[236:239], a[76:79], a[116:119], v[236:239]
    v_mfma_f32_16x16x32_bf16 v[232:235], a[72:75], a[116:119], v[232:235]
    v_mfma_f32_16x16x32_bf16 v[228:231], a[68:71], a[116:119], v[228:231]
    v_mfma_f32_16x16x32_bf16 v[224:227], a[64:67], a[116:119], v[224:227]
    s_waitcnt vmcnt(21) lgkmcnt(0)
    s_barrier
    v_mfma_f32_16x16x32_bf16 v[128:131], a[0:3], v[40:43], v[128:131]
    s_add_u32 m0, s30, 118272
    ds_read_b128 a[220:223], v9 offset:0
    v_mfma_f32_16x16x32_bf16 v[132:135], a[4:7], v[40:43], v[132:135]
    s_mul_i32 s35, s80, 3
    s_add_u32 s35, s35, s101
    ds_read_b128 a[224:227], v9 offset:64
    v_mfma_f32_16x16x32_bf16 v[136:139], a[8:11], v[40:43], v[136:139]
    s_and_b32 s35, s35, 0x1e000
    s_or_b32 s35, s35, s75
    ds_read_b128 a[228:231], v9 offset:128
    v_mfma_f32_16x16x32_bf16 v[140:143], a[12:15], v[40:43], v[140:143]
    buffer_load_dwordx4 v3, s[20:23], s35 offen offset:0 nt lds
    v_mfma_f32_16x16x32_bf16 v[144:147], a[16:19], v[40:43], v[144:147]
    v_mfma_f32_16x16x32_bf16 v[148:151], a[20:23], v[40:43], v[148:151]
    ds_read_b128 a[232:235], v9 offset:192
    v_mfma_f32_16x16x32_bf16 v[152:155], a[24:27], v[40:43], v[152:155]
    ds_read_b128 a[236:239], v9 offset:512
    v_mfma_f32_16x16x32_bf16 v[156:159], a[28:31], v[40:43], v[156:159]
    ds_read_b128 a[240:243], v9 offset:576
    v_mfma_f32_16x16x32_bf16 v[188:191], a[28:31], v[44:47], v[188:191]
    v_mfma_f32_16x16x32_bf16 v[184:187], a[24:27], v[44:47], v[184:187]
    ds_read_b128 a[244:247], v9 offset:640
    v_mfma_f32_16x16x32_bf16 v[180:183], a[20:23], v[44:47], v[180:183]
    ds_read_b128 a[248:251], v9 offset:704
    v_mfma_f32_16x16x32_bf16 v[176:179], a[16:19], v[44:47], v[176:179]
    v_mfma_f32_16x16x32_bf16 v[172:175], a[12:15], v[44:47], v[172:175]
    v_mfma_f32_16x16x32_bf16 v[168:171], a[8:11], v[44:47], v[168:171]
    s_add_u32 m0, s30, 119072
    v_mul_f32 v128, s38, v128
    v_mul_f32 v129, s38, v129
    v_mfma_f32_16x16x32_bf16 v[164:167], a[4:7], v[44:47], v[164:167]
    buffer_load_dwordx4 v3, s[20:23], s35 offen offset:256 nt lds
    v_mfma_f32_16x16x32_bf16 v[160:163], a[0:3], v[44:47], v[160:163]
    v_cvt_pk_bf16_f32 v128, v128, v129
    v_mul_f32 v130, s38, v130
    v_mfma_f32_16x16x32_bf16 v[64:67], a[0:3], v[32:35], v[64:67]
    v_mul_f32 v131, s38, v131
    v_cvt_pk_bf16_f32 v129, v130, v131
    v_mfma_f32_16x16x32_bf16 v[68:71], a[4:7], v[32:35], v[68:71]
    v_mul_f32 v132, s38, v132
    v_mul_f32 v133, s38, v133
    v_mfma_f32_16x16x32_bf16 v[72:75], a[8:11], v[32:35], v[72:75]
    v_cvt_pk_bf16_f32 v130, v132, v133
    v_mul_f32 v134, s38, v134
    v_mfma_f32_16x16x32_bf16 v[76:79], a[12:15], v[32:35], v[76:79]
    v_mul_f32 v135, s38, v135
    v_cvt_pk_bf16_f32 v131, v134, v135
    v_mfma_f32_16x16x32_bf16 v[80:83], a[16:19], v[32:35], v[80:83]
    v_mul_f32 v136, s38, v136
    v_mul_f32 v137, s38, v137
    v_mfma_f32_16x16x32_bf16 v[84:87], a[20:23], v[32:35], v[84:87]
    v_cvt_pk_bf16_f32 v132, v136, v137
    v_mul_f32 v138, s38, v138
    v_mfma_f32_16x16x32_bf16 v[88:91], a[24:27], v[32:35], v[88:91]
    v_mul_f32 v139, s38, v139
    v_cvt_pk_bf16_f32 v133, v138, v139
    v_mfma_f32_16x16x32_bf16 v[92:95], a[28:31], v[32:35], v[92:95]
    v_mul_f32 v140, s38, v140
    v_mul_f32 v141, s38, v141
    v_mfma_f32_16x16x32_bf16 v[124:127], a[28:31], v[36:39], v[124:127]
    s_add_u32 m0, s30, 119872
    v_cvt_pk_bf16_f32 v134, v140, v141
    v_mul_f32 v142, s38, v142
    v_mfma_f32_16x16x32_bf16 v[120:123], a[24:27], v[36:39], v[120:123]
    buffer_load_dwordx4 v3, s[20:23], s35 offen offset:512 nt lds
    v_mfma_f32_16x16x32_bf16 v[116:119], a[20:23], v[36:39], v[116:119]
    v_mul_f32 v143, s38, v143
    v_cvt_pk_bf16_f32 v135, v142, v143
    v_mfma_f32_16x16x32_bf16 v[112:115], a[16:19], v[36:39], v[112:115]
    v_mul_f32 v144, s38, v144
    v_mul_f32 v145, s38, v145
    v_mfma_f32_16x16x32_bf16 v[108:111], a[12:15], v[36:39], v[108:111]
    v_cvt_pk_bf16_f32 v136, v144, v145
    v_mul_f32 v146, s38, v146
    v_mfma_f32_16x16x32_bf16 v[104:107], a[8:11], v[36:39], v[104:107]
    v_mul_f32 v147, s38, v147
    v_cvt_pk_bf16_f32 v137, v146, v147
    v_mfma_f32_16x16x32_bf16 v[100:103], a[4:7], v[36:39], v[100:103]
    v_mul_f32 v148, s38, v148
    v_mul_f32 v149, s38, v149
    v_mfma_f32_16x16x32_bf16 v[96:99], a[0:3], v[36:39], v[96:99]
    v_cvt_pk_bf16_f32 v138, v148, v149
    v_mul_f32 v150, s38, v150
    v_mfma_f32_16x16x32_bf16 v[192:195], a[0:3], v[48:51], v[192:195]
    v_mul_f32 v151, s38, v151
    v_cvt_pk_bf16_f32 v139, v150, v151
    v_mfma_f32_16x16x32_bf16 v[196:199], a[4:7], v[48:51], v[196:199]
    v_mul_f32 v152, s38, v152
    v_mul_f32 v153, s38, v153
    v_mfma_f32_16x16x32_bf16 v[200:203], a[8:11], v[48:51], v[200:203]
    v_cvt_pk_bf16_f32 v140, v152, v153
    v_mul_f32 v154, s38, v154
    v_mfma_f32_16x16x32_bf16 v[204:207], a[12:15], v[48:51], v[204:207]
    s_add_u32 m0, s30, 120672
    v_mul_f32 v155, s38, v155
    v_cvt_pk_bf16_f32 v141, v154, v155
    v_mfma_f32_16x16x32_bf16 v[208:211], a[16:19], v[48:51], v[208:211]
    buffer_load_dwordx4 v3, s[20:23], s35 offen offset:768 nt lds
    v_mfma_f32_16x16x32_bf16 v[212:215], a[20:23], v[48:51], v[212:215]
    v_mul_f32 v156, s38, v156
    v_mul_f32 v157, s38, v157
    v_mfma_f32_16x16x32_bf16 v[216:219], a[24:27], v[48:51], v[216:219]
    v_cvt_pk_bf16_f32 v142, v156, v157
    v_mul_f32 v158, s38, v158
    v_mfma_f32_16x16x32_bf16 v[220:223], a[28:31], v[48:51], v[220:223]
    v_mul_f32 v159, s38, v159
    v_cvt_pk_bf16_f32 v143, v158, v159
    v_mfma_f32_16x16x32_bf16 v[252:255], a[28:31], v[52:55], v[252:255]
    v_mul_f32 v160, s38, v160
    v_mul_f32 v161, s38, v161
    v_mfma_f32_16x16x32_bf16 v[248:251], a[24:27], v[52:55], v[248:251]
    v_cvt_pk_bf16_f32 v160, v160, v161
    v_mul_f32 v162, s38, v162
    v_mfma_f32_16x16x32_bf16 v[244:247], a[20:23], v[52:55], v[244:247]
    v_mul_f32 v163, s38, v163
    v_cvt_pk_bf16_f32 v161, v162, v163
    v_mfma_f32_16x16x32_bf16 v[240:243], a[16:19], v[52:55], v[240:243]
    v_mul_f32 v164, s38, v164
    v_mul_f32 v165, s38, v165
    v_mfma_f32_16x16x32_bf16 v[236:239], a[12:15], v[52:55], v[236:239]
    v_cvt_pk_bf16_f32 v162, v164, v165
    v_mul_f32 v166, s38, v166
    v_mfma_f32_16x16x32_bf16 v[232:235], a[8:11], v[52:55], v[232:235]
    v_mul_f32 v167, s38, v167
    v_cvt_pk_bf16_f32 v163, v166, v167
    v_mfma_f32_16x16x32_bf16 v[228:231], a[4:7], v[52:55], v[228:231]
    v_mul_f32 v168, s38, v168
    v_mul_f32 v169, s38, v169
    v_mfma_f32_16x16x32_bf16 v[224:227], a[0:3], v[52:55], v[224:227]
    v_cvt_pk_bf16_f32 v164, v168, v169
    v_mul_f32 v170, s38, v170
    v_mul_f32 v171, s38, v171
    v_cvt_pk_bf16_f32 v165, v170, v171
    s_lshl_b32 s32, s80, 2
    s_add_u32 s32, s32, s101
    s_add_u32 s32, s32, 512
    s_sub_u32 s62, s80, 512
    s_add_u32 s33, s30, 19008
    s_mov_b32 s88, 3
    s_mov_b32 s84, 33792
    v_add_u32 v11, 33792, v9
    s_xor_b32 s61, s61, 512
    s_mov_b32 s7, 0
    s_mov_b32 s26, 2168832
    s_mul_i32 s34, s75, 6
    s_mov_b32 s86, 16384
    s_cmp_eq_u32 s37, 0
    s_cselect_b32 s83, 5, 1
    s_nop 0
    v_pk_mul_f32 v[172:173], v[172:173], s[38:39]
    v_cvt_pk_bf16_f32 v166, v172, v173
    v_pk_mul_f32 v[174:175], v[174:175], s[38:39]
    v_cvt_pk_bf16_f32 v167, v174, v175
    v_pk_mul_f32 v[176:177], v[176:177], s[38:39]
    v_cvt_pk_bf16_f32 v168, v176, v177
    v_pk_mul_f32 v[178:179], v[178:179], s[38:39]
    v_cvt_pk_bf16_f32 v169, v178, v179
    v_pk_mul_f32 v[180:181], v[180:181], s[38:39]
    v_cvt_pk_bf16_f32 v170, v180, v181
    v_pk_mul_f32 v[182:183], v[182:183], s[38:39]
    v_cvt_pk_bf16_f32 v171, v182, v183
    v_pk_mul_f32 v[184:185], v[184:185], s[38:39]
    v_cvt_pk_bf16_f32 v172, v184, v185
    v_pk_mul_f32 v[186:187], v[186:187], s[38:39]
    v_cvt_pk_bf16_f32 v173, v186, v187
    v_pk_mul_f32 v[188:189], v[188:189], s[38:39]
    v_cvt_pk_bf16_f32 v174, v188, v189
    v_pk_mul_f32 v[190:191], v[190:191], s[38:39]
    v_cvt_pk_bf16_f32 v175, v190, v191
    ds_read_b64_tr_b16 v[144:145], v10 offset:16896
    ds_read_b64_tr_b16 v[146:147], v10 offset:17408
    v_pk_mul_f32 v[64:65], v[64:65], s[38:39]
    v_cvt_pk_bf16_f32 v64, v64, v65
    v_pk_mul_f32 v[66:67], v[66:67], s[38:39]
    v_cvt_pk_bf16_f32 v65, v66, v67
    v_pk_mul_f32 v[68:69], v[68:69], s[38:39]
    v_cvt_pk_bf16_f32 v66, v68, v69
    v_pk_mul_f32 v[70:71], v[70:71], s[38:39]
    v_cvt_pk_bf16_f32 v67, v70, v71
    v_pk_mul_f32 v[72:73], v[72:73], s[38:39]
    v_cvt_pk_bf16_f32 v68, v72, v73
    v_pk_mul_f32 v[74:75], v[74:75], s[38:39]
    v_cvt_pk_bf16_f32 v69, v74, v75
    ds_read_b64_tr_b16 v[148:149], v10 offset:16928
    ds_read_b64_tr_b16 v[150:151], v10 offset:17440
    v_pk_mul_f32 v[76:77], v[76:77], s[38:39]
    v_cvt_pk_bf16_f32 v70, v76, v77
    v_pk_mul_f32 v[78:79], v[78:79], s[38:39]
    v_cvt_pk_bf16_f32 v71, v78, v79
    v_pk_mul_f32 v[80:81], v[80:81], s[38:39]
    v_cvt_pk_bf16_f32 v72, v80, v81
    v_pk_mul_f32 v[82:83], v[82:83], s[38:39]
    v_cvt_pk_bf16_f32 v73, v82, v83
    v_pk_mul_f32 v[84:85], v[84:85], s[38:39]
    v_cvt_pk_bf16_f32 v74, v84, v85
    v_pk_mul_f32 v[86:87], v[86:87], s[38:39]
    v_cvt_pk_bf16_f32 v75, v86, v87
    ds_read_b64_tr_b16 v[152:153], v10 offset:16960
    ds_read_b64_tr_b16 v[154:155], v10 offset:17472
    v_pk_mul_f32 v[88:89], v[88:89], s[38:39]
    v_cvt_pk_bf16_f32 v76, v88, v89
    v_pk_mul_f32 v[90:91], v[90:91], s[38:39]
    v_cvt_pk_bf16_f32 v77, v90, v91
    v_pk_mul_f32 v[92:93], v[92:93], s[38:39]
    v_cvt_pk_bf16_f32 v78, v92, v93
    v_pk_mul_f32 v[94:95], v[94:95], s[38:39]
    v_cvt_pk_bf16_f32 v79, v94, v95
    v_pk_mul_f32 v[96:97], v[96:97], s[38:39]
    v_cvt_pk_bf16_f32 v96, v96, v97
    v_pk_mul_f32 v[98:99], v[98:99], s[38:39]
    v_cvt_pk_bf16_f32 v97, v98, v99
    ds_read_b64_tr_b16 v[156:157], v10 offset:16992
    ds_read_b64_tr_b16 v[158:159], v10 offset:17504
    v_pk_mul_f32 v[100:101], v[100:101], s[38:39]
    v_cvt_pk_bf16_f32 v98, v100, v101
    v_pk_mul_f32 v[102:103], v[102:103], s[38:39]
    v_cvt_pk_bf16_f32 v99, v102, v103
    v_pk_mul_f32 v[104:105], v[104:105], s[38:39]
    v_cvt_pk_bf16_f32 v100, v104, v105
    v_pk_mul_f32 v[106:107], v[106:107], s[38:39]
    v_cvt_pk_bf16_f32 v101, v106, v107
    v_pk_mul_f32 v[108:109], v[108:109], s[38:39]
    v_cvt_pk_bf16_f32 v102, v108, v109
    v_pk_mul_f32 v[110:111], v[110:111], s[38:39]
    v_cvt_pk_bf16_f32 v103, v110, v111
    ds_read_b64_tr_b16 v[176:177], v10 offset:17024
    ds_read_b64_tr_b16 v[178:179], v10 offset:17536
    v_pk_mul_f32 v[112:113], v[112:113], s[38:39]
    v_cvt_pk_bf16_f32 v104, v112, v113
    v_pk_mul_f32 v[114:115], v[114:115], s[38:39]
    v_cvt_pk_bf16_f32 v105, v114, v115
    v_pk_mul_f32 v[116:117], v[116:117], s[38:39]
    v_cvt_pk_bf16_f32 v106, v116, v117
    v_pk_mul_f32 v[118:119], v[118:119], s[38:39]
    v_cvt_pk_bf16_f32 v107, v118, v119
    v_pk_mul_f32 v[120:121], v[120:121], s[38:39]
    v_cvt_pk_bf16_f32 v108, v120, v121
    v_pk_mul_f32 v[122:123], v[122:123], s[38:39]
    v_cvt_pk_bf16_f32 v109, v122, v123
    ds_read_b64_tr_b16 v[180:181], v10 offset:17056
    ds_read_b64_tr_b16 v[182:183], v10 offset:17568
    v_pk_mul_f32 v[124:125], v[124:125], s[38:39]
    v_cvt_pk_bf16_f32 v110, v124, v125
    v_pk_mul_f32 v[126:127], v[126:127], s[38:39]
    v_cvt_pk_bf16_f32 v111, v126, v127
    v_pk_mul_f32 v[192:193], v[192:193], s[38:39]
    v_cvt_pk_bf16_f32 v192, v192, v193
    v_pk_mul_f32 v[194:195], v[194:195], s[38:39]
    v_cvt_pk_bf16_f32 v193, v194, v195
    v_pk_mul_f32 v[196:197], v[196:197], s[38:39]
    v_cvt_pk_bf16_f32 v194, v196, v197
    v_pk_mul_f32 v[198:199], v[198:199], s[38:39]
    v_cvt_pk_bf16_f32 v195, v198, v199
    v_pk_mul_f32 v[200:201], v[200:201], s[38:39]
    v_cvt_pk_bf16_f32 v196, v200, v201
    v_pk_mul_f32 v[202:203], v[202:203], s[38:39]
    v_cvt_pk_bf16_f32 v197, v202, v203
    v_pk_mul_f32 v[204:205], v[204:205], s[38:39]
    v_cvt_pk_bf16_f32 v198, v204, v205
    v_pk_mul_f32 v[206:207], v[206:207], s[38:39]
    v_cvt_pk_bf16_f32 v199, v206, v207
    v_pk_mul_f32 v[208:209], v[208:209], s[38:39]
    v_cvt_pk_bf16_f32 v200, v208, v209
    v_pk_mul_f32 v[210:211], v[210:211], s[38:39]
    v_cvt_pk_bf16_f32 v201, v210, v211
    v_pk_mul_f32 v[212:213], v[212:213], s[38:39]
    v_cvt_pk_bf16_f32 v202, v212, v213
    v_pk_mul_f32 v[214:215], v[214:215], s[38:39]
    v_cvt_pk_bf16_f32 v203, v214, v215
    v_pk_mul_f32 v[216:217], v[216:217], s[38:39]
    v_cvt_pk_bf16_f32 v204, v216, v217
    v_pk_mul_f32 v[218:219], v[218:219], s[38:39]
    v_cvt_pk_bf16_f32 v205, v218, v219
    v_pk_mul_f32 v[220:221], v[220:221], s[38:39]
    v_cvt_pk_bf16_f32 v206, v220, v221
    v_pk_mul_f32 v[222:223], v[222:223], s[38:39]
    v_cvt_pk_bf16_f32 v207, v222, v223
    v_pk_mul_f32 v[224:225], v[224:225], s[38:39]
    v_cvt_pk_bf16_f32 v224, v224, v225
    v_pk_mul_f32 v[226:227], v[226:227], s[38:39]
    v_cvt_pk_bf16_f32 v225, v226, v227
    v_pk_mul_f32 v[228:229], v[228:229], s[38:39]
    v_cvt_pk_bf16_f32 v226, v228, v229
    v_pk_mul_f32 v[230:231], v[230:231], s[38:39]
    v_cvt_pk_bf16_f32 v227, v230, v231
    v_pk_mul_f32 v[232:233], v[232:233], s[38:39]
    v_cvt_pk_bf16_f32 v228, v232, v233
    v_pk_mul_f32 v[234:235], v[234:235], s[38:39]
    v_cvt_pk_bf16_f32 v229, v234, v235
    v_pk_mul_f32 v[236:237], v[236:237], s[38:39]
    v_cvt_pk_bf16_f32 v230, v236, v237
    v_pk_mul_f32 v[238:239], v[238:239], s[38:39]
    v_cvt_pk_bf16_f32 v231, v238, v239
    v_pk_mul_f32 v[240:241], v[240:241], s[38:39]
    v_cvt_pk_bf16_f32 v232, v240, v241
    v_pk_mul_f32 v[242:243], v[242:243], s[38:39]
    v_cvt_pk_bf16_f32 v233, v242, v243
    v_pk_mul_f32 v[244:245], v[244:245], s[38:39]
    v_cvt_pk_bf16_f32 v234, v244, v245
    v_pk_mul_f32 v[246:247], v[246:247], s[38:39]
    v_cvt_pk_bf16_f32 v235, v246, v247
    v_pk_mul_f32 v[248:249], v[248:249], s[38:39]
    v_cvt_pk_bf16_f32 v236, v248, v249
    v_pk_mul_f32 v[250:251], v[250:251], s[38:39]
    v_cvt_pk_bf16_f32 v237, v250, v251
    v_pk_mul_f32 v[252:253], v[252:253], s[38:39]
    v_cvt_pk_bf16_f32 v238, v252, v253
    v_pk_mul_f32 v[254:255], v[254:255], s[38:39]
    v_cvt_pk_bf16_f32 v239, v254, v255
K1_ATT:
    s_waitcnt vmcnt(63) lgkmcnt(0)
    s_barrier
    v_mfma_f32_16x16x32_bf16 v[32:35], a[220:223], v[64:67], 0
    ds_read_b64_tr_b16 v[184:185], v10 offset:17088
    v_mfma_f32_16x16x32_bf16 v[32:35], a[224:227], v[68:71], v[32:35]
    v_mfma_f32_16x16x32_bf16 v[32:35], a[228:231], v[72:75], v[32:35]
    ds_read_b64_tr_b16 v[186:187], v10 offset:17600
    v_mfma_f32_16x16x32_bf16 v[32:35], a[232:235], v[76:79], v[32:35]
    ds_read_b64_tr_b16 v[188:189], v10 offset:17120
    v_mfma_f32_16x16x32_bf16 v[36:39], a[236:239], v[64:67], 0
    s_add_u32 m0, s30, 0
    v_mfma_f32_16x16x32_bf16 v[36:39], a[240:243], v[68:71], v[36:39]
    s_mul_i32 s35, s80, 4
    s_add_u32 s35, s35, s101
    ds_read_b64_tr_b16 v[190:191], v10 offset:17632
    v_mfma_f32_16x16x32_bf16 v[36:39], a[244:247], v[72:75], v[36:39]
    s_and_b32 s35, s35, 0x1e000
    s_or_b32 s35, s35, s75
    s_waitcnt vmcnt(4)
    v_mfma_f32_16x16x32_bf16 v[36:39], a[248:251], v[76:79], v[36:39]
    buffer_load_dwordx4 v3, s[16:19], s35 offen offset:0 nt lds
    s_nop 3
    v_exp_f32 v32, v32
    v_exp_f32 v33, v33
    v_exp_f32 v34, v34
    v_exp_f32 v35, v35
    v_cvt_pk_bf16_f32 v48, v32, v33
    v_cvt_pk_bf16_f32 v49, v34, v35
    v_exp_f32 v36, v36
    v_mfma_f32_16x16x32_bf16 v[40:43], a[220:223], v[96:99], 0
    v_exp_f32 v37, v37
    v_mfma_f32_16x16x32_bf16 v[40:43], a[224:227], v[100:103], v[40:43]
    v_exp_f32 v38, v38
    v_mfma_f32_16x16x32_bf16 v[40:43], a[228:231], v[104:107], v[40:43]
    v_cvt_pk_bf16_f32 v50, v36, v37
    v_mfma_f32_16x16x32_bf16 v[40:43], a[232:235], v[108:111], v[40:43]
    v_exp_f32 v39, v39
    v_mfma_f32_16x16x32_bf16 v[44:47], a[236:239], v[96:99], 0
    v_mfma_f32_16x16x32_bf16 v[44:47], a[240:243], v[100:103], v[44:47]
    v_cvt_pk_bf16_f32 v51, v38, v39
    v_mfma_f32_16x16x32_bf16 v[44:47], a[244:247], v[104:107], v[44:47]
    v_mfma_f32_16x16x32_bf16 v[44:47], a[248:251], v[108:111], v[44:47]
    s_waitcnt vmcnt(22) lgkmcnt(0)
    s_barrier
    v_mfma_f32_16x16x32_bf16 a[0:3], v[144:147], v[48:51], 0
    v_exp_f32 v40, v40
    v_mfma_f32_16x16x32_bf16 a[4:7], v[148:151], v[48:51], 0
    s_add_u32 m0, s30, 800
    v_exp_f32 v41, v41
    v_mfma_f32_16x16x32_bf16 a[8:11], v[152:155], v[48:51], 0
    s_waitcnt vmcnt(4)
    ds_read_b128 v[80:83], v11 offset:0
    v_cvt_pk_bf16_f32 v52, v40, v41
    v_mfma_f32_16x16x32_bf16 a[12:15], v[156:159], v[48:51], 0
    buffer_load_dwordx4 v3, s[16:19], s35 offen offset:256 nt lds
    v_mfma_f32_16x16x32_bf16 a[16:19], v[176:179], v[48:51], 0
    v_exp_f32 v42, v42
    v_mfma_f32_16x16x32_bf16 a[20:23], v[180:183], v[48:51], 0
    v_exp_f32 v43, v43
    v_mfma_f32_16x16x32_bf16 a[24:27], v[184:187], v[48:51], 0
    ds_read_b128 v[84:87], v11 offset:64
    v_cvt_pk_bf16_f32 v53, v42, v43
    v_mfma_f32_16x16x32_bf16 a[28:31], v[188:191], v[48:51], 0
    v_exp_f32 v44, v44
    v_mfma_f32_16x16x32_bf16 v[32:35], a[220:223], v[128:131], 0
    v_exp_f32 v45, v45
    v_mfma_f32_16x16x32_bf16 v[32:35], a[224:227], v[132:135], v[32:35]
    v_exp_f32 v46, v46
    v_mfma_f32_16x16x32_bf16 v[32:35], a[228:231], v[136:139], v[32:35]
    ds_read_b128 v[88:91], v11 offset:128
    v_cvt_pk_bf16_f32 v54, v44, v45
    v_mfma_f32_16x16x32_bf16 v[32:35], a[232:235], v[140:143], v[32:35]
    v_exp_f32 v47, v47
    v_mfma_f32_16x16x32_bf16 v[36:39], a[236:239], v[128:131], 0
    v_mfma_f32_16x16x32_bf16 v[36:39], a[240:243], v[132:135], v[36:39]
    ds_read_b128 v[92:95], v11 offset:192
    v_cvt_pk_bf16_f32 v55, v46, v47
    v_mfma_f32_16x16x32_bf16 v[36:39], a[244:247], v[136:139], v[36:39]
    s_add_u32 m0, s30, 1600
    s_waitcnt vmcnt(3)
    ds_read_b128 v[112:115], v11 offset:512
    v_mfma_f32_16x16x32_bf16 v[36:39], a[248:251], v[140:143], v[36:39]
    buffer_load_dwordx4 v3, s[16:19], s35 offen offset:512 nt lds
    v_smfmac_f32_16x16x64_bf16 a[192:195], a[216:219], v[48:55], v29
    v_exp_f32 v32, v32
    v_mfma_f32_16x16x32_bf16 a[32:35], v[144:147], v[52:55], 0
    v_exp_f32 v33, v33
    v_mfma_f32_16x16x32_bf16 a[36:39], v[148:151], v[52:55], 0
    ds_read_b128 v[116:119], v11 offset:576
    v_cvt_pk_bf16_f32 v48, v32, v33
    v_mfma_f32_16x16x32_bf16 a[40:43], v[152:155], v[52:55], 0
    v_mfma_f32_16x16x32_bf16 a[44:47], v[156:159], v[52:55], 0
    v_exp_f32 v34, v34
    v_mfma_f32_16x16x32_bf16 a[48:51], v[176:179], v[52:55], 0
    v_exp_f32 v35, v35
    v_mfma_f32_16x16x32_bf16 a[52:55], v[180:183], v[52:55], 0
    ds_read_b128 v[120:123], v11 offset:640
    v_cvt_pk_bf16_f32 v49, v34, v35
    v_mfma_f32_16x16x32_bf16 a[56:59], v[184:187], v[52:55], 0
    v_mfma_f32_16x16x32_bf16 a[60:63], v[188:191], v[52:55], 0
    v_exp_f32 v36, v36
    v_mfma_f32_16x16x32_bf16 v[40:43], a[220:223], v[160:163], 0
    v_exp_f32 v37, v37
    v_mfma_f32_16x16x32_bf16 v[40:43], a[224:227], v[164:167], v[40:43]
    v_exp_f32 v38, v38
    v_mfma_f32_16x16x32_bf16 v[40:43], a[228:231], v[168:171], v[40:43]
    s_add_u32 m0, s30, 2400
    ds_read_b128 v[124:127], v11 offset:704
    v_cvt_pk_bf16_f32 v50, v36, v37
    v_mfma_f32_16x16x32_bf16 v[40:43], a[232:235], v[172:175], v[40:43]
    s_waitcnt vmcnt(4)
    v_exp_f32 v39, v39
    v_mfma_f32_16x16x32_bf16 v[44:47], a[236:239], v[160:163], 0
    buffer_load_dwordx4 v3, s[16:19], s35 offen offset:768 nt lds
    v_mfma_f32_16x16x32_bf16 v[44:47], a[240:243], v[164:167], v[44:47]
    v_cvt_pk_bf16_f32 v51, v38, v39
    v_mfma_f32_16x16x32_bf16 v[44:47], a[244:247], v[168:171], v[44:47]
    v_add_u32 v12, s84, v10
    v_mfma_f32_16x16x32_bf16 v[44:47], a[248:251], v[172:175], v[44:47]
    s_waitcnt vmcnt(21) lgkmcnt(0)
    s_barrier
    v_mfma_f32_16x16x32_bf16 a[64:67], v[144:147], v[48:51], 0
    s_add_u32 s84, s84, 33792
    v_exp_f32 v40, v40
    v_mfma_f32_16x16x32_bf16 a[68:71], v[148:151], v[48:51], 0
    v_exp_f32 v41, v41
    v_mfma_f32_16x16x32_bf16 a[72:75], v[152:155], v[48:51], 0
    ds_read_b64_tr_b16 v[208:209], v12 offset:16896
    v_cvt_pk_bf16_f32 v52, v40, v41
    v_mfma_f32_16x16x32_bf16 a[76:79], v[156:159], v[48:51], 0
    s_cmp_eq_u32 s84, 135168
    s_cselect_b32 s84, 0, s84
    v_mfma_f32_16x16x32_bf16 a[80:83], v[176:179], v[48:51], 0
    v_exp_f32 v42, v42
    v_mfma_f32_16x16x32_bf16 a[84:87], v[180:183], v[48:51], 0
    v_exp_f32 v43, v43
    v_mfma_f32_16x16x32_bf16 a[88:91], v[184:187], v[48:51], 0
    s_add_u32 m0, s30, 16896
    ds_read_b64_tr_b16 v[210:211], v12 offset:17408
    v_cvt_pk_bf16_f32 v53, v42, v43
    v_mfma_f32_16x16x32_bf16 a[92:95], v[188:191], v[48:51], 0
    s_mul_i32 s35, s80, 4
    v_exp_f32 v44, v44
    v_mfma_f32_16x16x32_bf16 v[32:35], a[220:223], v[192:195], 0
    s_add_u32 s35, s35, s101
    v_exp_f32 v45, v45
    v_mfma_f32_16x16x32_bf16 v[32:35], a[224:227], v[196:199], v[32:35]
    s_and_b32 s35, s35, 0x1e000
    v_exp_f32 v46, v46
    v_mfma_f32_16x16x32_bf16 v[32:35], a[228:231], v[200:203], v[32:35]
    s_or_b32 s35, s35, s75
    ds_read_b64_tr_b16 v[212:213], v12 offset:16928
    v_cvt_pk_bf16_f32 v54, v44, v45
    v_mfma_f32_16x16x32_bf16 v[32:35], a[232:235], v[204:207], v[32:35]
    s_waitcnt vmcnt(4)
    v_exp_f32 v47, v47
    v_mfma_f32_16x16x32_bf16 v[36:39], a[236:239], v[192:195], 0
    buffer_load_dwordx4 v3, s[20:23], s35 offen offset:0 nt lds
    v_mfma_f32_16x16x32_bf16 v[36:39], a[240:243], v[196:199], v[36:39]
    ds_read_b64_tr_b16 v[214:215], v12 offset:17440
    v_cvt_pk_bf16_f32 v55, v46, v47
    v_mfma_f32_16x16x32_bf16 v[36:39], a[244:247], v[200:203], v[36:39]
    ds_read_b64_tr_b16 v[216:217], v12 offset:16960
    v_mfma_f32_16x16x32_bf16 v[36:39], a[248:251], v[204:207], v[36:39]
    v_smfmac_f32_16x16x64_bf16 a[196:199], a[216:219], v[48:55], v29
    v_exp_f32 v32, v32
    v_mfma_f32_16x16x32_bf16 a[96:99], v[144:147], v[52:55], 0
    v_exp_f32 v33, v33
    v_mfma_f32_16x16x32_bf16 a[100:103], v[148:151], v[52:55], 0
    ds_read_b64_tr_b16 v[218:219], v12 offset:17472
    v_cvt_pk_bf16_f32 v48, v32, v33
    v_mfma_f32_16x16x32_bf16 a[104:107], v[152:155], v[52:55], 0
    v_mfma_f32_16x16x32_bf16 a[108:111], v[156:159], v[52:55], 0
    v_exp_f32 v34, v34
    v_mfma_f32_16x16x32_bf16 a[112:115], v[176:179], v[52:55], 0
    s_add_u32 m0, s30, 17696
    v_exp_f32 v35, v35
    v_mfma_f32_16x16x32_bf16 a[116:119], v[180:183], v[52:55], 0
    s_waitcnt vmcnt(3)
    ds_read_b64_tr_b16 v[220:221], v12 offset:16992
    v_cvt_pk_bf16_f32 v49, v34, v35
    v_mfma_f32_16x16x32_bf16 a[120:123], v[184:187], v[52:55], 0
    buffer_load_dwordx4 v3, s[20:23], s35 offen offset:256 nt lds
    v_mfma_f32_16x16x32_bf16 a[124:127], v[188:191], v[52:55], 0
    v_exp_f32 v36, v36
    v_mfma_f32_16x16x32_bf16 v[40:43], a[220:223], v[224:227], 0
    v_exp_f32 v37, v37
    v_mfma_f32_16x16x32_bf16 v[40:43], a[224:227], v[228:231], v[40:43]
    v_exp_f32 v38, v38
    v_mfma_f32_16x16x32_bf16 v[40:43], a[228:231], v[232:235], v[40:43]
    ds_read_b64_tr_b16 v[222:223], v12 offset:17504
    v_cvt_pk_bf16_f32 v50, v36, v37
    v_mfma_f32_16x16x32_bf16 v[40:43], a[232:235], v[236:239], v[40:43]
    v_exp_f32 v39, v39
    v_mfma_f32_16x16x32_bf16 v[44:47], a[236:239], v[224:227], 0
    v_mfma_f32_16x16x32_bf16 v[44:47], a[240:243], v[228:231], v[44:47]
    ds_read_b64_tr_b16 v[240:241], v12 offset:17024
    v_cvt_pk_bf16_f32 v51, v38, v39
    v_mfma_f32_16x16x32_bf16 v[44:47], a[244:247], v[232:235], v[44:47]
    ds_read_b64_tr_b16 v[242:243], v12 offset:17536
    v_add_u32 v11, s84, v9
    v_mfma_f32_16x16x32_bf16 v[44:47], a[248:251], v[236:239], v[44:47]
    v_mfma_f32_16x16x32_bf16 a[128:131], v[144:147], v[48:51], 0
    v_exp_f32 v40, v40
    v_mfma_f32_16x16x32_bf16 a[132:135], v[148:151], v[48:51], 0
    s_add_u32 m0, s30, 18496
    v_exp_f32 v41, v41
    v_mfma_f32_16x16x32_bf16 a[136:139], v[152:155], v[48:51], 0
    s_waitcnt vmcnt(4)
    ds_read_b64_tr_b16 v[244:245], v12 offset:17056
    v_cvt_pk_bf16_f32 v52, v40, v41
    v_mfma_f32_16x16x32_bf16 a[140:143], v[156:159], v[48:51], 0
    buffer_load_dwordx4 v3, s[20:23], s35 offen offset:512 nt lds
    v_mfma_f32_16x16x32_bf16 a[144:147], v[176:179], v[48:51], 0
    v_exp_f32 v42, v42
    v_mfma_f32_16x16x32_bf16 a[148:151], v[180:183], v[48:51], 0
    v_exp_f32 v43, v43
    v_mfma_f32_16x16x32_bf16 a[152:155], v[184:187], v[48:51], 0
    ds_read_b64_tr_b16 v[246:247], v12 offset:17568
    v_cvt_pk_bf16_f32 v53, v42, v43
    v_mfma_f32_16x16x32_bf16 a[156:159], v[188:191], v[48:51], 0
    v_exp_f32 v44, v44
    v_mfma_f32_16x16x32_bf16 v[32:35], v[80:83], v[64:67], 0
    v_exp_f32 v45, v45
    v_mfma_f32_16x16x32_bf16 v[32:35], v[84:87], v[68:71], v[32:35]
    v_exp_f32 v46, v46
    v_mfma_f32_16x16x32_bf16 v[32:35], v[88:91], v[72:75], v[32:35]
    ds_read_b64_tr_b16 v[248:249], v12 offset:17088
    v_cvt_pk_bf16_f32 v54, v44, v45
    v_mfma_f32_16x16x32_bf16 v[32:35], v[92:95], v[76:79], v[32:35]
    v_exp_f32 v47, v47
    v_mfma_f32_16x16x32_bf16 v[36:39], v[112:115], v[64:67], 0
    v_mfma_f32_16x16x32_bf16 v[36:39], v[116:119], v[68:71], v[36:39]
    ds_read_b64_tr_b16 v[250:251], v12 offset:17600
    v_cvt_pk_bf16_f32 v55, v46, v47
    v_mfma_f32_16x16x32_bf16 v[36:39], v[120:123], v[72:75], v[36:39]
    ds_read_b64_tr_b16 v[252:253], v12 offset:17120
    v_mfma_f32_16x16x32_bf16 v[36:39], v[124:127], v[76:79], v[36:39]
    v_smfmac_f32_16x16x64_bf16 a[200:203], a[216:219], v[48:55], v29
    v_exp_f32 v32, v32
    v_mfma_f32_16x16x32_bf16 a[160:163], v[144:147], v[52:55], 0
    s_add_u32 m0, s30, 19296
    v_exp_f32 v33, v33
    v_mfma_f32_16x16x32_bf16 a[164:167], v[148:151], v[52:55], 0
    s_waitcnt vmcnt(4)
    ds_read_b64_tr_b16 v[254:255], v12 offset:17632
    v_cvt_pk_bf16_f32 v48, v32, v33
    v_mfma_f32_16x16x32_bf16 a[168:171], v[152:155], v[52:55], 0
    buffer_load_dwordx4 v3, s[20:23], s35 offen offset:768 nt lds
    v_mfma_f32_16x16x32_bf16 a[172:175], v[156:159], v[52:55], 0
    v_exp_f32 v34, v34
    v_mfma_f32_16x16x32_bf16 a[176:179], v[176:179], v[52:55], 0
    v_exp_f32 v35, v35
    v_mfma_f32_16x16x32_bf16 a[180:183], v[180:183], v[52:55], 0
    v_cvt_pk_bf16_f32 v49, v34, v35
    v_mfma_f32_16x16x32_bf16 a[184:187], v[184:187], v[52:55], 0
    v_mfma_f32_16x16x32_bf16 a[188:191], v[188:191], v[52:55], 0
    v_exp_f32 v36, v36
    v_mfma_f32_16x16x32_bf16 v[40:43], v[80:83], v[96:99], 0
    v_exp_f32 v37, v37
    v_mfma_f32_16x16x32_bf16 v[40:43], v[84:87], v[100:103], v[40:43]
    v_exp_f32 v38, v38
    v_mfma_f32_16x16x32_bf16 v[40:43], v[88:91], v[104:107], v[40:43]
    v_cvt_pk_bf16_f32 v50, v36, v37
    v_mfma_f32_16x16x32_bf16 v[40:43], v[92:95], v[108:111], v[40:43]
    v_exp_f32 v39, v39
    v_mfma_f32_16x16x32_bf16 v[44:47], v[112:115], v[96:99], 0
K1_ALOOP0:
    v_mfma_f32_16x16x32_bf16 v[44:47], v[116:119], v[100:103], v[44:47]
    s_add_u32 s7, s7, 1
    v_cvt_pk_bf16_f32 v51, v38, v39
    v_mfma_f32_16x16x32_bf16 v[44:47], v[120:123], v[104:107], v[44:47]
    v_mfma_f32_16x16x32_bf16 v[44:47], v[124:127], v[108:111], v[44:47]
    s_waitcnt vmcnt(12) lgkmcnt(0)
    s_barrier
    s_add_u32 s88, s88, 1
    v_mfma_f32_16x16x32_bf16 a[0:3], v[208:211], v[48:51], a[0:3]
    s_bitcmp1_b32 s88, 1
    v_exp_f32 v40, v40
    v_mfma_f32_16x16x32_bf16 a[4:7], v[212:215], v[48:51], a[4:7]
    s_cselect_b32 s85, s73, s62
    v_exp_f32 v41, v41
    v_mfma_f32_16x16x32_bf16 a[8:11], v[216:219], v[48:51], a[8:11]
    s_cselect_b64 s[92:93], s[20:21], s[16:17]
    ds_read_b128 a[220:223], v11 offset:0
    v_cvt_pk_bf16_f32 v52, v40, v41
    v_mfma_f32_16x16x32_bf16 a[12:15], v[220:223], v[48:51], a[12:15]
    s_bitcmp1_b32 s88, 0
    s_cselect_b32 s85, 512, s85
    s_cselect_b32 s89, 2112, s74
    v_mfma_f32_16x16x32_bf16 a[16:19], v[240:243], v[48:51], a[16:19]
    s_add_u32 s32, s32, s85
    v_exp_f32 v42, v42
    v_mfma_f32_16x16x32_bf16 a[20:23], v[244:247], v[48:51], a[20:23]
    s_add_u32 s33, s33, s89
    v_exp_f32 v43, v43
    v_mfma_f32_16x16x32_bf16 a[24:27], v[248:251], v[48:51], a[24:27]
    s_cmp_ge_u32 s33, 135168
    ds_read_b128 a[224:227], v11 offset:64
    v_cvt_pk_bf16_f32 v53, v42, v43
    v_mfma_f32_16x16x32_bf16 a[28:31], v[252:255], v[48:51], a[28:31]
    s_cselect_b32 s33, s30, s33
    v_exp_f32 v44, v44
    v_mfma_f32_16x16x32_bf16 v[32:35], v[80:83], v[128:131], 0
    s_mov_b32 m0, s33
    v_exp_f32 v45, v45
    v_mfma_f32_16x16x32_bf16 v[32:35], v[84:87], v[132:135], v[32:35]
    s_and_b32 s96, s32, 0x1e3ff
    v_exp_f32 v46, v46
    v_mfma_f32_16x16x32_bf16 v[32:35], v[88:91], v[136:139], v[32:35]
    s_or_b32 s96, s96, s75
    ds_read_b128 a[228:231], v11 offset:128
    v_cvt_pk_bf16_f32 v54, v44, v45
    v_mfma_f32_16x16x32_bf16 v[32:35], v[92:95], v[140:143], v[32:35]
    s_waitcnt vmcnt(3)
    v_exp_f32 v47, v47
    v_mfma_f32_16x16x32_bf16 v[36:39], v[112:115], v[128:131], 0
    buffer_load_dwordx4 v3, s[92:95], s96 offen offset:0 nt lds
    v_mfma_f32_16x16x32_bf16 v[36:39], v[116:119], v[132:135], v[36:39]
    ds_read_b128 a[232:235], v11 offset:192
    v_cvt_pk_bf16_f32 v55, v46, v47
    v_mfma_f32_16x16x32_bf16 v[36:39], v[120:123], v[136:139], v[36:39]
    ds_read_b128 a[236:239], v11 offset:512
    v_mfma_f32_16x16x32_bf16 v[36:39], v[124:127], v[140:143], v[36:39]
    v_smfmac_f32_16x16x64_bf16 a[192:195], a[216:219], v[48:55], v29
    v_exp_f32 v32, v32
    v_mfma_f32_16x16x32_bf16 a[32:35], v[208:211], v[52:55], a[32:35]
    v_exp_f32 v33, v33
    v_mfma_f32_16x16x32_bf16 a[36:39], v[212:215], v[52:55], a[36:39]
    ds_read_b128 a[240:243], v11 offset:576
    v_cvt_pk_bf16_f32 v48, v32, v33
    v_mfma_f32_16x16x32_bf16 a[40:43], v[216:219], v[52:55], a[40:43]
    v_mfma_f32_16x16x32_bf16 a[44:47], v[220:223], v[52:55], a[44:47]
    v_exp_f32 v34, v34
    v_mfma_f32_16x16x32_bf16 a[48:51], v[240:243], v[52:55], a[48:51]
    s_add_u32 m0, s33, 800
    v_exp_f32 v35, v35
    v_mfma_f32_16x16x32_bf16 a[52:55], v[244:247], v[52:55], a[52:55]
    s_waitcnt vmcnt(4)
    ds_read_b128 a[244:247], v11 offset:640
    v_cvt_pk_bf16_f32 v49, v34, v35
    v_mfma_f32_16x16x32_bf16 a[56:59], v[248:251], v[52:55], a[56:59]
    buffer_load_dwordx4 v3, s[92:95], s96 offen offset:256 nt lds
    v_mfma_f32_16x16x32_bf16 a[60:63], v[252:255], v[52:55], a[60:63]
    s_add_u32 s88, s88, 1
    s_bitcmp1_b32 s88, 1
    s_cselect_b32 s85, s73, s62
    s_cselect_b64 s[92:93], s[20:21], s[16:17]
    s_bitcmp1_b32 s88, 0
    s_cselect_b32 s85, 512, s85
    s_cselect_b32 s89, 2112, s74
    s_add_u32 s32, s32, s85
    s_add_u32 s33, s33, s89
    s_cmp_ge_u32 s33, 135168
    s_cselect_b32 s33, s30, s33
    v_exp_f32 v36, v36
    v_mfma_f32_16x16x32_bf16 v[40:43], v[80:83], v[160:163], 0
    s_mov_b32 m0, s33
    v_exp_f32 v37, v37
    v_mfma_f32_16x16x32_bf16 v[40:43], v[84:87], v[164:167], v[40:43]
    s_and_b32 s96, s32, 0x1e3ff
    v_exp_f32 v38, v38
    v_mfma_f32_16x16x32_bf16 v[40:43], v[88:91], v[168:171], v[40:43]
    s_or_b32 s96, s96, s75
    ds_read_b128 a[248:251], v11 offset:704
    v_cvt_pk_bf16_f32 v50, v36, v37
    v_mfma_f32_16x16x32_bf16 v[40:43], v[92:95], v[172:175], v[40:43]
    s_waitcnt vmcnt(4)
    v_exp_f32 v39, v39
    v_mfma_f32_16x16x32_bf16 v[44:47], v[112:115], v[160:163], 0
    buffer_load_dwordx4 v3, s[92:95], s96 offen offset:0 nt lds
    v_mfma_f32_16x16x32_bf16 v[44:47], v[116:119], v[164:167], v[44:47]
    v_cvt_pk_bf16_f32 v51, v38, v39
    v_mfma_f32_16x16x32_bf16 v[44:47], v[120:123], v[168:171], v[44:47]
    v_add_u32 v12, s84, v10
    v_mfma_f32_16x16x32_bf16 v[44:47], v[124:127], v[172:175], v[44:47]
    s_waitcnt vmcnt(11) lgkmcnt(0)
    s_barrier
    v_mfma_f32_16x16x32_bf16 a[64:67], v[208:211], v[48:51], a[64:67]
    s_add_u32 s84, s84, 33792
    v_exp_f32 v40, v40
    v_mfma_f32_16x16x32_bf16 a[68:71], v[212:215], v[48:51], a[68:71]
    v_exp_f32 v41, v41
    v_mfma_f32_16x16x32_bf16 a[72:75], v[216:219], v[48:51], a[72:75]
    ds_read_b64_tr_b16 v[144:145], v12 offset:16896
    v_cvt_pk_bf16_f32 v52, v40, v41
    v_mfma_f32_16x16x32_bf16 a[76:79], v[220:223], v[48:51], a[76:79]
    s_cmp_eq_u32 s84, 135168
    s_cselect_b32 s84, 0, s84
    v_mfma_f32_16x16x32_bf16 a[80:83], v[240:243], v[48:51], a[80:83]
    v_exp_f32 v42, v42
    v_mfma_f32_16x16x32_bf16 a[84:87], v[244:247], v[48:51], a[84:87]
    v_exp_f32 v43, v43
    v_mfma_f32_16x16x32_bf16 a[88:91], v[248:251], v[48:51], a[88:91]
    ds_read_b64_tr_b16 v[146:147], v12 offset:17408
    v_cvt_pk_bf16_f32 v53, v42, v43
    v_mfma_f32_16x16x32_bf16 a[92:95], v[252:255], v[48:51], a[92:95]
    v_exp_f32 v44, v44
    v_mfma_f32_16x16x32_bf16 v[32:35], v[80:83], v[192:195], 0
    v_exp_f32 v45, v45
    v_mfma_f32_16x16x32_bf16 v[32:35], v[84:87], v[196:199], v[32:35]
    v_exp_f32 v46, v46
    v_mfma_f32_16x16x32_bf16 v[32:35], v[88:91], v[200:203], v[32:35]
    ds_read_b64_tr_b16 v[148:149], v12 offset:16928
    v_cvt_pk_bf16_f32 v54, v44, v45
    v_mfma_f32_16x16x32_bf16 v[32:35], v[92:95], v[204:207], v[32:35]
    v_exp_f32 v47, v47
    v_mfma_f32_16x16x32_bf16 v[36:39], v[112:115], v[192:195], 0
    v_mfma_f32_16x16x32_bf16 v[36:39], v[116:119], v[196:199], v[36:39]
    ds_read_b64_tr_b16 v[150:151], v12 offset:17440
    v_cvt_pk_bf16_f32 v55, v46, v47
    v_mfma_f32_16x16x32_bf16 v[36:39], v[120:123], v[200:203], v[36:39]
    ds_read_b64_tr_b16 v[152:153], v12 offset:16960
    v_mfma_f32_16x16x32_bf16 v[36:39], v[124:127], v[204:207], v[36:39]
    v_smfmac_f32_16x16x64_bf16 a[196:199], a[216:219], v[48:55], v29
    v_exp_f32 v32, v32
    v_mfma_f32_16x16x32_bf16 a[96:99], v[208:211], v[52:55], a[96:99]
    s_add_u32 m0, s33, 800
    v_exp_f32 v33, v33
    v_mfma_f32_16x16x32_bf16 a[100:103], v[212:215], v[52:55], a[100:103]
    s_waitcnt vmcnt(3)
    ds_read_b64_tr_b16 v[154:155], v12 offset:17472
    v_cvt_pk_bf16_f32 v48, v32, v33
    v_mfma_f32_16x16x32_bf16 a[104:107], v[216:219], v[52:55], a[104:107]
    buffer_load_dwordx4 v3, s[92:95], s96 offen offset:256 nt lds
    v_mfma_f32_16x16x32_bf16 a[108:111], v[220:223], v[52:55], a[108:111]
    v_exp_f32 v34, v34
    v_mfma_f32_16x16x32_bf16 a[112:115], v[240:243], v[52:55], a[112:115]
    s_add_u32 s88, s88, 1
    v_exp_f32 v35, v35
    v_mfma_f32_16x16x32_bf16 a[116:119], v[244:247], v[52:55], a[116:119]
    s_bitcmp1_b32 s88, 1
    ds_read_b64_tr_b16 v[156:157], v12 offset:16992
    v_cvt_pk_bf16_f32 v49, v34, v35
    v_mfma_f32_16x16x32_bf16 a[120:123], v[248:251], v[52:55], a[120:123]
    s_cselect_b32 s85, s73, s62
    s_cselect_b64 s[92:93], s[20:21], s[16:17]
    s_bitcmp1_b32 s88, 0
    v_mfma_f32_16x16x32_bf16 a[124:127], v[252:255], v[52:55], a[124:127]
    s_cselect_b32 s85, 512, s85
    v_exp_f32 v36, v36
    v_mfma_f32_16x16x32_bf16 v[40:43], v[80:83], v[224:227], 0
    s_cselect_b32 s89, 2112, s74
    v_exp_f32 v37, v37
    v_mfma_f32_16x16x32_bf16 v[40:43], v[84:87], v[228:231], v[40:43]
    s_add_u32 s32, s32, s85
    v_exp_f32 v38, v38
    v_mfma_f32_16x16x32_bf16 v[40:43], v[88:91], v[232:235], v[40:43]
    s_add_u32 s33, s33, s89
    ds_read_b64_tr_b16 v[158:159], v12 offset:17504
    v_cvt_pk_bf16_f32 v50, v36, v37
    v_mfma_f32_16x16x32_bf16 v[40:43], v[92:95], v[236:239], v[40:43]
    s_cmp_ge_u32 s33, 135168
    v_exp_f32 v39, v39
    v_mfma_f32_16x16x32_bf16 v[44:47], v[112:115], v[224:227], 0
    s_cselect_b32 s33, s30, s33
    s_mov_b32 m0, s33
    s_and_b32 s96, s32, 0x1e3ff
    v_mfma_f32_16x16x32_bf16 v[44:47], v[116:119], v[228:231], v[44:47]
    s_or_b32 s96, s96, s75
    ds_read_b64_tr_b16 v[176:177], v12 offset:17024
    v_cvt_pk_bf16_f32 v51, v38, v39
    v_mfma_f32_16x16x32_bf16 v[44:47], v[120:123], v[232:235], v[44:47]
    s_waitcnt vmcnt(4)
    ds_read_b64_tr_b16 v[178:179], v12 offset:17536
    v_add_u32 v11, s84, v9
    v_mfma_f32_16x16x32_bf16 v[44:47], v[124:127], v[236:239], v[44:47]
    buffer_load_dwordx4 v3, s[92:95], s96 offen offset:0 nt lds
    v_mfma_f32_16x16x32_bf16 a[128:131], v[208:211], v[48:51], a[128:131]
    v_exp_f32 v40, v40
    v_mfma_f32_16x16x32_bf16 a[132:135], v[212:215], v[48:51], a[132:135]
    v_exp_f32 v41, v41
    v_mfma_f32_16x16x32_bf16 a[136:139], v[216:219], v[48:51], a[136:139]
    ds_read_b64_tr_b16 v[180:181], v12 offset:17056
    v_cvt_pk_bf16_f32 v52, v40, v41
    v_mfma_f32_16x16x32_bf16 a[140:143], v[220:223], v[48:51], a[140:143]
    v_mfma_f32_16x16x32_bf16 a[144:147], v[240:243], v[48:51], a[144:147]
    v_exp_f32 v42, v42
    v_mfma_f32_16x16x32_bf16 a[148:151], v[244:247], v[48:51], a[148:151]
    v_exp_f32 v43, v43
    v_mfma_f32_16x16x32_bf16 a[152:155], v[248:251], v[48:51], a[152:155]
    ds_read_b64_tr_b16 v[182:183], v12 offset:17568
    v_cvt_pk_bf16_f32 v53, v42, v43
    v_mfma_f32_16x16x32_bf16 a[156:159], v[252:255], v[48:51], a[156:159]
    v_exp_f32 v44, v44
    v_mfma_f32_16x16x32_bf16 v[32:35], a[220:223], v[64:67], 0
    v_exp_f32 v45, v45
    v_mfma_f32_16x16x32_bf16 v[32:35], a[224:227], v[68:71], v[32:35]
    v_exp_f32 v46, v46
    v_mfma_f32_16x16x32_bf16 v[32:35], a[228:231], v[72:75], v[32:35]
    s_add_u32 m0, s33, 800
    ds_read_b64_tr_b16 v[184:185], v12 offset:17088
    v_cvt_pk_bf16_f32 v54, v44, v45
    v_mfma_f32_16x16x32_bf16 v[32:35], a[232:235], v[76:79], v[32:35]
    s_waitcnt vmcnt(4)
    v_exp_f32 v47, v47
    v_mfma_f32_16x16x32_bf16 v[36:39], a[236:239], v[64:67], 0
    buffer_load_dwordx4 v3, s[92:95], s96 offen offset:256 nt lds
    v_mfma_f32_16x16x32_bf16 v[36:39], a[240:243], v[68:71], v[36:39]
    ds_read_b64_tr_b16 v[186:187], v12 offset:17600
    v_cvt_pk_bf16_f32 v55, v46, v47
    v_mfma_f32_16x16x32_bf16 v[36:39], a[244:247], v[72:75], v[36:39]
    ds_read_b64_tr_b16 v[188:189], v12 offset:17120
    v_mfma_f32_16x16x32_bf16 v[36:39], a[248:251], v[76:79], v[36:39]
    v_smfmac_f32_16x16x64_bf16 a[200:203], a[216:219], v[48:55], v29
    v_exp_f32 v32, v32
    v_mfma_f32_16x16x32_bf16 a[160:163], v[208:211], v[52:55], a[160:163]
    v_exp_f32 v33, v33
    v_mfma_f32_16x16x32_bf16 a[164:167], v[212:215], v[52:55], a[164:167]
    ds_read_b64_tr_b16 v[190:191], v12 offset:17632
    v_cvt_pk_bf16_f32 v48, v32, v33
    v_mfma_f32_16x16x32_bf16 a[168:171], v[216:219], v[52:55], a[168:171]
    s_add_u32 s88, s88, 1
    s_bitcmp1_b32 s88, 1
    v_mfma_f32_16x16x32_bf16 a[172:175], v[220:223], v[52:55], a[172:175]
    s_cselect_b32 s85, s73, s62
    v_exp_f32 v34, v34
    v_mfma_f32_16x16x32_bf16 a[176:179], v[240:243], v[52:55], a[176:179]
    s_cselect_b64 s[92:93], s[20:21], s[16:17]
    v_exp_f32 v35, v35
    v_mfma_f32_16x16x32_bf16 a[180:183], v[244:247], v[52:55], a[180:183]
    s_bitcmp1_b32 s88, 0
    s_cselect_b32 s85, 512, s85
    v_cvt_pk_bf16_f32 v49, v34, v35
    v_mfma_f32_16x16x32_bf16 a[184:187], v[248:251], v[52:55], a[184:187]
    s_cselect_b32 s89, 2112, s74
    s_add_u32 s32, s32, s85
    s_add_u32 s33, s33, s89
    v_mfma_f32_16x16x32_bf16 a[188:191], v[252:255], v[52:55], a[188:191]
    s_cmp_ge_u32 s33, 135168
    v_exp_f32 v36, v36
    v_mfma_f32_16x16x32_bf16 v[40:43], a[220:223], v[96:99], 0
    s_cselect_b32 s33, s30, s33
    v_exp_f32 v37, v37
    v_mfma_f32_16x16x32_bf16 v[40:43], a[224:227], v[100:103], v[40:43]
    s_mov_b32 m0, s33
    v_exp_f32 v38, v38
    v_mfma_f32_16x16x32_bf16 v[40:43], a[228:231], v[104:107], v[40:43]
    s_and_b32 s96, s32, 0x1e3ff
    s_or_b32 s96, s96, s75
    v_cvt_pk_bf16_f32 v50, v36, v37
    v_mfma_f32_16x16x32_bf16 v[40:43], a[232:235], v[108:111], v[40:43]
    s_waitcnt vmcnt(3)
    v_exp_f32 v39, v39
    v_mfma_f32_16x16x32_bf16 v[44:47], a[236:239], v[96:99], 0
    buffer_load_dwordx4 v3, s[92:95], s96 offen offset:0 nt lds
    v_mfma_f32_16x16x32_bf16 v[44:47], a[240:243], v[100:103], v[44:47]
    v_cvt_pk_bf16_f32 v51, v38, v39
    v_mfma_f32_16x16x32_bf16 v[44:47], a[244:247], v[104:107], v[44:47]
    v_mfma_f32_16x16x32_bf16 v[44:47], a[248:251], v[108:111], v[44:47]
    s_waitcnt vmcnt(11) lgkmcnt(0)
    s_barrier
    v_mfma_f32_16x16x32_bf16 a[0:3], v[144:147], v[48:51], a[0:3]
    v_exp_f32 v40, v40
    v_mfma_f32_16x16x32_bf16 a[4:7], v[148:151], v[48:51], a[4:7]
    v_exp_f32 v41, v41
    v_mfma_f32_16x16x32_bf16 a[8:11], v[152:155], v[48:51], a[8:11]
    ds_read_b128 v[80:83], v11 offset:0
    v_cvt_pk_bf16_f32 v52, v40, v41
    v_mfma_f32_16x16x32_bf16 a[12:15], v[156:159], v[48:51], a[12:15]
    v_mfma_f32_16x16x32_bf16 a[16:19], v[176:179], v[48:51], a[16:19]
    v_exp_f32 v42, v42
    v_mfma_f32_16x16x32_bf16 a[20:23], v[180:183], v[48:51], a[20:23]
    v_exp_f32 v43, v43
    v_mfma_f32_16x16x32_bf16 a[24:27], v[184:187], v[48:51], a[24:27]
    ds_read_b128 v[84:87], v11 offset:64
    v_cvt_pk_bf16_f32 v53, v42, v43
    v_mfma_f32_16x16x32_bf16 a[28:31], v[188:191], v[48:51], a[28:31]
    v_exp_f32 v44, v44
    v_mfma_f32_16x16x32_bf16 v[32:35], a[220:223], v[128:131], 0
    v_exp_f32 v45, v45
    v_mfma_f32_16x16x32_bf16 v[32:35], a[224:227], v[132:135], v[32:35]
    v_exp_f32 v46, v46
    v_mfma_f32_16x16x32_bf16 v[32:35], a[228:231], v[136:139], v[32:35]
    s_add_u32 m0, s33, 800
    ds_read_b128 v[88:91], v11 offset:128
    v_cvt_pk_bf16_f32 v54, v44, v45
    v_mfma_f32_16x16x32_bf16 v[32:35], a[232:235], v[140:143], v[32:35]
    s_waitcnt vmcnt(4)
    v_exp_f32 v47, v47
    v_mfma_f32_16x16x32_bf16 v[36:39], a[236:239], v[128:131], 0
    buffer_load_dwordx4 v3, s[92:95], s96 offen offset:256 nt lds
    v_mfma_f32_16x16x32_bf16 v[36:39], a[240:243], v[132:135], v[36:39]
    s_add_u32 s88, s88, 1
    ds_read_b128 v[92:95], v11 offset:192
    v_cvt_pk_bf16_f32 v55, v46, v47
    v_mfma_f32_16x16x32_bf16 v[36:39], a[244:247], v[136:139], v[36:39]
    s_bitcmp1_b32 s88, 1
    s_cselect_b32 s85, s73, s62
    ds_read_b128 v[112:115], v11 offset:512
    v_mfma_f32_16x16x32_bf16 v[36:39], a[248:251], v[140:143], v[36:39]
    s_cselect_b64 s[92:93], s[20:21], s[16:17]
    s_bitcmp1_b32 s88, 0
    s_cselect_b32 s85, 512, s85
    v_smfmac_f32_16x16x64_bf16 a[192:195], a[216:219], v[48:55], v29
    s_cselect_b32 s89, 2112, s74
    v_exp_f32 v32, v32
    v_mfma_f32_16x16x32_bf16 a[32:35], v[144:147], v[52:55], a[32:35]
    s_add_u32 s32, s32, s85
    v_exp_f32 v33, v33
    v_mfma_f32_16x16x32_bf16 a[36:39], v[148:151], v[52:55], a[36:39]
    s_add_u32 s33, s33, s89
    ds_read_b128 v[116:119], v11 offset:576
    v_cvt_pk_bf16_f32 v48, v32, v33
    v_mfma_f32_16x16x32_bf16 a[40:43], v[152:155], v[52:55], a[40:43]
    s_cmp_ge_u32 s33, 135168
    s_cselect_b32 s33, s30, s33
    s_mov_b32 m0, s33
    v_mfma_f32_16x16x32_bf16 a[44:47], v[156:159], v[52:55], a[44:47]
    s_and_b32 s96, s32, 0x1e3ff
    v_exp_f32 v34, v34
    v_mfma_f32_16x16x32_bf16 a[48:51], v[176:179], v[52:55], a[48:51]
    s_or_b32 s96, s96, s75
    v_exp_f32 v35, v35
    v_mfma_f32_16x16x32_bf16 a[52:55], v[180:183], v[52:55], a[52:55]
    s_waitcnt vmcnt(4)
    ds_read_b128 v[120:123], v11 offset:640
    v_cvt_pk_bf16_f32 v49, v34, v35
    v_mfma_f32_16x16x32_bf16 a[56:59], v[184:187], v[52:55], a[56:59]
    buffer_load_dwordx4 v3, s[92:95], s96 offen offset:0 nt lds
    v_mfma_f32_16x16x32_bf16 a[60:63], v[188:191], v[52:55], a[60:63]
    v_exp_f32 v36, v36
    v_mfma_f32_16x16x32_bf16 v[40:43], a[220:223], v[160:163], 0
    v_exp_f32 v37, v37
    v_mfma_f32_16x16x32_bf16 v[40:43], a[224:227], v[164:167], v[40:43]
    v_exp_f32 v38, v38
    v_mfma_f32_16x16x32_bf16 v[40:43], a[228:231], v[168:171], v[40:43]
    s_add_u32 m0, s33, 800
    ds_read_b128 v[124:127], v11 offset:704
    v_cvt_pk_bf16_f32 v50, v36, v37
    v_mfma_f32_16x16x32_bf16 v[40:43], a[232:235], v[172:175], v[40:43]
    s_waitcnt vmcnt(3)
    v_exp_f32 v39, v39
    v_mfma_f32_16x16x32_bf16 v[44:47], a[236:239], v[160:163], 0
    buffer_load_dwordx4 v3, s[92:95], s96 offen offset:256 nt lds
    v_mfma_f32_16x16x32_bf16 v[44:47], a[240:243], v[164:167], v[44:47]
    v_cvt_pk_bf16_f32 v51, v38, v39
    v_mfma_f32_16x16x32_bf16 v[44:47], a[244:247], v[168:171], v[44:47]
    v_add_u32 v12, s84, v10
    v_mfma_f32_16x16x32_bf16 v[44:47], a[248:251], v[172:175], v[44:47]
    s_waitcnt vmcnt(10) lgkmcnt(0)
    s_barrier
    v_mfma_f32_16x16x32_bf16 a[64:67], v[144:147], v[48:51], a[64:67]
    s_add_u32 s84, s84, 33792
    v_exp_f32 v40, v40
    v_mfma_f32_16x16x32_bf16 a[68:71], v[148:151], v[48:51], a[68:71]
    v_exp_f32 v41, v41
    v_mfma_f32_16x16x32_bf16 a[72:75], v[152:155], v[48:51], a[72:75]
    ds_read_b64_tr_b16 v[208:209], v12 offset:16896
    v_cvt_pk_bf16_f32 v52, v40, v41
    v_mfma_f32_16x16x32_bf16 a[76:79], v[156:159], v[48:51], a[76:79]
    s_cmp_eq_u32 s84, 135168
    s_cselect_b32 s84, 0, s84
    s_add_u32 s88, s88, 1
    v_mfma_f32_16x16x32_bf16 a[80:83], v[176:179], v[48:51], a[80:83]
    s_bitcmp1_b32 s88, 1
    v_exp_f32 v42, v42
    v_mfma_f32_16x16x32_bf16 a[84:87], v[180:183], v[48:51], a[84:87]
    s_cselect_b32 s85, s73, s62
    v_exp_f32 v43, v43
    v_mfma_f32_16x16x32_bf16 a[88:91], v[184:187], v[48:51], a[88:91]
    s_cselect_b64 s[92:93], s[20:21], s[16:17]
    ds_read_b64_tr_b16 v[210:211], v12 offset:17408
    v_cvt_pk_bf16_f32 v53, v42, v43
    v_mfma_f32_16x16x32_bf16 a[92:95], v[188:191], v[48:51], a[92:95]
    s_bitcmp1_b32 s88, 0
    v_exp_f32 v44, v44
    v_mfma_f32_16x16x32_bf16 v[32:35], a[220:223], v[192:195], 0
    s_cselect_b32 s85, 512, s85
    v_exp_f32 v45, v45
    v_mfma_f32_16x16x32_bf16 v[32:35], a[224:227], v[196:199], v[32:35]
    s_cselect_b32 s89, 2112, s74
    v_exp_f32 v46, v46
    v_mfma_f32_16x16x32_bf16 v[32:35], a[228:231], v[200:203], v[32:35]
    s_add_u32 s32, s32, s85
    ds_read_b64_tr_b16 v[212:213], v12 offset:16928
    v_cvt_pk_bf16_f32 v54, v44, v45
    v_mfma_f32_16x16x32_bf16 v[32:35], a[232:235], v[204:207], v[32:35]
    s_add_u32 s33, s33, s89
    v_exp_f32 v47, v47
    v_mfma_f32_16x16x32_bf16 v[36:39], a[236:239], v[192:195], 0
    s_cmp_ge_u32 s33, 135168
    s_cselect_b32 s33, s30, s33
    s_mov_b32 m0, s33
    v_mfma_f32_16x16x32_bf16 v[36:39], a[240:243], v[196:199], v[36:39]
    s_and_b32 s96, s32, 0x1e3ff
    ds_read_b64_tr_b16 v[214:215], v12 offset:17440
    v_cvt_pk_bf16_f32 v55, v46, v47
    v_mfma_f32_16x16x32_bf16 v[36:39], a[244:247], v[200:203], v[36:39]
    s_or_b32 s96, s96, s75
    s_waitcnt vmcnt(4)
    ds_read_b64_tr_b16 v[216:217], v12 offset:16960
    v_mfma_f32_16x16x32_bf16 v[36:39], a[248:251], v[204:207], v[36:39]
    buffer_load_dwordx4 v3, s[92:95], s96 offen offset:0 nt lds
    v_smfmac_f32_16x16x64_bf16 a[196:199], a[216:219], v[48:55], v29
    v_exp_f32 v32, v32
    v_mfma_f32_16x16x32_bf16 a[96:99], v[144:147], v[52:55], a[96:99]
    v_exp_f32 v33, v33
    v_mfma_f32_16x16x32_bf16 a[100:103], v[148:151], v[52:55], a[100:103]
    ds_read_b64_tr_b16 v[218:219], v12 offset:17472
    v_cvt_pk_bf16_f32 v48, v32, v33
    v_mfma_f32_16x16x32_bf16 a[104:107], v[152:155], v[52:55], a[104:107]
    v_mfma_f32_16x16x32_bf16 a[108:111], v[156:159], v[52:55], a[108:111]
    v_exp_f32 v34, v34
    v_mfma_f32_16x16x32_bf16 a[112:115], v[176:179], v[52:55], a[112:115]
    v_exp_f32 v35, v35
    v_mfma_f32_16x16x32_bf16 a[116:119], v[180:183], v[52:55], a[116:119]
    ds_read_b64_tr_b16 v[220:221], v12 offset:16992
    v_cvt_pk_bf16_f32 v49, v34, v35
    v_mfma_f32_16x16x32_bf16 a[120:123], v[184:187], v[52:55], a[120:123]
    v_mfma_f32_16x16x32_bf16 a[124:127], v[188:191], v[52:55], a[124:127]
    v_exp_f32 v36, v36
    v_mfma_f32_16x16x32_bf16 v[40:43], a[220:223], v[224:227], 0
    v_exp_f32 v37, v37
    v_mfma_f32_16x16x32_bf16 v[40:43], a[224:227], v[228:231], v[40:43]
    v_exp_f32 v38, v38
    v_mfma_f32_16x16x32_bf16 v[40:43], a[228:231], v[232:235], v[40:43]
    ds_read_b64_tr_b16 v[222:223], v12 offset:17504
    v_cvt_pk_bf16_f32 v50, v36, v37
    v_mfma_f32_16x16x32_bf16 v[40:43], a[232:235], v[236:239], v[40:43]
    v_exp_f32 v39, v39
    v_mfma_f32_16x16x32_bf16 v[44:47], a[236:239], v[224:227], 0
    v_mfma_f32_16x16x32_bf16 v[44:47], a[240:243], v[228:231], v[44:47]
    s_add_u32 m0, s33, 800
    ds_read_b64_tr_b16 v[240:241], v12 offset:17024
    v_cvt_pk_bf16_f32 v51, v38, v39
    v_mfma_f32_16x16x32_bf16 v[44:47], a[244:247], v[232:235], v[44:47]
    s_waitcnt vmcnt(4)
    ds_read_b64_tr_b16 v[242:243], v12 offset:17536
    v_add_u32 v11, s84, v9
    v_mfma_f32_16x16x32_bf16 v[44:47], a[248:251], v[236:239], v[44:47]
    buffer_load_dwordx4 v3, s[92:95], s96 offen offset:256 nt lds
    v_mfma_f32_16x16x32_bf16 a[128:131], v[144:147], v[48:51], a[128:131]
    s_add_u32 s88, s88, 1
    s_bitcmp1_b32 s88, 1
    v_exp_f32 v40, v40
    v_mfma_f32_16x16x32_bf16 a[132:135], v[148:151], v[48:51], a[132:135]
    s_cselect_b32 s85, s73, s62
    v_exp_f32 v41, v41
    v_mfma_f32_16x16x32_bf16 a[136:139], v[152:155], v[48:51], a[136:139]
    s_cselect_b64 s[92:93], s[20:21], s[16:17]
    ds_read_b64_tr_b16 v[244:245], v12 offset:17056
    v_cvt_pk_bf16_f32 v52, v40, v41
    v_mfma_f32_16x16x32_bf16 a[140:143], v[156:159], v[48:51], a[140:143]
    s_bitcmp1_b32 s88, 0
    s_cselect_b32 s85, 512, s85
    s_cselect_b32 s89, 2112, s74
    v_mfma_f32_16x16x32_bf16 a[144:147], v[176:179], v[48:51], a[144:147]
    s_add_u32 s32, s32, s85
    v_exp_f32 v42, v42
    v_mfma_f32_16x16x32_bf16 a[148:151], v[180:183], v[48:51], a[148:151]
    s_add_u32 s33, s33, s89
    v_exp_f32 v43, v43
    v_mfma_f32_16x16x32_bf16 a[152:155], v[184:187], v[48:51], a[152:155]
    s_cmp_ge_u32 s33, 135168
    ds_read_b64_tr_b16 v[246:247], v12 offset:17568
    v_cvt_pk_bf16_f32 v53, v42, v43
    v_mfma_f32_16x16x32_bf16 a[156:159], v[188:191], v[48:51], a[156:159]
    s_cselect_b32 s33, s30, s33
    v_exp_f32 v44, v44
    v_mfma_f32_16x16x32_bf16 v[32:35], v[80:83], v[64:67], 0
    s_mov_b32 m0, s33
    v_exp_f32 v45, v45
    v_mfma_f32_16x16x32_bf16 v[32:35], v[84:87], v[68:71], v[32:35]
    s_and_b32 s96, s32, 0x1e3ff
    v_exp_f32 v46, v46
    v_mfma_f32_16x16x32_bf16 v[32:35], v[88:91], v[72:75], v[32:35]
    s_or_b32 s96, s96, s75
    ds_read_b64_tr_b16 v[248:249], v12 offset:17088
    v_cvt_pk_bf16_f32 v54, v44, v45
    v_mfma_f32_16x16x32_bf16 v[32:35], v[92:95], v[76:79], v[32:35]
    s_waitcnt vmcnt(3)
    v_exp_f32 v47, v47
    v_mfma_f32_16x16x32_bf16 v[36:39], v[112:115], v[64:67], 0
    buffer_load_dwordx4 v3, s[92:95], s96 offen offset:0 nt lds
    v_mfma_f32_16x16x32_bf16 v[36:39], v[116:119], v[68:71], v[36:39]
    ds_read_b64_tr_b16 v[250:251], v12 offset:17600
    v_cvt_pk_bf16_f32 v55, v46, v47
    v_mfma_f32_16x16x32_bf16 v[36:39], v[120:123], v[72:75], v[36:39]
    ds_read_b64_tr_b16 v[252:253], v12 offset:17120
    v_mfma_f32_16x16x32_bf16 v[36:39], v[124:127], v[76:79], v[36:39]
    v_smfmac_f32_16x16x64_bf16 a[200:203], a[216:219], v[48:55], v29
    v_exp_f32 v32, v32
    v_mfma_f32_16x16x32_bf16 a[160:163], v[144:147], v[52:55], a[160:163]
    v_exp_f32 v33, v33
    v_mfma_f32_16x16x32_bf16 a[164:167], v[148:151], v[52:55], a[164:167]
    ds_read_b64_tr_b16 v[254:255], v12 offset:17632
    v_cvt_pk_bf16_f32 v48, v32, v33
    v_mfma_f32_16x16x32_bf16 a[168:171], v[152:155], v[52:55], a[168:171]
    v_mfma_f32_16x16x32_bf16 a[172:175], v[156:159], v[52:55], a[172:175]
    v_exp_f32 v34, v34
    v_mfma_f32_16x16x32_bf16 a[176:179], v[176:179], v[52:55], a[176:179]
    v_exp_f32 v35, v35
    v_mfma_f32_16x16x32_bf16 a[180:183], v[180:183], v[52:55], a[180:183]
    s_add_u32 m0, s33, 800
    s_waitcnt vmcnt(4)
    v_cvt_pk_bf16_f32 v49, v34, v35
    v_mfma_f32_16x16x32_bf16 a[184:187], v[184:187], v[52:55], a[184:187]
    buffer_load_dwordx4 v3, s[92:95], s96 offen offset:256 nt lds
    v_mfma_f32_16x16x32_bf16 a[188:191], v[188:191], v[52:55], a[188:191]
    v_exp_f32 v36, v36
    v_mfma_f32_16x16x32_bf16 v[40:43], v[80:83], v[96:99], 0
    v_exp_f32 v37, v37
    v_mfma_f32_16x16x32_bf16 v[40:43], v[84:87], v[100:103], v[40:43]
    v_exp_f32 v38, v38
    v_mfma_f32_16x16x32_bf16 v[40:43], v[88:91], v[104:107], v[40:43]
    v_cvt_pk_bf16_f32 v50, v36, v37
    v_mfma_f32_16x16x32_bf16 v[40:43], v[92:95], v[108:111], v[40:43]
    v_exp_f32 v39, v39
    v_mfma_f32_16x16x32_bf16 v[44:47], v[112:115], v[96:99], 0
    s_cmp_lt_u32 s7, s83
    s_cbranch_scc1 K1_ALOOP0
K1_ALOOP1:
    v_mfma_f32_16x16x32_bf16 v[44:47], v[116:119], v[100:103], v[44:47]
    s_add_u32 s7, s7, 1
    v_cvt_pk_bf16_f32 v51, v38, v39
    v_mfma_f32_16x16x32_bf16 v[44:47], v[120:123], v[104:107], v[44:47]
    v_mfma_f32_16x16x32_bf16 v[44:47], v[124:127], v[108:111], v[44:47]
    s_waitcnt vmcnt(10) lgkmcnt(0)
    s_barrier
    s_add_u32 s88, s88, 1
    v_mfma_f32_16x16x32_bf16 a[0:3], v[208:211], v[48:51], a[0:3]
    s_bitcmp1_b32 s88, 1
    v_exp_f32 v40, v40
    v_mfma_f32_16x16x32_bf16 a[4:7], v[212:215], v[48:51], a[4:7]
    s_cselect_b32 s85, s73, s62
    v_exp_f32 v41, v41
    v_mfma_f32_16x16x32_bf16 a[8:11], v[216:219], v[48:51], a[8:11]
    s_cselect_b64 s[92:93], s[20:21], s[16:17]
    ds_read_b128 a[220:223], v11 offset:0
    v_cvt_pk_bf16_f32 v52, v40, v41
    v_mfma_f32_16x16x32_bf16 a[12:15], v[220:223], v[48:51], a[12:15]
    s_bitcmp1_b32 s88, 0
    s_cselect_b32 s85, 512, s85
    s_cselect_b32 s89, 2112, s74
    v_mfma_f32_16x16x32_bf16 a[16:19], v[240:243], v[48:51], a[16:19]
    s_add_u32 s32, s32, s85
    v_exp_f32 v42, v42
    v_mfma_f32_16x16x32_bf16 a[20:23], v[244:247], v[48:51], a[20:23]
    s_add_u32 s33, s33, s89
    v_exp_f32 v43, v43
    v_mfma_f32_16x16x32_bf16 a[24:27], v[248:251], v[48:51], a[24:27]
    s_cmp_ge_u32 s33, 135168
    ds_read_b128 a[224:227], v11 offset:64
    v_cvt_pk_bf16_f32 v53, v42, v43
    v_mfma_f32_16x16x32_bf16 a[28:31], v[252:255], v[48:51], a[28:31]
    s_cselect_b32 s33, s30, s33
    v_exp_f32 v44, v44
    v_mfma_f32_16x16x32_bf16 v[32:35], v[80:83], v[128:131], 0
    s_mov_b32 m0, s33
    v_exp_f32 v45, v45
    v_mfma_f32_16x16x32_bf16 v[32:35], v[84:87], v[132:135], v[32:35]
    s_and_b32 s96, s32, 0x1e3ff
    v_exp_f32 v46, v46
    v_mfma_f32_16x16x32_bf16 v[32:35], v[88:91], v[136:139], v[32:35]
    s_or_b32 s96, s96, s75
    ds_read_b128 a[228:231], v11 offset:128
    v_cvt_pk_bf16_f32 v54, v44, v45
    v_mfma_f32_16x16x32_bf16 v[32:35], v[92:95], v[140:143], v[32:35]
    s_waitcnt vmcnt(4)
    v_exp_f32 v47, v47
    v_mfma_f32_16x16x32_bf16 v[36:39], v[112:115], v[128:131], 0
    buffer_load_dwordx4 v3, s[92:95], s96 offen offset:0 nt lds
    v_mfma_f32_16x16x32_bf16 v[36:39], v[116:119], v[132:135], v[36:39]
    ds_read_b128 a[232:235], v11 offset:192
    v_cvt_pk_bf16_f32 v55, v46, v47
    v_mfma_f32_16x16x32_bf16 v[36:39], v[120:123], v[136:139], v[36:39]
    ds_read_b128 a[236:239], v11 offset:512
    v_mfma_f32_16x16x32_bf16 v[36:39], v[124:127], v[140:143], v[36:39]
    v_smfmac_f32_16x16x64_bf16 a[192:195], a[216:219], v[48:55], v29
    v_exp_f32 v32, v32
    v_mfma_f32_16x16x32_bf16 a[32:35], v[208:211], v[52:55], a[32:35]
    v_exp_f32 v33, v33
    v_mfma_f32_16x16x32_bf16 a[36:39], v[212:215], v[52:55], a[36:39]
    ds_read_b128 a[240:243], v11 offset:576
    v_cvt_pk_bf16_f32 v48, v32, v33
    v_mfma_f32_16x16x32_bf16 a[40:43], v[216:219], v[52:55], a[40:43]
    v_mfma_f32_16x16x32_bf16 a[44:47], v[220:223], v[52:55], a[44:47]
    v_exp_f32 v34, v34
    v_mfma_f32_16x16x32_bf16 a[48:51], v[240:243], v[52:55], a[48:51]
    s_add_u32 m0, s33, 800
    v_exp_f32 v35, v35
    v_mfma_f32_16x16x32_bf16 a[52:55], v[244:247], v[52:55], a[52:55]
    s_waitcnt vmcnt(4)
    ds_read_b128 a[244:247], v11 offset:640
    v_cvt_pk_bf16_f32 v49, v34, v35
    v_mfma_f32_16x16x32_bf16 a[56:59], v[248:251], v[52:55], a[56:59]
    buffer_load_dwordx4 v3, s[92:95], s96 offen offset:256 nt lds
    v_mfma_f32_16x16x32_bf16 a[60:63], v[252:255], v[52:55], a[60:63]
    s_add_u32 s88, s88, 1
    s_bitcmp1_b32 s88, 1
    s_cselect_b32 s85, s73, s62
    s_cselect_b64 s[92:93], s[20:21], s[16:17]
    s_bitcmp1_b32 s88, 0
    s_cselect_b32 s85, 512, s85
    s_cselect_b32 s89, 2112, s74
    s_add_u32 s32, s32, s85
    s_add_u32 s33, s33, s89
    s_cmp_ge_u32 s33, 135168
    s_cselect_b32 s33, s30, s33
    v_exp_f32 v36, v36
    v_mfma_f32_16x16x32_bf16 v[40:43], v[80:83], v[160:163], 0
    s_mov_b32 m0, s33
    v_exp_f32 v37, v37
    v_mfma_f32_16x16x32_bf16 v[40:43], v[84:87], v[164:167], v[40:43]
    s_and_b32 s96, s32, 0x1e3ff
    v_exp_f32 v38, v38
    v_mfma_f32_16x16x32_bf16 v[40:43], v[88:91], v[168:171], v[40:43]
    s_or_b32 s96, s96, s75
    ds_read_b128 a[248:251], v11 offset:704
    v_cvt_pk_bf16_f32 v50, v36, v37
    v_mfma_f32_16x16x32_bf16 v[40:43], v[92:95], v[172:175], v[40:43]
    s_waitcnt vmcnt(4)
    v_exp_f32 v39, v39
    v_mfma_f32_16x16x32_bf16 v[44:47], v[112:115], v[160:163], 0
    buffer_load_dwordx4 v3, s[92:95], s96 offen offset:0 nt lds
    v_mfma_f32_16x16x32_bf16 v[44:47], v[116:119], v[164:167], v[44:47]
    v_cvt_pk_bf16_f32 v51, v38, v39
    v_mfma_f32_16x16x32_bf16 v[44:47], v[120:123], v[168:171], v[44:47]
    v_add_u32 v12, s84, v10
    v_mfma_f32_16x16x32_bf16 v[44:47], v[124:127], v[172:175], v[44:47]
    s_waitcnt vmcnt(9) lgkmcnt(0)
    s_barrier
    v_mfma_f32_16x16x32_bf16 a[64:67], v[208:211], v[48:51], a[64:67]
    s_add_u32 s84, s84, 33792
    v_exp_f32 v40, v40
    v_mfma_f32_16x16x32_bf16 a[68:71], v[212:215], v[48:51], a[68:71]
    v_exp_f32 v41, v41
    v_mfma_f32_16x16x32_bf16 a[72:75], v[216:219], v[48:51], a[72:75]
    ds_read_b64_tr_b16 v[144:145], v12 offset:16896
    v_cvt_pk_bf16_f32 v52, v40, v41
    v_mfma_f32_16x16x32_bf16 a[76:79], v[220:223], v[48:51], a[76:79]
    s_cmp_eq_u32 s84, 135168
    s_cselect_b32 s84, 0, s84
    v_mfma_f32_16x16x32_bf16 a[80:83], v[240:243], v[48:51], a[80:83]
    v_exp_f32 v42, v42
    v_mfma_f32_16x16x32_bf16 a[84:87], v[244:247], v[48:51], a[84:87]
    v_exp_f32 v43, v43
    v_mfma_f32_16x16x32_bf16 a[88:91], v[248:251], v[48:51], a[88:91]
    ds_read_b64_tr_b16 v[146:147], v12 offset:17408
    v_cvt_pk_bf16_f32 v53, v42, v43
    v_mfma_f32_16x16x32_bf16 a[92:95], v[252:255], v[48:51], a[92:95]
    v_exp_f32 v44, v44
    v_mfma_f32_16x16x32_bf16 v[32:35], v[80:83], v[192:195], 0
    v_exp_f32 v45, v45
    v_mfma_f32_16x16x32_bf16 v[32:35], v[84:87], v[196:199], v[32:35]
    v_exp_f32 v46, v46
    v_mfma_f32_16x16x32_bf16 v[32:35], v[88:91], v[200:203], v[32:35]
    ds_read_b64_tr_b16 v[148:149], v12 offset:16928
    v_cvt_pk_bf16_f32 v54, v44, v45
    v_mfma_f32_16x16x32_bf16 v[32:35], v[92:95], v[204:207], v[32:35]
    v_exp_f32 v47, v47
    v_mfma_f32_16x16x32_bf16 v[36:39], v[112:115], v[192:195], 0
    v_mfma_f32_16x16x32_bf16 v[36:39], v[116:119], v[196:199], v[36:39]
    ds_read_b64_tr_b16 v[150:151], v12 offset:17440
    v_cvt_pk_bf16_f32 v55, v46, v47
    v_mfma_f32_16x16x32_bf16 v[36:39], v[120:123], v[200:203], v[36:39]
    ds_read_b64_tr_b16 v[152:153], v12 offset:16960
    v_mfma_f32_16x16x32_bf16 v[36:39], v[124:127], v[204:207], v[36:39]
    v_smfmac_f32_16x16x64_bf16 a[196:199], a[216:219], v[48:55], v29
    v_exp_f32 v32, v32
    v_mfma_f32_16x16x32_bf16 a[96:99], v[208:211], v[52:55], a[96:99]
    s_add_u32 m0, s33, 800
    v_exp_f32 v33, v33
    v_mfma_f32_16x16x32_bf16 a[100:103], v[212:215], v[52:55], a[100:103]
    s_waitcnt vmcnt(4)
    ds_read_b64_tr_b16 v[154:155], v12 offset:17472
    v_cvt_pk_bf16_f32 v48, v32, v33
    v_mfma_f32_16x16x32_bf16 a[104:107], v[216:219], v[52:55], a[104:107]
    buffer_load_dwordx4 v3, s[92:95], s96 offen offset:256 nt lds
    v_mfma_f32_16x16x32_bf16 a[108:111], v[220:223], v[52:55], a[108:111]
    v_exp_f32 v34, v34
    v_mfma_f32_16x16x32_bf16 a[112:115], v[240:243], v[52:55], a[112:115]
    s_add_u32 s88, s88, 1
    v_exp_f32 v35, v35
    v_mfma_f32_16x16x32_bf16 a[116:119], v[244:247], v[52:55], a[116:119]
    s_bitcmp1_b32 s88, 1
    ds_read_b64_tr_b16 v[156:157], v12 offset:16992
    v_cvt_pk_bf16_f32 v49, v34, v35
    v_mfma_f32_16x16x32_bf16 a[120:123], v[248:251], v[52:55], a[120:123]
    s_cselect_b32 s85, s73, s62
    s_cselect_b64 s[92:93], s[20:21], s[16:17]
    s_bitcmp1_b32 s88, 0
    v_mfma_f32_16x16x32_bf16 a[124:127], v[252:255], v[52:55], a[124:127]
    s_cselect_b32 s85, 512, s85
    v_exp_f32 v36, v36
    v_mfma_f32_16x16x32_bf16 v[40:43], v[80:83], v[224:227], 0
    s_cselect_b32 s89, 2112, s74
    v_exp_f32 v37, v37
    v_mfma_f32_16x16x32_bf16 v[40:43], v[84:87], v[228:231], v[40:43]
    s_add_u32 s32, s32, s85
    v_exp_f32 v38, v38
    v_mfma_f32_16x16x32_bf16 v[40:43], v[88:91], v[232:235], v[40:43]
    s_add_u32 s33, s33, s89
    ds_read_b64_tr_b16 v[158:159], v12 offset:17504
    v_cvt_pk_bf16_f32 v50, v36, v37
    v_mfma_f32_16x16x32_bf16 v[40:43], v[92:95], v[236:239], v[40:43]
    s_cmp_ge_u32 s33, 135168
    v_exp_f32 v39, v39
    v_mfma_f32_16x16x32_bf16 v[44:47], v[112:115], v[224:227], 0
    s_cselect_b32 s33, s30, s33
    s_mov_b32 m0, s33
    s_and_b32 s96, s32, 0x1e3ff
    v_mfma_f32_16x16x32_bf16 v[44:47], v[116:119], v[228:231], v[44:47]
    s_or_b32 s96, s96, s75
    ds_read_b64_tr_b16 v[176:177], v12 offset:17024
    v_cvt_pk_bf16_f32 v51, v38, v39
    v_mfma_f32_16x16x32_bf16 v[44:47], v[120:123], v[232:235], v[44:47]
    s_waitcnt vmcnt(4)
    ds_read_b64_tr_b16 v[178:179], v12 offset:17536
    v_add_u32 v11, s84, v9
    v_mfma_f32_16x16x32_bf16 v[44:47], v[124:127], v[236:239], v[44:47]
    buffer_load_dwordx4 v3, s[92:95], s96 offen offset:0 nt lds
    v_mfma_f32_16x16x32_bf16 a[128:131], v[208:211], v[48:51], a[128:131]
    v_exp_f32 v40, v40
    v_mfma_f32_16x16x32_bf16 a[132:135], v[212:215], v[48:51], a[132:135]
    v_exp_f32 v41, v41
    v_mfma_f32_16x16x32_bf16 a[136:139], v[216:219], v[48:51], a[136:139]
    ds_read_b64_tr_b16 v[180:181], v12 offset:17056
    v_cvt_pk_bf16_f32 v52, v40, v41
    v_mfma_f32_16x16x32_bf16 a[140:143], v[220:223], v[48:51], a[140:143]
    v_mfma_f32_16x16x32_bf16 a[144:147], v[240:243], v[48:51], a[144:147]
    v_exp_f32 v42, v42
    v_mfma_f32_16x16x32_bf16 a[148:151], v[244:247], v[48:51], a[148:151]
    v_exp_f32 v43, v43
    v_mfma_f32_16x16x32_bf16 a[152:155], v[248:251], v[48:51], a[152:155]
    ds_read_b64_tr_b16 v[182:183], v12 offset:17568
    v_cvt_pk_bf16_f32 v53, v42, v43
    v_mfma_f32_16x16x32_bf16 a[156:159], v[252:255], v[48:51], a[156:159]
    v_exp_f32 v44, v44
    v_mfma_f32_16x16x32_bf16 v[32:35], a[220:223], v[64:67], 0
    v_exp_f32 v45, v45
    v_mfma_f32_16x16x32_bf16 v[32:35], a[224:227], v[68:71], v[32:35]
    v_exp_f32 v46, v46
    v_mfma_f32_16x16x32_bf16 v[32:35], a[228:231], v[72:75], v[32:35]
    s_add_u32 m0, s33, 800
    ds_read_b64_tr_b16 v[184:185], v12 offset:17088
    v_cvt_pk_bf16_f32 v54, v44, v45
    v_mfma_f32_16x16x32_bf16 v[32:35], a[232:235], v[76:79], v[32:35]
    s_waitcnt vmcnt(4)
    v_exp_f32 v47, v47
    v_mfma_f32_16x16x32_bf16 v[36:39], a[236:239], v[64:67], 0
    buffer_load_dwordx4 v3, s[92:95], s96 offen offset:256 nt lds
    v_mfma_f32_16x16x32_bf16 v[36:39], a[240:243], v[68:71], v[36:39]
    ds_read_b64_tr_b16 v[186:187], v12 offset:17600
    v_cvt_pk_bf16_f32 v55, v46, v47
    v_mfma_f32_16x16x32_bf16 v[36:39], a[244:247], v[72:75], v[36:39]
    ds_read_b64_tr_b16 v[188:189], v12 offset:17120
    v_mfma_f32_16x16x32_bf16 v[36:39], a[248:251], v[76:79], v[36:39]
    v_smfmac_f32_16x16x64_bf16 a[200:203], a[216:219], v[48:55], v29
    v_exp_f32 v32, v32
    v_mfma_f32_16x16x32_bf16 a[160:163], v[208:211], v[52:55], a[160:163]
    v_exp_f32 v33, v33
    v_mfma_f32_16x16x32_bf16 a[164:167], v[212:215], v[52:55], a[164:167]
    ds_read_b64_tr_b16 v[190:191], v12 offset:17632
    v_cvt_pk_bf16_f32 v48, v32, v33
    v_mfma_f32_16x16x32_bf16 a[168:171], v[216:219], v[52:55], a[168:171]
    s_add_u32 s88, s88, 1
    s_bitcmp1_b32 s88, 1
    v_mfma_f32_16x16x32_bf16 a[172:175], v[220:223], v[52:55], a[172:175]
    s_cselect_b32 s85, s73, s62
    v_exp_f32 v34, v34
    v_mfma_f32_16x16x32_bf16 a[176:179], v[240:243], v[52:55], a[176:179]
    s_cselect_b64 s[92:93], s[20:21], s[16:17]
    v_exp_f32 v35, v35
    v_mfma_f32_16x16x32_bf16 a[180:183], v[244:247], v[52:55], a[180:183]
    s_bitcmp1_b32 s88, 0
    s_cselect_b32 s85, 512, s85
    v_cvt_pk_bf16_f32 v49, v34, v35
    v_mfma_f32_16x16x32_bf16 a[184:187], v[248:251], v[52:55], a[184:187]
    s_cselect_b32 s89, 2112, s74
    s_add_u32 s32, s32, s85
    s_add_u32 s33, s33, s89
    v_mfma_f32_16x16x32_bf16 a[188:191], v[252:255], v[52:55], a[188:191]
    s_cmp_ge_u32 s33, 135168
    v_exp_f32 v36, v36
    v_mfma_f32_16x16x32_bf16 v[40:43], a[220:223], v[96:99], 0
    s_cselect_b32 s33, s30, s33
    v_exp_f32 v37, v37
    v_mfma_f32_16x16x32_bf16 v[40:43], a[224:227], v[100:103], v[40:43]
    s_mov_b32 m0, s33
    v_exp_f32 v38, v38
    v_mfma_f32_16x16x32_bf16 v[40:43], a[228:231], v[104:107], v[40:43]
    s_and_b32 s96, s32, 0x1e3ff
    s_or_b32 s96, s96, s75
    v_cvt_pk_bf16_f32 v50, v36, v37
    v_mfma_f32_16x16x32_bf16 v[40:43], a[232:235], v[108:111], v[40:43]
    s_waitcnt vmcnt(4)
    v_exp_f32 v39, v39
    v_mfma_f32_16x16x32_bf16 v[44:47], a[236:239], v[96:99], 0
    buffer_load_dwordx4 v3, s[92:95], s96 offen offset:0 nt lds
    v_mfma_f32_16x16x32_bf16 v[44:47], a[240:243], v[100:103], v[44:47]
    v_cvt_pk_bf16_f32 v51, v38, v39
    v_mfma_f32_16x16x32_bf16 v[44:47], a[244:247], v[104:107], v[44:47]
    v_mfma_f32_16x16x32_bf16 v[44:47], a[248:251], v[108:111], v[44:47]
    s_waitcnt vmcnt(9) lgkmcnt(0)
    s_barrier
    v_mfma_f32_16x16x32_bf16 a[0:3], v[144:147], v[48:51], a[0:3]
    v_exp_f32 v40, v40
    v_mfma_f32_16x16x32_bf16 a[4:7], v[148:151], v[48:51], a[4:7]
    v_exp_f32 v41, v41
    v_mfma_f32_16x16x32_bf16 a[8:11], v[152:155], v[48:51], a[8:11]
    ds_read_b128 v[80:83], v11 offset:0
    v_cvt_pk_bf16_f32 v52, v40, v41
    v_mfma_f32_16x16x32_bf16 a[12:15], v[156:159], v[48:51], a[12:15]
    v_mfma_f32_16x16x32_bf16 a[16:19], v[176:179], v[48:51], a[16:19]
    v_exp_f32 v42, v42
    v_mfma_f32_16x16x32_bf16 a[20:23], v[180:183], v[48:51], a[20:23]
    v_exp_f32 v43, v43
    v_mfma_f32_16x16x32_bf16 a[24:27], v[184:187], v[48:51], a[24:27]
    ds_read_b128 v[84:87], v11 offset:64
    v_cvt_pk_bf16_f32 v53, v42, v43
    v_mfma_f32_16x16x32_bf16 a[28:31], v[188:191], v[48:51], a[28:31]
    v_exp_f32 v44, v44
    v_mfma_f32_16x16x32_bf16 v[32:35], a[220:223], v[128:131], 0
    v_exp_f32 v45, v45
    v_mfma_f32_16x16x32_bf16 v[32:35], a[224:227], v[132:135], v[32:35]
    v_exp_f32 v46, v46
    v_mfma_f32_16x16x32_bf16 v[32:35], a[228:231], v[136:139], v[32:35]
    s_add_u32 m0, s33, 800
    ds_read_b128 v[88:91], v11 offset:128
    v_cvt_pk_bf16_f32 v54, v44, v45
    v_mfma_f32_16x16x32_bf16 v[32:35], a[232:235], v[140:143], v[32:35]
    s_waitcnt vmcnt(4)
    v_exp_f32 v47, v47
    v_mfma_f32_16x16x32_bf16 v[36:39], a[236:239], v[128:131], 0
    buffer_load_dwordx4 v3, s[92:95], s96 offen offset:256 nt lds
    v_mfma_f32_16x16x32_bf16 v[36:39], a[240:243], v[132:135], v[36:39]
    s_add_u32 s88, s88, 1
    ds_read_b128 v[92:95], v11 offset:192
    v_cvt_pk_bf16_f32 v55, v46, v47
    v_mfma_f32_16x16x32_bf16 v[36:39], a[244:247], v[136:139], v[36:39]
    s_bitcmp1_b32 s88, 1
    s_cselect_b32 s85, s73, s62
    ds_read_b128 v[112:115], v11 offset:512
    v_mfma_f32_16x16x32_bf16 v[36:39], a[248:251], v[140:143], v[36:39]
    s_cselect_b64 s[92:93], s[20:21], s[16:17]
    s_bitcmp1_b32 s88, 0
    s_cselect_b32 s85, 512, s85
    v_smfmac_f32_16x16x64_bf16 a[192:195], a[216:219], v[48:55], v29
    s_cselect_b32 s89, 2112, s74
    v_exp_f32 v32, v32
    v_mfma_f32_16x16x32_bf16 a[32:35], v[144:147], v[52:55], a[32:35]
    s_add_u32 s32, s32, s85
    v_exp_f32 v33, v33
    v_mfma_f32_16x16x32_bf16 a[36:39], v[148:151], v[52:55], a[36:39]
    s_add_u32 s33, s33, s89
    ds_read_b128 v[116:119], v11 offset:576
    v_cvt_pk_bf16_f32 v48, v32, v33
    v_mfma_f32_16x16x32_bf16 a[40:43], v[152:155], v[52:55], a[40:43]
    s_cmp_ge_u32 s33, 135168
    s_cselect_b32 s33, s30, s33
    s_mov_b32 m0, s33
    v_mfma_f32_16x16x32_bf16 a[44:47], v[156:159], v[52:55], a[44:47]
    s_and_b32 s96, s32, 0x1e3ff
    v_exp_f32 v34, v34
    v_mfma_f32_16x16x32_bf16 a[48:51], v[176:179], v[52:55], a[48:51]
    s_or_b32 s96, s96, s75
    v_exp_f32 v35, v35
    v_mfma_f32_16x16x32_bf16 a[52:55], v[180:183], v[52:55], a[52:55]
    s_waitcnt vmcnt(4)
    ds_read_b128 v[120:123], v11 offset:640
    v_cvt_pk_bf16_f32 v49, v34, v35
    v_mfma_f32_16x16x32_bf16 a[56:59], v[184:187], v[52:55], a[56:59]
    buffer_load_dwordx4 v3, s[92:95], s96 offen offset:0 nt lds
    v_mfma_f32_16x16x32_bf16 a[60:63], v[188:191], v[52:55], a[60:63]
    v_exp_f32 v36, v36
    v_mfma_f32_16x16x32_bf16 v[40:43], a[220:223], v[160:163], 0
    v_exp_f32 v37, v37
    v_mfma_f32_16x16x32_bf16 v[40:43], a[224:227], v[164:167], v[40:43]
    v_exp_f32 v38, v38
    v_mfma_f32_16x16x32_bf16 v[40:43], a[228:231], v[168:171], v[40:43]
    s_add_u32 m0, s33, 800
    ds_read_b128 v[124:127], v11 offset:704
    v_cvt_pk_bf16_f32 v50, v36, v37
    v_mfma_f32_16x16x32_bf16 v[40:43], a[232:235], v[172:175], v[40:43]
    s_waitcnt vmcnt(4)
    v_exp_f32 v39, v39
    v_mfma_f32_16x16x32_bf16 v[44:47], a[236:239], v[160:163], 0
    buffer_load_dwordx4 v3, s[92:95], s96 offen offset:256 nt lds
    v_mfma_f32_16x16x32_bf16 v[44:47], a[240:243], v[164:167], v[44:47]
    v_cvt_pk_bf16_f32 v51, v38, v39
    v_mfma_f32_16x16x32_bf16 v[44:47], a[244:247], v[168:171], v[44:47]
    v_add_u32 v12, s84, v10
    v_mfma_f32_16x16x32_bf16 v[44:47], a[248:251], v[172:175], v[44:47]
    s_waitcnt vmcnt(8) lgkmcnt(0)
    s_barrier
    v_mfma_f32_16x16x32_bf16 a[64:67], v[144:147], v[48:51], a[64:67]
    s_add_u32 s84, s84, 33792
    v_exp_f32 v40, v40
    v_mfma_f32_16x16x32_bf16 a[68:71], v[148:151], v[48:51], a[68:71]
    v_exp_f32 v41, v41
    v_mfma_f32_16x16x32_bf16 a[72:75], v[152:155], v[48:51], a[72:75]
    ds_read_b64_tr_b16 v[208:209], v12 offset:16896
    v_cvt_pk_bf16_f32 v52, v40, v41
    v_mfma_f32_16x16x32_bf16 a[76:79], v[156:159], v[48:51], a[76:79]
    s_cmp_eq_u32 s84, 135168
    s_cselect_b32 s84, 0, s84
    s_add_u32 s88, s88, 1
    v_mfma_f32_16x16x32_bf16 a[80:83], v[176:179], v[48:51], a[80:83]
    s_bitcmp1_b32 s88, 1
    v_exp_f32 v42, v42
    v_mfma_f32_16x16x32_bf16 a[84:87], v[180:183], v[48:51], a[84:87]
    s_cselect_b32 s85, s73, s62
    v_exp_f32 v43, v43
    v_mfma_f32_16x16x32_bf16 a[88:91], v[184:187], v[48:51], a[88:91]
    s_cselect_b64 s[92:93], s[20:21], s[16:17]
    ds_read_b64_tr_b16 v[210:211], v12 offset:17408
    v_cvt_pk_bf16_f32 v53, v42, v43
    v_mfma_f32_16x16x32_bf16 a[92:95], v[188:191], v[48:51], a[92:95]
    s_bitcmp1_b32 s88, 0
    v_exp_f32 v44, v44
    v_mfma_f32_16x16x32_bf16 v[32:35], a[220:223], v[192:195], 0
    s_cselect_b32 s85, 512, s85
    v_exp_f32 v45, v45
    v_mfma_f32_16x16x32_bf16 v[32:35], a[224:227], v[196:199], v[32:35]
    s_cselect_b32 s89, 2112, s74
    v_exp_f32 v46, v46
    v_mfma_f32_16x16x32_bf16 v[32:35], a[228:231], v[200:203], v[32:35]
    s_add_u32 s32, s32, s85
    ds_read_b64_tr_b16 v[212:213], v12 offset:16928
    v_cvt_pk_bf16_f32 v54, v44, v45
    v_mfma_f32_16x16x32_bf16 v[32:35], a[232:235], v[204:207], v[32:35]
    s_add_u32 s33, s33, s89
    v_exp_f32 v47, v47
    v_mfma_f32_16x16x32_bf16 v[36:39], a[236:239], v[192:195], 0
    s_cmp_ge_u32 s33, 135168
    s_cselect_b32 s33, s30, s33
    s_mov_b32 m0, s33
    v_mfma_f32_16x16x32_bf16 v[36:39], a[240:243], v[196:199], v[36:39]
    s_and_b32 s96, s32, 0x1e3ff
    ds_read_b64_tr_b16 v[214:215], v12 offset:17440
    v_cvt_pk_bf16_f32 v55, v46, v47
    v_mfma_f32_16x16x32_bf16 v[36:39], a[244:247], v[200:203], v[36:39]
    s_or_b32 s96, s96, s75
    s_waitcnt vmcnt(4)
    ds_read_b64_tr_b16 v[216:217], v12 offset:16960
    v_mfma_f32_16x16x32_bf16 v[36:39], a[248:251], v[204:207], v[36:39]
    buffer_load_dwordx4 v3, s[92:95], s96 offen offset:0 nt lds
    v_smfmac_f32_16x16x64_bf16 a[196:199], a[216:219], v[48:55], v29
    v_exp_f32 v32, v32
    v_mfma_f32_16x16x32_bf16 a[96:99], v[144:147], v[52:55], a[96:99]
    v_exp_f32 v33, v33
    v_mfma_f32_16x16x32_bf16 a[100:103], v[148:151], v[52:55], a[100:103]
    ds_read_b64_tr_b16 v[218:219], v12 offset:17472
    v_cvt_pk_bf16_f32 v48, v32, v33
    v_mfma_f32_16x16x32_bf16 a[104:107], v[152:155], v[52:55], a[104:107]
    v_mfma_f32_16x16x32_bf16 a[108:111], v[156:159], v[52:55], a[108:111]
    v_exp_f32 v34, v34
    v_mfma_f32_16x16x32_bf16 a[112:115], v[176:179], v[52:55], a[112:115]
    v_exp_f32 v35, v35
    v_mfma_f32_16x16x32_bf16 a[116:119], v[180:183], v[52:55], a[116:119]
    ds_read_b64_tr_b16 v[220:221], v12 offset:16992
    v_cvt_pk_bf16_f32 v49, v34, v35
    v_mfma_f32_16x16x32_bf16 a[120:123], v[184:187], v[52:55], a[120:123]
    v_mfma_f32_16x16x32_bf16 a[124:127], v[188:191], v[52:55], a[124:127]
    v_exp_f32 v36, v36
    v_mfma_f32_16x16x32_bf16 v[40:43], a[220:223], v[224:227], 0
    v_exp_f32 v37, v37
    v_mfma_f32_16x16x32_bf16 v[40:43], a[224:227], v[228:231], v[40:43]
    v_exp_f32 v38, v38
    v_mfma_f32_16x16x32_bf16 v[40:43], a[228:231], v[232:235], v[40:43]
    ds_read_b64_tr_b16 v[222:223], v12 offset:17504
    v_cvt_pk_bf16_f32 v50, v36, v37
    v_mfma_f32_16x16x32_bf16 v[40:43], a[232:235], v[236:239], v[40:43]
    v_exp_f32 v39, v39
    v_mfma_f32_16x16x32_bf16 v[44:47], a[236:239], v[224:227], 0
    v_mfma_f32_16x16x32_bf16 v[44:47], a[240:243], v[228:231], v[44:47]
    s_add_u32 m0, s33, 800
    ds_read_b64_tr_b16 v[240:241], v12 offset:17024
    v_cvt_pk_bf16_f32 v51, v38, v39
    v_mfma_f32_16x16x32_bf16 v[44:47], a[244:247], v[232:235], v[44:47]
    s_waitcnt vmcnt(4)
    ds_read_b64_tr_b16 v[242:243], v12 offset:17536
    v_add_u32 v11, s84, v9
    v_mfma_f32_16x16x32_bf16 v[44:47], a[248:251], v[236:239], v[44:47]
    buffer_load_dwordx4 v3, s[92:95], s96 offen offset:256 nt lds
    v_mfma_f32_16x16x32_bf16 a[128:131], v[144:147], v[48:51], a[128:131]
    s_add_u32 s88, s88, 1
    s_bitcmp1_b32 s88, 1
    v_exp_f32 v40, v40
    v_mfma_f32_16x16x32_bf16 a[132:135], v[148:151], v[48:51], a[132:135]
    s_cselect_b32 s85, s73, s62
    v_exp_f32 v41, v41
    v_mfma_f32_16x16x32_bf16 a[136:139], v[152:155], v[48:51], a[136:139]
    s_cselect_b64 s[92:93], s[20:21], s[16:17]
    ds_read_b64_tr_b16 v[244:245], v12 offset:17056
    v_cvt_pk_bf16_f32 v52, v40, v41
    v_mfma_f32_16x16x32_bf16 a[140:143], v[156:159], v[48:51], a[140:143]
    s_bitcmp1_b32 s88, 0
    s_cselect_b32 s85, 512, s85
    s_cselect_b32 s89, 2112, s74
    v_mfma_f32_16x16x32_bf16 a[144:147], v[176:179], v[48:51], a[144:147]
    s_add_u32 s32, s32, s85
    v_exp_f32 v42, v42
    v_mfma_f32_16x16x32_bf16 a[148:151], v[180:183], v[48:51], a[148:151]
    s_add_u32 s33, s33, s89
    v_exp_f32 v43, v43
    v_mfma_f32_16x16x32_bf16 a[152:155], v[184:187], v[48:51], a[152:155]
    s_cmp_ge_u32 s33, 135168
    ds_read_b64_tr_b16 v[246:247], v12 offset:17568
    v_cvt_pk_bf16_f32 v53, v42, v43
    v_mfma_f32_16x16x32_bf16 a[156:159], v[188:191], v[48:51], a[156:159]
    s_cselect_b32 s33, s30, s33
    v_exp_f32 v44, v44
    v_mfma_f32_16x16x32_bf16 v[32:35], v[80:83], v[64:67], 0
    s_mov_b32 m0, s33
    v_exp_f32 v45, v45
    v_mfma_f32_16x16x32_bf16 v[32:35], v[84:87], v[68:71], v[32:35]
    s_and_b32 s96, s32, 0x1e3ff
    v_exp_f32 v46, v46
    v_mfma_f32_16x16x32_bf16 v[32:35], v[88:91], v[72:75], v[32:35]
    s_or_b32 s96, s96, s75
    ds_read_b64_tr_b16 v[248:249], v12 offset:17088
    v_cvt_pk_bf16_f32 v54, v44, v45
    v_mfma_f32_16x16x32_bf16 v[32:35], v[92:95], v[76:79], v[32:35]
    s_waitcnt vmcnt(4)
    v_exp_f32 v47, v47
    v_mfma_f32_16x16x32_bf16 v[36:39], v[112:115], v[64:67], 0
    buffer_load_dwordx4 v3, s[92:95], s96 offen offset:0 nt lds
    v_mfma_f32_16x16x32_bf16 v[36:39], v[116:119], v[68:71], v[36:39]
    ds_read_b64_tr_b16 v[250:251], v12 offset:17600
    v_cvt_pk_bf16_f32 v55, v46, v47
    v_mfma_f32_16x16x32_bf16 v[36:39], v[120:123], v[72:75], v[36:39]
    ds_read_b64_tr_b16 v[252:253], v12 offset:17120
    v_mfma_f32_16x16x32_bf16 v[36:39], v[124:127], v[76:79], v[36:39]
    v_smfmac_f32_16x16x64_bf16 a[200:203], a[216:219], v[48:55], v29
    v_exp_f32 v32, v32
    v_mfma_f32_16x16x32_bf16 a[160:163], v[144:147], v[52:55], a[160:163]
    v_exp_f32 v33, v33
    v_mfma_f32_16x16x32_bf16 a[164:167], v[148:151], v[52:55], a[164:167]
    ds_read_b64_tr_b16 v[254:255], v12 offset:17632
    v_cvt_pk_bf16_f32 v48, v32, v33
    v_mfma_f32_16x16x32_bf16 a[168:171], v[152:155], v[52:55], a[168:171]
    v_mfma_f32_16x16x32_bf16 a[172:175], v[156:159], v[52:55], a[172:175]
    v_exp_f32 v34, v34
    v_mfma_f32_16x16x32_bf16 a[176:179], v[176:179], v[52:55], a[176:179]
    v_exp_f32 v35, v35
    v_mfma_f32_16x16x32_bf16 a[180:183], v[180:183], v[52:55], a[180:183]
    s_add_u32 m0, s33, 800
    s_waitcnt vmcnt(4)
    v_cvt_pk_bf16_f32 v49, v34, v35
    v_mfma_f32_16x16x32_bf16 a[184:187], v[184:187], v[52:55], a[184:187]
    buffer_load_dwordx4 v3, s[92:95], s96 offen offset:256 nt lds
    v_mfma_f32_16x16x32_bf16 a[188:191], v[188:191], v[52:55], a[188:191]
    v_exp_f32 v36, v36
    v_mfma_f32_16x16x32_bf16 v[40:43], v[80:83], v[96:99], 0
    v_exp_f32 v37, v37
    v_mfma_f32_16x16x32_bf16 v[40:43], v[84:87], v[100:103], v[40:43]
    v_exp_f32 v38, v38
    v_mfma_f32_16x16x32_bf16 v[40:43], v[88:91], v[104:107], v[40:43]
    v_cvt_pk_bf16_f32 v50, v36, v37
    v_mfma_f32_16x16x32_bf16 v[40:43], v[92:95], v[108:111], v[40:43]
    v_exp_f32 v39, v39
    v_mfma_f32_16x16x32_bf16 v[44:47], v[112:115], v[96:99], 0
    s_cmp_lt_u32 s7, 6
    s_cbranch_scc1 K1_ALOOP1
K1_AEXIT:
    s_cmp_eq_u32 s37, 0
    s_cbranch_scc1 K1_TAILA
    v_mfma_f32_16x16x32_bf16 v[44:47], v[116:119], v[100:103], v[44:47]
    s_or_b32 s85, s63, s87
    v_cvt_pk_bf16_f32 v51, v38, v39
    v_mfma_f32_16x16x32_bf16 v[44:47], v[120:123], v[104:107], v[44:47]
    s_cmp_eq_u32 s85, 0
    s_cselect_b32 s33, -1, 0
    s_cselect_b32 s50, s50, 0
    v_mfma_f32_16x16x32_bf16 v[44:47], v[124:127], v[108:111], v[44:47]
    s_waitcnt vmcnt(8) lgkmcnt(0)
    s_barrier
    v_mfma_f32_16x16x32_bf16 a[0:3], v[208:211], v[48:51], a[0:3]
    s_add_u32 m0, s30, 118272
    s_mul_i32 s35, s80, 15
    s_add_u32 s35, s35, s101
    s_and_b32 s35, s35, 0x1e000
    v_exp_f32 v40, v40
    v_mfma_f32_16x16x32_bf16 a[4:7], v[212:215], v[48:51], a[4:7]
    s_or_b32 s35, s35, s75
    v_exp_f32 v41, v41
    v_mfma_f32_16x16x32_bf16 a[8:11], v[216:219], v[48:51], a[8:11]
    s_waitcnt vmcnt(4)
    ds_read_b128 a[220:223], v11 offset:0
    v_cvt_pk_bf16_f32 v52, v40, v41
    v_mfma_f32_16x16x32_bf16 a[12:15], v[220:223], v[48:51], a[12:15]
    buffer_load_dwordx4 v3, s[20:23], s35 offen offset:0 nt lds
    v_mfma_f32_16x16x32_bf16 a[16:19], v[240:243], v[48:51], a[16:19]
    v_exp_f32 v42, v42
    v_mfma_f32_16x16x32_bf16 a[20:23], v[244:247], v[48:51], a[20:23]
    v_exp_f32 v43, v43
    v_mfma_f32_16x16x32_bf16 a[24:27], v[248:251], v[48:51], a[24:27]
    ds_read_b128 a[224:227], v11 offset:64
    v_cvt_pk_bf16_f32 v53, v42, v43
    v_mfma_f32_16x16x32_bf16 a[28:31], v[252:255], v[48:51], a[28:31]
    v_exp_f32 v44, v44
    v_mfma_f32_16x16x32_bf16 v[32:35], v[80:83], v[128:131], 0
    v_exp_f32 v45, v45
    v_mfma_f32_16x16x32_bf16 v[32:35], v[84:87], v[132:135], v[32:35]
    v_exp_f32 v46, v46
    v_mfma_f32_16x16x32_bf16 v[32:35], v[88:91], v[136:139], v[32:35]
    s_add_u32 m0, s30, 119072
    ds_read_b128 a[228:231], v11 offset:128
    v_cvt_pk_bf16_f32 v54, v44, v45
    v_mfma_f32_16x16x32_bf16 v[32:35], v[92:95], v[140:143], v[32:35]
    s_waitcnt vmcnt(4)
    v_exp_f32 v47, v47
    v_mfma_f32_16x16x32_bf16 v[36:39], v[112:115], v[128:131], 0
    buffer_load_dwordx4 v3, s[20:23], s35 offen offset:256 nt lds
    v_mfma_f32_16x16x32_bf16 v[36:39], v[116:119], v[132:135], v[36:39]
    ds_read_b128 a[232:235], v11 offset:192
    v_cvt_pk_bf16_f32 v55, v46, v47
    v_mfma_f32_16x16x32_bf16 v[36:39], v[120:123], v[136:139], v[36:39]
    ds_read_b128 a[236:239], v11 offset:512
    v_mfma_f32_16x16x32_bf16 v[36:39], v[124:127], v[140:143], v[36:39]
    v_smfmac_f32_16x16x64_bf16 a[192:195], a[216:219], v[48:55], v29
    v_exp_f32 v32, v32
    v_mfma_f32_16x16x32_bf16 a[32:35], v[208:211], v[52:55], a[32:35]
    s_add_u32 m0, s30, 119872
    v_exp_f32 v33, v33
    v_mfma_f32_16x16x32_bf16 a[36:39], v[212:215], v[52:55], a[36:39]
    s_waitcnt vmcnt(4)
    ds_read_b128 a[240:243], v11 offset:576
    v_cvt_pk_bf16_f32 v48, v32, v33
    v_mfma_f32_16x16x32_bf16 a[40:43], v[216:219], v[52:55], a[40:43]
    buffer_load_dwordx4 v3, s[20:23], s35 offen offset:512 nt lds
    v_mfma_f32_16x16x32_bf16 a[44:47], v[220:223], v[52:55], a[44:47]
    v_exp_f32 v34, v34
    v_mfma_f32_16x16x32_bf16 a[48:51], v[240:243], v[52:55], a[48:51]
    v_exp_f32 v35, v35
    v_mfma_f32_16x16x32_bf16 a[52:55], v[244:247], v[52:55], a[52:55]
    ds_read_b128 a[244:247], v11 offset:640
    v_cvt_pk_bf16_f32 v49, v34, v35
    v_mfma_f32_16x16x32_bf16 a[56:59], v[248:251], v[52:55], a[56:59]
    v_mfma_f32_16x16x32_bf16 a[60:63], v[252:255], v[52:55], a[60:63]
    v_exp_f32 v36, v36
    v_mfma_f32_16x16x32_bf16 v[40:43], v[80:83], v[160:163], 0
    v_exp_f32 v37, v37
    v_mfma_f32_16x16x32_bf16 v[40:43], v[84:87], v[164:167], v[40:43]
    v_exp_f32 v38, v38
    v_mfma_f32_16x16x32_bf16 v[40:43], v[88:91], v[168:171], v[40:43]
    s_add_u32 m0, s30, 120672
    ds_read_b128 a[248:251], v11 offset:704
    v_cvt_pk_bf16_f32 v50, v36, v37
    v_mfma_f32_16x16x32_bf16 v[40:43], v[92:95], v[172:175], v[40:43]
    s_waitcnt vmcnt(4)
    v_exp_f32 v39, v39
    v_mfma_f32_16x16x32_bf16 v[44:47], v[112:115], v[160:163], 0
    buffer_load_dwordx4 v3, s[20:23], s35 offen offset:768 nt lds
    v_mfma_f32_16x16x32_bf16 v[44:47], v[116:119], v[164:167], v[44:47]
    v_cvt_pk_bf16_f32 v51, v38, v39
    v_mfma_f32_16x16x32_bf16 v[44:47], v[120:123], v[168:171], v[44:47]
    v_add_u32 v12, s84, v10
    v_mfma_f32_16x16x32_bf16 v[44:47], v[124:127], v[172:175], v[44:47]
    s_waitcnt vmcnt(8) lgkmcnt(0)
    s_barrier
    v_mfma_f32_16x16x32_bf16 a[64:67], v[208:211], v[48:51], a[64:67]
    v_exp_f32 v40, v40
    v_mfma_f32_16x16x32_bf16 a[68:71], v[212:215], v[48:51], a[68:71]
    v_exp_f32 v41, v41
    v_mfma_f32_16x16x32_bf16 a[72:75], v[216:219], v[48:51], a[72:75]
    ds_read_b64_tr_b16 v[144:145], v12 offset:16896
    v_cvt_pk_bf16_f32 v52, v40, v41
    v_mfma_f32_16x16x32_bf16 a[76:79], v[220:223], v[48:51], a[76:79]
    v_mfma_f32_16x16x32_bf16 a[80:83], v[240:243], v[48:51], a[80:83]
    v_exp_f32 v42, v42
    v_mfma_f32_16x16x32_bf16 a[84:87], v[244:247], v[48:51], a[84:87]
    v_exp_f32 v43, v43
    v_mfma_f32_16x16x32_bf16 a[88:91], v[248:251], v[48:51], a[88:91]
    ds_read_b64_tr_b16 v[146:147], v12 offset:17408
    v_cvt_pk_bf16_f32 v53, v42, v43
    v_mfma_f32_16x16x32_bf16 a[92:95], v[252:255], v[48:51], a[92:95]
    v_exp_f32 v44, v44
    v_mfma_f32_16x16x32_bf16 v[32:35], v[80:83], v[192:195], 0
    v_exp_f32 v45, v45
    v_mfma_f32_16x16x32_bf16 v[32:35], v[84:87], v[196:199], v[32:35]
    v_exp_f32 v46, v46
    v_mfma_f32_16x16x32_bf16 v[32:35], v[88:91], v[200:203], v[32:35]
    ds_read_b64_tr_b16 v[148:149], v12 offset:16928
    v_cvt_pk_bf16_f32 v54, v44, v45
    v_mfma_f32_16x16x32_bf16 v[32:35], v[92:95], v[204:207], v[32:35]
    v_exp_f32 v47, v47
    v_mfma_f32_16x16x32_bf16 v[36:39], v[112:115], v[192:195], 0
    v_mfma_f32_16x16x32_bf16 v[36:39], v[116:119], v[196:199], v[36:39]
    ds_read_b64_tr_b16 v[150:151], v12 offset:17440
    v_cvt_pk_bf16_f32 v55, v46, v47
    v_mfma_f32_16x16x32_bf16 v[36:39], v[120:123], v[200:203], v[36:39]
    ds_read_b64_tr_b16 v[152:153], v12 offset:16960
    v_mfma_f32_16x16x32_bf16 v[36:39], v[124:127], v[204:207], v[36:39]
    v_smfmac_f32_16x16x64_bf16 a[196:199], a[216:219], v[48:55], v29
    v_exp_f32 v32, v32
    v_mfma_f32_16x16x32_bf16 a[96:99], v[208:211], v[52:55], a[96:99]
    v_exp_f32 v33, v33
    v_mfma_f32_16x16x32_bf16 a[100:103], v[212:215], v[52:55], a[100:103]
    ds_read_b64_tr_b16 v[154:155], v12 offset:17472
    v_cvt_pk_bf16_f32 v48, v32, v33
    v_mfma_f32_16x16x32_bf16 a[104:107], v[216:219], v[52:55], a[104:107]
    v_mfma_f32_16x16x32_bf16 a[108:111], v[220:223], v[52:55], a[108:111]
    v_exp_f32 v34, v34
    v_mfma_f32_16x16x32_bf16 a[112:115], v[240:243], v[52:55], a[112:115]
    v_exp_f32 v35, v35
    v_mfma_f32_16x16x32_bf16 a[116:119], v[244:247], v[52:55], a[116:119]
    ds_read_b64_tr_b16 v[156:157], v12 offset:16992
    v_cvt_pk_bf16_f32 v49, v34, v35
    v_mfma_f32_16x16x32_bf16 a[120:123], v[248:251], v[52:55], a[120:123]
    v_mfma_f32_16x16x32_bf16 a[124:127], v[252:255], v[52:55], a[124:127]
    v_exp_f32 v36, v36
    v_mfma_f32_16x16x32_bf16 v[40:43], v[80:83], v[224:227], 0
    v_exp_f32 v37, v37
    v_mfma_f32_16x16x32_bf16 v[40:43], v[84:87], v[228:231], v[40:43]
    s_add_u32 m0, s30, 33792
    v_exp_f32 v38, v38
    v_mfma_f32_16x16x32_bf16 v[40:43], v[88:91], v[232:235], v[40:43]
    s_xor_b32 s35, s72, 0
    ds_read_b64_tr_b16 v[158:159], v12 offset:17504
    v_cvt_pk_bf16_f32 v50, v36, v37
    v_mfma_f32_16x16x32_bf16 v[40:43], v[92:95], v[236:239], v[40:43]
    s_mul_i32 s35, s35, 40960
    v_exp_f32 v39, v39
    v_mfma_f32_16x16x32_bf16 v[44:47], v[112:115], v[224:227], 0
    buffer_load_dwordx4 v16, s[52:55], s35 offen offset:0 lds
    v_mfma_f32_16x16x32_bf16 v[44:47], v[116:119], v[228:231], v[44:47]
    ds_read_b64_tr_b16 v[176:177], v12 offset:17024
    v_cvt_pk_bf16_f32 v51, v38, v39
    v_mfma_f32_16x16x32_bf16 v[44:47], v[120:123], v[232:235], v[44:47]
    s_add_u32 m0, s30, 33568
    ds_read_b64_tr_b16 v[178:179], v12 offset:17536
    v_mfma_f32_16x16x32_bf16 v[44:47], v[124:127], v[236:239], v[44:47]
    buffer_load_dwordx4 v16, s[52:55], s35 offen offset:1280 lds
    v_mfma_f32_16x16x32_bf16 a[128:131], v[208:211], v[48:51], a[128:131]
    v_exp_f32 v40, v40
    v_mfma_f32_16x16x32_bf16 a[132:135], v[212:215], v[48:51], a[132:135]
    v_exp_f32 v41, v41
    v_mfma_f32_16x16x32_bf16 a[136:139], v[216:219], v[48:51], a[136:139]
    s_add_u32 m0, s30, 33344
    ds_read_b64_tr_b16 v[180:181], v12 offset:17056
    v_cvt_pk_bf16_f32 v52, v40, v41
    v_mfma_f32_16x16x32_bf16 a[140:143], v[220:223], v[48:51], a[140:143]
    buffer_load_dwordx4 v16, s[52:55], s35 offen offset:2560 lds
    v_mfma_f32_16x16x32_bf16 a[144:147], v[240:243], v[48:51], a[144:147]
    v_exp_f32 v42, v42
    v_mfma_f32_16x16x32_bf16 a[148:151], v[244:247], v[48:51], a[148:151]
    v_exp_f32 v43, v43
    v_mfma_f32_16x16x32_bf16 a[152:155], v[248:251], v[48:51], a[152:155]
    ds_read_b64_tr_b16 v[182:183], v12 offset:17568
    v_cvt_pk_bf16_f32 v53, v42, v43
    v_mfma_f32_16x16x32_bf16 a[156:159], v[252:255], v[48:51], a[156:159]
    v_exp_f32 v44, v44
    v_mfma_f32_16x16x32_bf16 v[32:35], a[220:223], v[64:67], 0
    v_exp_f32 v45, v45
    v_mfma_f32_16x16x32_bf16 v[32:35], a[224:227], v[68:71], v[32:35]
    v_exp_f32 v46, v46
    v_mfma_f32_16x16x32_bf16 v[32:35], a[228:231], v[72:75], v[32:35]
    ds_read_b64_tr_b16 v[184:185], v12 offset:17088
    v_cvt_pk_bf16_f32 v54, v44, v45
    v_mfma_f32_16x16x32_bf16 v[32:35], a[232:235], v[76:79], v[32:35]
    s_add_u32 m0, s30, 33120
    v_exp_f32 v47, v47
    v_mfma_f32_16x16x32_bf16 v[36:39], a[236:239], v[64:67], 0
    buffer_load_dwordx4 v16, s[52:55], s35 offen offset:3840 lds
    v_mfma_f32_16x16x32_bf16 v[36:39], a[240:243], v[68:71], v[36:39]
    s_add_u32 m0, s30, 50688
    ds_read_b64_tr_b16 v[186:187], v12 offset:17600
    v_cvt_pk_bf16_f32 v55, v46, v47
    v_mfma_f32_16x16x32_bf16 v[36:39], a[244:247], v[72:75], v[36:39]
    s_xor_b32 s35, s72, 1
    s_mul_i32 s35, s35, 40960
    ds_read_b64_tr_b16 v[188:189], v12 offset:17120
    v_mfma_f32_16x16x32_bf16 v[36:39], a[248:251], v[76:79], v[36:39]
    buffer_load_dwordx4 v16, s[52:55], s35 offen offset:0 lds
    v_smfmac_f32_16x16x64_bf16 a[200:203], a[216:219], v[48:55], v29
    v_exp_f32 v32, v32
    v_mfma_f32_16x16x32_bf16 a[160:163], v[208:211], v[52:55], a[160:163]
    v_exp_f32 v33, v33
    v_mfma_f32_16x16x32_bf16 a[164:167], v[212:215], v[52:55], a[164:167]
    s_add_u32 m0, s30, 50464
    ds_read_b64_tr_b16 v[190:191], v12 offset:17632
    v_cvt_pk_bf16_f32 v48, v32, v33
    v_mfma_f32_16x16x32_bf16 a[168:171], v[216:219], v[52:55], a[168:171]
    buffer_load_dwordx4 v16, s[52:55], s35 offen offset:1280 lds
    v_mfma_f32_16x16x32_bf16 a[172:175], v[220:223], v[52:55], a[172:175]
    v_exp_f32 v34, v34
    v_mfma_f32_16x16x32_bf16 a[176:179], v[240:243], v[52:55], a[176:179]
    v_exp_f32 v35, v35
    v_mfma_f32_16x16x32_bf16 a[180:183], v[244:247], v[52:55], a[180:183]
    s_add_u32 m0, s30, 50240
    v_cvt_pk_bf16_f32 v49, v34, v35
    v_mfma_f32_16x16x32_bf16 a[184:187], v[248:251], v[52:55], a[184:187]
    buffer_load_dwordx4 v16, s[52:55], s35 offen offset:2560 lds
    v_mfma_f32_16x16x32_bf16 a[188:191], v[252:255], v[52:55], a[188:191]
    v_exp_f32 v36, v36
    v_mfma_f32_16x16x32_bf16 v[40:43], a[220:223], v[96:99], 0
    v_exp_f32 v37, v37
    v_mfma_f32_16x16x32_bf16 v[40:43], a[224:227], v[100:103], v[40:43]
    v_exp_f32 v38, v38
    v_mfma_f32_16x16x32_bf16 v[40:43], a[228:231], v[104:107], v[40:43]
    v_cvt_pk_bf16_f32 v50, v36, v37
    v_mfma_f32_16x16x32_bf16 v[40:43], a[232:235], v[108:111], v[40:43]
    s_add_u32 m0, s30, 50016
    v_exp_f32 v39, v39
    v_mfma_f32_16x16x32_bf16 v[44:47], a[236:239], v[96:99], 0
    buffer_load_dwordx4 v16, s[52:55], s35 offen offset:3840 lds
    v_mfma_f32_16x16x32_bf16 v[44:47], a[240:243], v[100:103], v[44:47]
    s_add_u32 m0, s30, 67584
    s_xor_b32 s35, s72, 2
    s_mul_i32 s35, s35, 40960
    v_cvt_pk_bf16_f32 v51, v38, v39
    v_mfma_f32_16x16x32_bf16 v[44:47], a[244:247], v[104:107], v[44:47]
    buffer_load_dwordx4 v16, s[52:55], s35 offen offset:0 lds
    v_mfma_f32_16x16x32_bf16 v[44:47], a[248:251], v[108:111], v[44:47]
    s_waitcnt vmcnt(13) lgkmcnt(0)
    s_barrier
    v_mfma_f32_16x16x32_bf16 a[0:3], v[144:147], v[48:51], a[0:3]
    v_exp_f32 v40, v40
    v_mfma_f32_16x16x32_bf16 a[4:7], v[148:151], v[48:51], a[4:7]
    v_exp_f32 v41, v41
    v_mfma_f32_16x16x32_bf16 a[8:11], v[152:155], v[48:51], a[8:11]
    s_add_u32 m0, s30, 67360
    ds_read_b128 v[80:83], v11 offset:33792
    v_cvt_pk_bf16_f32 v52, v40, v41
    v_mfma_f32_16x16x32_bf16 a[12:15], v[156:159], v[48:51], a[12:15]
    buffer_load_dwordx4 v16, s[52:55], s35 offen offset:1280 lds
    v_mfma_f32_16x16x32_bf16 a[16:19], v[176:179], v[48:51], a[16:19]
    v_exp_f32 v42, v42
    v_mfma_f32_16x16x32_bf16 a[20:23], v[180:183], v[48:51], a[20:23]
    v_exp_f32 v43, v43
    v_mfma_f32_16x16x32_bf16 a[24:27], v[184:187], v[48:51], a[24:27]
    ds_read_b128 v[84:87], v11 offset:33856
    v_cvt_pk_bf16_f32 v53, v42, v43
    v_mfma_f32_16x16x32_bf16 a[28:31], v[188:191], v[48:51], a[28:31]
    v_exp_f32 v44, v44
    v_mfma_f32_16x16x32_bf16 v[32:35], a[220:223], v[128:131], 0
    v_exp_f32 v45, v45
    v_mfma_f32_16x16x32_bf16 v[32:35], a[224:227], v[132:135], v[32:35]
    v_exp_f32 v46, v46
    v_mfma_f32_16x16x32_bf16 v[32:35], a[228:231], v[136:139], v[32:35]
    ds_read_b128 v[88:91], v11 offset:33920
    v_cvt_pk_bf16_f32 v54, v44, v45
    v_mfma_f32_16x16x32_bf16 v[32:35], a[232:235], v[140:143], v[32:35]
    s_add_u32 m0, s30, 67136
    v_exp_f32 v47, v47
    v_mfma_f32_16x16x32_bf16 v[36:39], a[236:239], v[128:131], 0
    buffer_load_dwordx4 v16, s[52:55], s35 offen offset:2560 lds
    v_mfma_f32_16x16x32_bf16 v[36:39], a[240:243], v[132:135], v[36:39]
    ds_read_b128 v[92:95], v11 offset:33984
    v_cvt_pk_bf16_f32 v55, v46, v47
    v_mfma_f32_16x16x32_bf16 v[36:39], a[244:247], v[136:139], v[36:39]
    s_add_u32 m0, s30, 66912
    ds_read_b128 v[112:115], v11 offset:34304
    v_mfma_f32_16x16x32_bf16 v[36:39], a[248:251], v[140:143], v[36:39]
    buffer_load_dwordx4 v16, s[52:55], s35 offen offset:3840 lds
    v_smfmac_f32_16x16x64_bf16 a[192:195], a[216:219], v[48:55], v29
    s_add_u32 m0, s30, 135168
    v_exp_f32 v32, v32
    v_mfma_f32_16x16x32_bf16 a[32:35], v[144:147], v[52:55], a[32:35]
    s_xor_b32 s35, s72, 4
    v_exp_f32 v33, v33
    v_mfma_f32_16x16x32_bf16 a[36:39], v[148:151], v[52:55], a[36:39]
    s_mul_i32 s35, s35, 40960
    ds_read_b128 v[116:119], v11 offset:34368
    v_cvt_pk_bf16_f32 v48, v32, v33
    v_mfma_f32_16x16x32_bf16 a[40:43], v[152:155], v[52:55], a[40:43]
    buffer_load_dwordx4 v16, s[52:55], s35 offen offset:0 lds
    v_mfma_f32_16x16x32_bf16 a[44:47], v[156:159], v[52:55], a[44:47]
    v_exp_f32 v34, v34
    v_mfma_f32_16x16x32_bf16 a[48:51], v[176:179], v[52:55], a[48:51]
    v_exp_f32 v35, v35
    v_mfma_f32_16x16x32_bf16 a[52:55], v[180:183], v[52:55], a[52:55]
    s_add_u32 m0, s30, 134944
    ds_read_b128 v[120:123], v11 offset:34432
    v_cvt_pk_bf16_f32 v49, v34, v35
    v_mfma_f32_16x16x32_bf16 a[56:59], v[184:187], v[52:55], a[56:59]
    buffer_load_dwordx4 v16, s[52:55], s35 offen offset:1280 lds
    v_mfma_f32_16x16x32_bf16 a[60:63], v[188:191], v[52:55], a[60:63]
    v_exp_f32 v36, v36
    v_mfma_f32_16x16x32_bf16 v[40:43], a[220:223], v[160:163], 0
    v_exp_f32 v37, v37
    v_mfma_f32_16x16x32_bf16 v[40:43], a[224:227], v[164:167], v[40:43]
    v_exp_f32 v38, v38
    v_mfma_f32_16x16x32_bf16 v[40:43], a[228:231], v[168:171], v[40:43]
    ds_read_b128 v[124:127], v11 offset:34496
    v_cvt_pk_bf16_f32 v50, v36, v37
    v_mfma_f32_16x16x32_bf16 v[40:43], a[232:235], v[172:175], v[40:43]
    s_add_u32 m0, s30, 134720
    v_exp_f32 v39, v39
    v_mfma_f32_16x16x32_bf16 v[44:47], a[236:239], v[160:163], 0
    buffer_load_dwordx4 v16, s[52:55], s35 offen offset:2560 lds
    v_mfma_f32_16x16x32_bf16 v[44:47], a[240:243], v[164:167], v[44:47]
    s_add_u32 m0, s30, 134496
    v_cvt_pk_bf16_f32 v51, v38, v39
    v_mfma_f32_16x16x32_bf16 v[44:47], a[244:247], v[168:171], v[44:47]
    buffer_load_dwordx4 v16, s[52:55], s35 offen offset:3840 lds
    v_mfma_f32_16x16x32_bf16 v[44:47], a[248:251], v[172:175], v[44:47]
    s_waitcnt vmcnt(16) lgkmcnt(0)
    s_barrier
    v_mfma_f32_16x16x32_bf16 a[64:67], v[144:147], v[48:51], a[64:67]
    s_add_u32 m0, s30, 16896
    v_exp_f32 v40, v40
    v_mfma_f32_16x16x32_bf16 a[68:71], v[148:151], v[48:51], a[68:71]
    s_xor_b32 s35, s72, 5
    v_exp_f32 v41, v41
    v_mfma_f32_16x16x32_bf16 a[72:75], v[152:155], v[48:51], a[72:75]
    s_mul_i32 s35, s35, 40960
    ds_read_b64_tr_b16 v[208:209], v12 offset:50688
    v_cvt_pk_bf16_f32 v52, v40, v41
    v_mfma_f32_16x16x32_bf16 a[76:79], v[156:159], v[48:51], a[76:79]
    buffer_load_dwordx4 v16, s[52:55], s35 offen offset:0 lds
    v_mfma_f32_16x16x32_bf16 a[80:83], v[176:179], v[48:51], a[80:83]
    v_exp_f32 v42, v42
    v_mfma_f32_16x16x32_bf16 a[84:87], v[180:183], v[48:51], a[84:87]
    v_exp_f32 v43, v43
    v_mfma_f32_16x16x32_bf16 a[88:91], v[184:187], v[48:51], a[88:91]
    ds_read_b64_tr_b16 v[210:211], v12 offset:51200
    v_cvt_pk_bf16_f32 v53, v42, v43
    v_mfma_f32_16x16x32_bf16 a[92:95], v[188:191], v[48:51], a[92:95]
    v_exp_f32 v44, v44
    v_mfma_f32_16x16x32_bf16 v[32:35], a[220:223], v[192:195], 0
    v_exp_f32 v45, v45
    v_mfma_f32_16x16x32_bf16 v[32:35], a[224:227], v[196:199], v[32:35]
    v_exp_f32 v46, v46
    v_mfma_f32_16x16x32_bf16 v[32:35], a[228:231], v[200:203], v[32:35]
    ds_read_b64_tr_b16 v[212:213], v12 offset:50720
    v_cvt_pk_bf16_f32 v54, v44, v45
    v_mfma_f32_16x16x32_bf16 v[32:35], a[232:235], v[204:207], v[32:35]
    s_add_u32 m0, s30, 16672
    v_exp_f32 v47, v47
    v_mfma_f32_16x16x32_bf16 v[36:39], a[236:239], v[192:195], 0
    buffer_load_dwordx4 v16, s[52:55], s35 offen offset:1280 lds
    v_mfma_f32_16x16x32_bf16 v[36:39], a[240:243], v[196:199], v[36:39]
    ds_read_b64_tr_b16 v[214:215], v12 offset:51232
    v_cvt_pk_bf16_f32 v55, v46, v47
    v_mfma_f32_16x16x32_bf16 v[36:39], a[244:247], v[200:203], v[36:39]
    s_add_u32 m0, s30, 16448
    ds_read_b64_tr_b16 v[216:217], v12 offset:50752
    v_mfma_f32_16x16x32_bf16 v[36:39], a[248:251], v[204:207], v[36:39]
    buffer_load_dwordx4 v16, s[52:55], s35 offen offset:2560 lds
    v_smfmac_f32_16x16x64_bf16 a[196:199], a[216:219], v[48:55], v29
    v_exp_f32 v32, v32
    v_mfma_f32_16x16x32_bf16 a[96:99], v[144:147], v[52:55], a[96:99]
    v_exp_f32 v33, v33
    v_mfma_f32_16x16x32_bf16 a[100:103], v[148:151], v[52:55], a[100:103]
    s_add_u32 m0, s30, 16224
    ds_read_b64_tr_b16 v[218:219], v12 offset:51264
    v_cvt_pk_bf16_f32 v48, v32, v33
    v_mfma_f32_16x16x32_bf16 a[104:107], v[152:155], v[52:55], a[104:107]
    buffer_load_dwordx4 v16, s[52:55], s35 offen offset:3840 lds
    v_mfma_f32_16x16x32_bf16 a[108:111], v[156:159], v[52:55], a[108:111]
    v_exp_f32 v34, v34
    v_mfma_f32_16x16x32_bf16 a[112:115], v[176:179], v[52:55], a[112:115]
    v_exp_f32 v35, v35
    v_mfma_f32_16x16x32_bf16 a[116:119], v[180:183], v[52:55], a[116:119]
    ds_read_b64_tr_b16 v[220:221], v12 offset:50784
    v_cvt_pk_bf16_f32 v49, v34, v35
    v_mfma_f32_16x16x32_bf16 a[120:123], v[184:187], v[52:55], a[120:123]
    buffer_load_dword v18, v17, s[64:67], 0 offen offset:0 sc1
    v_mfma_f32_16x16x32_bf16 a[124:127], v[188:191], v[52:55], a[124:127]
    v_exp_f32 v36, v36
    v_mfma_f32_16x16x32_bf16 v[40:43], a[220:223], v[224:227], 0
    v_exp_f32 v37, v37
    v_mfma_f32_16x16x32_bf16 v[40:43], a[224:227], v[228:231], v[40:43]
    s_add_u32 m0, s30, 84480
    v_exp_f32 v38, v38
    v_mfma_f32_16x16x32_bf16 v[40:43], a[228:231], v[232:235], v[40:43]
    s_xor_b32 s35, s72, 3
    ds_read_b64_tr_b16 v[222:223], v12 offset:51296
    v_cvt_pk_bf16_f32 v50, v36, v37
    v_mfma_f32_16x16x32_bf16 v[40:43], a[232:235], v[236:239], v[40:43]
    s_mul_i32 s35, s35, 40960
    v_exp_f32 v39, v39
    v_mfma_f32_16x16x32_bf16 v[44:47], a[236:239], v[224:227], 0
    buffer_load_dwordx4 v16, s[52:55], s35 offen offset:0 lds
    v_mfma_f32_16x16x32_bf16 v[44:47], a[240:243], v[228:231], v[44:47]
    ds_read_b64_tr_b16 v[240:241], v12 offset:50816
    v_cvt_pk_bf16_f32 v51, v38, v39
    v_mfma_f32_16x16x32_bf16 v[44:47], a[244:247], v[232:235], v[44:47]
    s_add_u32 m0, s30, 84256
    ds_read_b64_tr_b16 v[242:243], v12 offset:51328
    v_mfma_f32_16x16x32_bf16 v[44:47], a[248:251], v[236:239], v[44:47]
    buffer_load_dwordx4 v16, s[52:55], s35 offen offset:1280 lds
    v_mfma_f32_16x16x32_bf16 a[128:131], v[144:147], v[48:51], a[128:131]
    v_exp_f32 v40, v40
    v_mfma_f32_16x16x32_bf16 a[132:135], v[148:151], v[48:51], a[132:135]
    v_exp_f32 v41, v41
    v_mfma_f32_16x16x32_bf16 a[136:139], v[152:155], v[48:51], a[136:139]
    s_add_u32 m0, s30, 84032
    ds_read_b64_tr_b16 v[244:245], v12 offset:50848
    v_cvt_pk_bf16_f32 v52, v40, v41
    v_mfma_f32_16x16x32_bf16 a[140:143], v[156:159], v[48:51], a[140:143]
    buffer_load_dwordx4 v16, s[52:55], s35 offen offset:2560 lds
    v_mfma_f32_16x16x32_bf16 a[144:147], v[176:179], v[48:51], a[144:147]
    v_exp_f32 v42, v42
    v_mfma_f32_16x16x32_bf16 a[148:151], v[180:183], v[48:51], a[148:151]
    v_exp_f32 v43, v43
    v_mfma_f32_16x16x32_bf16 a[152:155], v[184:187], v[48:51], a[152:155]
    ds_read_b64_tr_b16 v[246:247], v12 offset:51360
    v_cvt_pk_bf16_f32 v53, v42, v43
    v_mfma_f32_16x16x32_bf16 a[156:159], v[188:191], v[48:51], a[156:159]
    v_exp_f32 v44, v44
    v_mfma_f32_16x16x32_bf16 v[32:35], v[80:83], v[64:67], 0
    v_exp_f32 v45, v45
    v_mfma_f32_16x16x32_bf16 v[32:35], v[84:87], v[68:71], v[32:35]
    v_exp_f32 v46, v46
    v_mfma_f32_16x16x32_bf16 v[32:35], v[88:91], v[72:75], v[32:35]
    ds_read_b64_tr_b16 v[248:249], v12 offset:50880
    v_cvt_pk_bf16_f32 v54, v44, v45
    v_mfma_f32_16x16x32_bf16 v[32:35], v[92:95], v[76:79], v[32:35]
    s_add_u32 m0, s30, 83808
    v_exp_f32 v47, v47
    v_mfma_f32_16x16x32_bf16 v[36:39], v[112:115], v[64:67], 0
    buffer_load_dwordx4 v16, s[52:55], s35 offen offset:3840 lds
    v_mfma_f32_16x16x32_bf16 v[36:39], v[116:119], v[68:71], v[36:39]
    s_add_u32 m0, s30, 101376
    ds_read_b64_tr_b16 v[250:251], v12 offset:51392
    v_cvt_pk_bf16_f32 v55, v46, v47
    v_mfma_f32_16x16x32_bf16 v[36:39], v[120:123], v[72:75], v[36:39]
    s_xor_b32 s35, s72, 6
    s_mul_i32 s35, s35, 40960
    ds_read_b64_tr_b16 v[252:253], v12 offset:50912
    v_mfma_f32_16x16x32_bf16 v[36:39], v[124:127], v[76:79], v[36:39]
    buffer_load_dwordx4 v16, s[52:55], s35 offen offset:0 lds
    v_smfmac_f32_16x16x64_bf16 a[200:203], a[216:219], v[48:55], v29
    v_exp_f32 v32, v32
    v_mfma_f32_16x16x32_bf16 a[160:163], v[144:147], v[52:55], a[160:163]
    v_exp_f32 v33, v33
    v_mfma_f32_16x16x32_bf16 a[164:167], v[148:151], v[52:55], a[164:167]
    s_add_u32 m0, s30, 101152
    ds_read_b64_tr_b16 v[254:255], v12 offset:51424
    v_cvt_pk_bf16_f32 v48, v32, v33
    v_mfma_f32_16x16x32_bf16 a[168:171], v[152:155], v[52:55], a[168:171]
    buffer_load_dwordx4 v16, s[52:55], s35 offen offset:1280 lds
    v_mfma_f32_16x16x32_bf16 a[172:175], v[156:159], v[52:55], a[172:175]
    v_exp_f32 v34, v34
    v_mfma_f32_16x16x32_bf16 a[176:179], v[176:179], v[52:55], a[176:179]
    v_exp_f32 v35, v35
    v_mfma_f32_16x16x32_bf16 a[180:183], v[180:183], v[52:55], a[180:183]
    s_add_u32 m0, s30, 100928
    v_cvt_pk_bf16_f32 v49, v34, v35
    v_add_u32 v11, 33792, v10
    v_mfma_f32_16x16x32_bf16 a[184:187], v[184:187], v[52:55], a[184:187]
    buffer_load_dwordx4 v16, s[52:55], s35 offen offset:2560 lds
    v_mfma_f32_16x16x32_bf16 a[188:191], v[188:191], v[52:55], a[188:191]
    v_exp_f32 v36, v36
    v_mfma_f32_16x16x32_bf16 v[40:43], v[80:83], v[96:99], 0
    v_exp_f32 v37, v37
    v_mfma_f32_16x16x32_bf16 v[40:43], v[84:87], v[100:103], v[40:43]
    v_exp_f32 v38, v38
    v_mfma_f32_16x16x32_bf16 v[40:43], v[88:91], v[104:107], v[40:43]
    v_cvt_pk_bf16_f32 v50, v36, v37
    v_add_u32 v12, 101376, v10
    v_mfma_f32_16x16x32_bf16 v[40:43], v[92:95], v[108:111], v[40:43]
    s_add_u32 m0, s30, 100704
    v_exp_f32 v39, v39
    v_mfma_f32_16x16x32_bf16 v[44:47], v[112:115], v[96:99], 0
    buffer_load_dwordx4 v16, s[52:55], s35 offen offset:3840 lds
    v_mfma_f32_16x16x32_bf16 v[44:47], v[116:119], v[100:103], v[44:47]
    v_cvt_pk_bf16_f32 v51, v38, v39
    v_mfma_f32_16x16x32_bf16 v[44:47], v[120:123], v[104:107], v[44:47]
    v_mfma_f32_16x16x32_bf16 v[44:47], v[124:127], v[108:111], v[44:47]
    s_waitcnt vmcnt(8) lgkmcnt(0)
    s_barrier
    v_mfma_f32_16x16x32_bf16 a[0:3], v[208:211], v[48:51], a[0:3]
    v_exp_f32 v40, v40
    v_mfma_f32_16x16x32_bf16 a[4:7], v[212:215], v[48:51], a[4:7]
    v_exp_f32 v41, v41
    v_mfma_f32_16x16x32_bf16 a[8:11], v[216:219], v[48:51], a[8:11]
    v_cvt_pk_bf16_f32 v52, v40, v41
    v_cmp_ne_u32 s[40:41], v18, v21
    v_mfma_f32_16x16x32_bf16 a[12:15], v[220:223], v[48:51], a[12:15]
    s_and_b32 s85, s40, s33
    s_cbranch_scc1 P_SPIN0
P_BACK0:
    v_mfma_f32_16x16x32_bf16 a[16:19], v[240:243], v[48:51], a[16:19]
    v_exp_f32 v42, v42
    v_mfma_f32_16x16x32_bf16 a[20:23], v[244:247], v[48:51], a[20:23]
    v_exp_f32 v43, v43
    v_mfma_f32_16x16x32_bf16 a[24:27], v[248:251], v[48:51], a[24:27]
    v_cvt_pk_bf16_f32 v53, v42, v43
    v_mfma_f32_16x16x32_bf16 a[28:31], v[252:255], v[48:51], a[28:31]
    v_exp_f32 v44, v44
    v_mfma_f32_16x16x32_bf16 v[32:35], v[80:83], v[128:131], 0
    v_exp_f32 v45, v45
    v_mfma_f32_16x16x32_bf16 v[32:35], v[84:87], v[132:135], v[32:35]
    v_exp_f32 v46, v46
    v_mfma_f32_16x16x32_bf16 v[32:35], v[88:91], v[136:139], v[32:35]
    s_xor_b32 s7, s72, 0
    ds_read_b64_tr_b16 a[220:221], v11 offset:0
    v_cvt_pk_bf16_f32 v54, v44, v45
    v_mfma_f32_16x16x32_bf16 v[32:35], v[92:95], v[140:143], v[32:35]
    s_mul_i32 s7, s7, 196608
    v_exp_f32 v47, v47
    v_mfma_f32_16x16x32_bf16 v[36:39], v[112:115], v[128:131], 0
    buffer_load_dwordx4 v[144:147], v14, s[48:51], s7 offen offset:0 sc1
    v_mfma_f32_16x16x32_bf16 v[36:39], v[116:119], v[132:135], v[36:39]
    ds_read_b64_tr_b16 a[222:223], v11 offset:512
    v_cvt_pk_bf16_f32 v55, v46, v47
    v_mfma_f32_16x16x32_bf16 v[36:39], v[120:123], v[136:139], v[36:39]
    buffer_load_dwordx4 v[148:151], v14, s[48:51], s7 offen offset:1024 sc1
    v_mfma_f32_16x16x32_bf16 v[36:39], v[124:127], v[140:143], v[36:39]
    v_smfmac_f32_16x16x64_bf16 a[192:195], a[216:219], v[48:55], v29
    v_exp_f32 v32, v32
    v_mfma_f32_16x16x32_bf16 a[32:35], v[208:211], v[52:55], a[32:35]
    v_exp_f32 v33, v33
    v_mfma_f32_16x16x32_bf16 a[36:39], v[212:215], v[52:55], a[36:39]
    ds_read_b64_tr_b16 a[224:225], v11 offset:32
    v_cvt_pk_bf16_f32 v48, v32, v33
    v_mfma_f32_16x16x32_bf16 a[40:43], v[216:219], v[52:55], a[40:43]
    buffer_load_dwordx4 v[152:155], v15, s[48:51], s7 offen offset:0 sc1
    v_mfma_f32_16x16x32_bf16 a[44:47], v[220:223], v[52:55], a[44:47]
    v_exp_f32 v34, v34
    v_mfma_f32_16x16x32_bf16 a[48:51], v[240:243], v[52:55], a[48:51]
    v_exp_f32 v35, v35
    v_mfma_f32_16x16x32_bf16 a[52:55], v[244:247], v[52:55], a[52:55]
    ds_read_b64_tr_b16 a[226:227], v11 offset:544
    v_cvt_pk_bf16_f32 v49, v34, v35
    v_mfma_f32_16x16x32_bf16 a[56:59], v[248:251], v[52:55], a[56:59]
    buffer_load_dwordx4 v[156:159], v15, s[48:51], s7 offen offset:1024 sc1
    v_mfma_f32_16x16x32_bf16 a[60:63], v[252:255], v[52:55], a[60:63]
    v_exp_f32 v36, v36
    v_mfma_f32_16x16x32_bf16 v[40:43], v[80:83], v[160:163], 0
    v_exp_f32 v37, v37
    v_mfma_f32_16x16x32_bf16 v[40:43], v[84:87], v[164:167], v[40:43]
    v_exp_f32 v38, v38
    v_mfma_f32_16x16x32_bf16 v[40:43], v[88:91], v[168:171], v[40:43]
    s_xor_b32 s7, s72, 1
    ds_read_b64_tr_b16 a[228:229], v11 offset:64
    v_cvt_pk_bf16_f32 v50, v36, v37
    v_mfma_f32_16x16x32_bf16 v[40:43], v[92:95], v[172:175], v[40:43]
    s_mul_i32 s7, s7, 196608
    v_exp_f32 v39, v39
    v_mfma_f32_16x16x32_bf16 v[44:47], v[112:115], v[160:163], 0
    buffer_load_dwordx4 v[176:179], v14, s[48:51], s7 offen offset:0 sc1
    v_mfma_f32_16x16x32_bf16 v[44:47], v[116:119], v[164:167], v[44:47]
    ds_read_b64_tr_b16 a[230:231], v11 offset:576
    v_cvt_pk_bf16_f32 v51, v38, v39
    v_mfma_f32_16x16x32_bf16 v[44:47], v[120:123], v[168:171], v[44:47]
    buffer_load_dwordx4 v[180:183], v14, s[48:51], s7 offen offset:1024 sc1
    v_mfma_f32_16x16x32_bf16 v[44:47], v[124:127], v[172:175], v[44:47]
    v_mfma_f32_16x16x32_bf16 a[64:67], v[208:211], v[48:51], a[64:67]
    v_exp_f32 v40, v40
    v_mfma_f32_16x16x32_bf16 a[68:71], v[212:215], v[48:51], a[68:71]
    v_exp_f32 v41, v41
    v_mfma_f32_16x16x32_bf16 a[72:75], v[216:219], v[48:51], a[72:75]
    ds_read_b64_tr_b16 a[232:233], v11 offset:96
    v_cvt_pk_bf16_f32 v52, v40, v41
    v_mfma_f32_16x16x32_bf16 a[76:79], v[220:223], v[48:51], a[76:79]
    buffer_load_dwordx4 v[184:187], v15, s[48:51], s7 offen offset:0 sc1
    v_mfma_f32_16x16x32_bf16 a[80:83], v[240:243], v[48:51], a[80:83]
    v_exp_f32 v42, v42
    v_mfma_f32_16x16x32_bf16 a[84:87], v[244:247], v[48:51], a[84:87]
    v_exp_f32 v43, v43
    v_mfma_f32_16x16x32_bf16 a[88:91], v[248:251], v[48:51], a[88:91]
    ds_read_b64_tr_b16 a[234:235], v11 offset:608
    v_cvt_pk_bf16_f32 v53, v42, v43
    v_mfma_f32_16x16x32_bf16 a[92:95], v[252:255], v[48:51], a[92:95]
    v_exp_f32 v44, v44
    v_mfma_f32_16x16x32_bf16 v[32:35], v[80:83], v[192:195], 0
    v_exp_f32 v45, v45
    v_mfma_f32_16x16x32_bf16 v[32:35], v[84:87], v[196:199], v[32:35]
    v_exp_f32 v46, v46
    v_mfma_f32_16x16x32_bf16 v[32:35], v[88:91], v[200:203], v[32:35]
    ds_read_b64_tr_b16 a[236:237], v11 offset:128
    v_cvt_pk_bf16_f32 v54, v44, v45
    v_mfma_f32_16x16x32_bf16 v[32:35], v[92:95], v[204:207], v[32:35]
    v_exp_f32 v47, v47
    v_mfma_f32_16x16x32_bf16 v[36:39], v[112:115], v[192:195], 0
    buffer_load_dwordx4 v[188:191], v15, s[48:51], s7 offen offset:1024 sc1
    v_mfma_f32_16x16x32_bf16 v[36:39], v[116:119], v[196:199], v[36:39]
    s_add_u32 m0, s30, 118272
    s_xor_b32 s35, s72, 7
    s_mul_i32 s35, s35, 40960
    ds_read_b64_tr_b16 a[238:239], v11 offset:640
    v_cvt_pk_bf16_f32 v55, v46, v47
    v_mfma_f32_16x16x32_bf16 v[36:39], v[120:123], v[200:203], v[36:39]
    buffer_load_dwordx4 v16, s[52:55], s35 offen offset:0 lds
    v_mfma_f32_16x16x32_bf16 v[36:39], v[124:127], v[204:207], v[36:39]
    v_smfmac_f32_16x16x64_bf16 a[196:199], a[216:219], v[48:55], v29
    v_exp_f32 v32, v32
    v_mfma_f32_16x16x32_bf16 a[96:99], v[208:211], v[52:55], a[96:99]
    v_exp_f32 v33, v33
    v_mfma_f32_16x16x32_bf16 a[100:103], v[212:215], v[52:55], a[100:103]
    s_add_u32 m0, s30, 118048
    ds_read_b64_tr_b16 a[240:241], v11 offset:160
    v_cvt_pk_bf16_f32 v48, v32, v33
    v_mfma_f32_16x16x32_bf16 a[104:107], v[216:219], v[52:55], a[104:107]
    buffer_load_dwordx4 v16, s[52:55], s35 offen offset:1280 lds
    v_mfma_f32_16x16x32_bf16 a[108:111], v[220:223], v[52:55], a[108:111]
    v_exp_f32 v34, v34
    v_mfma_f32_16x16x32_bf16 a[112:115], v[240:243], v[52:55], a[112:115]
    v_exp_f32 v35, v35
    v_mfma_f32_16x16x32_bf16 a[116:119], v[244:247], v[52:55], a[116:119]
    s_add_u32 m0, s30, 117824
    ds_read_b64_tr_b16 a[242:243], v11 offset:672
    v_cvt_pk_bf16_f32 v49, v34, v35
    v_mfma_f32_16x16x32_bf16 a[120:123], v[248:251], v[52:55], a[120:123]
    buffer_load_dwordx4 v16, s[52:55], s35 offen offset:2560 lds
    v_mfma_f32_16x16x32_bf16 a[124:127], v[252:255], v[52:55], a[124:127]
    v_exp_f32 v36, v36
    v_mfma_f32_16x16x32_bf16 v[40:43], v[80:83], v[224:227], 0
    v_exp_f32 v37, v37
    v_mfma_f32_16x16x32_bf16 v[40:43], v[84:87], v[228:231], v[40:43]
    v_exp_f32 v38, v38
    v_mfma_f32_16x16x32_bf16 v[40:43], v[88:91], v[232:235], v[40:43]
    ds_read_b64_tr_b16 a[244:245], v11 offset:192
    v_cvt_pk_bf16_f32 v50, v36, v37
    v_mfma_f32_16x16x32_bf16 v[40:43], v[92:95], v[236:239], v[40:43]
    s_add_u32 m0, s30, 117600
    v_exp_f32 v39, v39
    v_mfma_f32_16x16x32_bf16 v[44:47], v[112:115], v[224:227], 0
    buffer_load_dwordx4 v16, s[52:55], s35 offen offset:3840 lds
    v_mfma_f32_16x16x32_bf16 v[44:47], v[116:119], v[228:231], v[44:47]
    ds_read_b64_tr_b16 a[246:247], v11 offset:704
    v_cvt_pk_bf16_f32 v51, v38, v39
    v_mfma_f32_16x16x32_bf16 v[44:47], v[120:123], v[232:235], v[44:47]
    v_mfma_f32_16x16x32_bf16 v[44:47], v[124:127], v[236:239], v[44:47]
    v_mfma_f32_16x16x32_bf16 a[128:131], v[208:211], v[48:51], a[128:131]
    v_exp_f32 v40, v40
    v_mfma_f32_16x16x32_bf16 a[132:135], v[212:215], v[48:51], a[132:135]
    v_exp_f32 v41, v41
    v_mfma_f32_16x16x32_bf16 a[136:139], v[216:219], v[48:51], a[136:139]
    s_xor_b32 s7, s72, 2
    s_mul_i32 s7, s7, 196608
    ds_read_b64_tr_b16 a[248:249], v11 offset:224
    v_cvt_pk_bf16_f32 v52, v40, v41
    v_mfma_f32_16x16x32_bf16 a[140:143], v[220:223], v[48:51], a[140:143]
    buffer_load_dwordx4 v[80:83], v14, s[48:51], s7 offen offset:0 sc1
    v_mfma_f32_16x16x32_bf16 a[144:147], v[240:243], v[48:51], a[144:147]
    v_exp_f32 v42, v42
    v_mfma_f32_16x16x32_bf16 a[148:151], v[244:247], v[48:51], a[148:151]
    v_exp_f32 v43, v43
    v_mfma_f32_16x16x32_bf16 a[152:155], v[248:251], v[48:51], a[152:155]
    ds_read_b64_tr_b16 a[250:251], v11 offset:736
    v_cvt_pk_bf16_f32 v53, v42, v43
    v_mfma_f32_16x16x32_bf16 a[156:159], v[252:255], v[48:51], a[156:159]
    v_exp_f32 v44, v44
    v_exp_f32 v45, v45
    v_exp_f32 v46, v46
    v_exp_f32 v47, v47
    v_cvt_pk_bf16_f32 v54, v44, v45
    v_cvt_pk_bf16_f32 v55, v46, v47
    s_nop 1
    v_smfmac_f32_16x16x64_bf16 a[200:203], a[216:219], v[48:55], v29
    v_mfma_f32_16x16x32_bf16 a[160:163], v[208:211], v[52:55], a[160:163]
    buffer_load_dwordx4 v[84:87], v14, s[48:51], s7 offen offset:1024 sc1
    v_mfma_f32_16x16x32_bf16 a[164:167], v[212:215], v[52:55], a[164:167]
    v_mfma_f32_16x16x32_bf16 a[168:171], v[216:219], v[52:55], a[168:171]
    v_mfma_f32_16x16x32_bf16 a[172:175], v[220:223], v[52:55], a[172:175]
    buffer_load_dwordx4 v[88:91], v15, s[48:51], s7 offen offset:0 sc1
    v_mfma_f32_16x16x32_bf16 a[176:179], v[240:243], v[52:55], a[176:179]
    v_mfma_f32_16x16x32_bf16 a[180:183], v[244:247], v[52:55], a[180:183]
    v_mfma_f32_16x16x32_bf16 a[184:187], v[248:251], v[52:55], a[184:187]
    buffer_load_dwordx4 v[92:95], v15, s[48:51], s7 offen offset:1024 sc1
    v_mfma_f32_16x16x32_bf16 a[188:191], v[252:255], v[52:55], a[188:191]
    s_nop 3
    v_accvgpr_read_b32 v22, a192
    v_accvgpr_read_b32 v23, a193
    v_add_f32 v22, v22, v23
    v_subrev_u32 v28, s46, v22
    v_rcp_f32_e64 v22, v22
    v_accvgpr_read_b32 v56, a0
    v_accvgpr_read_b32 v57, a1
    v_accvgpr_read_b32 v58, a2
    v_accvgpr_read_b32 v59, a3
    v_accvgpr_read_b32 v60, a4
    v_accvgpr_read_b32 v61, a5
    v_accvgpr_read_b32 v62, a6
    v_accvgpr_read_b32 v63, a7
    v_pk_mul_f32 v[56:57], v[56:57], v[22:23] op_sel_hi:[1,0]
    v_pk_mul_f32 v[58:59], v[58:59], v[22:23] op_sel_hi:[1,0]
    v_pk_mul_f32 v[60:61], v[60:61], v[22:23] op_sel_hi:[1,0]
    v_pk_mul_f32 v[62:63], v[62:63], v[22:23] op_sel_hi:[1,0]
    s_add_u32 s36, s34, 0
    s_nop 0
    v_cvt_pk_bf16_f32 v24, v56, v57
    v_cvt_pk_bf16_f32 v25, v58, v59
    v_cvt_pk_bf16_f32 v26, v60, v61
    v_cvt_pk_bf16_f32 v27, v62, v63
    buffer_store_dwordx4 v[24:27], v4, s[24:27], s36 offen offset:0 sc1
    v_accvgpr_read_b32 v56, a8
    v_accvgpr_read_b32 v57, a9
    v_accvgpr_read_b32 v58, a10
    v_accvgpr_read_b32 v59, a11
    v_accvgpr_read_b32 v60, a12
    v_accvgpr_read_b32 v61, a13
    v_accvgpr_read_b32 v62, a14
    v_accvgpr_read_b32 v63, a15
    v_pk_mul_f32 v[56:57], v[56:57], v[22:23] op_sel_hi:[1,0]
    v_pk_mul_f32 v[58:59], v[58:59], v[22:23] op_sel_hi:[1,0]
    v_pk_mul_f32 v[60:61], v[60:61], v[22:23] op_sel_hi:[1,0]
    v_pk_mul_f32 v[62:63], v[62:63], v[22:23] op_sel_hi:[1,0]
    s_add_u32 s36, s34, 196608
    v_cvt_pk_bf16_f32 v24, v56, v57
    v_cvt_pk_bf16_f32 v25, v58, v59
    v_cvt_pk_bf16_f32 v26, v60, v61
    v_cvt_pk_bf16_f32 v27, v62, v63
    buffer_store_dwordx4 v[24:27], v4, s[24:27], s36 offen offset:0 sc1
    v_accvgpr_read_b32 v56, a16
    v_accvgpr_read_b32 v57, a17
    v_accvgpr_read_b32 v58, a18
    v_accvgpr_read_b32 v59, a19
    v_accvgpr_read_b32 v60, a20
    v_accvgpr_read_b32 v61, a21
    v_accvgpr_read_b32 v62, a22
    v_accvgpr_read_b32 v63, a23
    v_pk_mul_f32 v[56:57], v[56:57], v[22:23] op_sel_hi:[1,0]
    v_pk_mul_f32 v[58:59], v[58:59], v[22:23] op_sel_hi:[1,0]
    v_pk_mul_f32 v[60:61], v[60:61], v[22:23] op_sel_hi:[1,0]
    v_pk_mul_f32 v[62:63], v[62:63], v[22:23] op_sel_hi:[1,0]
    s_add_u32 s36, s34, 393216
    v_cvt_pk_bf16_f32 v24, v56, v57
    v_cvt_pk_bf16_f32 v25, v58, v59
    v_cvt_pk_bf16_f32 v26, v60, v61
    v_cvt_pk_bf16_f32 v27, v62, v63
    buffer_store_dwordx4 v[24:27], v4, s[24:27], s36 offen offset:0 sc1
    v_accvgpr_read_b32 v56, a24
    v_accvgpr_read_b32 v57, a25
    v_accvgpr_read_b32 v58, a26
    v_accvgpr_read_b32 v59, a27
    v_accvgpr_read_b32 v60, a28
    v_accvgpr_read_b32 v61, a29
    v_accvgpr_read_b32 v62, a30
    v_accvgpr_read_b32 v63, a31
    v_pk_mul_f32 v[56:57], v[56:57], v[22:23] op_sel_hi:[1,0]
    v_pk_mul_f32 v[58:59], v[58:59], v[22:23] op_sel_hi:[1,0]
    v_pk_mul_f32 v[60:61], v[60:61], v[22:23] op_sel_hi:[1,0]
    v_pk_mul_f32 v[62:63], v[62:63], v[22:23] op_sel_hi:[1,0]
    s_add_u32 s36, s34, 589824
    v_cvt_pk_bf16_f32 v24, v56, v57
    v_cvt_pk_bf16_f32 v25, v58, v59
    v_cvt_pk_bf16_f32 v26, v60, v61
    v_cvt_pk_bf16_f32 v27, v62, v63
    buffer_store_dwordx4 v[24:27], v4, s[24:27], s36 offen offset:0 sc1
    v_accvgpr_read_b32 v22, a194
    v_accvgpr_read_b32 v23, a195
    v_add_f32 v22, v22, v23
    v_subrev_u32 v23, s46, v22
    v_rcp_f32 v22, v22
    v_max_u32 v28, v28, v23
    v_accvgpr_read_b32 v56, a32
    v_accvgpr_read_b32 v57, a33
    v_accvgpr_read_b32 v58, a34
    v_accvgpr_read_b32 v59, a35
    v_accvgpr_read_b32 v60, a36
    v_accvgpr_read_b32 v61, a37
    v_accvgpr_read_b32 v62, a38
    v_accvgpr_read_b32 v63, a39
    v_pk_mul_f32 v[56:57], v[56:57], v[22:23] op_sel_hi:[1,0]
    v_pk_mul_f32 v[58:59], v[58:59], v[22:23] op_sel_hi:[1,0]
    v_pk_mul_f32 v[60:61], v[60:61], v[22:23] op_sel_hi:[1,0]
    v_pk_mul_f32 v[62:63], v[62:63], v[22:23] op_sel_hi:[1,0]
    v_cvt_pk_bf16_f32 v40, v56, v57
    v_cvt_pk_bf16_f32 v41, v58, v59
    v_cvt_pk_bf16_f32 v42, v60, v61
    v_cvt_pk_bf16_f32 v43, v62, v63
    v_accvgpr_read_b32 v56, a40
    v_accvgpr_read_b32 v57, a41
    v_accvgpr_read_b32 v58, a42
    v_accvgpr_read_b32 v59, a43
    v_accvgpr_read_b32 v60, a44
    v_accvgpr_read_b32 v61, a45
    v_accvgpr_read_b32 v62, a46
    v_accvgpr_read_b32 v63, a47
    v_pk_mul_f32 v[56:57], v[56:57], v[22:23] op_sel_hi:[1,0]
    v_pk_mul_f32 v[58:59], v[58:59], v[22:23] op_sel_hi:[1,0]
    v_pk_mul_f32 v[60:61], v[60:61], v[22:23] op_sel_hi:[1,0]
    v_pk_mul_f32 v[62:63], v[62:63], v[22:23] op_sel_hi:[1,0]
    v_cvt_pk_bf16_f32 v44, v56, v57
    v_cvt_pk_bf16_f32 v45, v58, v59
    v_cvt_pk_bf16_f32 v46, v60, v61
    v_cvt_pk_bf16_f32 v47, v62, v63
    v_accvgpr_read_b32 v56, a48
    v_accvgpr_read_b32 v57, a49
    v_accvgpr_read_b32 v58, a50
    v_accvgpr_read_b32 v59, a51
    v_accvgpr_read_b32 v60, a52
    v_accvgpr_read_b32 v61, a53
    v_accvgpr_read_b32 v62, a54
    v_accvgpr_read_b32 v63, a55
    v_pk_mul_f32 v[56:57], v[56:57], v[22:23] op_sel_hi:[1,0]
    v_pk_mul_f32 v[58:59], v[58:59], v[22:23] op_sel_hi:[1,0]
    v_pk_mul_f32 v[60:61], v[60:61], v[22:23] op_sel_hi:[1,0]
    v_pk_mul_f32 v[62:63], v[62:63], v[22:23] op_sel_hi:[1,0]
    v_cvt_pk_bf16_f32 v48, v56, v57
    v_cvt_pk_bf16_f32 v49, v58, v59
    v_cvt_pk_bf16_f32 v50, v60, v61
    v_cvt_pk_bf16_f32 v51, v62, v63
    v_accvgpr_read_b32 v56, a56
    v_accvgpr_read_b32 v57, a57
    v_accvgpr_read_b32 v58, a58
    v_accvgpr_read_b32 v59, a59
    v_accvgpr_read_b32 v60, a60
    v_accvgpr_read_b32 v61, a61
    v_accvgpr_read_b32 v62, a62
    v_accvgpr_read_b32 v63, a63
    v_pk_mul_f32 v[56:57], v[56:57], v[22:23] op_sel_hi:[1,0]
    v_pk_mul_f32 v[58:59], v[58:59], v[22:23] op_sel_hi:[1,0]
    v_pk_mul_f32 v[60:61], v[60:61], v[22:23] op_sel_hi:[1,0]
    v_pk_mul_f32 v[62:63], v[62:63], v[22:23] op_sel_hi:[1,0]
    v_cvt_pk_bf16_f32 v52, v56, v57
    v_cvt_pk_bf16_f32 v53, v58, v59
    v_cvt_pk_bf16_f32 v54, v60, v61
    v_cvt_pk_bf16_f32 v55, v62, v63
P_START:
    s_waitcnt vmcnt(16) lgkmcnt(0)
    s_barrier
    v_mfma_f32_16x16x32_bf16 v[64:67], a[220:223], v[144:147], 0
    ds_read_b64_tr_b16 a[0:1], v11 offset:16896
    v_accvgpr_read_b32 v22, a196
    v_mfma_f32_16x16x32_bf16 v[68:71], a[224:227], v[144:147], 0
    ds_read_b64_tr_b16 a[2:3], v11 offset:17408
    v_accvgpr_read_b32 v23, a197
    v_mfma_f32_16x16x32_bf16 v[72:75], a[228:231], v[144:147], 0
    s_xor_b32 s7, s72, 3
    s_mul_i32 s7, s7, 196608
    ds_read_b64_tr_b16 a[4:5], v11 offset:16928
    v_mfma_f32_16x16x32_bf16 v[76:79], a[232:235], v[144:147], 0
    buffer_load_dwordx4 v[112:115], v14, s[48:51], s7 offen offset:0 sc1
    v_mfma_f32_16x16x32_bf16 v[96:99], a[236:239], v[144:147], 0
    ds_read_b64_tr_b16 a[6:7], v11 offset:17440
    v_add_f32 v22, v22, v23
    v_mfma_f32_16x16x32_bf16 v[100:103], a[240:243], v[144:147], 0
    ds_read_b64_tr_b16 a[8:9], v11 offset:16960
    v_mfma_f32_16x16x32_bf16 v[104:107], a[244:247], v[144:147], 0
    ds_read_b64_tr_b16 a[10:11], v11 offset:17472
    v_mfma_f32_16x16x32_bf16 v[108:111], a[248:251], v[144:147], 0
    buffer_load_dwordx4 v[116:119], v14, s[48:51], s7 offen offset:1024 sc1
    v_mfma_f32_16x16x32_bf16 v[172:175], a[248:251], v[148:151], 0
    ds_read_b64_tr_b16 a[12:13], v11 offset:16992
    v_mfma_f32_16x16x32_bf16 v[168:171], a[244:247], v[148:151], 0
    s_add_u32 m0, s30, 33792
    ds_read_b64_tr_b16 a[14:15], v11 offset:17504
    v_mfma_f32_16x16x32_bf16 v[164:167], a[240:243], v[148:151], 0
    s_xor_b32 s35, s72, 24
    s_mul_i32 s35, s35, 40960
    ds_read_b64_tr_b16 a[16:17], v11 offset:17024
    v_mfma_f32_16x16x32_bf16 v[160:163], a[236:239], v[148:151], 0
    buffer_load_dwordx4 v16, s[52:55], s35 offen offset:0 lds
    v_mfma_f32_16x16x32_bf16 v[140:143], a[232:235], v[148:151], 0
    ds_read_b64_tr_b16 a[18:19], v11 offset:17536
    v_mfma_f32_16x16x32_bf16 v[136:139], a[228:231], v[148:151], 0
    ds_read_b64_tr_b16 a[20:21], v11 offset:17056
    v_mfma_f32_16x16x32_bf16 v[132:135], a[224:227], v[148:151], 0
    ds_read_b64_tr_b16 a[22:23], v11 offset:17568
    v_mfma_f32_16x16x32_bf16 v[128:131], a[220:223], v[148:151], 0
    buffer_load_dwordx4 v[120:123], v15, s[48:51], s7 offen offset:0 sc1
    v_mfma_f32_16x16x32_bf16 v[192:195], a[220:223], v[152:155], 0
    ds_read_b64_tr_b16 a[24:25], v11 offset:17088
    v_mfma_f32_16x16x32_bf16 v[196:199], a[224:227], v[152:155], 0
    ds_read_b64_tr_b16 a[26:27], v11 offset:17600
    v_mfma_f32_16x16x32_bf16 v[200:203], a[228:231], v[152:155], 0
    ds_read_b64_tr_b16 a[28:29], v11 offset:17120
    v_mfma_f32_16x16x32_bf16 v[204:207], a[232:235], v[152:155], 0
    v_rcp_f32 v22, v22
    v_mfma_f32_16x16x32_bf16 v[224:227], a[236:239], v[152:155], 0
    ds_read_b64_tr_b16 a[30:31], v11 offset:17632
    v_accvgpr_read_b32 v56, a64
    v_mfma_f32_16x16x32_bf16 v[228:231], a[240:243], v[152:155], 0
    v_accvgpr_read_b32 v57, a65
    v_accvgpr_read_b32 v58, a66
    v_mfma_f32_16x16x32_bf16 v[232:235], a[244:247], v[152:155], 0
    buffer_load_dwordx4 v[124:127], v15, s[48:51], s7 offen offset:1024 sc1
    v_mfma_f32_16x16x32_bf16 v[236:239], a[248:251], v[152:155], 0
    v_accvgpr_read_b32 v59, a67
    v_accvgpr_read_b32 v60, a68
    v_mfma_f32_16x16x32_bf16 v[252:255], a[248:251], v[156:159], 0
    v_accvgpr_read_b32 v61, a69
    v_accvgpr_read_b32 v62, a70
    v_mfma_f32_16x16x32_bf16 v[248:251], a[244:247], v[156:159], 0
    v_accvgpr_read_b32 v63, a71
    v_mul_f32 v56, v22, v56
    v_mfma_f32_16x16x32_bf16 v[244:247], a[240:243], v[156:159], 0
    v_mul_f32 v57, v22, v57
    v_mul_f32 v58, v22, v58
    v_mfma_f32_16x16x32_bf16 v[240:243], a[236:239], v[156:159], 0
    s_add_u32 m0, s30, 33568
    v_mul_f32 v59, v22, v59
    v_mul_f32 v60, v22, v60
    v_mfma_f32_16x16x32_bf16 v[220:223], a[232:235], v[156:159], 0
    buffer_load_dwordx4 v16, s[52:55], s35 offen offset:1280 lds
    v_mfma_f32_16x16x32_bf16 v[216:219], a[228:231], v[156:159], 0
    v_mul_f32 v61, v22, v61
    v_mul_f32 v62, v22, v62
    v_mfma_f32_16x16x32_bf16 v[212:215], a[224:227], v[156:159], 0
    v_mul_f32 v63, v22, v63
    v_mfma_f32_16x16x32_bf16 v[208:211], a[220:223], v[156:159], 0
    s_waitcnt vmcnt(18) lgkmcnt(0)
    s_barrier
    v_mfma_f32_16x16x32_bf16 v[64:67], a[0:3], v[176:179], v[64:67]
    ds_read_b64_tr_b16 a[220:221], v11 offset:33792
    v_mfma_f32_16x16x32_bf16 v[68:71], a[4:7], v[176:179], v[68:71]
    s_add_u32 s36, s34, 0
    ds_read_b64_tr_b16 a[222:223], v11 offset:34304
    v_cvt_pk_bf16_f32 v24, v56, v57
    v_mfma_f32_16x16x32_bf16 v[72:75], a[8:11], v[176:179], v[72:75]
    s_xor_b32 s7, s72, 4
    s_mul_i32 s7, s7, 196608
    ds_read_b64_tr_b16 a[224:225], v11 offset:33824
    v_mfma_f32_16x16x32_bf16 v[76:79], a[12:15], v[176:179], v[76:79]
    buffer_load_dwordx4 v[144:147], v14, s[48:51], s7 offen offset:0 sc1
    v_mfma_f32_16x16x32_bf16 v[96:99], a[16:19], v[176:179], v[96:99]
    ds_read_b64_tr_b16 a[226:227], v11 offset:34336
    v_cvt_pk_bf16_f32 v25, v58, v59
    v_mfma_f32_16x16x32_bf16 v[100:103], a[20:23], v[176:179], v[100:103]
    ds_read_b64_tr_b16 a[228:229], v11 offset:33856
    v_cvt_pk_bf16_f32 v26, v60, v61
    v_mfma_f32_16x16x32_bf16 v[104:107], a[24:27], v[176:179], v[104:107]
    ds_read_b64_tr_b16 a[230:231], v11 offset:34368
    v_cvt_pk_bf16_f32 v27, v62, v63
    v_mfma_f32_16x16x32_bf16 v[108:111], a[28:31], v[176:179], v[108:111]
    buffer_load_dwordx4 v[148:151], v14, s[48:51], s7 offen offset:1024 sc1
    v_mfma_f32_16x16x32_bf16 v[172:175], a[28:31], v[180:183], v[172:175]
    ds_read_b64_tr_b16 a[232:233], v11 offset:33888
    v_accvgpr_read_b32 v56, a72
    v_mfma_f32_16x16x32_bf16 v[168:171], a[24:27], v[180:183], v[168:171]
    s_add_u32 m0, s30, 33344
    ds_read_b64_tr_b16 a[234:235], v11 offset:34400
    v_accvgpr_read_b32 v57, a73
    v_mfma_f32_16x16x32_bf16 v[164:167], a[20:23], v[180:183], v[164:167]
    s_xor_b32 s35, s72, 24
    s_mul_i32 s35, s35, 40960
    ds_read_b64_tr_b16 a[236:237], v11 offset:33920
    v_mfma_f32_16x16x32_bf16 v[160:163], a[16:19], v[180:183], v[160:163]
    buffer_load_dwordx4 v16, s[52:55], s35 offen offset:2560 lds
    v_mfma_f32_16x16x32_bf16 v[140:143], a[12:15], v[180:183], v[140:143]
    ds_read_b64_tr_b16 a[238:239], v11 offset:34432
    v_accvgpr_read_b32 v58, a74
    v_mfma_f32_16x16x32_bf16 v[136:139], a[8:11], v[180:183], v[136:139]
    ds_read_b64_tr_b16 a[240:241], v11 offset:33952
    v_accvgpr_read_b32 v59, a75
    v_mfma_f32_16x16x32_bf16 v[132:135], a[4:7], v[180:183], v[132:135]
    ds_read_b64_tr_b16 a[242:243], v11 offset:34464
    v_accvgpr_read_b32 v60, a76
    v_mfma_f32_16x16x32_bf16 v[128:131], a[0:3], v[180:183], v[128:131]
    buffer_load_dwordx4 v[152:155], v15, s[48:51], s7 offen offset:0 sc1
    v_mfma_f32_16x16x32_bf16 v[192:195], a[0:3], v[184:187], v[192:195]
    ds_read_b64_tr_b16 a[244:245], v11 offset:33984
    v_accvgpr_read_b32 v61, a77
    v_mfma_f32_16x16x32_bf16 v[196:199], a[4:7], v[184:187], v[196:199]
    ds_read_b64_tr_b16 a[246:247], v11 offset:34496
    v_accvgpr_read_b32 v62, a78
    v_mfma_f32_16x16x32_bf16 v[200:203], a[8:11], v[184:187], v[200:203]
    ds_read_b64_tr_b16 a[248:249], v11 offset:34016
    v_accvgpr_read_b32 v63, a79
    v_mfma_f32_16x16x32_bf16 v[204:207], a[12:15], v[184:187], v[204:207]
    buffer_store_dwordx4 v[24:27], v4, s[24:27], s36 offen offset:2048 sc1
    v_mfma_f32_16x16x32_bf16 v[224:227], a[16:19], v[184:187], v[224:227]
    ds_read_b64_tr_b16 a[250:251], v11 offset:34528
    v_mul_f32 v56, v22, v56
    v_mfma_f32_16x16x32_bf16 v[228:231], a[20:23], v[184:187], v[228:231]
    v_mul_f32 v57, v22, v57
    v_mul_f32 v58, v22, v58
    v_mfma_f32_16x16x32_bf16 v[232:235], a[24:27], v[184:187], v[232:235]
    buffer_load_dwordx4 v[156:159], v15, s[48:51], s7 offen offset:1024 sc1
    v_mfma_f32_16x16x32_bf16 v[236:239], a[28:31], v[184:187], v[236:239]
    v_mul_f32 v59, v22, v59
    v_mul_f32 v60, v22, v60
    v_mfma_f32_16x16x32_bf16 v[252:255], a[28:31], v[188:191], v[252:255]
    v_mul_f32 v61, v22, v61
    v_mul_f32 v62, v22, v62
    v_mfma_f32_16x16x32_bf16 v[248:251], a[24:27], v[188:191], v[248:251]
    v_mul_f32 v63, v22, v63
    v_mfma_f32_16x16x32_bf16 v[244:247], a[20:23], v[188:191], v[244:247]
    s_add_u32 s36, s34, 196608
    v_cvt_pk_bf16_f32 v24, v56, v57
    v_cvt_pk_bf16_f32 v25, v58, v59
    v_mfma_f32_16x16x32_bf16 v[240:243], a[16:19], v[188:191], v[240:243]
    s_add_u32 m0, s30, 33120
    v_cvt_pk_bf16_f32 v26, v60, v61
    v_cvt_pk_bf16_f32 v27, v62, v63
    v_mfma_f32_16x16x32_bf16 v[220:223], a[12:15], v[188:191], v[220:223]
    buffer_load_dwordx4 v16, s[52:55], s35 offen offset:3840 lds
    v_mfma_f32_16x16x32_bf16 v[216:219], a[8:11], v[188:191], v[216:219]
    buffer_store_dwordx4 v[24:27], v4, s[24:27], s36 offen offset:2048 sc1
    v_mfma_f32_16x16x32_bf16 v[212:215], a[4:7], v[188:191], v[212:215]
    v_accvgpr_read_b32 v56, a80
    v_accvgpr_read_b32 v57, a81
    v_mfma_f32_16x16x32_bf16 v[208:211], a[0:3], v[188:191], v[208:211]
    s_waitcnt vmcnt(18) lgkmcnt(0)
    s_barrier
    v_mfma_f32_16x16x32_bf16 v[64:67], a[220:223], v[80:83], v[64:67]
    ds_read_b64_tr_b16 a[0:1], v11 offset:50688
    v_accvgpr_read_b32 v58, a82
    v_mfma_f32_16x16x32_bf16 v[68:71], a[224:227], v[80:83], v[68:71]
    ds_read_b64_tr_b16 a[2:3], v11 offset:51200
    v_accvgpr_read_b32 v59, a83
    v_mfma_f32_16x16x32_bf16 v[72:75], a[228:231], v[80:83], v[72:75]
    s_xor_b32 s7, s72, 5
    s_mul_i32 s7, s7, 196608
    ds_read_b64_tr_b16 a[4:5], v11 offset:50720
    v_mfma_f32_16x16x32_bf16 v[76:79], a[232:235], v[80:83], v[76:79]
    buffer_load_dwordx4 v[176:179], v14, s[48:51], s7 offen offset:0 sc1
    v_mfma_f32_16x16x32_bf16 v[96:99], a[236:239], v[80:83], v[96:99]
    ds_read_b64_tr_b16 a[6:7], v11 offset:51232
    v_accvgpr_read_b32 v60, a84
    v_mfma_f32_16x16x32_bf16 v[100:103], a[240:243], v[80:83], v[100:103]
    ds_read_b64_tr_b16 a[8:9], v11 offset:50752
    v_accvgpr_read_b32 v61, a85
    v_mfma_f32_16x16x32_bf16 v[104:107], a[244:247], v[80:83], v[104:107]
    ds_read_b64_tr_b16 a[10:11], v11 offset:51264
    v_accvgpr_read_b32 v62, a86
    v_mfma_f32_16x16x32_bf16 v[108:111], a[248:251], v[80:83], v[108:111]
    buffer_load_dwordx4 v[180:183], v14, s[48:51], s7 offen offset:1024 sc1
    v_mfma_f32_16x16x32_bf16 v[172:175], a[248:251], v[84:87], v[172:175]
    ds_read_b64_tr_b16 a[12:13], v11 offset:50784
    v_accvgpr_read_b32 v63, a87
    v_mfma_f32_16x16x32_bf16 v[168:171], a[244:247], v[84:87], v[168:171]
    s_add_u32 m0, s30, 50688
    ds_read_b64_tr_b16 a[14:15], v11 offset:51296
    v_mul_f32 v56, v22, v56
    v_mfma_f32_16x16x32_bf16 v[164:167], a[240:243], v[84:87], v[164:167]
    s_xor_b32 s35, s72, 25
    s_mul_i32 s35, s35, 40960
    ds_read_b64_tr_b16 a[16:17], v11 offset:50816
    v_mfma_f32_16x16x32_bf16 v[160:163], a[236:239], v[84:87], v[160:163]
    buffer_load_dwordx4 v16, s[52:55], s35 offen offset:0 lds
    v_mfma_f32_16x16x32_bf16 v[140:143], a[232:235], v[84:87], v[140:143]
    ds_read_b64_tr_b16 a[18:19], v11 offset:51328
    v_mul_f32 v57, v22, v57
    v_mfma_f32_16x16x32_bf16 v[136:139], a[228:231], v[84:87], v[136:139]
    ds_read_b64_tr_b16 a[20:21], v11 offset:50848
    v_mul_f32 v58, v22, v58
    v_mfma_f32_16x16x32_bf16 v[132:135], a[224:227], v[84:87], v[132:135]
    ds_read_b64_tr_b16 a[22:23], v11 offset:51360
    v_mul_f32 v59, v22, v59
    v_mfma_f32_16x16x32_bf16 v[128:131], a[220:223], v[84:87], v[128:131]
    buffer_load_dwordx4 v[184:187], v15, s[48:51], s7 offen offset:0 sc1
    v_mfma_f32_16x16x32_bf16 v[192:195], a[220:223], v[88:91], v[192:195]
    ds_read_b64_tr_b16 a[24:25], v11 offset:50880
    v_mul_f32 v60, v22, v60
    v_mfma_f32_16x16x32_bf16 v[196:199], a[224:227], v[88:91], v[196:199]
    ds_read_b64_tr_b16 a[26:27], v11 offset:51392
    v_mul_f32 v61, v22, v61
    v_mfma_f32_16x16x32_bf16 v[200:203], a[228:231], v[88:91], v[200:203]
    ds_read_b64_tr_b16 a[28:29], v11 offset:50912
    v_mul_f32 v62, v22, v62
    v_mfma_f32_16x16x32_bf16 v[204:207], a[232:235], v[88:91], v[204:207]
    v_mul_f32 v63, v22, v63
    v_mfma_f32_16x16x32_bf16 v[224:227], a[236:239], v[88:91], v[224:227]
    s_add_u32 s36, s34, 393216
    ds_read_b64_tr_b16 a[30:31], v11 offset:51424
    v_cvt_pk_bf16_f32 v24, v56, v57
    v_mfma_f32_16x16x32_bf16 v[228:231], a[240:243], v[88:91], v[228:231]
    v_cvt_pk_bf16_f32 v25, v58, v59
    v_cvt_pk_bf16_f32 v26, v60, v61
    v_mfma_f32_16x16x32_bf16 v[232:235], a[244:247], v[88:91], v[232:235]
    buffer_load_dwordx4 v[188:191], v15, s[48:51], s7 offen offset:1024 sc1
    v_mfma_f32_16x16x32_bf16 v[236:239], a[248:251], v[88:91], v[236:239]
    v_cvt_pk_bf16_f32 v27, v62, v63
    v_accvgpr_read_b32 v56, a88
    v_mfma_f32_16x16x32_bf16 v[252:255], a[248:251], v[92:95], v[252:255]
    buffer_store_dwordx4 v[24:27], v4, s[24:27], s36 offen offset:2048 sc1
    v_mfma_f32_16x16x32_bf16 v[248:251], a[244:247], v[92:95], v[248:251]
    v_accvgpr_read_b32 v57, a89
    v_accvgpr_read_b32 v58, a90
    v_mfma_f32_16x16x32_bf16 v[244:247], a[240:243], v[92:95], v[244:247]
    v_accvgpr_read_b32 v59, a91
    v_accvgpr_read_b32 v60, a92
    v_mfma_f32_16x16x32_bf16 v[240:243], a[236:239], v[92:95], v[240:243]
    s_add_u32 m0, s30, 50464
    v_accvgpr_read_b32 v61, a93
    v_accvgpr_read_b32 v62, a94
    v_mfma_f32_16x16x32_bf16 v[220:223], a[232:235], v[92:95], v[220:223]
    buffer_load_dwordx4 v16, s[52:55], s35 offen offset:1280 lds
    v_mfma_f32_16x16x32_bf16 v[216:219], a[228:231], v[92:95], v[216:219]
    v_accvgpr_read_b32 v63, a95
    v_mfma_f32_16x16x32_bf16 v[212:215], a[224:227], v[92:95], v[212:215]
    s_add_u32 s36, s34, 0
    v_mul_f32 v56, v22, v56
    v_mul_f32 v57, v22, v57
    v_mfma_f32_16x16x32_bf16 v[208:211], a[220:223], v[92:95], v[208:211]
    s_waitcnt vmcnt(16) lgkmcnt(0)
    s_barrier
    v_mfma_f32_16x16x32_bf16 v[64:67], a[0:3], v[112:115], v[64:67]
    ds_read_b64_tr_b16 a[220:221], v12 offset:33792
    v_mul_f32 v58, v22, v58
    v_mfma_f32_16x16x32_bf16 v[68:71], a[4:7], v[112:115], v[68:71]
    ds_read_b64_tr_b16 a[222:223], v12 offset:34304
    v_mul_f32 v59, v22, v59
    v_mfma_f32_16x16x32_bf16 v[72:75], a[8:11], v[112:115], v[72:75]
    s_xor_b32 s7, s72, 6
    s_mul_i32 s7, s7, 196608
    ds_read_b64_tr_b16 a[224:225], v12 offset:33824
    v_mfma_f32_16x16x32_bf16 v[76:79], a[12:15], v[112:115], v[76:79]
    buffer_load_dwordx4 v[80:83], v14, s[48:51], s7 offen offset:0 sc1
    v_mfma_f32_16x16x32_bf16 v[96:99], a[16:19], v[112:115], v[96:99]
    ds_read_b64_tr_b16 a[226:227], v12 offset:34336
    v_mul_f32 v60, v22, v60
    v_mfma_f32_16x16x32_bf16 v[100:103], a[20:23], v[112:115], v[100:103]
    ds_read_b64_tr_b16 a[228:229], v12 offset:33856
    v_mul_f32 v61, v22, v61
    v_mfma_f32_16x16x32_bf16 v[104:107], a[24:27], v[112:115], v[104:107]
    ds_read_b64_tr_b16 a[230:231], v12 offset:34368
    v_mul_f32 v62, v22, v62
    v_mfma_f32_16x16x32_bf16 v[108:111], a[28:31], v[112:115], v[108:111]
    buffer_load_dwordx4 v[84:87], v14, s[48:51], s7 offen offset:1024 sc1
    v_mfma_f32_16x16x32_bf16 v[172:175], a[28:31], v[116:119], v[172:175]
    ds_read_b64_tr_b16 a[232:233], v12 offset:33888
    v_mul_f32 v63, v22, v63
    v_mfma_f32_16x16x32_bf16 v[168:171], a[24:27], v[116:119], v[168:171]
    s_add_u32 m0, s30, 50240
    ds_read_b64_tr_b16 a[234:235], v12 offset:34400
    v_mfma_f32_16x16x32_bf16 v[164:167], a[20:23], v[116:119], v[164:167]
    s_xor_b32 s35, s72, 25
    s_mul_i32 s35, s35, 40960
    ds_read_b64_tr_b16 a[236:237], v12 offset:33920
    v_mfma_f32_16x16x32_bf16 v[160:163], a[16:19], v[116:119], v[160:163]
    buffer_load_dwordx4 v16, s[52:55], s35 offen offset:2560 lds
    v_mfma_f32_16x16x32_bf16 v[140:143], a[12:15], v[116:119], v[140:143]
    ds_read_b64_tr_b16 a[238:239], v12 offset:34432
    v_mfma_f32_16x16x32_bf16 v[136:139], a[8:11], v[116:119], v[136:139]
    ds_read_b64_tr_b16 a[240:241], v12 offset:33952
    v_mfma_f32_16x16x32_bf16 v[132:135], a[4:7], v[116:119], v[132:135]
    ds_read_b64_tr_b16 a[242:243], v12 offset:34464
    v_mfma_f32_16x16x32_bf16 v[128:131], a[0:3], v[116:119], v[128:131]
    buffer_load_dwordx4 v[88:91], v15, s[48:51], s7 offen offset:0 sc1
    v_mfma_f32_16x16x32_bf16 v[192:195], a[0:3], v[120:123], v[192:195]
    ds_read_b64_tr_b16 a[244:245], v12 offset:33984
    v_mfma_f32_16x16x32_bf16 v[196:199], a[4:7], v[120:123], v[196:199]
    ds_read_b64_tr_b16 a[246:247], v12 offset:34496
    v_mfma_f32_16x16x32_bf16 v[200:203], a[8:11], v[120:123], v[200:203]
    ds_read_b64_tr_b16 a[248:249], v12 offset:34016
    v_mfma_f32_16x16x32_bf16 v[204:207], a[12:15], v[120:123], v[204:207]
    buffer_store_dwordx4 v[40:43], v4, s[24:27], s36 offen offset:1024 sc1
    v_mfma_f32_16x16x32_bf16 v[224:227], a[16:19], v[120:123], v[224:227]
    ds_read_b64_tr_b16 a[250:251], v12 offset:34528
    v_mfma_f32_16x16x32_bf16 v[228:231], a[20:23], v[120:123], v[228:231]
    s_add_u32 s36, s34, 589824
    v_cvt_pk_bf16_f32 v24, v56, v57
    v_cvt_pk_bf16_f32 v25, v58, v59
    v_mfma_f32_16x16x32_bf16 v[232:235], a[24:27], v[120:123], v[232:235]
    buffer_load_dwordx4 v[92:95], v15, s[48:51], s7 offen offset:1024 sc1
    v_mfma_f32_16x16x32_bf16 v[236:239], a[28:31], v[120:123], v[236:239]
    v_cvt_pk_bf16_f32 v26, v60, v61
    v_cvt_pk_bf16_f32 v27, v62, v63
    v_mfma_f32_16x16x32_bf16 v[252:255], a[28:31], v[124:127], v[252:255]
    buffer_store_dwordx4 v[24:27], v4, s[24:27], s36 offen offset:2048 sc1
    v_mfma_f32_16x16x32_bf16 v[248:251], a[24:27], v[124:127], v[248:251]
    v_accvgpr_read_b32 v22, a198
    v_accvgpr_read_b32 v23, a199
    v_mfma_f32_16x16x32_bf16 v[244:247], a[20:23], v[124:127], v[244:247]
    v_add_f32 v22, v22, v23
    v_mfma_f32_16x16x32_bf16 v[240:243], a[16:19], v[124:127], v[240:243]
    s_add_u32 m0, s30, 50016
    v_rcp_f32 v22, v22
    v_mfma_f32_16x16x32_bf16 v[220:223], a[12:15], v[124:127], v[220:223]
    buffer_load_dwordx4 v16, s[52:55], s35 offen offset:3840 lds
    v_mfma_f32_16x16x32_bf16 v[216:219], a[8:11], v[124:127], v[216:219]
    v_accvgpr_read_b32 v56, a96
    v_accvgpr_read_b32 v57, a97
    v_mfma_f32_16x16x32_bf16 v[212:215], a[4:7], v[124:127], v[212:215]
    v_accvgpr_read_b32 v58, a98
    v_accvgpr_read_b32 v59, a99
    v_mfma_f32_16x16x32_bf16 v[208:211], a[0:3], v[124:127], v[208:211]
    s_waitcnt vmcnt(17) lgkmcnt(0)
    s_barrier
    v_mfma_f32_16x16x32_bf16 v[64:67], a[220:223], v[144:147], v[64:67]
    ds_read_b64_tr_b16 a[0:1], v10 offset:16896
    v_accvgpr_read_b32 v60, a100
    v_mfma_f32_16x16x32_bf16 v[68:71], a[224:227], v[144:147], v[68:71]
    ds_read_b64_tr_b16 a[2:3], v10 offset:17408
    v_accvgpr_read_b32 v61, a101
    v_mfma_f32_16x16x32_bf16 v[72:75], a[228:231], v[144:147], v[72:75]
    s_xor_b32 s7, s72, 7
    s_mul_i32 s7, s7, 196608
    ds_read_b64_tr_b16 a[4:5], v10 offset:16928
    v_mfma_f32_16x16x32_bf16 v[76:79], a[232:235], v[144:147], v[76:79]
    buffer_load_dwordx4 v[112:115], v14, s[48:51], s7 offen offset:0 sc1
    v_mfma_f32_16x16x32_bf16 v[96:99], a[236:239], v[144:147], v[96:99]
    ds_read_b64_tr_b16 a[6:7], v10 offset:17440
    v_accvgpr_read_b32 v62, a102
    v_mfma_f32_16x16x32_bf16 v[100:103], a[240:243], v[144:147], v[100:103]
    ds_read_b64_tr_b16 a[8:9], v10 offset:16960
    v_accvgpr_read_b32 v63, a103
    v_mfma_f32_16x16x32_bf16 v[104:107], a[244:247], v[144:147], v[104:107]
    ds_read_b64_tr_b16 a[10:11], v10 offset:17472
    v_mul_f32 v56, v22, v56
    v_mfma_f32_16x16x32_bf16 v[108:111], a[248:251], v[144:147], v[108:111]
    buffer_load_dwordx4 v[116:119], v14, s[48:51], s7 offen offset:1024 sc1
    v_mfma_f32_16x16x32_bf16 v[172:175], a[248:251], v[148:151], v[172:175]
    ds_read_b64_tr_b16 a[12:13], v10 offset:16992
    v_mul_f32 v57, v22, v57
    v_mfma_f32_16x16x32_bf16 v[168:171], a[244:247], v[148:151], v[168:171]
    s_add_u32 m0, s30, 67584
    ds_read_b64_tr_b16 a[14:15], v10 offset:17504
    v_mul_f32 v58, v22, v58
    v_mfma_f32_16x16x32_bf16 v[164:167], a[240:243], v[148:151], v[164:167]
    s_xor_b32 s35, s72, 26
    s_mul_i32 s35, s35, 40960
    ds_read_b64_tr_b16 a[16:17], v10 offset:17024
    v_mfma_f32_16x16x32_bf16 v[160:163], a[236:239], v[148:151], v[160:163]
    buffer_load_dwordx4 v16, s[52:55], s35 offen offset:0 lds
    v_mfma_f32_16x16x32_bf16 v[140:143], a[232:235], v[148:151], v[140:143]
    ds_read_b64_tr_b16 a[18:19], v10 offset:17536
    v_mul_f32 v59, v22, v59
    v_mfma_f32_16x16x32_bf16 v[136:139], a[228:231], v[148:151], v[136:139]
    ds_read_b64_tr_b16 a[20:21], v10 offset:17056
    v_mul_f32 v60, v22, v60
    v_mfma_f32_16x16x32_bf16 v[132:135], a[224:227], v[148:151], v[132:135]
    ds_read_b64_tr_b16 a[22:23], v10 offset:17568
    v_mul_f32 v61, v22, v61
    v_mfma_f32_16x16x32_bf16 v[128:131], a[220:223], v[148:151], v[128:131]
    buffer_load_dwordx4 v[120:123], v15, s[48:51], s7 offen offset:0 sc1
    v_mfma_f32_16x16x32_bf16 v[192:195], a[220:223], v[152:155], v[192:195]
    ds_read_b64_tr_b16 a[24:25], v10 offset:17088
    v_mul_f32 v62, v22, v62
    v_mfma_f32_16x16x32_bf16 v[196:199], a[224:227], v[152:155], v[196:199]
    ds_read_b64_tr_b16 a[26:27], v10 offset:17600
    v_mul_f32 v63, v22, v63
    v_mfma_f32_16x16x32_bf16 v[200:203], a[228:231], v[152:155], v[200:203]
    s_add_u32 s36, s34, 0
    ds_read_b64_tr_b16 a[28:29], v10 offset:17120
    v_cvt_pk_bf16_f32 v24, v56, v57
    v_mfma_f32_16x16x32_bf16 v[204:207], a[232:235], v[152:155], v[204:207]
    v_cvt_pk_bf16_f32 v25, v58, v59
    v_cvt_pk_bf16_f32 v26, v60, v61
    v_mfma_f32_16x16x32_bf16 v[224:227], a[236:239], v[152:155], v[224:227]
    ds_read_b64_tr_b16 a[30:31], v10 offset:17632
    v_cvt_pk_bf16_f32 v27, v62, v63
    v_mfma_f32_16x16x32_bf16 v[228:231], a[240:243], v[152:155], v[228:231]
    buffer_store_dwordx4 v[24:27], v4, s[24:27], s36 offen offset:3072 sc1
    v_mfma_f32_16x16x32_bf16 v[232:235], a[244:247], v[152:155], v[232:235]
    buffer_load_dwordx4 v[124:127], v15, s[48:51], s7 offen offset:1024 sc1
    v_mfma_f32_16x16x32_bf16 v[236:239], a[248:251], v[152:155], v[236:239]
    v_accvgpr_read_b32 v56, a104
    v_accvgpr_read_b32 v57, a105
    v_mfma_f32_16x16x32_bf16 v[252:255], a[248:251], v[156:159], v[252:255]
    v_accvgpr_read_b32 v58, a106
    v_accvgpr_read_b32 v59, a107
    v_mfma_f32_16x16x32_bf16 v[248:251], a[244:247], v[156:159], v[248:251]
    v_accvgpr_read_b32 v60, a108
    v_accvgpr_read_b32 v61, a109
    v_mfma_f32_16x16x32_bf16 v[244:247], a[240:243], v[156:159], v[244:247]
    v_accvgpr_read_b32 v62, a110
    v_accvgpr_read_b32 v63, a111
    v_mfma_f32_16x16x32_bf16 v[240:243], a[236:239], v[156:159], v[240:243]
    s_add_u32 m0, s30, 67360
    v_mul_f32 v56, v22, v56
    v_mul_f32 v57, v22, v57
    v_mfma_f32_16x16x32_bf16 v[220:223], a[232:235], v[156:159], v[220:223]
    buffer_load_dwordx4 v16, s[52:55], s35 offen offset:1280 lds
    v_mfma_f32_16x16x32_bf16 v[216:219], a[228:231], v[156:159], v[216:219]
    v_mul_f32 v58, v22, v58
    v_mul_f32 v59, v22, v59
    v_mfma_f32_16x16x32_bf16 v[212:215], a[224:227], v[156:159], v[212:215]
    v_mul_f32 v60, v22, v60
    v_mul_f32 v61, v22, v61
    v_mfma_f32_16x16x32_bf16 v[208:211], a[220:223], v[156:159], v[208:211]
    s_waitcnt vmcnt(17) lgkmcnt(0)
    s_barrier
    v_mfma_f32_16x16x32_bf16 v[64:67], a[0:3], v[176:179], v[64:67]
    ds_read_b64_tr_b16 a[220:221], v12 offset:0
    v_mul_f32 v62, v22, v62
    v_mfma_f32_16x16x32_bf16 v[68:71], a[4:7], v[176:179], v[68:71]
    ds_read_b64_tr_b16 a[222:223], v12 offset:512
    v_mul_f32 v63, v22, v63
    v_mfma_f32_16x16x32_bf16 v[72:75], a[8:11], v[176:179], v[72:75]
    s_xor_b32 s7, s72, 24
    s_mul_i32 s7, s7, 196608
    ds_read_b64_tr_b16 a[224:225], v12 offset:32
    v_mfma_f32_16x16x32_bf16 v[76:79], a[12:15], v[176:179], v[76:79]
    s_add_u32 s36, s34, 196608
    buffer_load_dwordx4 v[144:147], v15, s[48:51], s7 offen offset:0 sc1
    v_mfma_f32_16x16x32_bf16 v[96:99], a[16:19], v[176:179], v[96:99]
    ds_read_b64_tr_b16 a[226:227], v12 offset:544
    v_cvt_pk_bf16_f32 v24, v56, v57
    v_mfma_f32_16x16x32_bf16 v[100:103], a[20:23], v[176:179], v[100:103]
    ds_read_b64_tr_b16 a[228:229], v12 offset:64
    v_cvt_pk_bf16_f32 v25, v58, v59
    v_mfma_f32_16x16x32_bf16 v[104:107], a[24:27], v[176:179], v[104:107]
    ds_read_b64_tr_b16 a[230:231], v12 offset:576
    v_cvt_pk_bf16_f32 v26, v60, v61
    v_mfma_f32_16x16x32_bf16 v[108:111], a[28:31], v[176:179], v[108:111]
    buffer_load_dwordx4 v[148:151], v15, s[48:51], s7 offen offset:1024 sc1
    v_mfma_f32_16x16x32_bf16 v[172:175], a[28:31], v[180:183], v[172:175]
    ds_read_b64_tr_b16 a[232:233], v12 offset:96
    v_cvt_pk_bf16_f32 v27, v62, v63
    v_mfma_f32_16x16x32_bf16 v[168:171], a[24:27], v[180:183], v[168:171]
    s_add_u32 m0, s30, 67136
    ds_read_b64_tr_b16 a[234:235], v12 offset:608
    v_accvgpr_read_b32 v56, a112
    v_mfma_f32_16x16x32_bf16 v[164:167], a[20:23], v[180:183], v[164:167]
    s_xor_b32 s35, s72, 26
    s_mul_i32 s35, s35, 40960
    ds_read_b64_tr_b16 a[236:237], v12 offset:128
    v_mfma_f32_16x16x32_bf16 v[160:163], a[16:19], v[180:183], v[160:163]
    buffer_load_dwordx4 v16, s[52:55], s35 offen offset:2560 lds
    v_mfma_f32_16x16x32_bf16 v[140:143], a[12:15], v[180:183], v[140:143]
    ds_read_b64_tr_b16 a[238:239], v12 offset:640
    v_accvgpr_read_b32 v57, a113
    v_mfma_f32_16x16x32_bf16 v[136:139], a[8:11], v[180:183], v[136:139]
    ds_read_b64_tr_b16 a[240:241], v12 offset:160
    v_accvgpr_read_b32 v58, a114
    v_mfma_f32_16x16x32_bf16 v[132:135], a[4:7], v[180:183], v[132:135]
    s_xor_b32 s7, s72, 25
    s_mul_i32 s7, s7, 196608
    ds_read_b64_tr_b16 a[242:243], v12 offset:672
    v_mfma_f32_16x16x32_bf16 v[128:131], a[0:3], v[180:183], v[128:131]
    buffer_load_dwordx4 v[152:155], v15, s[48:51], s7 offen offset:0 sc1
    v_mfma_f32_16x16x32_bf16 v[192:195], a[0:3], v[184:187], v[192:195]
    ds_read_b64_tr_b16 a[244:245], v12 offset:192
    v_accvgpr_read_b32 v59, a115
    v_mfma_f32_16x16x32_bf16 v[196:199], a[4:7], v[184:187], v[196:199]
    ds_read_b64_tr_b16 a[246:247], v12 offset:704
    v_accvgpr_read_b32 v60, a116
    v_mfma_f32_16x16x32_bf16 v[200:203], a[8:11], v[184:187], v[200:203]
    ds_read_b64_tr_b16 a[248:249], v12 offset:224
    v_accvgpr_read_b32 v61, a117
    v_mfma_f32_16x16x32_bf16 v[204:207], a[12:15], v[184:187], v[204:207]
    buffer_store_dwordx4 v[24:27], v4, s[24:27], s36 offen offset:3072 sc1
    v_mfma_f32_16x16x32_bf16 v[224:227], a[16:19], v[184:187], v[224:227]
    ds_read_b64_tr_b16 a[250:251], v12 offset:736
    v_accvgpr_read_b32 v62, a118
    v_mfma_f32_16x16x32_bf16 v[228:231], a[20:23], v[184:187], v[228:231]
    v_accvgpr_read_b32 v63, a119
    v_mul_f32 v56, v22, v56
    v_mfma_f32_16x16x32_bf16 v[232:235], a[24:27], v[184:187], v[232:235]
    buffer_load_dwordx4 v[156:159], v15, s[48:51], s7 offen offset:1024 sc1
    v_mfma_f32_16x16x32_bf16 v[236:239], a[28:31], v[184:187], v[236:239]
    v_mul_f32 v57, v22, v57
    v_mul_f32 v58, v22, v58
    v_mfma_f32_16x16x32_bf16 v[252:255], a[28:31], v[188:191], v[252:255]
    v_mul_f32 v59, v22, v59
    v_mul_f32 v60, v22, v60
    v_mfma_f32_16x16x32_bf16 v[248:251], a[24:27], v[188:191], v[248:251]
    v_mul_f32 v61, v22, v61
    v_mul_f32 v62, v22, v62
    v_mfma_f32_16x16x32_bf16 v[244:247], a[20:23], v[188:191], v[244:247]
    v_mul_f32 v63, v22, v63
    v_mfma_f32_16x16x32_bf16 v[240:243], a[16:19], v[188:191], v[240:243]
    s_add_u32 m0, s30, 66912
    s_add_u32 s36, s34, 393216
    v_cvt_pk_bf16_f32 v24, v56, v57
    v_mfma_f32_16x16x32_bf16 v[220:223], a[12:15], v[188:191], v[220:223]
    buffer_load_dwordx4 v16, s[52:55], s35 offen offset:3840 lds
    v_mfma_f32_16x16x32_bf16 v[216:219], a[8:11], v[188:191], v[216:219]
    v_cvt_pk_bf16_f32 v25, v58, v59
    v_cvt_pk_bf16_f32 v26, v60, v61
    v_mfma_f32_16x16x32_bf16 v[212:215], a[4:7], v[188:191], v[212:215]
    v_cvt_pk_bf16_f32 v27, v62, v63
    v_accvgpr_read_b32 v56, a120
    v_mfma_f32_16x16x32_bf16 v[208:211], a[0:3], v[188:191], v[208:211]
    s_waitcnt vmcnt(14) lgkmcnt(0)
    s_barrier
    v_mfma_f32_16x16x32_bf16 v[64:67], a[220:223], v[80:83], v[64:67]
    ds_read_b64_tr_b16 a[0:1], v12 offset:16896
    v_accvgpr_read_b32 v57, a121
    v_mfma_f32_16x16x32_bf16 v[68:71], a[224:227], v[80:83], v[68:71]
    ds_read_b64_tr_b16 a[2:3], v12 offset:17408
    v_accvgpr_read_b32 v58, a122
    v_mfma_f32_16x16x32_bf16 v[72:75], a[228:231], v[80:83], v[72:75]
    s_xor_b32 s7, s72, 24
    s_mul_i32 s7, s7, 196608
    ds_read_b64_tr_b16 a[4:5], v12 offset:16928
    v_mfma_f32_16x16x32_bf16 v[76:79], a[232:235], v[80:83], v[76:79]
    buffer_load_dwordx4 v[176:179], v14, s[48:51], s7 offen offset:0 sc1
    v_mfma_f32_16x16x32_bf16 v[96:99], a[236:239], v[80:83], v[96:99]
    ds_read_b64_tr_b16 a[6:7], v12 offset:17440
    v_accvgpr_read_b32 v59, a123
    v_mfma_f32_16x16x32_bf16 v[100:103], a[240:243], v[80:83], v[100:103]
    ds_read_b64_tr_b16 a[8:9], v12 offset:16960
    v_accvgpr_read_b32 v60, a124
    v_mfma_f32_16x16x32_bf16 v[104:107], a[244:247], v[80:83], v[104:107]
    ds_read_b64_tr_b16 a[10:11], v12 offset:17472
    v_accvgpr_read_b32 v61, a125
    v_mfma_f32_16x16x32_bf16 v[108:111], a[248:251], v[80:83], v[108:111]
    buffer_load_dwordx4 v[180:183], v14, s[48:51], s7 offen offset:1024 sc1
    v_mfma_f32_16x16x32_bf16 v[172:175], a[248:251], v[84:87], v[172:175]
    ds_read_b64_tr_b16 a[12:13], v12 offset:16992
    v_accvgpr_read_b32 v62, a126
    v_mfma_f32_16x16x32_bf16 v[168:171], a[244:247], v[84:87], v[168:171]
    s_add_u32 m0, s30, 84480
    ds_read_b64_tr_b16 a[14:15], v12 offset:17504
    v_accvgpr_read_b32 v63, a127
    v_mfma_f32_16x16x32_bf16 v[164:167], a[240:243], v[84:87], v[164:167]
    s_xor_b32 s35, s72, 27
    s_mul_i32 s35, s35, 40960
    ds_read_b64_tr_b16 a[16:17], v12 offset:17024
    v_mfma_f32_16x16x32_bf16 v[160:163], a[236:239], v[84:87], v[160:163]
    buffer_load_dwordx4 v16, s[52:55], s35 offen offset:0 lds
    v_mfma_f32_16x16x32_bf16 v[140:143], a[232:235], v[84:87], v[140:143]
    ds_read_b64_tr_b16 a[18:19], v12 offset:17536
    v_mfma_f32_16x16x32_bf16 v[136:139], a[228:231], v[84:87], v[136:139]
    ds_read_b64_tr_b16 a[20:21], v12 offset:17056
    v_mfma_f32_16x16x32_bf16 v[132:135], a[224:227], v[84:87], v[132:135]
    s_xor_b32 s7, s72, 25
    s_mul_i32 s7, s7, 196608
    ds_read_b64_tr_b16 a[22:23], v12 offset:17568
    v_mfma_f32_16x16x32_bf16 v[128:131], a[220:223], v[84:87], v[128:131]
    buffer_load_dwordx4 v[184:187], v14, s[48:51], s7 offen offset:0 sc1
    v_mfma_f32_16x16x32_bf16 v[192:195], a[220:223], v[88:91], v[192:195]
    ds_read_b64_tr_b16 a[24:25], v12 offset:17088
    v_mfma_f32_16x16x32_bf16 v[196:199], a[224:227], v[88:91], v[196:199]
    ds_read_b64_tr_b16 a[26:27], v12 offset:17600
    v_mfma_f32_16x16x32_bf16 v[200:203], a[228:231], v[88:91], v[200:203]
    ds_read_b64_tr_b16 a[28:29], v12 offset:17120
    v_mfma_f32_16x16x32_bf16 v[204:207], a[232:235], v[88:91], v[204:207]
    ds_read_b64_tr_b16 a[30:31], v12 offset:17632
    v_mfma_f32_16x16x32_bf16 v[224:227], a[236:239], v[88:91], v[224:227]
    ds_read_b64_tr_b16 a[32:33], v11 offset:16896
    v_mfma_f32_16x16x32_bf16 v[228:231], a[240:243], v[88:91], v[228:231]
    ds_read_b64_tr_b16 a[34:35], v11 offset:17408
    v_mfma_f32_16x16x32_bf16 v[232:235], a[244:247], v[88:91], v[232:235]
    buffer_load_dwordx4 v[188:191], v14, s[48:51], s7 offen offset:1024 sc1
    v_mfma_f32_16x16x32_bf16 v[236:239], a[248:251], v[88:91], v[236:239]
    ds_read_b64_tr_b16 a[36:37], v11 offset:16928
    v_mfma_f32_16x16x32_bf16 v[252:255], a[248:251], v[92:95], v[252:255]
    ds_read_b64_tr_b16 a[38:39], v11 offset:17440
    v_mfma_f32_16x16x32_bf16 v[248:251], a[244:247], v[92:95], v[248:251]
    ds_read_b64_tr_b16 a[40:41], v11 offset:16960
    v_mfma_f32_16x16x32_bf16 v[244:247], a[240:243], v[92:95], v[244:247]
    ds_read_b64_tr_b16 a[42:43], v11 offset:17472
    v_mfma_f32_16x16x32_bf16 v[240:243], a[236:239], v[92:95], v[240:243]
    s_add_u32 m0, s30, 84256
    ds_read_b64_tr_b16 a[44:45], v11 offset:16992
    v_mfma_f32_16x16x32_bf16 v[220:223], a[232:235], v[92:95], v[220:223]
    buffer_load_dwordx4 v16, s[52:55], s35 offen offset:1280 lds
    v_mfma_f32_16x16x32_bf16 v[216:219], a[228:231], v[92:95], v[216:219]
    ds_read_b64_tr_b16 a[46:47], v11 offset:17504
    v_mfma_f32_16x16x32_bf16 v[212:215], a[224:227], v[92:95], v[212:215]
    buffer_store_dwordx4 v[24:27], v4, s[24:27], s36 offen offset:3072 sc1
    v_mfma_f32_16x16x32_bf16 v[208:211], a[220:223], v[92:95], v[208:211]
    s_waitcnt vmcnt(15) lgkmcnt(0)
    s_barrier
    v_mfma_f32_16x16x32_bf16 v[64:67], a[0:3], v[112:115], v[64:67]
    ds_read_b64_tr_b16 a[220:221], v11 offset:0
    v_mfma_f32_16x16x32_bf16 v[68:71], a[4:7], v[112:115], v[68:71]
    s_add_u32 s36, s34, 196608
    ds_read_b64_tr_b16 a[222:223], v11 offset:512
    v_mul_f32 v56, v22, v56
    v_mfma_f32_16x16x32_bf16 v[72:75], a[8:11], v[112:115], v[72:75]
    s_xor_b32 s7, s72, 26
    s_mul_i32 s7, s7, 196608
    ds_read_b64_tr_b16 a[224:225], v11 offset:32
    v_mfma_f32_16x16x32_bf16 v[76:79], a[12:15], v[112:115], v[76:79]
    buffer_load_dwordx4 v[80:83], v15, s[48:51], s7 offen offset:0 sc1
    v_mfma_f32_16x16x32_bf16 v[96:99], a[16:19], v[112:115], v[96:99]
    ds_read_b64_tr_b16 a[226:227], v11 offset:544
    v_mul_f32 v57, v22, v57
    v_mfma_f32_16x16x32_bf16 v[100:103], a[20:23], v[112:115], v[100:103]
    ds_read_b64_tr_b16 a[228:229], v11 offset:64
    v_mul_f32 v58, v22, v58
    v_mfma_f32_16x16x32_bf16 v[104:107], a[24:27], v[112:115], v[104:107]
    ds_read_b64_tr_b16 a[230:231], v11 offset:576
    v_mul_f32 v59, v22, v59
    v_mfma_f32_16x16x32_bf16 v[108:111], a[28:31], v[112:115], v[108:111]
    buffer_load_dwordx4 v[84:87], v15, s[48:51], s7 offen offset:1024 sc1
    v_mfma_f32_16x16x32_bf16 v[172:175], a[28:31], v[116:119], v[172:175]
    ds_read_b64_tr_b16 a[232:233], v11 offset:96
    v_mul_f32 v60, v22, v60
    v_mfma_f32_16x16x32_bf16 v[168:171], a[24:27], v[116:119], v[168:171]
    s_add_u32 m0, s30, 84032
    ds_read_b64_tr_b16 a[234:235], v11 offset:608
    v_mul_f32 v61, v22, v61
    v_mfma_f32_16x16x32_bf16 v[164:167], a[20:23], v[116:119], v[164:167]
    s_xor_b32 s35, s72, 27
    s_mul_i32 s35, s35, 40960
    ds_read_b64_tr_b16 a[236:237], v11 offset:128
    v_mfma_f32_16x16x32_bf16 v[160:163], a[16:19], v[116:119], v[160:163]
    buffer_load_dwordx4 v16, s[52:55], s35 offen offset:2560 lds
    v_mfma_f32_16x16x32_bf16 v[140:143], a[12:15], v[116:119], v[140:143]
    ds_read_b64_tr_b16 a[238:239], v11 offset:640
    v_mul_f32 v62, v22, v62
    v_mfma_f32_16x16x32_bf16 v[136:139], a[8:11], v[116:119], v[136:139]
    ds_read_b64_tr_b16 a[240:241], v11 offset:160
    v_mul_f32 v63, v22, v63
    v_mfma_f32_16x16x32_bf16 v[132:135], a[4:7], v[116:119], v[132:135]
    s_xor_b32 s7, s72, 27
    s_mul_i32 s7, s7, 196608
    ds_read_b64_tr_b16 a[242:243], v11 offset:672
    v_mfma_f32_16x16x32_bf16 v[128:131], a[0:3], v[116:119], v[128:131]
    buffer_load_dwordx4 v[88:91], v15, s[48:51], s7 offen offset:0 sc1
    v_mfma_f32_16x16x32_bf16 v[192:195], a[0:3], v[120:123], v[192:195]
    ds_read_b64_tr_b16 a[244:245], v11 offset:192
    v_mfma_f32_16x16x32_bf16 v[196:199], a[4:7], v[120:123], v[196:199]
    ds_read_b64_tr_b16 a[246:247], v11 offset:704
    v_mfma_f32_16x16x32_bf16 v[200:203], a[8:11], v[120:123], v[200:203]
    ds_read_b64_tr_b16 a[248:249], v11 offset:224
    v_mfma_f32_16x16x32_bf16 v[204:207], a[12:15], v[120:123], v[204:207]
    ds_read_b64_tr_b16 a[250:251], v11 offset:736
    v_mfma_f32_16x16x32_bf16 v[224:227], a[16:19], v[120:123], v[224:227]
    ds_read_b64_tr_b16 a[48:49], v11 offset:17024
    v_mfma_f32_16x16x32_bf16 v[228:231], a[20:23], v[120:123], v[228:231]
    ds_read_b64_tr_b16 a[50:51], v11 offset:17536
    v_mfma_f32_16x16x32_bf16 v[232:235], a[24:27], v[120:123], v[232:235]
    buffer_load_dwordx4 v[92:95], v15, s[48:51], s7 offen offset:1024 sc1
    v_mfma_f32_16x16x32_bf16 v[236:239], a[28:31], v[120:123], v[236:239]
    ds_read_b64_tr_b16 a[52:53], v11 offset:17056
    v_mfma_f32_16x16x32_bf16 v[252:255], a[28:31], v[124:127], v[252:255]
    ds_read_b64_tr_b16 a[54:55], v11 offset:17568
    v_mfma_f32_16x16x32_bf16 v[248:251], a[24:27], v[124:127], v[248:251]
    ds_read_b64_tr_b16 a[56:57], v11 offset:17088
    v_mfma_f32_16x16x32_bf16 v[244:247], a[20:23], v[124:127], v[244:247]
    ds_read_b64_tr_b16 a[58:59], v11 offset:17600
    v_mfma_f32_16x16x32_bf16 v[240:243], a[16:19], v[124:127], v[240:243]
    s_add_u32 m0, s30, 83808
    ds_read_b64_tr_b16 a[60:61], v11 offset:17120
    v_mfma_f32_16x16x32_bf16 v[220:223], a[12:15], v[124:127], v[220:223]
    buffer_load_dwordx4 v16, s[52:55], s35 offen offset:3840 lds
    v_mfma_f32_16x16x32_bf16 v[216:219], a[8:11], v[124:127], v[216:219]
    ds_read_b64_tr_b16 a[62:63], v11 offset:17632
    v_mfma_f32_16x16x32_bf16 v[212:215], a[4:7], v[124:127], v[212:215]
    buffer_store_dwordx4 v[44:47], v4, s[24:27], s36 offen offset:1024 sc1
    v_mfma_f32_16x16x32_bf16 v[208:211], a[0:3], v[124:127], v[208:211]
    s_waitcnt vmcnt(14) lgkmcnt(0)
    s_barrier
    v_mfma_f32_16x16x32_bf16 v[192:195], a[220:223], v[144:147], v[192:195]
    ds_read_b64_tr_b16 a[0:1], v11 offset:33792
    v_mfma_f32_16x16x32_bf16 v[192:195], a[32:35], v[152:155], v[192:195]
    s_add_u32 s36, s34, 589824
    ds_read_b64_tr_b16 a[2:3], v11 offset:34304
    v_cvt_pk_bf16_f32 v24, v56, v57
    v_mfma_f32_16x16x32_bf16 v[196:199], a[36:39], v[152:155], v[196:199]
    s_xor_b32 s7, s72, 26
    s_mul_i32 s7, s7, 196608
    ds_read_b64_tr_b16 a[4:5], v11 offset:33824
    v_mfma_f32_16x16x32_bf16 v[196:199], a[224:227], v[144:147], v[196:199]
    buffer_load_dwordx4 v[112:115], v14, s[48:51], s7 offen offset:0 sc1
    v_mfma_f32_16x16x32_bf16 v[200:203], a[228:231], v[144:147], v[200:203]
    s_add_u32 m0, s30, 33792
    ds_read_b64_tr_b16 a[6:7], v11 offset:34336
    v_cvt_pk_bf16_f32 v25, v58, v59
    v_mfma_f32_16x16x32_bf16 v[200:203], a[40:43], v[152:155], v[200:203]
    s_xor_b32 s35, s72, 28
    s_mul_i32 s35, s35, 40960
    ds_read_b64_tr_b16 a[8:9], v11 offset:33856
    v_mfma_f32_16x16x32_bf16 v[204:207], a[44:47], v[152:155], v[204:207]
    buffer_load_dwordx4 v16, s[52:55], s35 offen offset:0 lds
    v_mfma_f32_16x16x32_bf16 v[204:207], a[232:235], v[144:147], v[204:207]
    ds_read_b64_tr_b16 a[10:11], v11 offset:34368
    v_cvt_pk_bf16_f32 v26, v60, v61
    v_mfma_f32_16x16x32_bf16 v[224:227], a[236:239], v[144:147], v[224:227]
    ds_read_b64_tr_b16 a[12:13], v11 offset:33888
    v_cvt_pk_bf16_f32 v27, v62, v63
    v_mfma_f32_16x16x32_bf16 v[224:227], a[48:51], v[152:155], v[224:227]
    buffer_load_dwordx4 v[116:119], v14, s[48:51], s7 offen offset:1024 sc1
    v_mfma_f32_16x16x32_bf16 v[228:231], a[52:55], v[152:155], v[228:231]
    ds_read_b64_tr_b16 a[14:15], v11 offset:34400
    v_accvgpr_read_b32 v22, a200
    v_mfma_f32_16x16x32_bf16 v[228:231], a[240:243], v[144:147], v[228:231]
    s_add_u32 m0, s30, 33568
    ds_read_b64_tr_b16 a[16:17], v11 offset:33920
    v_accvgpr_read_b32 v23, a201
    v_mfma_f32_16x16x32_bf16 v[232:235], a[244:247], v[144:147], v[232:235]
    buffer_load_dwordx4 v16, s[52:55], s35 offen offset:1280 lds
    v_mfma_f32_16x16x32_bf16 v[232:235], a[56:59], v[152:155], v[232:235]
    ds_read_b64_tr_b16 a[18:19], v11 offset:34432
    v_add_f32 v22, v22, v23
    v_mfma_f32_16x16x32_bf16 v[236:239], a[60:63], v[152:155], v[236:239]
    s_xor_b32 s7, s72, 27
    s_mul_i32 s7, s7, 196608
    ds_read_b64_tr_b16 a[20:21], v11 offset:33952
    v_mfma_f32_16x16x32_bf16 v[236:239], a[248:251], v[144:147], v[236:239]
    buffer_load_dwordx4 v[120:123], v14, s[48:51], s7 offen offset:0 sc1
    v_mfma_f32_16x16x32_bf16 v[252:255], a[248:251], v[148:151], v[252:255]
    ds_read_b64_tr_b16 a[22:23], v11 offset:34464
    v_mfma_f32_16x16x32_bf16 v[252:255], a[60:63], v[156:159], v[252:255]
    s_add_u32 m0, s30, 33344
    ds_read_b64_tr_b16 a[24:25], v11 offset:33984
    v_mfma_f32_16x16x32_bf16 v[248:251], a[56:59], v[156:159], v[248:251]
    buffer_load_dwordx4 v16, s[52:55], s35 offen offset:2560 lds
    v_mfma_f32_16x16x32_bf16 v[248:251], a[244:247], v[148:151], v[248:251]
    ds_read_b64_tr_b16 a[26:27], v11 offset:34496
    v_mfma_f32_16x16x32_bf16 v[244:247], a[240:243], v[148:151], v[244:247]
    ds_read_b64_tr_b16 a[28:29], v11 offset:34016
    v_mfma_f32_16x16x32_bf16 v[244:247], a[52:55], v[156:159], v[244:247]
    buffer_load_dwordx4 v[124:127], v14, s[48:51], s7 offen offset:1024 sc1
    v_mfma_f32_16x16x32_bf16 v[240:243], a[48:51], v[156:159], v[240:243]
    ds_read_b64_tr_b16 a[30:31], v11 offset:34528
    v_mfma_f32_16x16x32_bf16 v[240:243], a[236:239], v[148:151], v[240:243]
    s_add_u32 m0, s30, 33120
    buffer_store_dwordx4 v[24:27], v4, s[24:27], s36 offen offset:3072 sc1
    v_mfma_f32_16x16x32_bf16 v[220:223], a[232:235], v[148:151], v[220:223]
    buffer_load_dwordx4 v16, s[52:55], s35 offen offset:3840 lds
    v_mfma_f32_16x16x32_bf16 v[220:223], a[44:47], v[156:159], v[220:223]
    v_rcp_f32 v22, v22
    v_mfma_f32_16x16x32_bf16 v[216:219], a[40:43], v[156:159], v[216:219]
    s_add_u32 m0, s30, 50688
    s_xor_b32 s35, s72, 29
    s_mul_i32 s35, s35, 40960
    v_mfma_f32_16x16x32_bf16 v[216:219], a[228:231], v[148:151], v[216:219]
    buffer_load_dwordx4 v16, s[52:55], s35 offen offset:0 lds
    v_mfma_f32_16x16x32_bf16 v[212:215], a[224:227], v[148:151], v[212:215]
    v_accvgpr_read_b32 v56, a128
    v_accvgpr_read_b32 v57, a129
    v_mfma_f32_16x16x32_bf16 v[212:215], a[36:39], v[156:159], v[212:215]
    s_add_u32 m0, s30, 50464
    v_accvgpr_read_b32 v58, a130
    v_accvgpr_read_b32 v59, a131
    v_mfma_f32_16x16x32_bf16 v[208:211], a[32:35], v[156:159], v[208:211]
    buffer_load_dwordx4 v16, s[52:55], s35 offen offset:1280 lds
    v_mfma_f32_16x16x32_bf16 v[208:211], a[220:223], v[148:151], v[208:211]
    s_waitcnt vmcnt(12) lgkmcnt(0)
    s_barrier
    v_mfma_f32_16x16x32_bf16 v[64:67], a[220:223], v[176:179], v[64:67]
    ds_read_b64_tr_b16 a[64:65], v11 offset:50688
    v_accvgpr_read_b32 v60, a132
    v_mfma_f32_16x16x32_bf16 v[64:67], a[32:35], v[184:187], v[64:67]
    s_add_u32 m0, s30, 50240
    ds_read_b64_tr_b16 a[66:67], v11 offset:51200
    v_accvgpr_read_b32 v61, a133
    v_mfma_f32_16x16x32_bf16 v[68:71], a[36:39], v[184:187], v[68:71]
    s_xor_b32 s35, s72, 29
    s_mul_i32 s35, s35, 40960
    ds_read_b64_tr_b16 a[68:69], v11 offset:50720
    v_mfma_f32_16x16x32_bf16 v[68:71], a[224:227], v[176:179], v[68:71]
    buffer_load_dwordx4 v16, s[52:55], s35 offen offset:2560 lds
    v_mfma_f32_16x16x32_bf16 v[72:75], a[228:231], v[176:179], v[72:75]
    ds_read_b64_tr_b16 a[70:71], v11 offset:51232
    v_accvgpr_read_b32 v62, a134
    v_mfma_f32_16x16x32_bf16 v[72:75], a[40:43], v[184:187], v[72:75]
    s_add_u32 m0, s30, 50016
    ds_read_b64_tr_b16 a[72:73], v11 offset:50752
    v_accvgpr_read_b32 v63, a135
    v_mfma_f32_16x16x32_bf16 v[76:79], a[44:47], v[184:187], v[76:79]
    buffer_load_dwordx4 v16, s[52:55], s35 offen offset:3840 lds
    v_mfma_f32_16x16x32_bf16 v[76:79], a[232:235], v[176:179], v[76:79]
    ds_read_b64_tr_b16 a[74:75], v11 offset:51264
    v_mul_f32 v56, v22, v56
    v_mfma_f32_16x16x32_bf16 v[96:99], a[236:239], v[176:179], v[96:99]
    s_xor_b32 s7, s72, 28
    s_mul_i32 s7, s7, 196608
    ds_read_b64_tr_b16 a[76:77], v11 offset:50784
    v_mfma_f32_16x16x32_bf16 v[96:99], a[48:51], v[184:187], v[96:99]
    buffer_load_dwordx4 v[144:147], v15, s[48:51], s7 offen offset:0 sc1
    v_mfma_f32_16x16x32_bf16 v[100:103], a[52:55], v[184:187], v[100:103]
    s_add_u32 m0, s30, 67584
    ds_read_b64_tr_b16 a[78:79], v11 offset:51296
    v_mul_f32 v57, v22, v57
    v_mfma_f32_16x16x32_bf16 v[100:103], a[240:243], v[176:179], v[100:103]
    s_xor_b32 s35, s72, 30
    s_mul_i32 s35, s35, 40960
    ds_read_b64_tr_b16 a[80:81], v11 offset:50816
    v_mfma_f32_16x16x32_bf16 v[104:107], a[244:247], v[176:179], v[104:107]
    buffer_load_dwordx4 v16, s[52:55], s35 offen offset:0 lds
    v_mfma_f32_16x16x32_bf16 v[104:107], a[56:59], v[184:187], v[104:107]
    ds_read_b64_tr_b16 a[82:83], v11 offset:51328
    v_mul_f32 v58, v22, v58
    v_mfma_f32_16x16x32_bf16 v[108:111], a[60:63], v[184:187], v[108:111]
    ds_read_b64_tr_b16 a[84:85], v11 offset:50848
    v_mul_f32 v59, v22, v59
    v_mfma_f32_16x16x32_bf16 v[108:111], a[248:251], v[176:179], v[108:111]
    buffer_load_dwordx4 v[148:151], v15, s[48:51], s7 offen offset:1024 sc1
    v_mfma_f32_16x16x32_bf16 v[172:175], a[248:251], v[180:183], v[172:175]
    ds_read_b64_tr_b16 a[86:87], v11 offset:51360
    v_mul_f32 v60, v22, v60
    v_mfma_f32_16x16x32_bf16 v[172:175], a[60:63], v[188:191], v[172:175]
    s_add_u32 m0, s30, 67360
    ds_read_b64_tr_b16 a[88:89], v11 offset:50880
    v_mul_f32 v61, v22, v61
    v_mfma_f32_16x16x32_bf16 v[168:171], a[56:59], v[188:191], v[168:171]
    buffer_load_dwordx4 v16, s[52:55], s35 offen offset:1280 lds
    v_mfma_f32_16x16x32_bf16 v[168:171], a[244:247], v[180:183], v[168:171]
    ds_read_b64_tr_b16 a[90:91], v11 offset:51392
    v_mul_f32 v62, v22, v62
    v_mfma_f32_16x16x32_bf16 v[164:167], a[240:243], v[180:183], v[164:167]
    s_xor_b32 s7, s72, 29
    s_mul_i32 s7, s7, 196608
    ds_read_b64_tr_b16 a[92:93], v11 offset:50912
    v_mfma_f32_16x16x32_bf16 v[164:167], a[52:55], v[188:191], v[164:167]
    buffer_load_dwordx4 v[152:155], v15, s[48:51], s7 offen offset:0 sc1
    v_mfma_f32_16x16x32_bf16 v[160:163], a[48:51], v[188:191], v[160:163]
    ds_read_b64_tr_b16 a[94:95], v11 offset:51424
    v_mul_f32 v63, v22, v63
    v_mfma_f32_16x16x32_bf16 v[160:163], a[236:239], v[180:183], v[160:163]
    s_add_u32 m0, s30, 67136
    s_add_u32 s36, s34, 4096
    v_cvt_pk_bf16_f32 v24, v56, v57
    v_mfma_f32_16x16x32_bf16 v[140:143], a[232:235], v[180:183], v[140:143]
    buffer_load_dwordx4 v16, s[52:55], s35 offen offset:2560 lds
    v_mfma_f32_16x16x32_bf16 v[140:143], a[44:47], v[188:191], v[140:143]
    v_cvt_pk_bf16_f32 v25, v58, v59
    v_cvt_pk_bf16_f32 v26, v60, v61
    v_mfma_f32_16x16x32_bf16 v[136:139], a[40:43], v[188:191], v[136:139]
    v_cvt_pk_bf16_f32 v27, v62, v63
    v_accvgpr_read_b32 v56, a136
    v_mfma_f32_16x16x32_bf16 v[136:139], a[228:231], v[180:183], v[136:139]
    buffer_load_dwordx4 v[156:159], v15, s[48:51], s7 offen offset:1024 sc1
    v_mfma_f32_16x16x32_bf16 v[132:135], a[224:227], v[180:183], v[132:135]
    buffer_store_dwordx4 v[24:27], v4, s[24:27], s36 offen offset:0 sc1
    v_mfma_f32_16x16x32_bf16 v[132:135], a[36:39], v[188:191], v[132:135]
    s_add_u32 m0, s30, 66912
    v_accvgpr_read_b32 v57, a137
    v_accvgpr_read_b32 v58, a138
    v_mfma_f32_16x16x32_bf16 v[128:131], a[32:35], v[188:191], v[128:131]
    buffer_load_dwordx4 v16, s[52:55], s35 offen offset:3840 lds
    v_mfma_f32_16x16x32_bf16 v[128:131], a[220:223], v[180:183], v[128:131]
    s_waitcnt vmcnt(13) lgkmcnt(0)
    s_barrier
    v_mfma_f32_16x16x32_bf16 v[192:195], a[0:3], v[80:83], v[192:195]
    ds_read_b64_tr_b16 a[220:221], v11 offset:0
    v_accvgpr_read_b32 v59, a139
    v_mfma_f32_16x16x32_bf16 v[192:195], a[64:67], v[88:91], v[192:195]
    ds_read_b64_tr_b16 a[222:223], v11 offset:512
    v_accvgpr_read_b32 v60, a140
    v_mfma_f32_16x16x32_bf16 v[196:199], a[68:71], v[88:91], v[196:199]
    s_xor_b32 s7, s72, 28
    s_mul_i32 s7, s7, 196608
    ds_read_b64_tr_b16 a[224:225], v11 offset:32
    v_mfma_f32_16x16x32_bf16 v[196:199], a[4:7], v[80:83], v[196:199]
    buffer_load_dwordx4 v[176:179], v14, s[48:51], s7 offen offset:0 sc1
    v_mfma_f32_16x16x32_bf16 v[200:203], a[8:11], v[80:83], v[200:203]
    ds_read_b64_tr_b16 a[226:227], v11 offset:544
    v_accvgpr_read_b32 v61, a141
    v_mfma_f32_16x16x32_bf16 v[200:203], a[72:75], v[88:91], v[200:203]
    s_add_u32 m0, s30, 84480
    ds_read_b64_tr_b16 a[228:229], v11 offset:64
    v_accvgpr_read_b32 v62, a142
    v_mfma_f32_16x16x32_bf16 v[204:207], a[76:79], v[88:91], v[204:207]
    s_xor_b32 s35, s72, 31
    s_mul_i32 s35, s35, 40960
    ds_read_b64_tr_b16 a[230:231], v11 offset:576
    v_mfma_f32_16x16x32_bf16 v[204:207], a[12:15], v[80:83], v[204:207]
    buffer_load_dwordx4 v16, s[52:55], s35 offen offset:0 lds
    v_mfma_f32_16x16x32_bf16 v[224:227], a[16:19], v[80:83], v[224:227]
    ds_read_b64_tr_b16 a[232:233], v11 offset:96
    v_accvgpr_read_b32 v63, a143
    v_mfma_f32_16x16x32_bf16 v[224:227], a[80:83], v[88:91], v[224:227]
    ds_read_b64_tr_b16 a[234:235], v11 offset:608
    v_mul_f32 v56, v22, v56
    v_mfma_f32_16x16x32_bf16 v[228:231], a[84:87], v[88:91], v[228:231]
    ds_read_b64_tr_b16 a[236:237], v11 offset:128
    v_mul_f32 v57, v22, v57
    v_mfma_f32_16x16x32_bf16 v[228:231], a[20:23], v[80:83], v[228:231]
    buffer_load_dwordx4 v[180:183], v14, s[48:51], s7 offen offset:1024 sc1
    v_mfma_f32_16x16x32_bf16 v[232:235], a[24:27], v[80:83], v[232:235]
    ds_read_b64_tr_b16 a[238:239], v11 offset:640
    v_mul_f32 v58, v22, v58
    v_mfma_f32_16x16x32_bf16 v[232:235], a[88:91], v[88:91], v[232:235]
    ds_read_b64_tr_b16 a[240:241], v11 offset:160
    v_mul_f32 v59, v22, v59
    v_mfma_f32_16x16x32_bf16 v[236:239], a[92:95], v[88:91], v[236:239]
    s_add_u32 m0, s30, 84256
    ds_read_b64_tr_b16 a[242:243], v11 offset:672
    v_mul_f32 v60, v22, v60
    v_mfma_f32_16x16x32_bf16 v[236:239], a[28:31], v[80:83], v[236:239]
    buffer_load_dwordx4 v16, s[52:55], s35 offen offset:1280 lds
    v_mfma_f32_16x16x32_bf16 v[252:255], a[28:31], v[84:87], v[252:255]
    ds_read_b64_tr_b16 a[244:245], v11 offset:192
    v_mul_f32 v61, v22, v61
    v_mfma_f32_16x16x32_bf16 v[252:255], a[92:95], v[92:95], v[252:255]
    ds_read_b64_tr_b16 a[246:247], v11 offset:704
    v_mul_f32 v62, v22, v62
    v_mfma_f32_16x16x32_bf16 v[248:251], a[88:91], v[92:95], v[248:251]
    s_xor_b32 s7, s72, 29
    s_mul_i32 s7, s7, 196608
    ds_read_b64_tr_b16 a[248:249], v11 offset:224
    v_mfma_f32_16x16x32_bf16 v[248:251], a[24:27], v[84:87], v[248:251]
    buffer_load_dwordx4 v[184:187], v14, s[48:51], s7 offen offset:0 sc1
    v_mfma_f32_16x16x32_bf16 v[244:247], a[20:23], v[84:87], v[244:247]
    ds_read_b64_tr_b16 a[250:251], v11 offset:736
    v_mul_f32 v63, v22, v63
    v_mfma_f32_16x16x32_bf16 v[244:247], a[84:87], v[92:95], v[244:247]
    s_add_u32 m0, s30, 84032
    s_add_u32 s36, s34, 200704
    v_cvt_pk_bf16_f32 v24, v56, v57
    v_mfma_f32_16x16x32_bf16 v[240:243], a[80:83], v[92:95], v[240:243]
    buffer_load_dwordx4 v16, s[52:55], s35 offen offset:2560 lds
    v_mfma_f32_16x16x32_bf16 v[240:243], a[16:19], v[84:87], v[240:243]
    v_cvt_pk_bf16_f32 v25, v58, v59
    v_cvt_pk_bf16_f32 v26, v60, v61
    v_mfma_f32_16x16x32_bf16 v[220:223], a[12:15], v[84:87], v[220:223]
    v_cvt_pk_bf16_f32 v27, v62, v63
    v_accvgpr_read_b32 v56, a144
    v_mfma_f32_16x16x32_bf16 v[220:223], a[76:79], v[92:95], v[220:223]
    buffer_load_dwordx4 v[188:191], v14, s[48:51], s7 offen offset:1024 sc1
    v_mfma_f32_16x16x32_bf16 v[216:219], a[72:75], v[92:95], v[216:219]
    buffer_store_dwordx4 v[24:27], v4, s[24:27], s36 offen offset:0 sc1
    v_mfma_f32_16x16x32_bf16 v[216:219], a[8:11], v[84:87], v[216:219]
    s_add_u32 m0, s30, 83808
    v_accvgpr_read_b32 v57, a145
    v_accvgpr_read_b32 v58, a146
    v_mfma_f32_16x16x32_bf16 v[212:215], a[4:7], v[84:87], v[212:215]
    buffer_load_dwordx4 v16, s[52:55], s35 offen offset:3840 lds
    v_mfma_f32_16x16x32_bf16 v[212:215], a[68:71], v[92:95], v[212:215]
    v_accvgpr_read_b32 v59, a147
    v_accvgpr_read_b32 v60, a148
    v_mfma_f32_16x16x32_bf16 v[208:211], a[64:67], v[92:95], v[208:211]
    v_accvgpr_read_b32 v61, a149
    v_accvgpr_read_b32 v62, a150
    v_mfma_f32_16x16x32_bf16 v[208:211], a[0:3], v[84:87], v[208:211]
    s_waitcnt vmcnt(18) lgkmcnt(0)
    s_barrier
    v_mfma_f32_16x16x32_bf16 v[64:67], a[0:3], v[112:115], v[64:67]
    ds_read_b64_tr_b16 a[32:33], v11 offset:16896
    v_accvgpr_read_b32 v63, a151
    v_mfma_f32_16x16x32_bf16 v[64:67], a[64:67], v[120:123], v[64:67]
    ds_read_b64_tr_b16 a[34:35], v11 offset:17408
    v_mul_f32 v56, v22, v56
    v_mfma_f32_16x16x32_bf16 v[68:71], a[68:71], v[120:123], v[68:71]
    s_xor_b32 s7, s72, 30
    s_mul_i32 s7, s7, 196608
    ds_read_b64_tr_b16 a[36:37], v11 offset:16928
    v_mfma_f32_16x16x32_bf16 v[68:71], a[4:7], v[112:115], v[68:71]
    buffer_load_dwordx4 v[80:83], v15, s[48:51], s7 offen offset:0 sc1
    v_mfma_f32_16x16x32_bf16 v[72:75], a[8:11], v[112:115], v[72:75]
    ds_read_b64_tr_b16 a[38:39], v11 offset:17440
    v_mul_f32 v57, v22, v57
    v_mfma_f32_16x16x32_bf16 v[72:75], a[72:75], v[120:123], v[72:75]
    s_add_u32 m0, s30, 33792
    ds_read_b64_tr_b16 a[40:41], v11 offset:16960
    v_mul_f32 v58, v22, v58
    v_mfma_f32_16x16x32_bf16 v[76:79], a[76:79], v[120:123], v[76:79]
    s_xor_b32 s35, s72, 32
    s_mul_i32 s35, s35, 40960
    ds_read_b64_tr_b16 a[42:43], v11 offset:17472
    v_mfma_f32_16x16x32_bf16 v[76:79], a[12:15], v[112:115], v[76:79]
    buffer_load_dwordx4 v16, s[52:55], s35 offen offset:0 lds
    v_mfma_f32_16x16x32_bf16 v[96:99], a[16:19], v[112:115], v[96:99]
    ds_read_b64_tr_b16 a[44:45], v11 offset:16992
    v_mul_f32 v59, v22, v59
    v_mfma_f32_16x16x32_bf16 v[96:99], a[80:83], v[120:123], v[96:99]
    ds_read_b64_tr_b16 a[46:47], v11 offset:17504
    v_mul_f32 v60, v22, v60
    v_mfma_f32_16x16x32_bf16 v[100:103], a[84:87], v[120:123], v[100:103]
    ds_read_b64_tr_b16 a[48:49], v11 offset:17024
    v_mul_f32 v61, v22, v61
    v_mfma_f32_16x16x32_bf16 v[100:103], a[20:23], v[112:115], v[100:103]
    buffer_load_dwordx4 v[84:87], v15, s[48:51], s7 offen offset:1024 sc1
    v_mfma_f32_16x16x32_bf16 v[104:107], a[24:27], v[112:115], v[104:107]
    ds_read_b64_tr_b16 a[50:51], v11 offset:17536
    v_mul_f32 v62, v22, v62
    v_mfma_f32_16x16x32_bf16 v[104:107], a[88:91], v[120:123], v[104:107]
    ds_read_b64_tr_b16 a[52:53], v11 offset:17056
    v_mul_f32 v63, v22, v63
    v_mfma_f32_16x16x32_bf16 v[108:111], a[92:95], v[120:123], v[108:111]
    s_add_u32 m0, s30, 33568
    s_add_u32 s36, s34, 397312
    ds_read_b64_tr_b16 a[54:55], v11 offset:17568
    v_mfma_f32_16x16x32_bf16 v[108:111], a[28:31], v[112:115], v[108:111]
    buffer_load_dwordx4 v16, s[52:55], s35 offen offset:1280 lds
    v_mfma_f32_16x16x32_bf16 v[172:175], a[28:31], v[116:119], v[172:175]
    ds_read_b64_tr_b16 a[56:57], v11 offset:17088
    v_cvt_pk_bf16_f32 v24, v56, v57
    v_mfma_f32_16x16x32_bf16 v[172:175], a[92:95], v[124:127], v[172:175]
    ds_read_b64_tr_b16 a[58:59], v11 offset:17600
    v_cvt_pk_bf16_f32 v25, v58, v59
    v_mfma_f32_16x16x32_bf16 v[168:171], a[88:91], v[124:127], v[168:171]
    s_xor_b32 s7, s72, 31
    s_mul_i32 s7, s7, 196608
    ds_read_b64_tr_b16 a[60:61], v11 offset:17120
    v_mfma_f32_16x16x32_bf16 v[168:171], a[24:27], v[116:119], v[168:171]
    buffer_load_dwordx4 v[88:91], v15, s[48:51], s7 offen offset:0 sc1
    v_mfma_f32_16x16x32_bf16 v[164:167], a[20:23], v[116:119], v[164:167]
    ds_read_b64_tr_b16 a[62:63], v11 offset:17632
    v_cvt_pk_bf16_f32 v26, v60, v61
    v_mfma_f32_16x16x32_bf16 v[164:167], a[84:87], v[124:127], v[164:167]
    s_add_u32 m0, s30, 33344
    v_cvt_pk_bf16_f32 v27, v62, v63
    v_accvgpr_read_b32 v56, a152
    v_mfma_f32_16x16x32_bf16 v[160:163], a[80:83], v[124:127], v[160:163]
    buffer_load_dwordx4 v16, s[52:55], s35 offen offset:2560 lds
    v_mfma_f32_16x16x32_bf16 v[160:163], a[16:19], v[116:119], v[160:163]
    buffer_store_dwordx4 v[24:27], v4, s[24:27], s36 offen offset:0 sc1
    v_mfma_f32_16x16x32_bf16 v[140:143], a[12:15], v[116:119], v[140:143]
    v_accvgpr_read_b32 v57, a153
    v_accvgpr_read_b32 v58, a154
    v_mfma_f32_16x16x32_bf16 v[140:143], a[76:79], v[124:127], v[140:143]
    buffer_load_dwordx4 v[92:95], v15, s[48:51], s7 offen offset:1024 sc1
    v_mfma_f32_16x16x32_bf16 v[136:139], a[72:75], v[124:127], v[136:139]
    v_accvgpr_read_b32 v59, a155
    v_accvgpr_read_b32 v60, a156
    v_mfma_f32_16x16x32_bf16 v[136:139], a[8:11], v[116:119], v[136:139]
    s_add_u32 m0, s30, 33120
    v_accvgpr_read_b32 v61, a157
    v_accvgpr_read_b32 v62, a158
    v_mfma_f32_16x16x32_bf16 v[132:135], a[4:7], v[116:119], v[132:135]
    buffer_load_dwordx4 v16, s[52:55], s35 offen offset:3840 lds
    v_mfma_f32_16x16x32_bf16 v[132:135], a[68:71], v[124:127], v[132:135]
    v_accvgpr_read_b32 v63, a159
    v_mfma_f32_16x16x32_bf16 v[128:131], a[64:67], v[124:127], v[128:131]
    s_add_u32 s36, s34, 393216
    v_mul_f32 v56, v22, v56
    v_mul_f32 v57, v22, v57
    v_mfma_f32_16x16x32_bf16 v[128:131], a[0:3], v[116:119], v[128:131]
    s_waitcnt vmcnt(18) lgkmcnt(0)
    s_barrier
    v_mfma_f32_16x16x32_bf16 v[192:195], a[220:223], v[144:147], v[192:195]
    ds_read_b64_tr_b16 a[0:1], v11 offset:33792
    v_mul_f32 v58, v22, v58
    v_mfma_f32_16x16x32_bf16 v[192:195], a[32:35], v[152:155], v[192:195]
    ds_read_b64_tr_b16 a[2:3], v11 offset:34304
    v_mul_f32 v59, v22, v59
    v_mfma_f32_16x16x32_bf16 v[196:199], a[36:39], v[152:155], v[196:199]
    s_xor_b32 s7, s72, 30
    s_mul_i32 s7, s7, 196608
    ds_read_b64_tr_b16 a[4:5], v11 offset:33824
    v_mfma_f32_16x16x32_bf16 v[196:199], a[224:227], v[144:147], v[196:199]
    buffer_load_dwordx4 v[112:115], v14, s[48:51], s7 offen offset:0 sc1
    v_mfma_f32_16x16x32_bf16 v[200:203], a[228:231], v[144:147], v[200:203]
    ds_read_b64_tr_b16 a[6:7], v11 offset:34336
    v_mul_f32 v60, v22, v60
    v_mfma_f32_16x16x32_bf16 v[200:203], a[40:43], v[152:155], v[200:203]
    s_add_u32 m0, s30, 50688
    ds_read_b64_tr_b16 a[8:9], v11 offset:33856
    v_mul_f32 v61, v22, v61
    v_mfma_f32_16x16x32_bf16 v[204:207], a[44:47], v[152:155], v[204:207]
    s_xor_b32 s35, s72, 33
    s_mul_i32 s35, s35, 40960
    ds_read_b64_tr_b16 a[10:11], v11 offset:34368
    v_mfma_f32_16x16x32_bf16 v[204:207], a[232:235], v[144:147], v[204:207]
    buffer_load_dwordx4 v16, s[52:55], s35 offen offset:0 lds
    v_mfma_f32_16x16x32_bf16 v[224:227], a[236:239], v[144:147], v[224:227]
    ds_read_b64_tr_b16 a[12:13], v11 offset:33888
    v_mul_f32 v62, v22, v62
    v_mfma_f32_16x16x32_bf16 v[224:227], a[48:51], v[152:155], v[224:227]
    ds_read_b64_tr_b16 a[14:15], v11 offset:34400
    v_mul_f32 v63, v22, v63
    v_mfma_f32_16x16x32_bf16 v[228:231], a[52:55], v[152:155], v[228:231]
    ds_read_b64_tr_b16 a[16:17], v11 offset:33920
    v_mfma_f32_16x16x32_bf16 v[228:231], a[240:243], v[144:147], v[228:231]
    buffer_load_dwordx4 v[116:119], v14, s[48:51], s7 offen offset:1024 sc1
    v_mfma_f32_16x16x32_bf16 v[232:235], a[244:247], v[144:147], v[232:235]
    ds_read_b64_tr_b16 a[18:19], v11 offset:34432
    v_mfma_f32_16x16x32_bf16 v[232:235], a[56:59], v[152:155], v[232:235]
    ds_read_b64_tr_b16 a[20:21], v11 offset:33952
    v_mfma_f32_16x16x32_bf16 v[236:239], a[60:63], v[152:155], v[236:239]
    s_add_u32 m0, s30, 50464
    ds_read_b64_tr_b16 a[22:23], v11 offset:34464
    v_mfma_f32_16x16x32_bf16 v[236:239], a[248:251], v[144:147], v[236:239]
    buffer_load_dwordx4 v16, s[52:55], s35 offen offset:1280 lds
    v_mfma_f32_16x16x32_bf16 v[252:255], a[248:251], v[148:151], v[252:255]
    ds_read_b64_tr_b16 a[24:25], v11 offset:33984
    v_mfma_f32_16x16x32_bf16 v[252:255], a[60:63], v[156:159], v[252:255]
    ds_read_b64_tr_b16 a[26:27], v11 offset:34496
    v_mfma_f32_16x16x32_bf16 v[248:251], a[56:59], v[156:159], v[248:251]
    s_xor_b32 s7, s72, 31
    s_mul_i32 s7, s7, 196608
    ds_read_b64_tr_b16 a[28:29], v11 offset:34016
    v_mfma_f32_16x16x32_bf16 v[248:251], a[244:247], v[148:151], v[248:251]
    buffer_load_dwordx4 v[120:123], v14, s[48:51], s7 offen offset:0 sc1
    v_mfma_f32_16x16x32_bf16 v[244:247], a[240:243], v[148:151], v[244:247]
    ds_read_b64_tr_b16 a[30:31], v11 offset:34528
    v_mfma_f32_16x16x32_bf16 v[244:247], a[52:55], v[156:159], v[244:247]
    s_add_u32 m0, s30, 50240
    buffer_store_dwordx4 v[48:51], v4, s[24:27], s36 offen offset:1024 sc1
    v_mfma_f32_16x16x32_bf16 v[240:243], a[48:51], v[156:159], v[240:243]
    buffer_load_dwordx4 v16, s[52:55], s35 offen offset:2560 lds
    v_mfma_f32_16x16x32_bf16 v[240:243], a[236:239], v[148:151], v[240:243]
    s_add_u32 s36, s34, 593920
    v_cvt_pk_bf16_f32 v24, v56, v57
    v_cvt_pk_bf16_f32 v25, v58, v59
    v_mfma_f32_16x16x32_bf16 v[220:223], a[232:235], v[148:151], v[220:223]
    v_cvt_pk_bf16_f32 v26, v60, v61
    v_cvt_pk_bf16_f32 v27, v62, v63
    v_mfma_f32_16x16x32_bf16 v[220:223], a[44:47], v[156:159], v[220:223]
    buffer_load_dwordx4 v[124:127], v14, s[48:51], s7 offen offset:1024 sc1
    v_mfma_f32_16x16x32_bf16 v[216:219], a[40:43], v[156:159], v[216:219]
    buffer_store_dwordx4 v[24:27], v4, s[24:27], s36 offen offset:0 sc1
    v_mfma_f32_16x16x32_bf16 v[216:219], a[228:231], v[148:151], v[216:219]
    s_add_u32 m0, s30, 50016
    v_accvgpr_read_b32 v22, a202
    v_accvgpr_read_b32 v23, a203
    v_mfma_f32_16x16x32_bf16 v[212:215], a[224:227], v[148:151], v[212:215]
    buffer_load_dwordx4 v16, s[52:55], s35 offen offset:3840 lds
    v_mfma_f32_16x16x32_bf16 v[212:215], a[36:39], v[156:159], v[212:215]
    v_add_f32 v22, v22, v23
    v_mfma_f32_16x16x32_bf16 v[208:211], a[32:35], v[156:159], v[208:211]
    v_rcp_f32 v22, v22
    v_mfma_f32_16x16x32_bf16 v[208:211], a[220:223], v[148:151], v[208:211]
    s_waitcnt vmcnt(19) lgkmcnt(0)
    s_barrier
    v_mfma_f32_16x16x32_bf16 v[64:67], a[220:223], v[176:179], v[64:67]
    ds_read_b64_tr_b16 a[64:65], v11 offset:50688
    v_accvgpr_read_b32 v56, a160
    v_mfma_f32_16x16x32_bf16 v[64:67], a[32:35], v[184:187], v[64:67]
    ds_read_b64_tr_b16 a[66:67], v11 offset:51200
    v_accvgpr_read_b32 v57, a161
    v_mfma_f32_16x16x32_bf16 v[68:71], a[36:39], v[184:187], v[68:71]
    s_xor_b32 s7, s72, 32
    s_mul_i32 s7, s7, 196608
    ds_read_b64_tr_b16 a[68:69], v11 offset:50720
    v_mfma_f32_16x16x32_bf16 v[68:71], a[224:227], v[176:179], v[68:71]
    buffer_load_dwordx4 v[144:147], v15, s[48:51], s7 offen offset:0 sc1
    v_mfma_f32_16x16x32_bf16 v[72:75], a[228:231], v[176:179], v[72:75]
    ds_read_b64_tr_b16 a[70:71], v11 offset:51232
    v_accvgpr_read_b32 v58, a162
    v_mfma_f32_16x16x32_bf16 v[72:75], a[40:43], v[184:187], v[72:75]
    s_add_u32 m0, s30, 67584
    ds_read_b64_tr_b16 a[72:73], v11 offset:50752
    v_accvgpr_read_b32 v59, a163
    v_mfma_f32_16x16x32_bf16 v[76:79], a[44:47], v[184:187], v[76:79]
    s_xor_b32 s35, s72, 34
    s_mul_i32 s35, s35, 40960
    ds_read_b64_tr_b16 a[74:75], v11 offset:51264
    v_mfma_f32_16x16x32_bf16 v[76:79], a[232:235], v[176:179], v[76:79]
    buffer_load_dwordx4 v16, s[52:55], s35 offen offset:0 lds
    v_mfma_f32_16x16x32_bf16 v[96:99], a[236:239], v[176:179], v[96:99]
    ds_read_b64_tr_b16 a[76:77], v11 offset:50784
    v_accvgpr_read_b32 v60, a164
    v_mfma_f32_16x16x32_bf16 v[96:99], a[48:51], v[184:187], v[96:99]
    ds_read_b64_tr_b16 a[78:79], v11 offset:51296
    v_accvgpr_read_b32 v61, a165
    v_mfma_f32_16x16x32_bf16 v[100:103], a[52:55], v[184:187], v[100:103]
    ds_read_b64_tr_b16 a[80:81], v11 offset:50816
    v_accvgpr_read_b32 v62, a166
    v_mfma_f32_16x16x32_bf16 v[100:103], a[240:243], v[176:179], v[100:103]
    buffer_load_dwordx4 v[148:151], v15, s[48:51], s7 offen offset:1024 sc1
    v_mfma_f32_16x16x32_bf16 v[104:107], a[244:247], v[176:179], v[104:107]
    ds_read_b64_tr_b16 a[82:83], v11 offset:51328
    v_accvgpr_read_b32 v63, a167
    v_mfma_f32_16x16x32_bf16 v[104:107], a[56:59], v[184:187], v[104:107]
    ds_read_b64_tr_b16 a[84:85], v11 offset:50848
    v_mul_f32 v56, v22, v56
    v_mfma_f32_16x16x32_bf16 v[108:111], a[60:63], v[184:187], v[108:111]
    s_add_u32 m0, s30, 67360
    ds_read_b64_tr_b16 a[86:87], v11 offset:51360
    v_mul_f32 v57, v22, v57
    v_mfma_f32_16x16x32_bf16 v[108:111], a[248:251], v[176:179], v[108:111]
    buffer_load_dwordx4 v16, s[52:55], s35 offen offset:1280 lds
    v_mfma_f32_16x16x32_bf16 v[172:175], a[248:251], v[180:183], v[172:175]
    ds_read_b64_tr_b16 a[88:89], v11 offset:50880
    v_mul_f32 v58, v22, v58
    v_mfma_f32_16x16x32_bf16 v[172:175], a[60:63], v[188:191], v[172:175]
    ds_read_b64_tr_b16 a[90:91], v11 offset:51392
    v_mul_f32 v59, v22, v59
    v_mfma_f32_16x16x32_bf16 v[168:171], a[56:59], v[188:191], v[168:171]
    s_xor_b32 s7, s72, 33
    s_mul_i32 s7, s7, 196608
    ds_read_b64_tr_b16 a[92:93], v11 offset:50912
    v_mfma_f32_16x16x32_bf16 v[168:171], a[244:247], v[180:183], v[168:171]
    buffer_load_dwordx4 v[152:155], v15, s[48:51], s7 offen offset:0 sc1
    v_mfma_f32_16x16x32_bf16 v[164:167], a[240:243], v[180:183], v[164:167]
    ds_read_b64_tr_b16 a[94:95], v11 offset:51424
    v_mul_f32 v60, v22, v60
    v_mfma_f32_16x16x32_bf16 v[164:167], a[52:55], v[188:191], v[164:167]
    s_add_u32 m0, s30, 67136
    v_mul_f32 v61, v22, v61
    v_mul_f32 v62, v22, v62
    v_mfma_f32_16x16x32_bf16 v[160:163], a[48:51], v[188:191], v[160:163]
    buffer_load_dwordx4 v16, s[52:55], s35 offen offset:2560 lds
    v_mfma_f32_16x16x32_bf16 v[160:163], a[236:239], v[180:183], v[160:163]
    v_mul_f32 v63, v22, v63
    v_mfma_f32_16x16x32_bf16 v[140:143], a[232:235], v[180:183], v[140:143]
    s_add_u32 s36, s34, 4096
    v_cvt_pk_bf16_f32 v24, v56, v57
    v_cvt_pk_bf16_f32 v25, v58, v59
    v_mfma_f32_16x16x32_bf16 v[140:143], a[44:47], v[188:191], v[140:143]
    buffer_load_dwordx4 v[156:159], v15, s[48:51], s7 offen offset:1024 sc1
    v_mfma_f32_16x16x32_bf16 v[136:139], a[40:43], v[188:191], v[136:139]
    v_cvt_pk_bf16_f32 v26, v60, v61
    v_cvt_pk_bf16_f32 v27, v62, v63
    v_mfma_f32_16x16x32_bf16 v[136:139], a[228:231], v[180:183], v[136:139]
    s_add_u32 m0, s30, 66912
    buffer_store_dwordx4 v[24:27], v4, s[24:27], s36 offen offset:1024 sc1
    v_mfma_f32_16x16x32_bf16 v[132:135], a[224:227], v[180:183], v[132:135]
    buffer_load_dwordx4 v16, s[52:55], s35 offen offset:3840 lds
    v_mfma_f32_16x16x32_bf16 v[132:135], a[36:39], v[188:191], v[132:135]
    v_accvgpr_read_b32 v56, a168
    v_accvgpr_read_b32 v57, a169
    v_mfma_f32_16x16x32_bf16 v[128:131], a[32:35], v[188:191], v[128:131]
    v_accvgpr_read_b32 v58, a170
    v_accvgpr_read_b32 v59, a171
    v_mfma_f32_16x16x32_bf16 v[128:131], a[220:223], v[180:183], v[128:131]
    s_waitcnt vmcnt(19) lgkmcnt(0)
    s_barrier
    v_mfma_f32_16x16x32_bf16 v[192:195], a[0:3], v[80:83], v[192:195]
    ds_read_b64_tr_b16 a[220:221], v11 offset:0
    v_accvgpr_read_b32 v60, a172
    v_mfma_f32_16x16x32_bf16 v[192:195], a[64:67], v[88:91], v[192:195]
    ds_read_b64_tr_b16 a[222:223], v11 offset:512
    v_accvgpr_read_b32 v61, a173
    v_mfma_f32_16x16x32_bf16 v[196:199], a[68:71], v[88:91], v[196:199]
    s_xor_b32 s7, s72, 32
    s_mul_i32 s7, s7, 196608
    ds_read_b64_tr_b16 a[224:225], v11 offset:32
    v_mfma_f32_16x16x32_bf16 v[196:199], a[4:7], v[80:83], v[196:199]
    buffer_load_dwordx4 v[176:179], v14, s[48:51], s7 offen offset:0 sc1
    v_mfma_f32_16x16x32_bf16 v[200:203], a[8:11], v[80:83], v[200:203]
    ds_read_b64_tr_b16 a[226:227], v11 offset:544
    v_accvgpr_read_b32 v62, a174
    v_mfma_f32_16x16x32_bf16 v[200:203], a[72:75], v[88:91], v[200:203]
    s_add_u32 m0, s30, 84480
    ds_read_b64_tr_b16 a[228:229], v11 offset:64
    v_accvgpr_read_b32 v63, a175
    v_mfma_f32_16x16x32_bf16 v[204:207], a[76:79], v[88:91], v[204:207]
    s_xor_b32 s35, s72, 35
    s_mul_i32 s35, s35, 40960
    ds_read_b64_tr_b16 a[230:231], v11 offset:576
    v_mfma_f32_16x16x32_bf16 v[204:207], a[12:15], v[80:83], v[204:207]
    buffer_load_dwordx4 v16, s[52:55], s35 offen offset:0 lds
    v_mfma_f32_16x16x32_bf16 v[224:227], a[16:19], v[80:83], v[224:227]
    ds_read_b64_tr_b16 a[232:233], v11 offset:96
    v_mul_f32 v56, v22, v56
    v_mfma_f32_16x16x32_bf16 v[224:227], a[80:83], v[88:91], v[224:227]
    ds_read_b64_tr_b16 a[234:235], v11 offset:608
    v_mul_f32 v57, v22, v57
    v_mfma_f32_16x16x32_bf16 v[228:231], a[84:87], v[88:91], v[228:231]
    ds_read_b64_tr_b16 a[236:237], v11 offset:128
    v_mul_f32 v58, v22, v58
    v_mfma_f32_16x16x32_bf16 v[228:231], a[20:23], v[80:83], v[228:231]
    buffer_load_dwordx4 v[180:183], v14, s[48:51], s7 offen offset:1024 sc1
    v_mfma_f32_16x16x32_bf16 v[232:235], a[24:27], v[80:83], v[232:235]
    ds_read_b64_tr_b16 a[238:239], v11 offset:640
    v_mul_f32 v59, v22, v59
    v_mfma_f32_16x16x32_bf16 v[232:235], a[88:91], v[88:91], v[232:235]
    ds_read_b64_tr_b16 a[240:241], v11 offset:160
    v_mul_f32 v60, v22, v60
    v_mfma_f32_16x16x32_bf16 v[236:239], a[92:95], v[88:91], v[236:239]
    s_add_u32 m0, s30, 84256
    ds_read_b64_tr_b16 a[242:243], v11 offset:672
    v_mul_f32 v61, v22, v61
    v_mfma_f32_16x16x32_bf16 v[236:239], a[28:31], v[80:83], v[236:239]
    buffer_load_dwordx4 v16, s[52:55], s35 offen offset:1280 lds
    v_mfma_f32_16x16x32_bf16 v[252:255], a[28:31], v[84:87], v[252:255]
    ds_read_b64_tr_b16 a[244:245], v11 offset:192
    v_mul_f32 v62, v22, v62
    v_mfma_f32_16x16x32_bf16 v[252:255], a[92:95], v[92:95], v[252:255]
    ds_read_b64_tr_b16 a[246:247], v11 offset:704
    v_mul_f32 v63, v22, v63
    v_mfma_f32_16x16x32_bf16 v[248:251], a[88:91], v[92:95], v[248:251]
    s_xor_b32 s7, s72, 33
    s_mul_i32 s7, s7, 196608
    ds_read_b64_tr_b16 a[248:249], v11 offset:224
    v_mfma_f32_16x16x32_bf16 v[248:251], a[24:27], v[84:87], v[248:251]
    s_add_u32 s36, s34, 200704
    buffer_load_dwordx4 v[184:187], v14, s[48:51], s7 offen offset:0 sc1
    v_mfma_f32_16x16x32_bf16 v[244:247], a[20:23], v[84:87], v[244:247]
    ds_read_b64_tr_b16 a[250:251], v11 offset:736
    v_cvt_pk_bf16_f32 v24, v56, v57
    v_mfma_f32_16x16x32_bf16 v[244:247], a[84:87], v[92:95], v[244:247]
    s_add_u32 m0, s30, 84032
    v_cvt_pk_bf16_f32 v25, v58, v59
    v_cvt_pk_bf16_f32 v26, v60, v61
    v_mfma_f32_16x16x32_bf16 v[240:243], a[80:83], v[92:95], v[240:243]
    buffer_load_dwordx4 v16, s[52:55], s35 offen offset:2560 lds
    v_mfma_f32_16x16x32_bf16 v[240:243], a[16:19], v[84:87], v[240:243]
    v_cvt_pk_bf16_f32 v27, v62, v63
    v_accvgpr_read_b32 v56, a176
    v_mfma_f32_16x16x32_bf16 v[220:223], a[12:15], v[84:87], v[220:223]
    buffer_store_dwordx4 v[24:27], v4, s[24:27], s36 offen offset:1024 sc1
    v_mfma_f32_16x16x32_bf16 v[220:223], a[76:79], v[92:95], v[220:223]
    buffer_load_dwordx4 v[188:191], v14, s[48:51], s7 offen offset:1024 sc1
    v_mfma_f32_16x16x32_bf16 v[216:219], a[72:75], v[92:95], v[216:219]
    v_accvgpr_read_b32 v57, a177
    v_accvgpr_read_b32 v58, a178
    v_mfma_f32_16x16x32_bf16 v[216:219], a[8:11], v[84:87], v[216:219]
    s_add_u32 m0, s30, 83808
    v_accvgpr_read_b32 v59, a179
    v_accvgpr_read_b32 v60, a180
    v_mfma_f32_16x16x32_bf16 v[212:215], a[4:7], v[84:87], v[212:215]
    buffer_load_dwordx4 v16, s[52:55], s35 offen offset:3840 lds
    v_mfma_f32_16x16x32_bf16 v[212:215], a[68:71], v[92:95], v[212:215]
    v_accvgpr_read_b32 v61, a181
    v_accvgpr_read_b32 v62, a182
    v_mfma_f32_16x16x32_bf16 v[208:211], a[64:67], v[92:95], v[208:211]
    v_accvgpr_read_b32 v63, a183
    v_mul_f32 v56, v22, v56
    v_mfma_f32_16x16x32_bf16 v[208:211], a[0:3], v[84:87], v[208:211]
    s_waitcnt vmcnt(18) lgkmcnt(0)
    s_barrier
    v_mfma_f32_16x16x32_bf16 v[64:67], a[0:3], v[112:115], v[64:67]
    ds_read_b64_tr_b16 a[32:33], v11 offset:16896
    v_mul_f32 v57, v22, v57
    v_mfma_f32_16x16x32_bf16 v[64:67], a[64:67], v[120:123], v[64:67]
    ds_read_b64_tr_b16 a[34:35], v11 offset:17408
    v_mul_f32 v58, v22, v58
    v_mfma_f32_16x16x32_bf16 v[68:71], a[68:71], v[120:123], v[68:71]
    s_xor_b32 s7, s72, 34
    s_mul_i32 s7, s7, 196608
    ds_read_b64_tr_b16 a[36:37], v11 offset:16928
    v_mfma_f32_16x16x32_bf16 v[68:71], a[4:7], v[112:115], v[68:71]
    buffer_load_dwordx4 v[80:83], v15, s[48:51], s7 offen offset:0 sc1
    v_mfma_f32_16x16x32_bf16 v[72:75], a[8:11], v[112:115], v[72:75]
    ds_read_b64_tr_b16 a[38:39], v11 offset:17440
    v_mul_f32 v59, v22, v59
    v_mfma_f32_16x16x32_bf16 v[72:75], a[72:75], v[120:123], v[72:75]
    s_add_u32 m0, s30, 33792
    ds_read_b64_tr_b16 a[40:41], v11 offset:16960
    v_mul_f32 v60, v22, v60
    v_mfma_f32_16x16x32_bf16 v[76:79], a[76:79], v[120:123], v[76:79]
    s_xor_b32 s35, s72, 36
    s_mul_i32 s35, s35, 40960
    ds_read_b64_tr_b16 a[42:43], v11 offset:17472
    v_mfma_f32_16x16x32_bf16 v[76:79], a[12:15], v[112:115], v[76:79]
    buffer_load_dwordx4 v16, s[52:55], s35 offen offset:0 lds
    v_mfma_f32_16x16x32_bf16 v[96:99], a[16:19], v[112:115], v[96:99]
    ds_read_b64_tr_b16 a[44:45], v11 offset:16992
    v_mul_f32 v61, v22, v61
    v_mfma_f32_16x16x32_bf16 v[96:99], a[80:83], v[120:123], v[96:99]
    ds_read_b64_tr_b16 a[46:47], v11 offset:17504
    v_mul_f32 v62, v22, v62
    v_mfma_f32_16x16x32_bf16 v[100:103], a[84:87], v[120:123], v[100:103]
    ds_read_b64_tr_b16 a[48:49], v11 offset:17024
    v_mul_f32 v63, v22, v63
    v_mfma_f32_16x16x32_bf16 v[100:103], a[20:23], v[112:115], v[100:103]
    s_add_u32 s36, s34, 397312
    buffer_load_dwordx4 v[84:87], v15, s[48:51], s7 offen offset:1024 sc1
    v_mfma_f32_16x16x32_bf16 v[104:107], a[24:27], v[112:115], v[104:107]
    ds_read_b64_tr_b16 a[50:51], v11 offset:17536
    v_cvt_pk_bf16_f32 v24, v56, v57
    v_mfma_f32_16x16x32_bf16 v[104:107], a[88:91], v[120:123], v[104:107]
    ds_read_b64_tr_b16 a[52:53], v11 offset:17056
    v_cvt_pk_bf16_f32 v25, v58, v59
    v_mfma_f32_16x16x32_bf16 v[108:111], a[92:95], v[120:123], v[108:111]
    s_add_u32 m0, s30, 33568
    ds_read_b64_tr_b16 a[54:55], v11 offset:17568
    v_cvt_pk_bf16_f32 v26, v60, v61
    v_mfma_f32_16x16x32_bf16 v[108:111], a[28:31], v[112:115], v[108:111]
    buffer_load_dwordx4 v16, s[52:55], s35 offen offset:1280 lds
    v_mfma_f32_16x16x32_bf16 v[172:175], a[28:31], v[116:119], v[172:175]
    ds_read_b64_tr_b16 a[56:57], v11 offset:17088
    v_cvt_pk_bf16_f32 v27, v62, v63
    v_mfma_f32_16x16x32_bf16 v[172:175], a[92:95], v[124:127], v[172:175]
    ds_read_b64_tr_b16 a[58:59], v11 offset:17600
    v_accvgpr_read_b32 v56, a184
    v_mfma_f32_16x16x32_bf16 v[168:171], a[88:91], v[124:127], v[168:171]
    s_xor_b32 s7, s72, 35
    s_mul_i32 s7, s7, 196608
    ds_read_b64_tr_b16 a[60:61], v11 offset:17120
    v_mfma_f32_16x16x32_bf16 v[168:171], a[24:27], v[116:119], v[168:171]
    buffer_load_dwordx4 v[88:91], v15, s[48:51], s7 offen offset:0 sc1
    v_mfma_f32_16x16x32_bf16 v[164:167], a[20:23], v[116:119], v[164:167]
    ds_read_b64_tr_b16 a[62:63], v11 offset:17632
    v_accvgpr_read_b32 v57, a185
    v_mfma_f32_16x16x32_bf16 v[164:167], a[84:87], v[124:127], v[164:167]
    s_add_u32 m0, s30, 33344
    buffer_store_dwordx4 v[24:27], v4, s[24:27], s36 offen offset:1024 sc1
    v_mfma_f32_16x16x32_bf16 v[160:163], a[80:83], v[124:127], v[160:163]
    buffer_load_dwordx4 v16, s[52:55], s35 offen offset:2560 lds
    v_mfma_f32_16x16x32_bf16 v[160:163], a[16:19], v[116:119], v[160:163]
    v_accvgpr_read_b32 v58, a186
    v_accvgpr_read_b32 v59, a187
    v_mfma_f32_16x16x32_bf16 v[140:143], a[12:15], v[116:119], v[140:143]
    v_accvgpr_read_b32 v60, a188
    v_accvgpr_read_b32 v61, a189
    v_mfma_f32_16x16x32_bf16 v[140:143], a[76:79], v[124:127], v[140:143]
    buffer_load_dwordx4 v[92:95], v15, s[48:51], s7 offen offset:1024 sc1
    v_mfma_f32_16x16x32_bf16 v[136:139], a[72:75], v[124:127], v[136:139]
    v_accvgpr_read_b32 v62, a190
    v_accvgpr_read_b32 v63, a191
    v_mfma_f32_16x16x32_bf16 v[136:139], a[8:11], v[116:119], v[136:139]
    s_add_u32 m0, s30, 33120
    s_add_u32 s36, s34, 589824
    v_mul_f32 v56, v22, v56
    v_mfma_f32_16x16x32_bf16 v[132:135], a[4:7], v[116:119], v[132:135]
    buffer_load_dwordx4 v16, s[52:55], s35 offen offset:3840 lds
    v_mfma_f32_16x16x32_bf16 v[132:135], a[68:71], v[124:127], v[132:135]
    buffer_store_dwordx4 v[52:55], v4, s[24:27], s36 offen offset:1024 sc1
    v_mfma_f32_16x16x32_bf16 v[128:131], a[64:67], v[124:127], v[128:131]
    v_mul_f32 v57, v22, v57
    v_mul_f32 v58, v22, v58
    v_mfma_f32_16x16x32_bf16 v[128:131], a[0:3], v[116:119], v[128:131]
    s_waitcnt vmcnt(19) lgkmcnt(0)
    s_barrier
    v_mfma_f32_16x16x32_bf16 v[192:195], a[220:223], v[144:147], v[192:195]
    ds_read_b64_tr_b16 a[0:1], v11 offset:33792
    v_accvgpr_read_b32 v32, a196
    v_mfma_f32_16x16x32_bf16 v[192:195], a[32:35], v[152:155], v[192:195]
    ds_read_b64_tr_b16 a[2:3], v11 offset:34304
    v_accvgpr_read_b32 v33, a197
    v_mfma_f32_16x16x32_bf16 v[196:199], a[36:39], v[152:155], v[196:199]
    s_xor_b32 s7, s72, 34
    s_mul_i32 s7, s7, 196608
    ds_read_b64_tr_b16 a[4:5], v11 offset:33824
    v_mfma_f32_16x16x32_bf16 v[196:199], a[224:227], v[144:147], v[196:199]
    buffer_load_dwordx4 v[112:115], v14, s[48:51], s7 offen offset:0 sc1
    v_mfma_f32_16x16x32_bf16 v[200:203], a[228:231], v[144:147], v[200:203]
    ds_read_b64_tr_b16 a[6:7], v11 offset:34336
    v_add_f32 v32, v32, v33
    v_mfma_f32_16x16x32_bf16 v[200:203], a[40:43], v[152:155], v[200:203]
    s_add_u32 m0, s30, 50688
    ds_read_b64_tr_b16 a[8:9], v11 offset:33856
    v_subrev_u32 v32, s46, v32
    v_mfma_f32_16x16x32_bf16 v[204:207], a[44:47], v[152:155], v[204:207]
    s_xor_b32 s35, s72, 37
    s_mul_i32 s35, s35, 40960
    ds_read_b64_tr_b16 a[10:11], v11 offset:34368
    v_mfma_f32_16x16x32_bf16 v[204:207], a[232:235], v[144:147], v[204:207]
    buffer_load_dwordx4 v16, s[52:55], s35 offen offset:0 lds
    v_mfma_f32_16x16x32_bf16 v[224:227], a[236:239], v[144:147], v[224:227]
    ds_read_b64_tr_b16 a[12:13], v11 offset:33888
    v_max_u32 v28, v28, v32
    v_mfma_f32_16x16x32_bf16 v[224:227], a[48:51], v[152:155], v[224:227]
    ds_read_b64_tr_b16 a[14:15], v11 offset:34400
    v_accvgpr_read_b32 v32, a198
    v_mfma_f32_16x16x32_bf16 v[228:231], a[52:55], v[152:155], v[228:231]
    ds_read_b64_tr_b16 a[16:17], v11 offset:33920
    v_accvgpr_read_b32 v33, a199
    v_mfma_f32_16x16x32_bf16 v[228:231], a[240:243], v[144:147], v[228:231]
    buffer_load_dwordx4 v[116:119], v14, s[48:51], s7 offen offset:1024 sc1
    v_mfma_f32_16x16x32_bf16 v[232:235], a[244:247], v[144:147], v[232:235]
    ds_read_b64_tr_b16 a[18:19], v11 offset:34432
    v_add_f32 v32, v32, v33
    v_mfma_f32_16x16x32_bf16 v[232:235], a[56:59], v[152:155], v[232:235]
    ds_read_b64_tr_b16 a[20:21], v11 offset:33952
    v_subrev_u32 v32, s46, v32
    v_mfma_f32_16x16x32_bf16 v[236:239], a[60:63], v[152:155], v[236:239]
    s_add_u32 m0, s30, 50464
    ds_read_b64_tr_b16 a[22:23], v11 offset:34464
    v_max_u32 v28, v28, v32
    v_mfma_f32_16x16x32_bf16 v[236:239], a[248:251], v[144:147], v[236:239]
    buffer_load_dwordx4 v16, s[52:55], s35 offen offset:1280 lds
    v_mfma_f32_16x16x32_bf16 v[252:255], a[248:251], v[148:151], v[252:255]
    ds_read_b64_tr_b16 a[24:25], v11 offset:33984
    v_accvgpr_read_b32 v32, a200
    v_mfma_f32_16x16x32_bf16 v[252:255], a[60:63], v[156:159], v[252:255]
    ds_read_b64_tr_b16 a[26:27], v11 offset:34496
    v_accvgpr_read_b32 v33, a201
    v_mfma_f32_16x16x32_bf16 v[248:251], a[56:59], v[156:159], v[248:251]
    s_xor_b32 s7, s72, 35
    s_mul_i32 s7, s7, 196608
    ds_read_b64_tr_b16 a[28:29], v11 offset:34016
    v_mfma_f32_16x16x32_bf16 v[248:251], a[244:247], v[148:151], v[248:251]
    buffer_load_dwordx4 v[120:123], v14, s[48:51], s7 offen offset:0 sc1
    v_mfma_f32_16x16x32_bf16 v[244:247], a[240:243], v[148:151], v[244:247]
    ds_read_b64_tr_b16 a[30:31], v11 offset:34528
    v_add_f32 v32, v32, v33
    v_mfma_f32_16x16x32_bf16 v[244:247], a[52:55], v[156:159], v[244:247]
    s_add_u32 m0, s30, 50240
    v_subrev_u32 v32, s46, v32
    v_max_u32 v28, v28, v32
    v_mfma_f32_16x16x32_bf16 v[240:243], a[48:51], v[156:159], v[240:243]
    buffer_load_dwordx4 v16, s[52:55], s35 offen offset:2560 lds
    v_mfma_f32_16x16x32_bf16 v[240:243], a[236:239], v[148:151], v[240:243]
    v_accvgpr_read_b32 v32, a202
    v_accvgpr_read_b32 v33, a203
    v_mfma_f32_16x16x32_bf16 v[220:223], a[232:235], v[148:151], v[220:223]
    v_add_f32 v32, v32, v33
    v_subrev_u32 v32, s46, v32
    v_mfma_f32_16x16x32_bf16 v[220:223], a[44:47], v[156:159], v[220:223]
    buffer_load_dwordx4 v[124:127], v14, s[48:51], s7 offen offset:1024 sc1
    v_mfma_f32_16x16x32_bf16 v[216:219], a[40:43], v[156:159], v[216:219]
    v_max_u32 v28, v28, v32
    v_cmp_le_u32 s[40:41], s47, v28
    v_mfma_f32_16x16x32_bf16 v[216:219], a[228:231], v[148:151], v[216:219]
    s_add_u32 m0, s30, 50016
    v_mov_b32 v33, 163776
    v_mul_f32 v59, v22, v59
    v_mfma_f32_16x16x32_bf16 v[212:215], a[224:227], v[148:151], v[212:215]
    buffer_load_dwordx4 v16, s[52:55], s35 offen offset:3840 lds
    v_mfma_f32_16x16x32_bf16 v[212:215], a[36:39], v[156:159], v[212:215]
    s_cmp_lg_u64 s[40:41], 0
    s_cselect_b32 s85, 2, 0
    s_or_b32 s42, s42, s85
    v_mfma_f32_16x16x32_bf16 v[208:211], a[32:35], v[156:159], v[208:211]
    s_lshl_b32 s85, s43, 2
    v_mov_b32 v32, s42
    v_add_u32 v34, s85, v33
    v_mfma_f32_16x16x32_bf16 v[208:211], a[220:223], v[148:151], v[208:211]
    s_waitcnt vmcnt(18) lgkmcnt(0)
    s_barrier
    v_mfma_f32_16x16x32_bf16 v[64:67], a[220:223], v[176:179], v[64:67]
    ds_read_b64_tr_b16 a[64:65], v11 offset:50688
    v_mul_f32 v60, v22, v60
    v_mfma_f32_16x16x32_bf16 v[64:67], a[32:35], v[184:187], v[64:67]
    ds_read_b64_tr_b16 a[66:67], v11 offset:51200
    v_mul_f32 v61, v22, v61
    v_mfma_f32_16x16x32_bf16 v[68:71], a[36:39], v[184:187], v[68:71]
    s_xor_b32 s7, s72, 36
    s_mul_i32 s7, s7, 196608
    ds_read_b64_tr_b16 a[68:69], v11 offset:50720
    v_mfma_f32_16x16x32_bf16 v[68:71], a[224:227], v[176:179], v[68:71]
    buffer_load_dwordx4 v[144:147], v15, s[48:51], s7 offen offset:0 sc1
    v_mfma_f32_16x16x32_bf16 v[72:75], a[228:231], v[176:179], v[72:75]
    ds_read_b64_tr_b16 a[70:71], v11 offset:51232
    v_mul_f32 v62, v22, v62
    v_mfma_f32_16x16x32_bf16 v[72:75], a[40:43], v[184:187], v[72:75]
    s_add_u32 m0, s30, 67584
    ds_read_b64_tr_b16 a[72:73], v11 offset:50752
    v_mul_f32 v63, v22, v63
    v_mfma_f32_16x16x32_bf16 v[76:79], a[44:47], v[184:187], v[76:79]
    s_xor_b32 s35, s72, 38
    s_mul_i32 s35, s35, 40960
    ds_read_b64_tr_b16 a[74:75], v11 offset:51264
    v_mfma_f32_16x16x32_bf16 v[76:79], a[232:235], v[176:179], v[76:79]
    s_add_u32 s36, s34, 593920
    buffer_load_dwordx4 v16, s[52:55], s35 offen offset:0 lds
    v_mfma_f32_16x16x32_bf16 v[96:99], a[236:239], v[176:179], v[96:99]
    ds_read_b64_tr_b16 a[76:77], v11 offset:50784
    v_cvt_pk_bf16_f32 v24, v56, v57
    v_mfma_f32_16x16x32_bf16 v[96:99], a[48:51], v[184:187], v[96:99]
    ds_read_b64_tr_b16 a[78:79], v11 offset:51296
    v_cvt_pk_bf16_f32 v25, v58, v59
    v_mfma_f32_16x16x32_bf16 v[100:103], a[52:55], v[184:187], v[100:103]
    ds_read_b64_tr_b16 a[80:81], v11 offset:50816
    v_cvt_pk_bf16_f32 v26, v60, v61
    v_mfma_f32_16x16x32_bf16 v[100:103], a[240:243], v[176:179], v[100:103]
    buffer_load_dwordx4 v[148:151], v15, s[48:51], s7 offen offset:1024 sc1
    v_mfma_f32_16x16x32_bf16 v[104:107], a[244:247], v[176:179], v[104:107]
    ds_read_b64_tr_b16 a[82:83], v11 offset:51328
    v_cvt_pk_bf16_f32 v27, v62, v63
    v_mfma_f32_16x16x32_bf16 v[104:107], a[56:59], v[184:187], v[104:107]
    ds_read_b64_tr_b16 a[84:85], v11 offset:50848
    v_mfma_f32_16x16x32_bf16 v[108:111], a[60:63], v[184:187], v[108:111]
    s_add_u32 m0, s30, 67360
    ds_read_b64_tr_b16 a[86:87], v11 offset:51360
    v_mfma_f32_16x16x32_bf16 v[108:111], a[248:251], v[176:179], v[108:111]
    buffer_load_dwordx4 v16, s[52:55], s35 offen offset:1280 lds
    v_mfma_f32_16x16x32_bf16 v[172:175], a[248:251], v[180:183], v[172:175]
    ds_read_b64_tr_b16 a[88:89], v11 offset:50880
    v_mfma_f32_16x16x32_bf16 v[172:175], a[60:63], v[188:191], v[172:175]
    ds_read_b64_tr_b16 a[90:91], v11 offset:51392
    v_mfma_f32_16x16x32_bf16 v[168:171], a[56:59], v[188:191], v[168:171]
    s_xor_b32 s7, s72, 37
    s_mul_i32 s7, s7, 196608
    ds_read_b64_tr_b16 a[92:93], v11 offset:50912
    v_mfma_f32_16x16x32_bf16 v[168:171], a[244:247], v[180:183], v[168:171]
    buffer_load_dwordx4 v[152:155], v15, s[48:51], s7 offen offset:0 sc1
    v_mfma_f32_16x16x32_bf16 v[164:167], a[240:243], v[180:183], v[164:167]
    ds_read_b64_tr_b16 a[94:95], v11 offset:51424
    v_mfma_f32_16x16x32_bf16 v[164:167], a[52:55], v[188:191], v[164:167]
    s_add_u32 m0, s30, 67136
    ds_write_b32 v34, v32
    v_mfma_f32_16x16x32_bf16 v[160:163], a[48:51], v[188:191], v[160:163]
    buffer_load_dwordx4 v16, s[52:55], s35 offen offset:2560 lds
    v_mfma_f32_16x16x32_bf16 v[160:163], a[236:239], v[180:183], v[160:163]
    buffer_store_dwordx4 v[24:27], v4, s[24:27], s36 offen offset:1024 sc1
    v_mfma_f32_16x16x32_bf16 v[140:143], a[232:235], v[180:183], v[140:143]
    v_mfma_f32_16x16x32_bf16 v[140:143], a[44:47], v[188:191], v[140:143]
    buffer_load_dwordx4 v[156:159], v15, s[48:51], s7 offen offset:1024 sc1
    v_mfma_f32_16x16x32_bf16 v[136:139], a[40:43], v[188:191], v[136:139]
    v_mfma_f32_16x16x32_bf16 v[136:139], a[228:231], v[180:183], v[136:139]
    s_add_u32 m0, s30, 66912
    v_mfma_f32_16x16x32_bf16 v[132:135], a[224:227], v[180:183], v[132:135]
    buffer_load_dwordx4 v16, s[52:55], s35 offen offset:3840 lds
    v_mfma_f32_16x16x32_bf16 v[132:135], a[36:39], v[188:191], v[132:135]
    v_mfma_f32_16x16x32_bf16 v[128:131], a[32:35], v[188:191], v[128:131]
    v_mfma_f32_16x16x32_bf16 v[128:131], a[220:223], v[180:183], v[128:131]
    s_waitcnt vmcnt(18) lgkmcnt(0)
    s_barrier
    v_mfma_f32_16x16x32_bf16 v[192:195], a[0:3], v[80:83], v[192:195]
    ds_read_b64_tr_b16 a[220:221], v11 offset:0
    v_mfma_f32_16x16x32_bf16 v[192:195], a[64:67], v[88:91], v[192:195]
    ds_read_b64_tr_b16 a[222:223], v11 offset:512
    v_mfma_f32_16x16x32_bf16 v[196:199], a[68:71], v[88:91], v[196:199]
    s_xor_b32 s7, s72, 36
    s_mul_i32 s7, s7, 196608
    ds_read_b64_tr_b16 a[224:225], v11 offset:32
    v_mfma_f32_16x16x32_bf16 v[196:199], a[4:7], v[80:83], v[196:199]
    buffer_load_dwordx4 v[176:179], v14, s[48:51], s7 offen offset:0 sc1
    v_mfma_f32_16x16x32_bf16 v[200:203], a[8:11], v[80:83], v[200:203]
    ds_read_b64_tr_b16 a[226:227], v11 offset:544
    v_mfma_f32_16x16x32_bf16 v[200:203], a[72:75], v[88:91], v[200:203]
    s_add_u32 m0, s30, 84480
    ds_read_b64_tr_b16 a[228:229], v11 offset:64
    v_mfma_f32_16x16x32_bf16 v[204:207], a[76:79], v[88:91], v[204:207]
    s_xor_b32 s35, s72, 39
    s_mul_i32 s35, s35, 40960
    ds_read_b64_tr_b16 a[230:231], v11 offset:576
    v_mfma_f32_16x16x32_bf16 v[204:207], a[12:15], v[80:83], v[204:207]
    buffer_load_dwordx4 v16, s[52:55], s35 offen offset:0 lds
    v_mfma_f32_16x16x32_bf16 v[224:227], a[16:19], v[80:83], v[224:227]
    ds_read_b64_tr_b16 a[232:233], v11 offset:96
    v_mfma_f32_16x16x32_bf16 v[224:227], a[80:83], v[88:91], v[224:227]
    ds_read_b64_tr_b16 a[234:235], v11 offset:608
    v_mfma_f32_16x16x32_bf16 v[228:231], a[84:87], v[88:91], v[228:231]
    ds_read_b64_tr_b16 a[236:237], v11 offset:128
    v_mfma_f32_16x16x32_bf16 v[228:231], a[20:23], v[80:83], v[228:231]
    buffer_load_dwordx4 v[180:183], v14, s[48:51], s7 offen offset:1024 sc1
    v_mfma_f32_16x16x32_bf16 v[232:235], a[24:27], v[80:83], v[232:235]
    ds_read_b64_tr_b16 a[238:239], v11 offset:640
    v_mfma_f32_16x16x32_bf16 v[232:235], a[88:91], v[88:91], v[232:235]
    ds_read_b64_tr_b16 a[240:241], v11 offset:160
    v_mfma_f32_16x16x32_bf16 v[236:239], a[92:95], v[88:91], v[236:239]
    s_add_u32 m0, s30, 84256
    ds_read_b64_tr_b16 a[242:243], v11 offset:672
    v_mfma_f32_16x16x32_bf16 v[236:239], a[28:31], v[80:83], v[236:239]
    buffer_load_dwordx4 v16, s[52:55], s35 offen offset:1280 lds
    v_mfma_f32_16x16x32_bf16 v[252:255], a[28:31], v[84:87], v[252:255]
    ds_read_b64_tr_b16 a[244:245], v11 offset:192
    v_mfma_f32_16x16x32_bf16 v[252:255], a[92:95], v[92:95], v[252:255]
    ds_read_b64_tr_b16 a[246:247], v11 offset:704
    v_mfma_f32_16x16x32_bf16 v[248:251], a[88:91], v[92:95], v[248:251]
    s_xor_b32 s7, s72, 37
    s_mul_i32 s7, s7, 196608
    ds_read_b64_tr_b16 a[248:249], v11 offset:224
    v_mfma_f32_16x16x32_bf16 v[248:251], a[24:27], v[84:87], v[248:251]
    buffer_load_dwordx4 v[184:187], v14, s[48:51], s7 offen offset:0 sc1
    v_mfma_f32_16x16x32_bf16 v[244:247], a[20:23], v[84:87], v[244:247]
    ds_read_b64_tr_b16 a[250:251], v11 offset:736
    v_mfma_f32_16x16x32_bf16 v[244:247], a[84:87], v[92:95], v[244:247]
    s_add_u32 m0, s30, 84032
    ds_read_b128 v[36:39], v33
    v_mfma_f32_16x16x32_bf16 v[240:243], a[80:83], v[92:95], v[240:243]
    buffer_load_dwordx4 v16, s[52:55], s35 offen offset:2560 lds
    v_mfma_f32_16x16x32_bf16 v[240:243], a[16:19], v[84:87], v[240:243]
    v_mfma_f32_16x16x32_bf16 v[220:223], a[12:15], v[84:87], v[220:223]
    v_mfma_f32_16x16x32_bf16 v[220:223], a[76:79], v[92:95], v[220:223]
    buffer_load_dwordx4 v[188:191], v14, s[48:51], s7 offen offset:1024 sc1
    v_mfma_f32_16x16x32_bf16 v[216:219], a[72:75], v[92:95], v[216:219]
    v_mfma_f32_16x16x32_bf16 v[216:219], a[8:11], v[84:87], v[216:219]
    s_add_u32 m0, s30, 83808
    v_mfma_f32_16x16x32_bf16 v[212:215], a[4:7], v[84:87], v[212:215]
    buffer_load_dwordx4 v16, s[52:55], s35 offen offset:3840 lds
    v_mfma_f32_16x16x32_bf16 v[212:215], a[68:71], v[92:95], v[212:215]
    v_mfma_f32_16x16x32_bf16 v[208:211], a[64:67], v[92:95], v[208:211]
    v_mfma_f32_16x16x32_bf16 v[208:211], a[0:3], v[84:87], v[208:211]
    s_waitcnt vmcnt(17) lgkmcnt(0)
    s_barrier
    v_mfma_f32_16x16x32_bf16 v[64:67], a[0:3], v[112:115], v[64:67]
    ds_read_b64_tr_b16 a[32:33], v11 offset:16896
    v_or3_b32 v32, v36, v37, v38
    v_mfma_f32_16x16x32_bf16 v[64:67], a[64:67], v[120:123], v[64:67]
    ds_read_b64_tr_b16 a[34:35], v11 offset:17408
    v_or_b32 v32, v32, v39
    v_mfma_f32_16x16x32_bf16 v[68:71], a[68:71], v[120:123], v[68:71]
    s_xor_b32 s7, s72, 38
    s_mul_i32 s7, s7, 196608
    ds_read_b64_tr_b16 a[36:37], v11 offset:16928
    v_mfma_f32_16x16x32_bf16 v[68:71], a[4:7], v[112:115], v[68:71]
    buffer_load_dwordx4 v[80:83], v15, s[48:51], s7 offen offset:0 sc1
    v_mfma_f32_16x16x32_bf16 v[72:75], a[8:11], v[112:115], v[72:75]
    ds_read_b64_tr_b16 a[38:39], v11 offset:17440
    v_readfirstlane_b32 s87, v32
    v_mfma_f32_16x16x32_bf16 v[72:75], a[72:75], v[120:123], v[72:75]
    s_add_u32 m0, s30, 33792
    s_lshl_b32 s85, s45, 14
    ds_read_b64_tr_b16 a[40:41], v11 offset:16960
    v_mfma_f32_16x16x32_bf16 v[76:79], a[76:79], v[120:123], v[76:79]
    s_xor_b32 s35, s72, 56
    s_mul_i32 s35, s35, 40960
    ds_read_b64_tr_b16 a[42:43], v11 offset:17472
    v_mfma_f32_16x16x32_bf16 v[76:79], a[12:15], v[112:115], v[76:79]
    buffer_load_dwordx4 v16, s[52:55], s35 offen offset:0 lds
    v_mfma_f32_16x16x32_bf16 v[96:99], a[16:19], v[112:115], v[96:99]
    ds_read_b64_tr_b16 a[44:45], v11 offset:16992
    v_add_u32 v32, s85, v4
    v_mfma_f32_16x16x32_bf16 v[96:99], a[80:83], v[120:123], v[96:99]
    s_mul_i32 s85, s44, 101376
    ds_read_b64_tr_b16 a[46:47], v11 offset:17504
    v_add_u32 v1, s85, v32
    v_mfma_f32_16x16x32_bf16 v[100:103], a[84:87], v[120:123], v[100:103]
    s_sub_u32 s85, 101376, s85
    ds_read_b64_tr_b16 a[48:49], v11 offset:17024
    v_add_u32 v5, s85, v32
    v_mfma_f32_16x16x32_bf16 v[100:103], a[20:23], v[112:115], v[100:103]
    buffer_load_dwordx4 v[84:87], v15, s[48:51], s7 offen offset:1024 sc1
    v_mfma_f32_16x16x32_bf16 v[104:107], a[24:27], v[112:115], v[104:107]
    ds_read_b64_tr_b16 a[50:51], v11 offset:17536
    v_and_b32 v32, 15, v0
    v_mfma_f32_16x16x32_bf16 v[104:107], a[88:91], v[120:123], v[104:107]
    ds_read_b64_tr_b16 a[52:53], v11 offset:17056
    v_lshrrev_b32 v33, 4, v0
    v_mfma_f32_16x16x32_bf16 v[108:111], a[92:95], v[120:123], v[108:111]
    s_add_u32 m0, s30, 33568
    s_mul_i32 s85, s43, 8704
    ds_read_b64_tr_b16 a[54:55], v11 offset:17568
    v_mfma_f32_16x16x32_bf16 v[108:111], a[28:31], v[112:115], v[108:111]
    s_add_u32 s85, s85, 33792
    buffer_load_dwordx4 v16, s[52:55], s35 offen offset:1280 lds
    v_mfma_f32_16x16x32_bf16 v[172:175], a[28:31], v[116:119], v[172:175]
    ds_read_b64_tr_b16 a[56:57], v11 offset:17088
    v_mul_u32_u24 v34, 2560, v33
    v_mfma_f32_16x16x32_bf16 v[172:175], a[92:95], v[124:127], v[172:175]
    ds_read_b64_tr_b16 a[58:59], v11 offset:17600
    v_lshl_add_u32 v2, v32, 4, v34
    v_mfma_f32_16x16x32_bf16 v[168:171], a[88:91], v[124:127], v[168:171]
    s_xor_b32 s7, s72, 39
    s_mul_i32 s7, s7, 196608
    ds_read_b64_tr_b16 a[60:61], v11 offset:17120
    v_mfma_f32_16x16x32_bf16 v[168:171], a[24:27], v[116:119], v[168:171]
    buffer_load_dwordx4 v[88:91], v15, s[48:51], s7 offen offset:0 sc1
    v_mfma_f32_16x16x32_bf16 v[164:167], a[20:23], v[116:119], v[164:167]
    ds_read_b64_tr_b16 a[62:63], v11 offset:17632
    v_mul_u32_u24 v34, 272, v32
    v_mfma_f32_16x16x32_bf16 v[164:167], a[84:87], v[124:127], v[164:167]
    s_add_u32 m0, s30, 33344
    v_lshl_add_u32 v34, v33, 3, v34
    v_add_u32 v6, s85, v34
    v_mfma_f32_16x16x32_bf16 v[160:163], a[80:83], v[124:127], v[160:163]
    buffer_load_dwordx4 v16, s[52:55], s35 offen offset:2560 lds
    v_mfma_f32_16x16x32_bf16 v[160:163], a[16:19], v[116:119], v[160:163]
    v_mul_u32_u24 v34, 272, v33
    v_lshl_add_u32 v34, v32, 4, v34
    v_mfma_f32_16x16x32_bf16 v[140:143], a[12:15], v[116:119], v[140:143]
    v_add_u32 v7, s85, v34
    v_mfma_f32_16x16x32_bf16 v[140:143], a[76:79], v[124:127], v[140:143]
    s_mov_b32 s88, 0xba5432fe
    buffer_load_dwordx4 v[92:95], v15, s[48:51], s7 offen offset:1024 sc1
    v_mfma_f32_16x16x32_bf16 v[136:139], a[72:75], v[124:127], v[136:139]
    s_mov_b32 s89, 0xdc
    s_xor_b32 s98, s72, 36
    s_xor_b32 s99, s72, 56
    v_mfma_f32_16x16x32_bf16 v[136:139], a[8:11], v[116:119], v[136:139]
    s_add_u32 m0, s30, 33120
    s_mov_b32 s101, 5
    v_mfma_f32_16x16x32_bf16 v[132:135], a[4:7], v[116:119], v[132:135]
    buffer_load_dwordx4 v16, s[52:55], s35 offen offset:3840 lds
    v_mfma_f32_16x16x32_bf16 v[132:135], a[68:71], v[124:127], v[132:135]
    v_mfma_f32_16x16x32_bf16 v[128:131], a[64:67], v[124:127], v[128:131]
    v_mfma_f32_16x16x32_bf16 v[128:131], a[0:3], v[116:119], v[128:131]
    s_cmp_lg_u32 s87, 0
    s_cbranch_scc1 SLOW
    s_cmp_lg_u32 s63, 0
    s_cbranch_scc1 NOTILE
P_LOOP:
    s_waitcnt vmcnt(16) lgkmcnt(0)
    s_barrier
    v_mfma_f32_16x16x32_bf16 v[192:195], a[220:223], v[144:147], v[192:195]
    ds_read_b64_tr_b16 a[0:1], v11 offset:33792
    v_mfma_f32_16x16x32_bf16 v[192:195], a[32:35], v[152:155], v[192:195]
    ds_read_b64_tr_b16 a[2:3], v11 offset:34304
    v_mfma_f32_16x16x32_bf16 v[196:199], a[36:39], v[152:155], v[196:199]
    s_xor_b32 s7, s98, 2
    s_mul_i32 s7, s7, 196608
    ds_read_b64_tr_b16 a[4:5], v11 offset:33824
    v_mfma_f32_16x16x32_bf16 v[196:199], a[224:227], v[144:147], v[196:199]
    buffer_load_dwordx4 v[112:115], v14, s[48:51], s7 offen offset:0 sc1
    v_mfma_f32_16x16x32_bf16 v[200:203], a[228:231], v[144:147], v[200:203]
    ds_read_b64_tr_b16 a[6:7], v11 offset:34336
    v_mfma_f32_16x16x32_bf16 v[200:203], a[40:43], v[152:155], v[200:203]
    s_add_u32 m0, s30, 50688
    ds_read_b64_tr_b16 a[8:9], v11 offset:33856
    v_mfma_f32_16x16x32_bf16 v[204:207], a[44:47], v[152:155], v[204:207]
    s_xor_b32 s35, s99, 1
    s_mul_i32 s35, s35, 40960
    ds_read_b64_tr_b16 a[10:11], v11 offset:34368
    v_mfma_f32_16x16x32_bf16 v[204:207], a[232:235], v[144:147], v[204:207]
    buffer_load_dwordx4 v16, s[52:55], s35 offen offset:0 lds
    v_mfma_f32_16x16x32_bf16 v[224:227], a[236:239], v[144:147], v[224:227]
    s_lshr_b64 s[88:89], s[88:89], 4
    s_and_b32 s100, s88, 15
    ds_read_b64_tr_b16 a[12:13], v11 offset:33888
    v_mfma_f32_16x16x32_bf16 v[224:227], a[48:51], v[152:155], v[224:227]
    s_cmp_ge_u32 s101, 14
    s_cselect_b32 s100, 16, s100
    ds_read_b64_tr_b16 a[14:15], v11 offset:34400
    v_mfma_f32_16x16x32_bf16 v[228:231], a[52:55], v[152:155], v[228:231]
    s_lshl_b32 s100, s100, 2
    s_xor_b32 s100, s100, s72
    ds_read_b64_tr_b16 a[16:17], v11 offset:33920
    v_mfma_f32_16x16x32_bf16 v[228:231], a[240:243], v[144:147], v[228:231]
    buffer_load_dwordx4 v[116:119], v14, s[48:51], s7 offen offset:1024 sc1
    v_mfma_f32_16x16x32_bf16 v[232:235], a[244:247], v[144:147], v[232:235]
    ds_read_b64_tr_b16 a[18:19], v11 offset:34432
    v_mfma_f32_16x16x32_bf16 v[232:235], a[56:59], v[152:155], v[232:235]
    ds_read_b64_tr_b16 a[20:21], v11 offset:33952
    v_mfma_f32_16x16x32_bf16 v[236:239], a[60:63], v[152:155], v[236:239]
    s_add_u32 m0, s30, 50464
    ds_read_b64_tr_b16 a[22:23], v11 offset:34464
    v_mfma_f32_16x16x32_bf16 v[236:239], a[248:251], v[144:147], v[236:239]
    buffer_load_dwordx4 v16, s[52:55], s35 offen offset:1280 lds
    v_mfma_f32_16x16x32_bf16 v[252:255], a[248:251], v[148:151], v[252:255]
    ds_read_b64_tr_b16 a[24:25], v11 offset:33984
    v_mfma_f32_16x16x32_bf16 v[252:255], a[60:63], v[156:159], v[252:255]
    ds_read_b64_tr_b16 a[26:27], v11 offset:34496
    v_mfma_f32_16x16x32_bf16 v[248:251], a[56:59], v[156:159], v[248:251]
    s_xor_b32 s7, s98, 3
    s_mul_i32 s7, s7, 196608
    ds_read_b64_tr_b16 a[28:29], v11 offset:34016
    v_mfma_f32_16x16x32_bf16 v[248:251], a[244:247], v[148:151], v[248:251]
    buffer_load_dwordx4 v[120:123], v14, s[48:51], s7 offen offset:0 sc1
    v_mfma_f32_16x16x32_bf16 v[244:247], a[240:243], v[148:151], v[244:247]
    ds_read_b64_tr_b16 a[30:31], v11 offset:34528
    v_mfma_f32_16x16x32_bf16 v[244:247], a[52:55], v[156:159], v[244:247]
    s_add_u32 m0, s30, 50240
    v_mfma_f32_16x16x32_bf16 v[240:243], a[48:51], v[156:159], v[240:243]
    buffer_load_dwordx4 v16, s[52:55], s35 offen offset:2560 lds
    v_mfma_f32_16x16x32_bf16 v[240:243], a[236:239], v[148:151], v[240:243]
    v_mfma_f32_16x16x32_bf16 v[220:223], a[232:235], v[148:151], v[220:223]
    v_mfma_f32_16x16x32_bf16 v[220:223], a[44:47], v[156:159], v[220:223]
    buffer_load_dwordx4 v[124:127], v14, s[48:51], s7 offen offset:1024 sc1
    v_mfma_f32_16x16x32_bf16 v[216:219], a[40:43], v[156:159], v[216:219]
    v_mfma_f32_16x16x32_bf16 v[216:219], a[228:231], v[148:151], v[216:219]
    s_add_u32 m0, s30, 50016
    v_mfma_f32_16x16x32_bf16 v[212:215], a[224:227], v[148:151], v[212:215]
    buffer_load_dwordx4 v16, s[52:55], s35 offen offset:3840 lds
    v_mfma_f32_16x16x32_bf16 v[212:215], a[36:39], v[156:159], v[212:215]
    s_cmp_eq_u32 s101, 7
    s_cselect_b32 s33, -1, 0
    v_mfma_f32_16x16x32_bf16 v[208:211], a[32:35], v[156:159], v[208:211]
    v_mfma_f32_16x16x32_bf16 v[208:211], a[220:223], v[148:151], v[208:211]
    s_waitcnt vmcnt(16) lgkmcnt(0)
    s_barrier
    v_mfma_f32_16x16x32_bf16 v[64:67], a[220:223], v[176:179], v[64:67]
    ds_read_b64_tr_b16 a[64:65], v11 offset:50688
    v_mfma_f32_16x16x32_bf16 v[64:67], a[32:35], v[184:187], v[64:67]
    s_add_u32 m0, s30, 67584
    ds_read_b64_tr_b16 a[66:67], v11 offset:51200
    v_mfma_f32_16x16x32_bf16 v[68:71], a[36:39], v[184:187], v[68:71]
    s_xor_b32 s35, s99, 2
    s_mul_i32 s35, s35, 40960
    ds_read_b64_tr_b16 a[68:69], v11 offset:50720
    v_mfma_f32_16x16x32_bf16 v[68:71], a[224:227], v[176:179], v[68:71]
    buffer_load_dwordx4 v16, s[52:55], s35 offen offset:0 lds
    v_mfma_f32_16x16x32_bf16 v[72:75], a[228:231], v[176:179], v[72:75]
    ds_read_b64_tr_b16 a[70:71], v11 offset:51232
    v_cmp_ne_u32 s[40:41], v18, v21
    v_mfma_f32_16x16x32_bf16 v[72:75], a[40:43], v[184:187], v[72:75]
    s_and_b32 s85, s40, s33
    s_cbranch_scc1 P_SPIN1
P_BACK1:
    ds_read_b64_tr_b16 a[72:73], v11 offset:50752
    v_mfma_f32_16x16x32_bf16 v[76:79], a[44:47], v[184:187], v[76:79]
    s_xor_b32 s7, s99, 0
    s_mul_i32 s7, s7, 196608
    ds_read_b64_tr_b16 a[74:75], v11 offset:51264
    v_mfma_f32_16x16x32_bf16 v[76:79], a[232:235], v[176:179], v[76:79]
    buffer_load_dwordx4 v[144:147], v15, s[48:51], s7 offen offset:0 sc1
    v_mfma_f32_16x16x32_bf16 v[96:99], a[236:239], v[176:179], v[96:99]
    ds_read_b64_tr_b16 a[76:77], v11 offset:50784
    v_mfma_f32_16x16x32_bf16 v[96:99], a[48:51], v[184:187], v[96:99]
    ds_read_b64_tr_b16 a[78:79], v11 offset:51296
    v_mfma_f32_16x16x32_bf16 v[100:103], a[52:55], v[184:187], v[100:103]
    s_add_u32 m0, s30, 67360
    ds_read_b64_tr_b16 a[80:81], v11 offset:50816
    v_mfma_f32_16x16x32_bf16 v[100:103], a[240:243], v[176:179], v[100:103]
    buffer_load_dwordx4 v16, s[52:55], s35 offen offset:1280 lds
    v_mfma_f32_16x16x32_bf16 v[104:107], a[244:247], v[176:179], v[104:107]
    ds_read_b64_tr_b16 a[82:83], v11 offset:51328
    v_mfma_f32_16x16x32_bf16 v[104:107], a[56:59], v[184:187], v[104:107]
    ds_read_b64_tr_b16 a[84:85], v11 offset:50848
    v_mfma_f32_16x16x32_bf16 v[108:111], a[60:63], v[184:187], v[108:111]
    ds_read_b64_tr_b16 a[86:87], v11 offset:51360
    v_mfma_f32_16x16x32_bf16 v[108:111], a[248:251], v[176:179], v[108:111]
    buffer_load_dwordx4 v[148:151], v15, s[48:51], s7 offen offset:1024 sc1
    v_mfma_f32_16x16x32_bf16 v[172:175], a[248:251], v[180:183], v[172:175]
    ds_read_b64_tr_b16 a[88:89], v11 offset:50880
    v_mfma_f32_16x16x32_bf16 v[172:175], a[60:63], v[188:191], v[172:175]
    ds_read_b64_tr_b16 a[90:91], v11 offset:51392
    v_mfma_f32_16x16x32_bf16 v[168:171], a[56:59], v[188:191], v[168:171]
    s_add_u32 m0, s30, 67136
    ds_read_b64_tr_b16 a[92:93], v11 offset:50912
    v_mfma_f32_16x16x32_bf16 v[168:171], a[244:247], v[180:183], v[168:171]
    buffer_load_dwordx4 v16, s[52:55], s35 offen offset:2560 lds
    v_mfma_f32_16x16x32_bf16 v[164:167], a[240:243], v[180:183], v[164:167]
    ds_read_b64_tr_b16 a[94:95], v11 offset:51424
    v_mfma_f32_16x16x32_bf16 v[164:167], a[52:55], v[188:191], v[164:167]
    s_xor_b32 s7, s99, 1
    s_mul_i32 s7, s7, 196608
    v_mfma_f32_16x16x32_bf16 v[160:163], a[48:51], v[188:191], v[160:163]
    buffer_load_dwordx4 v[152:155], v15, s[48:51], s7 offen offset:0 sc1
    v_mfma_f32_16x16x32_bf16 v[160:163], a[236:239], v[180:183], v[160:163]
    v_mfma_f32_16x16x32_bf16 v[140:143], a[232:235], v[180:183], v[140:143]
    s_add_u32 m0, s30, 66912
    v_mfma_f32_16x16x32_bf16 v[140:143], a[44:47], v[188:191], v[140:143]
    buffer_load_dwordx4 v16, s[52:55], s35 offen offset:3840 lds
    v_mfma_f32_16x16x32_bf16 v[136:139], a[40:43], v[188:191], v[136:139]
    v_mfma_f32_16x16x32_bf16 v[136:139], a[228:231], v[180:183], v[136:139]
    v_mfma_f32_16x16x32_bf16 v[132:135], a[224:227], v[180:183], v[132:135]
    buffer_load_dwordx4 v[156:159], v15, s[48:51], s7 offen offset:1024 sc1
    v_mfma_f32_16x16x32_bf16 v[132:135], a[36:39], v[188:191], v[132:135]
    v_mfma_f32_16x16x32_bf16 v[128:131], a[32:35], v[188:191], v[128:131]
    v_mfma_f32_16x16x32_bf16 v[128:131], a[220:223], v[180:183], v[128:131]
    s_waitcnt vmcnt(16) lgkmcnt(0)
    s_barrier
    v_mfma_f32_16x16x32_bf16 v[192:195], a[0:3], v[80:83], v[192:195]
    ds_read_b64_tr_b16 a[220:221], v11 offset:0
    v_mfma_f32_16x16x32_bf16 v[192:195], a[64:67], v[88:91], v[192:195]
    ds_read_b64_tr_b16 a[222:223], v11 offset:512
    v_mfma_f32_16x16x32_bf16 v[196:199], a[68:71], v[88:91], v[196:199]
    s_cmp_eq_u32 s101, 6
    s_cselect_b32 s32, 0, 0x40000000
    ds_read_b64_tr_b16 a[224:225], v11 offset:32
    v_mfma_f32_16x16x32_bf16 v[196:199], a[4:7], v[80:83], v[196:199]
    buffer_load_dword v18, v17, s[64:67], s32 offen offset:128 sc1
    v_mfma_f32_16x16x32_bf16 v[200:203], a[8:11], v[80:83], v[200:203]
    ds_read_b64_tr_b16 a[226:227], v11 offset:544
    v_mfma_f32_16x16x32_bf16 v[200:203], a[72:75], v[88:91], v[200:203]
    ds_read_b64_tr_b16 a[228:229], v11 offset:64
    v_mfma_f32_16x16x32_bf16 v[204:207], a[76:79], v[88:91], v[204:207]
    s_cmp_eq_u32 s101, 5
    s_cselect_b32 s70, s86, 0
    ds_read_b64_tr_b16 a[230:231], v11 offset:576
    v_mfma_f32_16x16x32_bf16 v[204:207], a[12:15], v[80:83], v[204:207]
    buffer_store_dword v21, v20, s[68:71], 0 offen offset:128 sc1
    v_mfma_f32_16x16x32_bf16 v[224:227], a[16:19], v[80:83], v[224:227]
    ds_read_b64_tr_b16 a[232:233], v11 offset:96
    v_mfma_f32_16x16x32_bf16 v[224:227], a[80:83], v[88:91], v[224:227]
    ds_read_b64_tr_b16 a[234:235], v11 offset:608
    v_mfma_f32_16x16x32_bf16 v[228:231], a[84:87], v[88:91], v[228:231]
    s_xor_b32 s7, s99, 0
    s_mul_i32 s7, s7, 196608
    ds_read_b64_tr_b16 a[236:237], v11 offset:128
    v_mfma_f32_16x16x32_bf16 v[228:231], a[20:23], v[80:83], v[228:231]
    buffer_load_dwordx4 v[176:179], v14, s[48:51], s7 offen offset:0 sc1
    v_mfma_f32_16x16x32_bf16 v[232:235], a[24:27], v[80:83], v[232:235]
    ds_read_b64_tr_b16 a[238:239], v11 offset:640
    v_mfma_f32_16x16x32_bf16 v[232:235], a[88:91], v[88:91], v[232:235]
    s_add_u32 m0, s30, 84480
    ds_read_b64_tr_b16 a[240:241], v11 offset:160
    v_mfma_f32_16x16x32_bf16 v[236:239], a[92:95], v[88:91], v[236:239]
    s_xor_b32 s35, s99, 3
    s_mul_i32 s35, s35, 40960
    ds_read_b64_tr_b16 a[242:243], v11 offset:672
    v_mfma_f32_16x16x32_bf16 v[236:239], a[28:31], v[80:83], v[236:239]
    buffer_load_dwordx4 v16, s[52:55], s35 offen offset:0 lds
    v_mfma_f32_16x16x32_bf16 v[252:255], a[28:31], v[84:87], v[252:255]
    ds_read_b64_tr_b16 a[244:245], v11 offset:192
    v_mfma_f32_16x16x32_bf16 v[252:255], a[92:95], v[92:95], v[252:255]
    ds_read_b64_tr_b16 a[246:247], v11 offset:704
    v_mfma_f32_16x16x32_bf16 v[248:251], a[88:91], v[92:95], v[248:251]
    ds_read_b64_tr_b16 a[248:249], v11 offset:224
    v_mfma_f32_16x16x32_bf16 v[248:251], a[24:27], v[84:87], v[248:251]
    buffer_load_dwordx4 v[180:183], v14, s[48:51], s7 offen offset:1024 sc1
    v_mfma_f32_16x16x32_bf16 v[244:247], a[20:23], v[84:87], v[244:247]
    s_add_u32 m0, s30, 84256
    ds_read_b64_tr_b16 a[250:251], v11 offset:736
    v_mfma_f32_16x16x32_bf16 v[244:247], a[84:87], v[92:95], v[244:247]
    buffer_load_dwordx4 v16, s[52:55], s35 offen offset:1280 lds
    v_mfma_f32_16x16x32_bf16 v[240:243], a[80:83], v[92:95], v[240:243]
    s_xor_b32 s7, s99, 1
    s_mul_i32 s7, s7, 196608
    v_mfma_f32_16x16x32_bf16 v[240:243], a[16:19], v[84:87], v[240:243]
    buffer_load_dwordx4 v[184:187], v14, s[48:51], s7 offen offset:0 sc1
    v_mfma_f32_16x16x32_bf16 v[220:223], a[12:15], v[84:87], v[220:223]
    s_add_u32 m0, s30, 84032
    v_mfma_f32_16x16x32_bf16 v[220:223], a[76:79], v[92:95], v[220:223]
    buffer_load_dwordx4 v16, s[52:55], s35 offen offset:2560 lds
    v_mfma_f32_16x16x32_bf16 v[216:219], a[72:75], v[92:95], v[216:219]
    v_mfma_f32_16x16x32_bf16 v[216:219], a[8:11], v[84:87], v[216:219]
    buffer_load_dwordx4 v[188:191], v14, s[48:51], s7 offen offset:1024 sc1
    v_mfma_f32_16x16x32_bf16 v[212:215], a[4:7], v[84:87], v[212:215]
    v_mfma_f32_16x16x32_bf16 v[212:215], a[68:71], v[92:95], v[212:215]
    s_add_u32 m0, s30, 83808
    v_mfma_f32_16x16x32_bf16 v[208:211], a[64:67], v[92:95], v[208:211]
    buffer_load_dwordx4 v16, s[52:55], s35 offen offset:3840 lds
    v_mfma_f32_16x16x32_bf16 v[208:211], a[0:3], v[84:87], v[208:211]
    s_waitcnt vmcnt(18) lgkmcnt(0)
    s_barrier
    v_mfma_f32_16x16x32_bf16 v[64:67], a[0:3], v[112:115], v[64:67]
    ds_read_b64_tr_b16 a[32:33], v11 offset:16896
    v_mfma_f32_16x16x32_bf16 v[64:67], a[64:67], v[120:123], v[64:67]
    ds_read_b64_tr_b16 a[34:35], v11 offset:17408
    v_mfma_f32_16x16x32_bf16 v[68:71], a[68:71], v[120:123], v[68:71]
    s_xor_b32 s7, s99, 2
    s_mul_i32 s7, s7, 196608
    ds_read_b64_tr_b16 a[36:37], v11 offset:16928
    v_mfma_f32_16x16x32_bf16 v[68:71], a[4:7], v[112:115], v[68:71]
    buffer_load_dwordx4 v[80:83], v15, s[48:51], s7 offen offset:0 sc1
    v_mfma_f32_16x16x32_bf16 v[72:75], a[8:11], v[112:115], v[72:75]
    ds_read_b64_tr_b16 a[38:39], v11 offset:17440
    v_mfma_f32_16x16x32_bf16 v[72:75], a[72:75], v[120:123], v[72:75]
    s_add_u32 m0, s30, 33792
    ds_read_b64_tr_b16 a[40:41], v11 offset:16960
    v_mfma_f32_16x16x32_bf16 v[76:79], a[76:79], v[120:123], v[76:79]
    s_xor_b32 s35, s100, 0
    s_mul_i32 s35, s35, 40960
    ds_read_b64_tr_b16 a[42:43], v11 offset:17472
    v_mfma_f32_16x16x32_bf16 v[76:79], a[12:15], v[112:115], v[76:79]
    buffer_load_dwordx4 v16, s[52:55], s35 offen offset:0 lds
    v_mfma_f32_16x16x32_bf16 v[96:99], a[16:19], v[112:115], v[96:99]
    ds_read_b64_tr_b16 a[44:45], v11 offset:16992
    v_mfma_f32_16x16x32_bf16 v[96:99], a[80:83], v[120:123], v[96:99]
    ds_read_b64_tr_b16 a[46:47], v11 offset:17504
    v_mfma_f32_16x16x32_bf16 v[100:103], a[84:87], v[120:123], v[100:103]
    ds_read_b64_tr_b16 a[48:49], v11 offset:17024
    v_mfma_f32_16x16x32_bf16 v[100:103], a[20:23], v[112:115], v[100:103]
    buffer_load_dwordx4 v[84:87], v15, s[48:51], s7 offen offset:1024 sc1
    v_mfma_f32_16x16x32_bf16 v[104:107], a[24:27], v[112:115], v[104:107]
    ds_read_b64_tr_b16 a[50:51], v11 offset:17536
    v_mfma_f32_16x16x32_bf16 v[104:107], a[88:91], v[120:123], v[104:107]
    ds_read_b64_tr_b16 a[52:53], v11 offset:17056
    v_mfma_f32_16x16x32_bf16 v[108:111], a[92:95], v[120:123], v[108:111]
    s_add_u32 m0, s30, 33568
    ds_read_b64_tr_b16 a[54:55], v11 offset:17568
    v_mfma_f32_16x16x32_bf16 v[108:111], a[28:31], v[112:115], v[108:111]
    buffer_load_dwordx4 v16, s[52:55], s35 offen offset:1280 lds
    v_mfma_f32_16x16x32_bf16 v[172:175], a[28:31], v[116:119], v[172:175]
    ds_read_b64_tr_b16 a[56:57], v11 offset:17088
    v_mfma_f32_16x16x32_bf16 v[172:175], a[92:95], v[124:127], v[172:175]
    ds_read_b64_tr_b16 a[58:59], v11 offset:17600
    v_mfma_f32_16x16x32_bf16 v[168:171], a[88:91], v[124:127], v[168:171]
    s_xor_b32 s7, s99, 3
    s_mul_i32 s7, s7, 196608
    ds_read_b64_tr_b16 a[60:61], v11 offset:17120
    v_mfma_f32_16x16x32_bf16 v[168:171], a[24:27], v[116:119], v[168:171]
    buffer_load_dwordx4 v[88:91], v15, s[48:51], s7 offen offset:0 sc1
    v_mfma_f32_16x16x32_bf16 v[164:167], a[20:23], v[116:119], v[164:167]
    s_mov_b32 s98, s99
    s_mov_b32 s99, s100
    ds_read_b64_tr_b16 a[62:63], v11 offset:17632
    v_mfma_f32_16x16x32_bf16 v[164:167], a[84:87], v[124:127], v[164:167]
    s_add_u32 m0, s30, 33344
    s_add_u32 s101, s101, 1
    v_mfma_f32_16x16x32_bf16 v[160:163], a[80:83], v[124:127], v[160:163]
    buffer_load_dwordx4 v16, s[52:55], s35 offen offset:2560 lds
    v_mfma_f32_16x16x32_bf16 v[160:163], a[16:19], v[116:119], v[160:163]
    v_mfma_f32_16x16x32_bf16 v[140:143], a[12:15], v[116:119], v[140:143]
    v_mfma_f32_16x16x32_bf16 v[140:143], a[76:79], v[124:127], v[140:143]
    buffer_load_dwordx4 v[92:95], v15, s[48:51], s7 offen offset:1024 sc1
    v_mfma_f32_16x16x32_bf16 v[136:139], a[72:75], v[124:127], v[136:139]
    v_mfma_f32_16x16x32_bf16 v[136:139], a[8:11], v[116:119], v[136:139]
    s_add_u32 m0, s30, 33120
    v_mfma_f32_16x16x32_bf16 v[132:135], a[4:7], v[116:119], v[132:135]
    buffer_load_dwordx4 v16, s[52:55], s35 offen offset:3840 lds
    v_mfma_f32_16x16x32_bf16 v[132:135], a[68:71], v[124:127], v[132:135]
    v_mfma_f32_16x16x32_bf16 v[128:131], a[64:67], v[124:127], v[128:131]
    s_cmp_lt_u32 s101, 15
    v_mfma_f32_16x16x32_bf16 v[128:131], a[0:3], v[116:119], v[128:131]
    s_cbranch_scc1 P_LOOP
    s_waitcnt vmcnt(18) lgkmcnt(0)
    s_barrier
    v_mfma_f32_16x16x32_bf16 v[192:195], a[220:223], v[144:147], v[192:195]
    ds_read_b64_tr_b16 a[0:1], v11 offset:33792
    v_mfma_f32_16x16x32_bf16 v[192:195], a[32:35], v[152:155], v[192:195]
    ds_read_b64_tr_b16 a[2:3], v11 offset:34304
    v_mfma_f32_16x16x32_bf16 v[196:199], a[36:39], v[152:155], v[196:199]
    s_xor_b32 s7, s72, 54
    s_mul_i32 s7, s7, 196608
    ds_read_b64_tr_b16 a[4:5], v11 offset:33824
    v_mfma_f32_16x16x32_bf16 v[196:199], a[224:227], v[144:147], v[196:199]
    buffer_load_dwordx4 v[112:115], v14, s[48:51], s7 offen offset:0 sc1
    v_mfma_f32_16x16x32_bf16 v[200:203], a[228:231], v[144:147], v[200:203]
    ds_read_b64_tr_b16 a[6:7], v11 offset:34336
    v_mfma_f32_16x16x32_bf16 v[200:203], a[40:43], v[152:155], v[200:203]
    ds_read_b64_tr_b16 a[8:9], v11 offset:33856
    v_mfma_f32_16x16x32_bf16 v[204:207], a[44:47], v[152:155], v[204:207]
    ds_read_b64_tr_b16 a[10:11], v11 offset:34368
    v_mfma_f32_16x16x32_bf16 v[204:207], a[232:235], v[144:147], v[204:207]
    buffer_load_dwordx4 v[116:119], v14, s[48:51], s7 offen offset:1024 sc1
    v_mfma_f32_16x16x32_bf16 v[224:227], a[236:239], v[144:147], v[224:227]
    ds_read_b64_tr_b16 a[12:13], v11 offset:33888
    v_mfma_f32_16x16x32_bf16 v[224:227], a[48:51], v[152:155], v[224:227]
    ds_read_b64_tr_b16 a[14:15], v11 offset:34400
    v_mfma_f32_16x16x32_bf16 v[228:231], a[52:55], v[152:155], v[228:231]
    s_xor_b32 s7, s72, 55
    s_mul_i32 s7, s7, 196608
    ds_read_b64_tr_b16 a[16:17], v11 offset:33920
    v_mfma_f32_16x16x32_bf16 v[228:231], a[240:243], v[144:147], v[228:231]
    buffer_load_dwordx4 v[120:123], v14, s[48:51], s7 offen offset:0 sc1
    v_mfma_f32_16x16x32_bf16 v[232:235], a[244:247], v[144:147], v[232:235]
    ds_read_b64_tr_b16 a[18:19], v11 offset:34432
    v_mfma_f32_16x16x32_bf16 v[232:235], a[56:59], v[152:155], v[232:235]
    ds_read_b64_tr_b16 a[20:21], v11 offset:33952
    v_mfma_f32_16x16x32_bf16 v[236:239], a[60:63], v[152:155], v[236:239]
    ds_read_b64_tr_b16 a[22:23], v11 offset:34464
    v_mfma_f32_16x16x32_bf16 v[236:239], a[248:251], v[144:147], v[236:239]
    buffer_load_dwordx4 v[124:127], v14, s[48:51], s7 offen offset:1024 sc1
    v_mfma_f32_16x16x32_bf16 v[252:255], a[248:251], v[148:151], v[252:255]
    ds_read_b64_tr_b16 a[24:25], v11 offset:33984
    v_mfma_f32_16x16x32_bf16 v[252:255], a[60:63], v[156:159], v[252:255]
    ds_read_b64_tr_b16 a[26:27], v11 offset:34496
    v_mfma_f32_16x16x32_bf16 v[248:251], a[56:59], v[156:159], v[248:251]
    ds_read_b64_tr_b16 a[28:29], v11 offset:34016
    v_mfma_f32_16x16x32_bf16 v[248:251], a[244:247], v[148:151], v[248:251]
    v_mfma_f32_16x16x32_bf16 v[244:247], a[240:243], v[148:151], v[244:247]
    ds_read_b64_tr_b16 a[30:31], v11 offset:34528
    v_mfma_f32_16x16x32_bf16 v[244:247], a[52:55], v[156:159], v[244:247]
    v_mfma_f32_16x16x32_bf16 v[240:243], a[48:51], v[156:159], v[240:243]
    v_mfma_f32_16x16x32_bf16 v[240:243], a[236:239], v[148:151], v[240:243]
    v_mfma_f32_16x16x32_bf16 v[220:223], a[232:235], v[148:151], v[220:223]
    v_mfma_f32_16x16x32_bf16 v[220:223], a[44:47], v[156:159], v[220:223]
    v_mfma_f32_16x16x32_bf16 v[216:219], a[40:43], v[156:159], v[216:219]
    v_mfma_f32_16x16x32_bf16 v[216:219], a[228:231], v[148:151], v[216:219]
    v_mfma_f32_16x16x32_bf16 v[212:215], a[224:227], v[148:151], v[212:215]
    v_mfma_f32_16x16x32_bf16 v[212:215], a[36:39], v[156:159], v[212:215]
    v_mfma_f32_16x16x32_bf16 v[208:211], a[32:35], v[156:159], v[208:211]
    v_mfma_f32_16x16x32_bf16 v[208:211], a[220:223], v[148:151], v[208:211]
    s_waitcnt vmcnt(12) lgkmcnt(0)
    s_barrier
    v_mfma_f32_16x16x32_bf16 v[64:67], a[220:223], v[176:179], v[64:67]
    ds_read_b64_tr_b16 a[64:65], v11 offset:50688
    v_mfma_f32_16x16x32_bf16 v[64:67], a[32:35], v[184:187], v[64:67]
    ds_read_b64_tr_b16 a[66:67], v11 offset:51200
    v_mfma_f32_16x16x32_bf16 v[68:71], a[36:39], v[184:187], v[68:71]
    ds_read_b64_tr_b16 a[68:69], v11 offset:50720
    v_mfma_f32_16x16x32_bf16 v[68:71], a[224:227], v[176:179], v[68:71]
    v_mfma_f32_16x16x32_bf16 v[72:75], a[228:231], v[176:179], v[72:75]
    ds_read_b64_tr_b16 a[70:71], v11 offset:51232
    v_mfma_f32_16x16x32_bf16 v[72:75], a[40:43], v[184:187], v[72:75]
    ds_read_b64_tr_b16 a[72:73], v11 offset:50752
    v_mfma_f32_16x16x32_bf16 v[76:79], a[44:47], v[184:187], v[76:79]
    ds_read_b64_tr_b16 a[74:75], v11 offset:51264
    v_mfma_f32_16x16x32_bf16 v[76:79], a[232:235], v[176:179], v[76:79]
    v_mfma_f32_16x16x32_bf16 v[96:99], a[236:239], v[176:179], v[96:99]
    ds_read_b64_tr_b16 a[76:77], v11 offset:50784
    v_mfma_f32_16x16x32_bf16 v[96:99], a[48:51], v[184:187], v[96:99]
    ds_read_b64_tr_b16 a[78:79], v11 offset:51296
    v_mfma_f32_16x16x32_bf16 v[100:103], a[52:55], v[184:187], v[100:103]
    ds_read_b64_tr_b16 a[80:81], v11 offset:50816
    v_mfma_f32_16x16x32_bf16 v[100:103], a[240:243], v[176:179], v[100:103]
    v_mfma_f32_16x16x32_bf16 v[104:107], a[244:247], v[176:179], v[104:107]
    ds_read_b64_tr_b16 a[82:83], v11 offset:51328
    v_mfma_f32_16x16x32_bf16 v[104:107], a[56:59], v[184:187], v[104:107]
    ds_read_b64_tr_b16 a[84:85], v11 offset:50848
    v_mfma_f32_16x16x32_bf16 v[108:111], a[60:63], v[184:187], v[108:111]
    ds_read_b64_tr_b16 a[86:87], v11 offset:51360
    v_mfma_f32_16x16x32_bf16 v[108:111], a[248:251], v[176:179], v[108:111]
    v_mfma_f32_16x16x32_bf16 v[172:175], a[248:251], v[180:183], v[172:175]
    ds_read_b64_tr_b16 a[88:89], v11 offset:50880
    v_mfma_f32_16x16x32_bf16 v[172:175], a[60:63], v[188:191], v[172:175]
    ds_read_b64_tr_b16 a[90:91], v11 offset:51392
    v_mfma_f32_16x16x32_bf16 v[168:171], a[56:59], v[188:191], v[168:171]
    ds_read_b64_tr_b16 a[92:93], v11 offset:50912
    v_mfma_f32_16x16x32_bf16 v[168:171], a[244:247], v[180:183], v[168:171]
    v_mfma_f32_16x16x32_bf16 v[164:167], a[240:243], v[180:183], v[164:167]
    ds_read_b64_tr_b16 a[94:95], v11 offset:51424
    v_mfma_f32_16x16x32_bf16 v[164:167], a[52:55], v[188:191], v[164:167]
    v_mfma_f32_16x16x32_bf16 v[160:163], a[48:51], v[188:191], v[160:163]
    v_mfma_f32_16x16x32_bf16 v[160:163], a[236:239], v[180:183], v[160:163]
    v_mfma_f32_16x16x32_bf16 v[140:143], a[232:235], v[180:183], v[140:143]
    v_mfma_f32_16x16x32_bf16 v[140:143], a[44:47], v[188:191], v[140:143]
    v_mfma_f32_16x16x32_bf16 v[136:139], a[40:43], v[188:191], v[136:139]
    v_mfma_f32_16x16x32_bf16 v[136:139], a[228:231], v[180:183], v[136:139]
    v_mfma_f32_16x16x32_bf16 v[132:135], a[224:227], v[180:183], v[132:135]
    v_mfma_f32_16x16x32_bf16 v[132:135], a[36:39], v[188:191], v[132:135]
    v_mfma_f32_16x16x32_bf16 v[128:131], a[32:35], v[188:191], v[128:131]
    v_mfma_f32_16x16x32_bf16 v[128:131], a[220:223], v[180:183], v[128:131]
    s_waitcnt vmcnt(5) lgkmcnt(0)
    s_barrier
    v_mfma_f32_16x16x32_bf16 v[192:195], a[0:3], v[80:83], v[192:195]
    v_mfma_f32_16x16x32_bf16 v[192:195], a[64:67], v[88:91], v[192:195]
    v_mfma_f32_16x16x32_bf16 v[196:199], a[68:71], v[88:91], v[196:199]
    v_mfma_f32_16x16x32_bf16 v[196:199], a[4:7], v[80:83], v[196:199]
    v_mfma_f32_16x16x32_bf16 v[200:203], a[8:11], v[80:83], v[200:203]
    v_mfma_f32_16x16x32_bf16 v[200:203], a[72:75], v[88:91], v[200:203]
    v_mfma_f32_16x16x32_bf16 v[204:207], a[76:79], v[88:91], v[204:207]
    v_mfma_f32_16x16x32_bf16 v[204:207], a[12:15], v[80:83], v[204:207]
    v_mfma_f32_16x16x32_bf16 v[224:227], a[16:19], v[80:83], v[224:227]
    v_mfma_f32_16x16x32_bf16 v[224:227], a[80:83], v[88:91], v[224:227]
    v_mfma_f32_16x16x32_bf16 v[228:231], a[84:87], v[88:91], v[228:231]
    v_mfma_f32_16x16x32_bf16 v[228:231], a[20:23], v[80:83], v[228:231]
    v_mfma_f32_16x16x32_bf16 v[232:235], a[24:27], v[80:83], v[232:235]
    v_mfma_f32_16x16x32_bf16 v[232:235], a[88:91], v[88:91], v[232:235]
    v_mfma_f32_16x16x32_bf16 v[236:239], a[92:95], v[88:91], v[236:239]
    ds_write_b128 v1, v[192:195] offset:0
    v_mfma_f32_16x16x32_bf16 v[236:239], a[28:31], v[80:83], v[236:239]
    v_mfma_f32_16x16x32_bf16 v[252:255], a[28:31], v[84:87], v[252:255]
    ds_write_b128 v1, v[196:199] offset:1024
    v_mfma_f32_16x16x32_bf16 v[252:255], a[92:95], v[92:95], v[252:255]
    v_mfma_f32_16x16x32_bf16 v[248:251], a[88:91], v[92:95], v[248:251]
    ds_write_b128 v1, v[200:203] offset:2048
    v_mfma_f32_16x16x32_bf16 v[248:251], a[24:27], v[84:87], v[248:251]
    v_mfma_f32_16x16x32_bf16 v[244:247], a[20:23], v[84:87], v[244:247]
    ds_write_b128 v1, v[204:207] offset:3072
    v_mfma_f32_16x16x32_bf16 v[244:247], a[84:87], v[92:95], v[244:247]
    v_mfma_f32_16x16x32_bf16 v[240:243], a[80:83], v[92:95], v[240:243]
    ds_write_b128 v1, v[224:227] offset:4096
    v_mfma_f32_16x16x32_bf16 v[240:243], a[16:19], v[84:87], v[240:243]
    v_mfma_f32_16x16x32_bf16 v[220:223], a[12:15], v[84:87], v[220:223]
    ds_write_b128 v1, v[228:231] offset:5120
    v_mfma_f32_16x16x32_bf16 v[220:223], a[76:79], v[92:95], v[220:223]
    v_mfma_f32_16x16x32_bf16 v[216:219], a[72:75], v[92:95], v[216:219]
    ds_write_b128 v1, v[232:235] offset:6144
    v_mfma_f32_16x16x32_bf16 v[216:219], a[8:11], v[84:87], v[216:219]
    v_mfma_f32_16x16x32_bf16 v[212:215], a[4:7], v[84:87], v[212:215]
    ds_write_b128 v1, v[236:239] offset:7168
    v_mfma_f32_16x16x32_bf16 v[212:215], a[68:71], v[92:95], v[212:215]
    v_mfma_f32_16x16x32_bf16 v[208:211], a[64:67], v[92:95], v[208:211]
    v_mfma_f32_16x16x32_bf16 v[208:211], a[0:3], v[84:87], v[208:211]
    s_waitcnt vmcnt(0) lgkmcnt(0)
    s_barrier
    v_mfma_f32_16x16x32_bf16 v[64:67], a[0:3], v[112:115], v[64:67]
    v_mfma_f32_16x16x32_bf16 v[64:67], a[64:67], v[120:123], v[64:67]
    ds_write_b128 v1, v[252:255] offset:15360
    v_mfma_f32_16x16x32_bf16 v[68:71], a[68:71], v[120:123], v[68:71]
    ds_write_b128 v1, v[248:251] offset:14336
    v_mfma_f32_16x16x32_bf16 v[68:71], a[4:7], v[112:115], v[68:71]
    ds_write_b128 v1, v[244:247] offset:13312
    v_mfma_f32_16x16x32_bf16 v[72:75], a[8:11], v[112:115], v[72:75]
    ds_write_b128 v1, v[240:243] offset:12288
    v_mfma_f32_16x16x32_bf16 v[72:75], a[72:75], v[120:123], v[72:75]
    ds_write_b128 v1, v[220:223] offset:11264
    v_mfma_f32_16x16x32_bf16 v[76:79], a[76:79], v[120:123], v[76:79]
    ds_write_b128 v1, v[216:219] offset:10240
    v_mfma_f32_16x16x32_bf16 v[76:79], a[12:15], v[112:115], v[76:79]
    ds_write_b128 v1, v[212:215] offset:9216
    v_mfma_f32_16x16x32_bf16 v[96:99], a[16:19], v[112:115], v[96:99]
    ds_write_b128 v1, v[208:211] offset:8192
    v_mfma_f32_16x16x32_bf16 v[96:99], a[80:83], v[120:123], v[96:99]
    v_mfma_f32_16x16x32_bf16 v[100:103], a[84:87], v[120:123], v[100:103]
    v_mfma_f32_16x16x32_bf16 v[100:103], a[20:23], v[112:115], v[100:103]
    v_mfma_f32_16x16x32_bf16 v[104:107], a[24:27], v[112:115], v[104:107]
    v_mfma_f32_16x16x32_bf16 v[104:107], a[88:91], v[120:123], v[104:107]
    v_mfma_f32_16x16x32_bf16 v[108:111], a[92:95], v[120:123], v[108:111]
    v_mfma_f32_16x16x32_bf16 v[108:111], a[28:31], v[112:115], v[108:111]
    s_waitcnt lgkmcnt(0)
    s_barrier
    v_mfma_f32_16x16x32_bf16 v[172:175], a[28:31], v[116:119], v[172:175]
    ds_read_b128 v[144:147], v5 offset:0
    v_mfma_f32_16x16x32_bf16 v[172:175], a[92:95], v[124:127], v[172:175]
    ds_read_b128 v[148:151], v5 offset:1024
    v_mfma_f32_16x16x32_bf16 v[168:171], a[88:91], v[124:127], v[168:171]
    ds_read_b128 v[152:155], v5 offset:2048
    v_mfma_f32_16x16x32_bf16 v[168:171], a[24:27], v[116:119], v[168:171]
    ds_read_b128 v[156:159], v5 offset:3072
    v_mfma_f32_16x16x32_bf16 v[164:167], a[20:23], v[116:119], v[164:167]
    ds_read_b128 v[176:179], v5 offset:4096
    v_mfma_f32_16x16x32_bf16 v[164:167], a[84:87], v[124:127], v[164:167]
    ds_read_b128 v[180:183], v5 offset:5120
    v_mfma_f32_16x16x32_bf16 v[160:163], a[80:83], v[124:127], v[160:163]
    ds_read_b128 v[184:187], v5 offset:6144
    v_mfma_f32_16x16x32_bf16 v[160:163], a[16:19], v[116:119], v[160:163]
    ds_read_b128 v[188:191], v5 offset:7168
    v_mfma_f32_16x16x32_bf16 v[140:143], a[12:15], v[116:119], v[140:143]
    ds_read_b128 v[80:83], v5 offset:8192
    v_mfma_f32_16x16x32_bf16 v[140:143], a[76:79], v[124:127], v[140:143]
    ds_read_b128 v[84:87], v5 offset:9216
    v_mfma_f32_16x16x32_bf16 v[136:139], a[72:75], v[124:127], v[136:139]
    ds_read_b128 v[88:91], v5 offset:10240
    v_mfma_f32_16x16x32_bf16 v[136:139], a[8:11], v[116:119], v[136:139]
    ds_read_b128 v[92:95], v5 offset:11264
    v_mfma_f32_16x16x32_bf16 v[132:135], a[4:7], v[116:119], v[132:135]
    v_mfma_f32_16x16x32_bf16 v[132:135], a[68:71], v[124:127], v[132:135]
    v_mfma_f32_16x16x32_bf16 v[128:131], a[64:67], v[124:127], v[128:131]
    v_mfma_f32_16x16x32_bf16 v[128:131], a[0:3], v[116:119], v[128:131]
    ds_read_b128 v[112:115], v5 offset:12288
    ds_read_b128 v[116:119], v5 offset:13312
    ds_read_b128 v[120:123], v5 offset:14336
    ds_read_b128 v[124:127], v5 offset:15360
    s_waitcnt lgkmcnt(8)
    s_nop 0
    v_pk_add_f32 v[64:65], v[64:65], v[144:145]
    v_pk_add_f32 v[66:67], v[66:67], v[146:147]
    v_cvt_pk_bf16_f32 v64, v64, v65
    v_cvt_pk_bf16_f32 v65, v66, v67
    ds_write_b64 v6, v[64:65] offset:0
    v_pk_add_f32 v[68:69], v[68:69], v[148:149]
    v_pk_add_f32 v[70:71], v[70:71], v[150:151]
    v_cvt_pk_bf16_f32 v68, v68, v69
    v_cvt_pk_bf16_f32 v69, v70, v71
    ds_write_b64 v6, v[68:69] offset:32
    v_pk_add_f32 v[72:73], v[72:73], v[152:153]
    v_pk_add_f32 v[74:75], v[74:75], v[154:155]
    v_cvt_pk_bf16_f32 v72, v72, v73
    v_cvt_pk_bf16_f32 v73, v74, v75
    ds_write_b64 v6, v[72:73] offset:64
    v_pk_add_f32 v[76:77], v[76:77], v[156:157]
    v_pk_add_f32 v[78:79], v[78:79], v[158:159]
    v_cvt_pk_bf16_f32 v76, v76, v77
    v_cvt_pk_bf16_f32 v77, v78, v79
    ds_write_b64 v6, v[76:77] offset:96
    v_pk_add_f32 v[96:97], v[96:97], v[176:177]
    v_pk_add_f32 v[98:99], v[98:99], v[178:179]
    v_cvt_pk_bf16_f32 v96, v96, v97
    v_cvt_pk_bf16_f32 v97, v98, v99
    ds_write_b64 v6, v[96:97] offset:128
    v_pk_add_f32 v[100:101], v[100:101], v[180:181]
    v_pk_add_f32 v[102:103], v[102:103], v[182:183]
    v_cvt_pk_bf16_f32 v100, v100, v101
    v_cvt_pk_bf16_f32 v101, v102, v103
    ds_write_b64 v6, v[100:101] offset:160
    v_pk_add_f32 v[104:105], v[104:105], v[184:185]
    v_pk_add_f32 v[106:107], v[106:107], v[186:187]
    v_cvt_pk_bf16_f32 v104, v104, v105
    v_cvt_pk_bf16_f32 v105, v106, v107
    ds_write_b64 v6, v[104:105] offset:192
    v_pk_add_f32 v[108:109], v[108:109], v[188:189]
    v_pk_add_f32 v[110:111], v[110:111], v[190:191]
    v_cvt_pk_bf16_f32 v108, v108, v109
    v_cvt_pk_bf16_f32 v109, v110, v111
    ds_write_b64 v6, v[108:109] offset:224
    s_nop 0
    ds_read_b128 v[192:195], v7 offset:0
    ds_read_b128 v[196:199], v7 offset:1088
    ds_read_b128 v[200:203], v7 offset:2176
    ds_read_b128 v[204:207], v7 offset:3264
    s_waitcnt lgkmcnt(12)
    v_pk_add_f32 v[128:129], v[128:129], v[80:81]
    v_pk_add_f32 v[130:131], v[130:131], v[82:83]
    v_cvt_pk_bf16_f32 v128, v128, v129
    v_cvt_pk_bf16_f32 v129, v130, v131
    ds_write_b64 v6, v[128:129] offset:4352
    v_pk_add_f32 v[132:133], v[132:133], v[84:85]
    v_pk_add_f32 v[134:135], v[134:135], v[86:87]
    v_cvt_pk_bf16_f32 v132, v132, v133
    v_cvt_pk_bf16_f32 v133, v134, v135
    ds_write_b64 v6, v[132:133] offset:4384
    v_pk_add_f32 v[136:137], v[136:137], v[88:89]
    v_pk_add_f32 v[138:139], v[138:139], v[90:91]
    v_cvt_pk_bf16_f32 v136, v136, v137
    v_cvt_pk_bf16_f32 v137, v138, v139
    ds_write_b64 v6, v[136:137] offset:4416
    v_pk_add_f32 v[140:141], v[140:141], v[92:93]
    v_pk_add_f32 v[142:143], v[142:143], v[94:95]
    v_cvt_pk_bf16_f32 v140, v140, v141
    v_cvt_pk_bf16_f32 v141, v142, v143
    ds_write_b64 v6, v[140:141] offset:4448
    s_waitcnt lgkmcnt(4)
    s_mov_b32 s35, 0
    buffer_store_dwordx4 v[192:195], v2, s[56:59], s35 offen sc1 nt
    s_mov_b32 s35, 10240
    buffer_store_dwordx4 v[196:199], v2, s[56:59], s35 offen sc1 nt
    s_mov_b32 s35, 20480
    buffer_store_dwordx4 v[200:203], v2, s[56:59], s35 offen sc1 nt
    s_mov_b32 s35, 30720
    buffer_store_dwordx4 v[204:207], v2, s[56:59], s35 offen sc1 nt
    v_pk_add_f32 v[160:161], v[160:161], v[112:113]
    v_pk_add_f32 v[162:163], v[162:163], v[114:115]
    v_cvt_pk_bf16_f32 v160, v160, v161
    v_cvt_pk_bf16_f32 v161, v162, v163
    ds_write_b64 v6, v[160:161] offset:4480
    v_pk_add_f32 v[164:165], v[164:165], v[116:117]
    v_pk_add_f32 v[166:167], v[166:167], v[118:119]
    v_cvt_pk_bf16_f32 v164, v164, v165
    v_cvt_pk_bf16_f32 v165, v166, v167
    ds_write_b64 v6, v[164:165] offset:4512
    v_pk_add_f32 v[168:169], v[168:169], v[120:121]
    v_pk_add_f32 v[170:171], v[170:171], v[122:123]
    v_cvt_pk_bf16_f32 v168, v168, v169
    v_cvt_pk_bf16_f32 v169, v170, v171
    ds_write_b64 v6, v[168:169] offset:4544
    v_pk_add_f32 v[172:173], v[172:173], v[124:125]
    v_pk_add_f32 v[174:175], v[174:175], v[126:127]
    v_cvt_pk_bf16_f32 v172, v172, v173
    v_cvt_pk_bf16_f32 v173, v174, v175
    ds_write_b64 v6, v[172:173] offset:4576
    ds_read_b128 v[208:211], v7 offset:4352
    ds_read_b128 v[212:215], v7 offset:5440
    ds_read_b128 v[216:219], v7 offset:6528
    ds_read_b128 v[220:223], v7 offset:7616
    s_mov_b32 s35, 40960
    s_waitcnt lgkmcnt(3)
    buffer_store_dwordx4 v[208:211], v2, s[56:59], s35 offen sc1 nt
    s_mov_b32 s35, 51200
    s_waitcnt lgkmcnt(2)
    buffer_store_dwordx4 v[212:215], v2, s[56:59], s35 offen sc1 nt
    s_mov_b32 s35, 61440
    s_waitcnt lgkmcnt(1)
    buffer_store_dwordx4 v[216:219], v2, s[56:59], s35 offen sc1 nt
    s_mov_b32 s35, 71680
    s_waitcnt lgkmcnt(0)
    buffer_store_dwordx4 v[220:223], v2, s[56:59], s35 offen sc1 nt
    s_endpgm
K1_TAILA:
    v_mfma_f32_16x16x32_bf16 v[44:47], v[116:119], v[100:103], v[44:47]
    v_cvt_pk_bf16_f32 v51, v38, v39
    v_lshlrev_b32 v58, 14, v0
    v_mfma_f32_16x16x32_bf16 v[44:47], v[120:123], v[104:107], v[44:47]
    s_add_u32 m0, s30, 118272
    s_mul_i32 s35, s80, 15
    v_mfma_f32_16x16x32_bf16 v[44:47], v[124:127], v[108:111], v[44:47]
    s_waitcnt vmcnt(8) lgkmcnt(0)
    s_barrier
    s_add_u32 s35, s35, s101
    v_mfma_f32_16x16x32_bf16 a[0:3], v[208:211], v[48:51], a[0:3]
    s_and_b32 s35, s35, 0x1e000
    v_exp_f32 v40, v40
    v_mfma_f32_16x16x32_bf16 a[4:7], v[212:215], v[48:51], a[4:7]
    s_or_b32 s35, s35, s75
    v_exp_f32 v41, v41
    v_mfma_f32_16x16x32_bf16 a[8:11], v[216:219], v[48:51], a[8:11]
    s_waitcnt vmcnt(4)
    ds_read_b128 a[220:223], v11 offset:0
    v_cvt_pk_bf16_f32 v52, v40, v41
    v_mfma_f32_16x16x32_bf16 a[12:15], v[220:223], v[48:51], a[12:15]
    buffer_load_dwordx4 v3, s[20:23], s35 offen offset:0 nt lds
    v_mfma_f32_16x16x32_bf16 a[16:19], v[240:243], v[48:51], a[16:19]
    v_exp_f32 v42, v42
    v_mfma_f32_16x16x32_bf16 a[20:23], v[244:247], v[48:51], a[20:23]
    v_exp_f32 v43, v43
    v_mfma_f32_16x16x32_bf16 a[24:27], v[248:251], v[48:51], a[24:27]
    ds_read_b128 a[224:227], v11 offset:64
    v_cvt_pk_bf16_f32 v53, v42, v43
    v_mfma_f32_16x16x32_bf16 a[28:31], v[252:255], v[48:51], a[28:31]
    v_exp_f32 v44, v44
    v_mfma_f32_16x16x32_bf16 v[32:35], v[80:83], v[128:131], 0
    v_exp_f32 v45, v45
    v_mfma_f32_16x16x32_bf16 v[32:35], v[84:87], v[132:135], v[32:35]
    v_exp_f32 v46, v46
    v_mfma_f32_16x16x32_bf16 v[32:35], v[88:91], v[136:139], v[32:35]
    s_add_u32 m0, s30, 119072
    ds_read_b128 a[228:231], v11 offset:128
    v_cvt_pk_bf16_f32 v54, v44, v45
    v_mfma_f32_16x16x32_bf16 v[32:35], v[92:95], v[140:143], v[32:35]
    s_waitcnt vmcnt(4)
    v_exp_f32 v47, v47
    v_mfma_f32_16x16x32_bf16 v[36:39], v[112:115], v[128:131], 0
    buffer_load_dwordx4 v3, s[20:23], s35 offen offset:256 nt lds
    v_mfma_f32_16x16x32_bf16 v[36:39], v[116:119], v[132:135], v[36:39]
    ds_read_b128 a[232:235], v11 offset:192
    v_cvt_pk_bf16_f32 v55, v46, v47
    v_mfma_f32_16x16x32_bf16 v[36:39], v[120:123], v[136:139], v[36:39]
    ds_read_b128 a[236:239], v11 offset:512
    v_mfma_f32_16x16x32_bf16 v[36:39], v[124:127], v[140:143], v[36:39]
    s_getpc_b64 s[76:77]
CT_A:
    s_add_u32 s76, s76, K1_Q1-CT_A
    s_addc_u32 s77, s77, 0
    v_smfmac_f32_16x16x64_bf16 a[192:195], a[216:219], v[48:55], v29
    s_mov_b32 s78, NOTILE-K1_Q1
    v_exp_f32 v32, v32
    v_mfma_f32_16x16x32_bf16 a[32:35], v[208:211], v[52:55], a[32:35]
    s_add_u32 m0, s30, 119872
    v_exp_f32 v33, v33
    v_mfma_f32_16x16x32_bf16 a[36:39], v[212:215], v[52:55], a[36:39]
    s_waitcnt vmcnt(4)
    ds_read_b128 a[240:243], v11 offset:576
    v_cvt_pk_bf16_f32 v48, v32, v33
    v_mfma_f32_16x16x32_bf16 a[40:43], v[216:219], v[52:55], a[40:43]
    s_lshl_b32 s36, s3, 2
    buffer_load_dwordx4 v3, s[20:23], s35 offen offset:512 nt lds
    v_mfma_f32_16x16x32_bf16 a[44:47], v[220:223], v[52:55], a[44:47]
    s_add_u32 s36, s36, s43
    v_exp_f32 v34, v34
    v_mfma_f32_16x16x32_bf16 a[48:51], v[240:243], v[52:55], a[48:51]
    s_lshl_b32 s36, s36, 7
    v_exp_f32 v35, v35
    v_mfma_f32_16x16x32_bf16 a[52:55], v[244:247], v[52:55], a[52:55]
    ds_read_b128 a[244:247], v11 offset:640
    v_cvt_pk_bf16_f32 v49, v34, v35
    v_mfma_f32_16x16x32_bf16 a[56:59], v[248:251], v[52:55], a[56:59]
    v_mfma_f32_16x16x32_bf16 a[60:63], v[252:255], v[52:55], a[60:63]
    v_exp_f32 v36, v36
    v_mfma_f32_16x16x32_bf16 v[40:43], v[80:83], v[160:163], 0
    v_exp_f32 v37, v37
    v_mfma_f32_16x16x32_bf16 v[40:43], v[84:87], v[164:167], v[40:43]
    v_exp_f32 v38, v38
    v_mfma_f32_16x16x32_bf16 v[40:43], v[88:91], v[168:171], v[40:43]
    s_add_u32 m0, s30, 120672
    ds_read_b128 a[248:251], v11 offset:704
    v_cvt_pk_bf16_f32 v50, v36, v37
    v_mfma_f32_16x16x32_bf16 v[40:43], v[92:95], v[172:175], v[40:43]
    s_waitcnt vmcnt(4)
    v_exp_f32 v39, v39
    v_mfma_f32_16x16x32_bf16 v[44:47], v[112:115], v[160:163], 0
    buffer_load_dwordx4 v3, s[20:23], s35 offen offset:768 nt lds
    v_mfma_f32_16x16x32_bf16 v[44:47], v[116:119], v[164:167], v[44:47]
    v_cvt_pk_bf16_f32 v51, v38, v39
    v_mfma_f32_16x16x32_bf16 v[44:47], v[120:123], v[168:171], v[44:47]
    v_add_u32 v12, s84, v10
    v_mfma_f32_16x16x32_bf16 v[44:47], v[124:127], v[172:175], v[44:47]
    s_waitcnt vmcnt(8) lgkmcnt(0)
    s_barrier
    v_mfma_f32_16x16x32_bf16 a[64:67], v[208:211], v[48:51], a[64:67]
    v_exp_f32 v40, v40
    v_mfma_f32_16x16x32_bf16 a[68:71], v[212:215], v[48:51], a[68:71]
    v_exp_f32 v41, v41
    v_mfma_f32_16x16x32_bf16 a[72:75], v[216:219], v[48:51], a[72:75]
    ds_read_b64_tr_b16 v[144:145], v12 offset:16896
    v_cvt_pk_bf16_f32 v52, v40, v41
    v_mfma_f32_16x16x32_bf16 a[76:79], v[220:223], v[48:51], a[76:79]
    buffer_load_dword v13, v58, s[76:79], s36 offen
    v_mfma_f32_16x16x32_bf16 a[80:83], v[240:243], v[48:51], a[80:83]
    v_exp_f32 v42, v42
    v_mfma_f32_16x16x32_bf16 a[84:87], v[244:247], v[48:51], a[84:87]
    v_exp_f32 v43, v43
    v_mfma_f32_16x16x32_bf16 a[88:91], v[248:251], v[48:51], a[88:91]
    ds_read_b64_tr_b16 v[146:147], v12 offset:17408
    v_cvt_pk_bf16_f32 v53, v42, v43
    v_mfma_f32_16x16x32_bf16 a[92:95], v[252:255], v[48:51], a[92:95]
    v_exp_f32 v44, v44
    v_mfma_f32_16x16x32_bf16 v[32:35], v[80:83], v[192:195], 0
    v_exp_f32 v45, v45
    v_mfma_f32_16x16x32_bf16 v[32:35], v[84:87], v[196:199], v[32:35]
    v_exp_f32 v46, v46
    v_mfma_f32_16x16x32_bf16 v[32:35], v[88:91], v[200:203], v[32:35]
    ds_read_b64_tr_b16 v[148:149], v12 offset:16928
    v_cvt_pk_bf16_f32 v54, v44, v45
    v_mfma_f32_16x16x32_bf16 v[32:35], v[92:95], v[204:207], v[32:35]
    v_exp_f32 v47, v47
    v_mfma_f32_16x16x32_bf16 v[36:39], v[112:115], v[192:195], 0
    v_mfma_f32_16x16x32_bf16 v[36:39], v[116:119], v[196:199], v[36:39]
    ds_read_b64_tr_b16 v[150:151], v12 offset:17440
    v_cvt_pk_bf16_f32 v55, v46, v47
    v_mfma_f32_16x16x32_bf16 v[36:39], v[120:123], v[200:203], v[36:39]
    ds_read_b64_tr_b16 v[152:153], v12 offset:16960
    v_mfma_f32_16x16x32_bf16 v[36:39], v[124:127], v[204:207], v[36:39]
    v_smfmac_f32_16x16x64_bf16 a[196:199], a[216:219], v[48:55], v29
    v_exp_f32 v32, v32
    v_mfma_f32_16x16x32_bf16 a[96:99], v[208:211], v[52:55], a[96:99]
    v_exp_f32 v33, v33
    v_mfma_f32_16x16x32_bf16 a[100:103], v[212:215], v[52:55], a[100:103]
    ds_read_b64_tr_b16 v[154:155], v12 offset:17472
    v_cvt_pk_bf16_f32 v48, v32, v33
    v_mfma_f32_16x16x32_bf16 a[104:107], v[216:219], v[52:55], a[104:107]
    v_mfma_f32_16x16x32_bf16 a[108:111], v[220:223], v[52:55], a[108:111]
    v_exp_f32 v34, v34
    v_mfma_f32_16x16x32_bf16 a[112:115], v[240:243], v[52:55], a[112:115]
    v_exp_f32 v35, v35
    v_mfma_f32_16x16x32_bf16 a[116:119], v[244:247], v[52:55], a[116:119]
    ds_read_b64_tr_b16 v[156:157], v12 offset:16992
    v_cvt_pk_bf16_f32 v49, v34, v35
    v_mfma_f32_16x16x32_bf16 a[120:123], v[248:251], v[52:55], a[120:123]
    buffer_load_dword v21, off, s[64:67], 0 sc1
    v_mfma_f32_16x16x32_bf16 a[124:127], v[252:255], v[52:55], a[124:127]
    v_exp_f32 v36, v36
    v_mfma_f32_16x16x32_bf16 v[40:43], v[80:83], v[224:227], 0
    v_exp_f32 v37, v37
    v_mfma_f32_16x16x32_bf16 v[40:43], v[84:87], v[228:231], v[40:43]
    v_exp_f32 v38, v38
    v_mfma_f32_16x16x32_bf16 v[40:43], v[88:91], v[232:235], v[40:43]
    s_add_u32 m0, s29, 24832
    ds_read_b64_tr_b16 v[158:159], v12 offset:17504
    v_cvt_pk_bf16_f32 v50, v36, v37
    v_mfma_f32_16x16x32_bf16 v[40:43], v[92:95], v[236:239], v[40:43]
    s_xor_b32 s35, s61, 0
    v_exp_f32 v39, v39
    v_mfma_f32_16x16x32_bf16 v[44:47], v[112:115], v[224:227], 0
    buffer_load_dwordx4 v2, s[12:15], s35 offen lds
    v_mfma_f32_16x16x32_bf16 v[44:47], v[116:119], v[228:231], v[44:47]
    ds_read_b64_tr_b16 v[176:177], v12 offset:17024
    v_cvt_pk_bf16_f32 v51, v38, v39
    v_mfma_f32_16x16x32_bf16 v[44:47], v[120:123], v[232:235], v[44:47]
    s_add_u32 m0, s29, 25920
    s_xor_b32 s35, s61, 8192
    ds_read_b64_tr_b16 v[178:179], v12 offset:17536
    v_mfma_f32_16x16x32_bf16 v[44:47], v[124:127], v[236:239], v[44:47]
    buffer_load_dwordx4 v2, s[12:15], s35 offen lds
    v_mfma_f32_16x16x32_bf16 a[128:131], v[208:211], v[48:51], a[128:131]
    v_exp_f32 v40, v40
    v_mfma_f32_16x16x32_bf16 a[132:135], v[212:215], v[48:51], a[132:135]
    s_add_u32 m0, s29, 27008
    v_exp_f32 v41, v41
    v_mfma_f32_16x16x32_bf16 a[136:139], v[216:219], v[48:51], a[136:139]
    s_xor_b32 s35, s61, 16384
    ds_read_b64_tr_b16 v[180:181], v12 offset:17056
    v_cvt_pk_bf16_f32 v52, v40, v41
    v_mfma_f32_16x16x32_bf16 a[140:143], v[220:223], v[48:51], a[140:143]
    buffer_load_dwordx4 v2, s[12:15], s35 offen lds
    v_mfma_f32_16x16x32_bf16 a[144:147], v[240:243], v[48:51], a[144:147]
    v_exp_f32 v42, v42
    v_mfma_f32_16x16x32_bf16 a[148:151], v[244:247], v[48:51], a[148:151]
    v_exp_f32 v43, v43
    v_mfma_f32_16x16x32_bf16 a[152:155], v[248:251], v[48:51], a[152:155]
    ds_read_b64_tr_b16 v[182:183], v12 offset:17568
    v_cvt_pk_bf16_f32 v53, v42, v43
    v_mfma_f32_16x16x32_bf16 a[156:159], v[252:255], v[48:51], a[156:159]
    v_exp_f32 v44, v44
    v_mfma_f32_16x16x32_bf16 v[32:35], a[220:223], v[64:67], 0
    v_exp_f32 v45, v45
    v_mfma_f32_16x16x32_bf16 v[32:35], a[224:227], v[68:71], v[32:35]
    v_exp_f32 v46, v46
    v_mfma_f32_16x16x32_bf16 v[32:35], a[228:231], v[72:75], v[32:35]
    s_add_u32 m0, s29, 28096
    ds_read_b64_tr_b16 v[184:185], v12 offset:17088
    v_cvt_pk_bf16_f32 v54, v44, v45
    v_mfma_f32_16x16x32_bf16 v[32:35], a[232:235], v[76:79], v[32:35]
    s_xor_b32 s35, s61, 24576
    v_exp_f32 v47, v47
    v_mfma_f32_16x16x32_bf16 v[36:39], a[236:239], v[64:67], 0
    buffer_load_dwordx4 v2, s[12:15], s35 offen lds
    v_mfma_f32_16x16x32_bf16 v[36:39], a[240:243], v[68:71], v[36:39]
    ds_read_b64_tr_b16 v[186:187], v12 offset:17600
    v_cvt_pk_bf16_f32 v55, v46, v47
    v_mfma_f32_16x16x32_bf16 v[36:39], a[244:247], v[72:75], v[36:39]
    s_add_u32 m0, s28, 136864
    s_xor_b32 s35, s60, 0
    ds_read_b64_tr_b16 v[188:189], v12 offset:17120
    v_mfma_f32_16x16x32_bf16 v[36:39], a[248:251], v[76:79], v[36:39]
    buffer_load_dwordx4 v1, s[8:11], s35 offen offset:0 lds
    v_smfmac_f32_16x16x64_bf16 a[200:203], a[216:219], v[48:55], v29
    v_exp_f32 v32, v32
    v_mfma_f32_16x16x32_bf16 a[160:163], v[208:211], v[52:55], a[160:163]
    v_exp_f32 v33, v33
    v_mfma_f32_16x16x32_bf16 a[164:167], v[212:215], v[52:55], a[164:167]
    s_add_u32 m0, s28, 138688
    ds_read_b64_tr_b16 v[190:191], v12 offset:17632
    v_cvt_pk_bf16_f32 v48, v32, v33
    v_mfma_f32_16x16x32_bf16 a[168:171], v[216:219], v[52:55], a[168:171]
    buffer_load_dwordx4 v1, s[8:11], s35 offen offset:1280 lds
    v_mfma_f32_16x16x32_bf16 a[172:175], v[220:223], v[52:55], a[172:175]
    v_exp_f32 v34, v34
    v_mfma_f32_16x16x32_bf16 a[176:179], v[240:243], v[52:55], a[176:179]
    v_exp_f32 v35, v35
    v_mfma_f32_16x16x32_bf16 a[180:183], v[244:247], v[52:55], a[180:183]
    s_add_u32 m0, s28, 137888
    s_xor_b32 s35, s60, 81920
    v_cvt_pk_bf16_f32 v49, v34, v35
    v_mfma_f32_16x16x32_bf16 a[184:187], v[248:251], v[52:55], a[184:187]
    buffer_load_dwordx4 v1, s[8:11], s35 offen offset:0 lds
    v_mfma_f32_16x16x32_bf16 a[188:191], v[252:255], v[52:55], a[188:191]
    v_exp_f32 v36, v36
    v_mfma_f32_16x16x32_bf16 v[40:43], a[220:223], v[96:99], 0
    v_exp_f32 v37, v37
    v_mfma_f32_16x16x32_bf16 v[40:43], a[224:227], v[100:103], v[40:43]
    v_exp_f32 v38, v38
    v_mfma_f32_16x16x32_bf16 v[40:43], a[228:231], v[104:107], v[40:43]
    v_cvt_pk_bf16_f32 v50, v36, v37
    v_mfma_f32_16x16x32_bf16 v[40:43], a[232:235], v[108:111], v[40:43]
    s_add_u32 m0, s28, 139712
    v_exp_f32 v39, v39
    v_mfma_f32_16x16x32_bf16 v[44:47], a[236:239], v[96:99], 0
    buffer_load_dwordx4 v1, s[8:11], s35 offen offset:1280 lds
    v_mfma_f32_16x16x32_bf16 v[44:47], a[240:243], v[100:103], v[44:47]
    s_add_u32 m0, s28, 138912
    s_xor_b32 s35, s60, 163840
    v_cvt_pk_bf16_f32 v51, v38, v39
    v_mfma_f32_16x16x32_bf16 v[44:47], a[244:247], v[104:107], v[44:47]
    buffer_load_dwordx4 v1, s[8:11], s35 offen offset:0 lds
    v_mfma_f32_16x16x32_bf16 v[44:47], a[248:251], v[108:111], v[44:47]
    s_waitcnt vmcnt(15) lgkmcnt(0)
    s_barrier
    v_mfma_f32_16x16x32_bf16 a[0:3], v[144:147], v[48:51], a[0:3]
    v_exp_f32 v40, v40
    v_mfma_f32_16x16x32_bf16 a[4:7], v[148:151], v[48:51], a[4:7]
    v_exp_f32 v41, v41
    v_mfma_f32_16x16x32_bf16 a[8:11], v[152:155], v[48:51], a[8:11]
    s_add_u32 m0, s28, 140736
    ds_read_b128 v[80:83], v11 offset:33792
    v_cvt_pk_bf16_f32 v52, v40, v41
    v_mfma_f32_16x16x32_bf16 a[12:15], v[156:159], v[48:51], a[12:15]
    buffer_load_dwordx4 v1, s[8:11], s35 offen offset:1280 lds
    v_mfma_f32_16x16x32_bf16 a[16:19], v[176:179], v[48:51], a[16:19]
    v_exp_f32 v42, v42
    v_mfma_f32_16x16x32_bf16 a[20:23], v[180:183], v[48:51], a[20:23]
    v_exp_f32 v43, v43
    v_mfma_f32_16x16x32_bf16 a[24:27], v[184:187], v[48:51], a[24:27]
    ds_read_b128 v[84:87], v11 offset:33856
    v_cvt_pk_bf16_f32 v53, v42, v43
    v_mfma_f32_16x16x32_bf16 a[28:31], v[188:191], v[48:51], a[28:31]
    v_exp_f32 v44, v44
    v_mfma_f32_16x16x32_bf16 v[32:35], a[220:223], v[128:131], 0
    v_exp_f32 v45, v45
    v_mfma_f32_16x16x32_bf16 v[32:35], a[224:227], v[132:135], v[32:35]
    v_exp_f32 v46, v46
    v_mfma_f32_16x16x32_bf16 v[32:35], a[228:231], v[136:139], v[32:35]
    s_add_u32 m0, s29, 42272
    ds_read_b128 v[88:91], v11 offset:33920
    v_cvt_pk_bf16_f32 v54, v44, v45
    v_mfma_f32_16x16x32_bf16 v[32:35], a[232:235], v[140:143], v[32:35]
    s_xor_b32 s35, s61, 262144
    v_exp_f32 v47, v47
    v_mfma_f32_16x16x32_bf16 v[36:39], a[236:239], v[128:131], 0
    buffer_load_dwordx4 v2, s[12:15], s35 offen lds
    v_mfma_f32_16x16x32_bf16 v[36:39], a[240:243], v[132:135], v[36:39]
    ds_read_b128 v[92:95], v11 offset:33984
    v_cvt_pk_bf16_f32 v55, v46, v47
    v_mfma_f32_16x16x32_bf16 v[36:39], a[244:247], v[136:139], v[36:39]
    s_add_u32 m0, s29, 43360
    s_xor_b32 s35, s61, 270336
    ds_read_b128 v[112:115], v11 offset:34304
    v_mfma_f32_16x16x32_bf16 v[36:39], a[248:251], v[140:143], v[36:39]
    buffer_load_dwordx4 v2, s[12:15], s35 offen lds
    v_smfmac_f32_16x16x64_bf16 a[192:195], a[216:219], v[48:55], v29
    v_exp_f32 v32, v32
    v_mfma_f32_16x16x32_bf16 a[32:35], v[144:147], v[52:55], a[32:35]
    s_add_u32 m0, s29, 44448
    v_exp_f32 v33, v33
    v_mfma_f32_16x16x32_bf16 a[36:39], v[148:151], v[52:55], a[36:39]
    s_xor_b32 s35, s61, 278528
    ds_read_b128 v[116:119], v11 offset:34368
    v_cvt_pk_bf16_f32 v48, v32, v33
    v_mfma_f32_16x16x32_bf16 a[40:43], v[152:155], v[52:55], a[40:43]
    buffer_load_dwordx4 v2, s[12:15], s35 offen lds
    v_mfma_f32_16x16x32_bf16 a[44:47], v[156:159], v[52:55], a[44:47]
    v_exp_f32 v34, v34
    v_mfma_f32_16x16x32_bf16 a[48:51], v[176:179], v[52:55], a[48:51]
    s_add_u32 m0, s29, 45536
    v_exp_f32 v35, v35
    v_mfma_f32_16x16x32_bf16 a[52:55], v[180:183], v[52:55], a[52:55]
    s_xor_b32 s35, s61, 286720
    ds_read_b128 v[120:123], v11 offset:34432
    v_cvt_pk_bf16_f32 v49, v34, v35
    v_mfma_f32_16x16x32_bf16 a[56:59], v[184:187], v[52:55], a[56:59]
    buffer_load_dwordx4 v2, s[12:15], s35 offen lds
    v_mfma_f32_16x16x32_bf16 a[60:63], v[188:191], v[52:55], a[60:63]
    v_exp_f32 v36, v36
    v_mfma_f32_16x16x32_bf16 v[40:43], a[220:223], v[160:163], 0
    v_exp_f32 v37, v37
    v_mfma_f32_16x16x32_bf16 v[40:43], a[224:227], v[164:167], v[40:43]
    v_exp_f32 v38, v38
    v_mfma_f32_16x16x32_bf16 v[40:43], a[228:231], v[168:171], v[40:43]
    s_add_u32 m0, s28, 0
    ds_read_b128 v[124:127], v11 offset:34496
    v_cvt_pk_bf16_f32 v50, v36, v37
    v_mfma_f32_16x16x32_bf16 v[40:43], a[232:235], v[172:175], v[40:43]
    s_xor_b32 s35, s60, 128
    v_exp_f32 v39, v39
    v_mfma_f32_16x16x32_bf16 v[44:47], a[236:239], v[160:163], 0
    buffer_load_dwordx4 v1, s[8:11], s35 offen offset:0 lds
    v_mfma_f32_16x16x32_bf16 v[44:47], a[240:243], v[164:167], v[44:47]
    s_add_u32 m0, s28, 1824
    v_cvt_pk_bf16_f32 v51, v38, v39
    v_mfma_f32_16x16x32_bf16 v[44:47], a[244:247], v[168:171], v[44:47]
    buffer_load_dwordx4 v1, s[8:11], s35 offen offset:1280 lds
    v_mfma_f32_16x16x32_bf16 v[44:47], a[248:251], v[172:175], v[44:47]
    s_waitcnt vmcnt(18) lgkmcnt(0)
    s_barrier
    v_mfma_f32_16x16x32_bf16 a[64:67], v[144:147], v[48:51], a[64:67]
    v_exp_f32 v40, v40
    v_mfma_f32_16x16x32_bf16 a[68:71], v[148:151], v[48:51], a[68:71]
    s_add_u32 m0, s28, 1024
    v_exp_f32 v41, v41
    v_mfma_f32_16x16x32_bf16 a[72:75], v[152:155], v[48:51], a[72:75]
    s_xor_b32 s35, s60, 82048
    ds_read_b64_tr_b16 v[208:209], v12 offset:50688
    v_cvt_pk_bf16_f32 v52, v40, v41
    v_mfma_f32_16x16x32_bf16 a[76:79], v[156:159], v[48:51], a[76:79]
    buffer_load_dwordx4 v1, s[8:11], s35 offen offset:0 lds
    v_mfma_f32_16x16x32_bf16 a[80:83], v[176:179], v[48:51], a[80:83]
    v_exp_f32 v42, v42
    v_mfma_f32_16x16x32_bf16 a[84:87], v[180:183], v[48:51], a[84:87]
    v_exp_f32 v43, v43
    v_mfma_f32_16x16x32_bf16 a[88:91], v[184:187], v[48:51], a[88:91]
    ds_read_b64_tr_b16 v[210:211], v12 offset:51200
    v_cvt_pk_bf16_f32 v53, v42, v43
    v_mfma_f32_16x16x32_bf16 a[92:95], v[188:191], v[48:51], a[92:95]
    v_exp_f32 v44, v44
    v_mfma_f32_16x16x32_bf16 v[32:35], a[220:223], v[192:195], 0
    v_exp_f32 v45, v45
    v_mfma_f32_16x16x32_bf16 v[32:35], a[224:227], v[196:199], v[32:35]
    v_exp_f32 v46, v46
    v_mfma_f32_16x16x32_bf16 v[32:35], a[228:231], v[200:203], v[32:35]
    ds_read_b64_tr_b16 v[212:213], v12 offset:50720
    v_cvt_pk_bf16_f32 v54, v44, v45
    v_mfma_f32_16x16x32_bf16 v[32:35], a[232:235], v[204:207], v[32:35]
    s_add_u32 m0, s28, 2848
    v_exp_f32 v47, v47
    v_mfma_f32_16x16x32_bf16 v[36:39], a[236:239], v[192:195], 0
    buffer_load_dwordx4 v1, s[8:11], s35 offen offset:1280 lds
    v_mfma_f32_16x16x32_bf16 v[36:39], a[240:243], v[196:199], v[36:39]
    ds_read_b64_tr_b16 v[214:215], v12 offset:51232
    v_cvt_pk_bf16_f32 v55, v46, v47
    v_mfma_f32_16x16x32_bf16 v[36:39], a[244:247], v[200:203], v[36:39]
    s_add_u32 m0, s28, 2048
    s_xor_b32 s35, s60, 163968
    ds_read_b64_tr_b16 v[216:217], v12 offset:50752
    v_mfma_f32_16x16x32_bf16 v[36:39], a[248:251], v[204:207], v[36:39]
    buffer_load_dwordx4 v1, s[8:11], s35 offen offset:0 lds
    v_smfmac_f32_16x16x64_bf16 a[196:199], a[216:219], v[48:55], v29
    v_exp_f32 v32, v32
    v_mfma_f32_16x16x32_bf16 a[96:99], v[144:147], v[52:55], a[96:99]
    v_exp_f32 v33, v33
    v_mfma_f32_16x16x32_bf16 a[100:103], v[148:151], v[52:55], a[100:103]
    s_add_u32 m0, s28, 3872
    ds_read_b64_tr_b16 v[218:219], v12 offset:51264
    v_cvt_pk_bf16_f32 v48, v32, v33
    v_mfma_f32_16x16x32_bf16 a[104:107], v[152:155], v[52:55], a[104:107]
    buffer_load_dwordx4 v1, s[8:11], s35 offen offset:1280 lds
    v_mfma_f32_16x16x32_bf16 a[108:111], v[156:159], v[52:55], a[108:111]
    v_exp_f32 v34, v34
    v_mfma_f32_16x16x32_bf16 a[112:115], v[176:179], v[52:55], a[112:115]
    s_add_u32 m0, s29, 84544
    v_exp_f32 v35, v35
    v_mfma_f32_16x16x32_bf16 a[116:119], v[180:183], v[52:55], a[116:119]
    s_xor_b32 s35, s61, 524288
    ds_read_b64_tr_b16 v[220:221], v12 offset:50784
    v_cvt_pk_bf16_f32 v49, v34, v35
    v_mfma_f32_16x16x32_bf16 a[120:123], v[184:187], v[52:55], a[120:123]
    buffer_load_dwordx4 v2, s[12:15], s35 offen lds
    v_mfma_f32_16x16x32_bf16 a[124:127], v[188:191], v[52:55], a[124:127]
    v_exp_f32 v36, v36
    v_mfma_f32_16x16x32_bf16 v[40:43], a[220:223], v[224:227], 0
    v_exp_f32 v37, v37
    v_mfma_f32_16x16x32_bf16 v[40:43], a[224:227], v[228:231], v[40:43]
    v_exp_f32 v38, v38
    v_mfma_f32_16x16x32_bf16 v[40:43], a[228:231], v[232:235], v[40:43]
    s_add_u32 m0, s29, 85632
    ds_read_b64_tr_b16 v[222:223], v12 offset:51296
    v_cvt_pk_bf16_f32 v50, v36, v37
    v_mfma_f32_16x16x32_bf16 v[40:43], a[232:235], v[236:239], v[40:43]
    s_xor_b32 s35, s61, 532480
    v_exp_f32 v39, v39
    v_mfma_f32_16x16x32_bf16 v[44:47], a[236:239], v[224:227], 0
    buffer_load_dwordx4 v2, s[12:15], s35 offen lds
    v_mfma_f32_16x16x32_bf16 v[44:47], a[240:243], v[228:231], v[44:47]
    ds_read_b64_tr_b16 v[240:241], v12 offset:50816
    v_cvt_pk_bf16_f32 v51, v38, v39
    v_mfma_f32_16x16x32_bf16 v[44:47], a[244:247], v[232:235], v[44:47]
    s_add_u32 m0, s29, 86720
    s_xor_b32 s35, s61, 540672
    ds_read_b64_tr_b16 v[242:243], v12 offset:51328
    v_mfma_f32_16x16x32_bf16 v[44:47], a[248:251], v[236:239], v[44:47]
    buffer_load_dwordx4 v2, s[12:15], s35 offen lds
    v_mfma_f32_16x16x32_bf16 a[128:131], v[144:147], v[48:51], a[128:131]
    v_exp_f32 v40, v40
    v_mfma_f32_16x16x32_bf16 a[132:135], v[148:151], v[48:51], a[132:135]
    s_add_u32 m0, s29, 87808
    v_exp_f32 v41, v41
    v_mfma_f32_16x16x32_bf16 a[136:139], v[152:155], v[48:51], a[136:139]
    s_xor_b32 s35, s61, 548864
    ds_read_b64_tr_b16 v[244:245], v12 offset:50848
    v_cvt_pk_bf16_f32 v52, v40, v41
    v_mfma_f32_16x16x32_bf16 a[140:143], v[156:159], v[48:51], a[140:143]
    buffer_load_dwordx4 v2, s[12:15], s35 offen lds
    v_mfma_f32_16x16x32_bf16 a[144:147], v[176:179], v[48:51], a[144:147]
    v_exp_f32 v42, v42
    v_mfma_f32_16x16x32_bf16 a[148:151], v[180:183], v[48:51], a[148:151]
    v_exp_f32 v43, v43
    v_mfma_f32_16x16x32_bf16 a[152:155], v[184:187], v[48:51], a[152:155]
    ds_read_b64_tr_b16 v[246:247], v12 offset:51360
    v_cvt_pk_bf16_f32 v53, v42, v43
    v_mfma_f32_16x16x32_bf16 a[156:159], v[188:191], v[48:51], a[156:159]
    v_exp_f32 v44, v44
    v_mfma_f32_16x16x32_bf16 v[32:35], v[80:83], v[64:67], 0
    v_exp_f32 v45, v45
    v_mfma_f32_16x16x32_bf16 v[32:35], v[84:87], v[68:71], v[32:35]
    v_exp_f32 v46, v46
    v_mfma_f32_16x16x32_bf16 v[32:35], v[88:91], v[72:75], v[32:35]
    s_add_u32 m0, s28, 59712
    ds_read_b64_tr_b16 v[248:249], v12 offset:50880
    v_cvt_pk_bf16_f32 v54, v44, v45
    v_mfma_f32_16x16x32_bf16 v[32:35], v[92:95], v[76:79], v[32:35]
    s_xor_b32 s35, s60, 256
    v_exp_f32 v47, v47
    v_mfma_f32_16x16x32_bf16 v[36:39], v[112:115], v[64:67], 0
    buffer_load_dwordx4 v1, s[8:11], s35 offen offset:0 lds
    v_mfma_f32_16x16x32_bf16 v[36:39], v[116:119], v[68:71], v[36:39]
    ds_read_b64_tr_b16 v[250:251], v12 offset:51392
    v_cvt_pk_bf16_f32 v55, v46, v47
    v_mfma_f32_16x16x32_bf16 v[36:39], v[120:123], v[72:75], v[36:39]
    s_add_u32 m0, s28, 61536
    ds_read_b64_tr_b16 v[252:253], v12 offset:50912
    v_mfma_f32_16x16x32_bf16 v[36:39], v[124:127], v[76:79], v[36:39]
    buffer_load_dwordx4 v1, s[8:11], s35 offen offset:1280 lds
    v_smfmac_f32_16x16x64_bf16 a[200:203], a[216:219], v[48:55], v29
    v_exp_f32 v32, v32
    v_mfma_f32_16x16x32_bf16 a[160:163], v[144:147], v[52:55], a[160:163]
    s_add_u32 m0, s28, 60736
    v_exp_f32 v33, v33
    v_mfma_f32_16x16x32_bf16 a[164:167], v[148:151], v[52:55], a[164:167]
    s_xor_b32 s35, s60, 82176
    ds_read_b64_tr_b16 v[254:255], v12 offset:51424
    v_cvt_pk_bf16_f32 v48, v32, v33
    v_mfma_f32_16x16x32_bf16 a[168:171], v[152:155], v[52:55], a[168:171]
    buffer_load_dwordx4 v1, s[8:11], s35 offen offset:0 lds
    v_mfma_f32_16x16x32_bf16 a[172:175], v[156:159], v[52:55], a[172:175]
    v_exp_f32 v34, v34
    v_mfma_f32_16x16x32_bf16 a[176:179], v[176:179], v[52:55], a[176:179]
    v_exp_f32 v35, v35
    v_mfma_f32_16x16x32_bf16 a[180:183], v[180:183], v[52:55], a[180:183]
    s_add_u32 m0, s28, 62560
    v_cvt_pk_bf16_f32 v49, v34, v35
    v_mfma_f32_16x16x32_bf16 a[184:187], v[184:187], v[52:55], a[184:187]
    buffer_load_dwordx4 v1, s[8:11], s35 offen offset:1280 lds
    v_mfma_f32_16x16x32_bf16 a[188:191], v[188:191], v[52:55], a[188:191]
    v_exp_f32 v36, v36
    v_mfma_f32_16x16x32_bf16 v[40:43], v[80:83], v[96:99], 0
    v_exp_f32 v37, v37
    v_mfma_f32_16x16x32_bf16 v[40:43], v[84:87], v[100:103], v[40:43]
    v_exp_f32 v38, v38
    v_mfma_f32_16x16x32_bf16 v[40:43], v[88:91], v[104:107], v[40:43]
    s_add_u32 m0, s28, 61760
    v_cvt_pk_bf16_f32 v50, v36, v37
    v_mfma_f32_16x16x32_bf16 v[40:43], v[92:95], v[108:111], v[40:43]
    s_xor_b32 s35, s60, 164096
    v_exp_f32 v39, v39
    v_mfma_f32_16x16x32_bf16 v[44:47], v[112:115], v[96:99], 0
    buffer_load_dwordx4 v1, s[8:11], s35 offen offset:0 lds
    v_mfma_f32_16x16x32_bf16 v[44:47], v[116:119], v[100:103], v[44:47]
    s_add_u32 m0, s28, 63584
    v_cvt_pk_bf16_f32 v51, v38, v39
    v_mfma_f32_16x16x32_bf16 v[44:47], v[120:123], v[104:107], v[44:47]
    buffer_load_dwordx4 v1, s[8:11], s35 offen offset:1280 lds
    v_mfma_f32_16x16x32_bf16 v[44:47], v[124:127], v[108:111], v[44:47]
    s_waitcnt vmcnt(20) lgkmcnt(0)
    s_barrier
    v_mfma_f32_16x16x32_bf16 a[0:3], v[208:211], v[48:51], a[0:3]
    v_exp_f32 v40, v40
    v_mfma_f32_16x16x32_bf16 a[4:7], v[212:215], v[48:51], a[4:7]
    v_exp_f32 v41, v41
    v_mfma_f32_16x16x32_bf16 a[8:11], v[216:219], v[48:51], a[8:11]
    s_add_u32 m0, s29, 101984
    s_xor_b32 s35, s61, 786432
    ds_read_b64_tr_b16 a[220:221], v7 offset:0
    v_cvt_pk_bf16_f32 v52, v40, v41
    v_mfma_f32_16x16x32_bf16 a[12:15], v[220:223], v[48:51], a[12:15]
    buffer_load_dwordx4 v2, s[12:15], s35 offen lds
    v_mfma_f32_16x16x32_bf16 a[16:19], v[240:243], v[48:51], a[16:19]
    v_exp_f32 v42, v42
    v_mfma_f32_16x16x32_bf16 a[20:23], v[244:247], v[48:51], a[20:23]
    v_exp_f32 v43, v43
    v_mfma_f32_16x16x32_bf16 a[24:27], v[248:251], v[48:51], a[24:27]
    ds_read_b64_tr_b16 a[222:223], v7 offset:512
    v_cvt_pk_bf16_f32 v53, v42, v43
    v_mfma_f32_16x16x32_bf16 a[28:31], v[252:255], v[48:51], a[28:31]
    v_exp_f32 v44, v44
    v_mfma_f32_16x16x32_bf16 v[32:35], v[80:83], v[128:131], 0
    v_exp_f32 v45, v45
    v_mfma_f32_16x16x32_bf16 v[32:35], v[84:87], v[132:135], v[32:35]
    v_exp_f32 v46, v46
    v_mfma_f32_16x16x32_bf16 v[32:35], v[88:91], v[136:139], v[32:35]
    s_add_u32 m0, s29, 103072
    ds_read_b64_tr_b16 a[224:225], v7 offset:8
    v_cvt_pk_bf16_f32 v54, v44, v45
    v_mfma_f32_16x16x32_bf16 v[32:35], v[92:95], v[140:143], v[32:35]
    s_xor_b32 s35, s61, 794624
    v_exp_f32 v47, v47
    v_mfma_f32_16x16x32_bf16 v[36:39], v[112:115], v[128:131], 0
    buffer_load_dwordx4 v2, s[12:15], s35 offen lds
    v_mfma_f32_16x16x32_bf16 v[36:39], v[116:119], v[132:135], v[36:39]
    s_add_u32 m0, s29, 104160
    s_xor_b32 s35, s61, 802816
    ds_read_b64_tr_b16 a[226:227], v7 offset:520
    v_cvt_pk_bf16_f32 v55, v46, v47
    v_mfma_f32_16x16x32_bf16 v[36:39], v[120:123], v[136:139], v[36:39]
    buffer_load_dwordx4 v2, s[12:15], s35 offen lds
    v_mfma_f32_16x16x32_bf16 v[36:39], v[124:127], v[140:143], v[36:39]
    v_cmp_eq_u32 s[40:41], 0, v21
    v_smfmac_f32_16x16x64_bf16 a[192:195], a[216:219], v[48:55], v29
    v_exp_f32 v32, v32
    v_mfma_f32_16x16x32_bf16 a[32:35], v[208:211], v[52:55], a[32:35]
    v_exp_f32 v33, v33
    v_mfma_f32_16x16x32_bf16 a[36:39], v[212:215], v[52:55], a[36:39]
    s_add_u32 m0, s29, 105248
    s_xor_b32 s35, s61, 811008
    ds_read_b64_tr_b16 a[228:229], v7 offset:64
    v_cvt_pk_bf16_f32 v48, v32, v33
    v_mfma_f32_16x16x32_bf16 a[40:43], v[216:219], v[52:55], a[40:43]
    buffer_load_dwordx4 v2, s[12:15], s35 offen lds
    v_mfma_f32_16x16x32_bf16 a[44:47], v[220:223], v[52:55], a[44:47]
    v_exp_f32 v34, v34
    v_mfma_f32_16x16x32_bf16 a[48:51], v[240:243], v[52:55], a[48:51]
    v_exp_f32 v35, v35
    v_mfma_f32_16x16x32_bf16 a[52:55], v[244:247], v[52:55], a[52:55]
    s_add_u32 m0, s29, 119424
    s_xor_b32 s35, s61, 1048576
    ds_read_b64_tr_b16 a[230:231], v7 offset:576
    v_cvt_pk_bf16_f32 v49, v34, v35
    v_mfma_f32_16x16x32_bf16 a[56:59], v[248:251], v[52:55], a[56:59]
    buffer_load_dwordx4 v2, s[12:15], s35 offen lds
    v_mfma_f32_16x16x32_bf16 a[60:63], v[252:255], v[52:55], a[60:63]
    v_exp_f32 v36, v36
    v_mfma_f32_16x16x32_bf16 v[40:43], v[80:83], v[160:163], 0
    v_exp_f32 v37, v37
    v_mfma_f32_16x16x32_bf16 v[40:43], v[84:87], v[164:167], v[40:43]
    v_exp_f32 v38, v38
    v_mfma_f32_16x16x32_bf16 v[40:43], v[88:91], v[168:171], v[40:43]
    s_add_u32 m0, s29, 120512
    ds_read_b64_tr_b16 a[232:233], v7 offset:72
    v_cvt_pk_bf16_f32 v50, v36, v37
    v_mfma_f32_16x16x32_bf16 v[40:43], v[92:95], v[172:175], v[40:43]
    s_xor_b32 s35, s61, 1056768
    v_exp_f32 v39, v39
    v_mfma_f32_16x16x32_bf16 v[44:47], v[112:115], v[160:163], 0
    buffer_load_dwordx4 v2, s[12:15], s35 offen lds
    v_mfma_f32_16x16x32_bf16 v[44:47], v[116:119], v[164:167], v[44:47]
    s_cmp_lg_u32 s40, 0
    s_cbranch_scc1 T_SPIN
T_BACK:
    ds_read_b64_tr_b16 a[234:235], v7 offset:584
    v_cvt_pk_bf16_f32 v51, v38, v39
    v_mfma_f32_16x16x32_bf16 v[44:47], v[120:123], v[168:171], v[44:47]
    s_mov_b64 s[64:65], s[68:69]
    s_mov_b32 s66, 16384
    v_accvgpr_read_b32 v22, a192
    v_mfma_f32_16x16x32_bf16 v[44:47], v[124:127], v[172:175], v[44:47]
    v_accvgpr_read_b32 v23, a193
    v_add_f32 v22, v22, v23
    v_mfma_f32_16x16x32_bf16 a[64:67], v[208:211], v[48:51], a[64:67]
    v_exp_f32 v40, v40
    v_mfma_f32_16x16x32_bf16 a[68:71], v[212:215], v[48:51], a[68:71]
    v_exp_f32 v41, v41
    v_mfma_f32_16x16x32_bf16 a[72:75], v[216:219], v[48:51], a[72:75]
    s_add_u32 m0, s29, 121600
    s_xor_b32 s35, s61, 1064960
    ds_read_b64_tr_b16 a[236:237], v7 offset:128
    v_cvt_pk_bf16_f32 v52, v40, v41
    v_mfma_f32_16x16x32_bf16 a[76:79], v[220:223], v[48:51], a[76:79]
    buffer_load_dwordx4 v2, s[12:15], s35 offen lds
    v_mfma_f32_16x16x32_bf16 a[80:83], v[240:243], v[48:51], a[80:83]
    v_exp_f32 v42, v42
    v_mfma_f32_16x16x32_bf16 a[84:87], v[244:247], v[48:51], a[84:87]
    v_exp_f32 v43, v43
    v_mfma_f32_16x16x32_bf16 a[88:91], v[248:251], v[48:51], a[88:91]
    ds_read_b64_tr_b16 a[238:239], v7 offset:640
    v_cvt_pk_bf16_f32 v53, v42, v43
    v_mfma_f32_16x16x32_bf16 a[92:95], v[252:255], v[48:51], a[92:95]
    v_exp_f32 v44, v44
    v_mfma_f32_16x16x32_bf16 v[32:35], v[80:83], v[192:195], 0
    v_exp_f32 v45, v45
    v_mfma_f32_16x16x32_bf16 v[32:35], v[84:87], v[196:199], v[32:35]
    v_exp_f32 v46, v46
    v_mfma_f32_16x16x32_bf16 v[32:35], v[88:91], v[200:203], v[32:35]
    s_add_u32 m0, s29, 122688
    ds_read_b64_tr_b16 a[240:241], v7 offset:136
    v_cvt_pk_bf16_f32 v54, v44, v45
    v_mfma_f32_16x16x32_bf16 v[32:35], v[92:95], v[204:207], v[32:35]
    s_xor_b32 s35, s61, 1073152
    v_exp_f32 v47, v47
    v_mfma_f32_16x16x32_bf16 v[36:39], v[112:115], v[192:195], 0
    buffer_load_dwordx4 v2, s[12:15], s35 offen lds
    v_mfma_f32_16x16x32_bf16 v[36:39], v[116:119], v[196:199], v[36:39]
    ds_read_b64_tr_b16 a[242:243], v7 offset:648
    v_cvt_pk_bf16_f32 v55, v46, v47
    v_mfma_f32_16x16x32_bf16 v[36:39], v[120:123], v[200:203], v[36:39]
    v_subrev_u32 v28, s46, v22
    v_mfma_f32_16x16x32_bf16 v[36:39], v[124:127], v[204:207], v[36:39]
    v_rcp_f32 v22, v22
    v_smfmac_f32_16x16x64_bf16 a[196:199], a[216:219], v[48:55], v29
    v_exp_f32 v32, v32
    v_mfma_f32_16x16x32_bf16 a[96:99], v[208:211], v[52:55], a[96:99]
    v_exp_f32 v33, v33
    v_mfma_f32_16x16x32_bf16 a[100:103], v[212:215], v[52:55], a[100:103]
    ds_read_b64_tr_b16 a[244:245], v7 offset:192
    v_cvt_pk_bf16_f32 v48, v32, v33
    v_mfma_f32_16x16x32_bf16 a[104:107], v[216:219], v[52:55], a[104:107]
    v_accvgpr_read_b32 v56, a0
    v_accvgpr_read_b32 v57, a1
    v_mfma_f32_16x16x32_bf16 a[108:111], v[220:223], v[52:55], a[108:111]
    v_exp_f32 v34, v34
    v_mfma_f32_16x16x32_bf16 a[112:115], v[240:243], v[52:55], a[112:115]
    v_exp_f32 v35, v35
    v_mfma_f32_16x16x32_bf16 a[116:119], v[244:247], v[52:55], a[116:119]
    ds_read_b64_tr_b16 a[246:247], v7 offset:704
    v_cvt_pk_bf16_f32 v49, v34, v35
    v_mfma_f32_16x16x32_bf16 a[120:123], v[248:251], v[52:55], a[120:123]
    v_accvgpr_read_b32 v58, a2
    v_accvgpr_read_b32 v59, a3
    v_mfma_f32_16x16x32_bf16 a[124:127], v[252:255], v[52:55], a[124:127]
    v_exp_f32 v36, v36
    v_mfma_f32_16x16x32_bf16 v[40:43], v[80:83], v[224:227], 0
    v_exp_f32 v37, v37
    v_mfma_f32_16x16x32_bf16 v[40:43], v[84:87], v[228:231], v[40:43]
    v_exp_f32 v38, v38
    v_mfma_f32_16x16x32_bf16 v[40:43], v[88:91], v[232:235], v[40:43]
    ds_read_b64_tr_b16 a[248:249], v7 offset:200
    v_cvt_pk_bf16_f32 v50, v36, v37
    v_mfma_f32_16x16x32_bf16 v[40:43], v[92:95], v[236:239], v[40:43]
    v_exp_f32 v39, v39
    v_mfma_f32_16x16x32_bf16 v[44:47], v[112:115], v[224:227], 0
    v_accvgpr_read_b32 v60, a4
    v_accvgpr_read_b32 v61, a5
    v_mfma_f32_16x16x32_bf16 v[44:47], v[116:119], v[228:231], v[44:47]
    ds_read_b64_tr_b16 a[250:251], v7 offset:712
    v_cvt_pk_bf16_f32 v51, v38, v39
    v_mfma_f32_16x16x32_bf16 v[44:47], v[120:123], v[232:235], v[44:47]
    v_accvgpr_read_b32 v62, a6
    v_accvgpr_read_b32 v63, a7
    v_mfma_f32_16x16x32_bf16 v[44:47], v[124:127], v[236:239], v[44:47]
    v_mul_f32 v56, v22, v56
    v_mul_f32 v57, v22, v57
    v_mfma_f32_16x16x32_bf16 a[128:131], v[208:211], v[48:51], a[128:131]
    v_exp_f32 v40, v40
    v_mfma_f32_16x16x32_bf16 a[132:135], v[212:215], v[48:51], a[132:135]
    v_exp_f32 v41, v41
    v_mfma_f32_16x16x32_bf16 a[136:139], v[216:219], v[48:51], a[136:139]
    v_cvt_pk_bf16_f32 v52, v40, v41
    v_mul_f32 v58, v22, v58
    v_mfma_f32_16x16x32_bf16 a[140:143], v[220:223], v[48:51], a[140:143]
    v_mul_f32 v59, v22, v59
    v_mul_f32 v60, v22, v60
    v_mfma_f32_16x16x32_bf16 a[144:147], v[240:243], v[48:51], a[144:147]
    v_exp_f32 v42, v42
    v_mfma_f32_16x16x32_bf16 a[148:151], v[244:247], v[48:51], a[148:151]
    v_exp_f32 v43, v43
    v_mfma_f32_16x16x32_bf16 a[152:155], v[248:251], v[48:51], a[152:155]
    v_cvt_pk_bf16_f32 v53, v42, v43
    v_mul_f32 v61, v22, v61
    v_mfma_f32_16x16x32_bf16 a[156:159], v[252:255], v[48:51], a[156:159]
    v_exp_f32 v44, v44
    v_exp_f32 v45, v45
    v_exp_f32 v46, v46
    v_exp_f32 v47, v47
    v_cvt_pk_bf16_f32 v54, v44, v45
    v_cvt_pk_bf16_f32 v55, v46, v47
    s_nop 1
    v_smfmac_f32_16x16x64_bf16 a[200:203], a[216:219], v[48:55], v29
    v_mul_f32 v62, v22, v62
    v_mul_f32 v63, v22, v63
    v_mfma_f32_16x16x32_bf16 a[160:163], v[208:211], v[52:55], a[160:163]
    s_add_u32 s36, s34, 0
    v_cvt_pk_bf16_f32 v24, v56, v57
    v_cvt_pk_bf16_f32 v25, v58, v59
    v_mfma_f32_16x16x32_bf16 a[164:167], v[212:215], v[52:55], a[164:167]
    v_cvt_pk_bf16_f32 v26, v60, v61
    v_cvt_pk_bf16_f32 v27, v62, v63
    v_mfma_f32_16x16x32_bf16 a[168:171], v[216:219], v[52:55], a[168:171]
    buffer_store_dwordx4 v[24:27], v4, s[24:27], s36 offen offset:0 sc1
    v_mfma_f32_16x16x32_bf16 a[172:175], v[220:223], v[52:55], a[172:175]
    v_accvgpr_read_b32 v56, a8
    v_accvgpr_read_b32 v57, a9
    v_mfma_f32_16x16x32_bf16 a[176:179], v[240:243], v[52:55], a[176:179]
    v_accvgpr_read_b32 v58, a10
    v_accvgpr_read_b32 v59, a11
    v_mfma_f32_16x16x32_bf16 a[180:183], v[244:247], v[52:55], a[180:183]
    v_accvgpr_read_b32 v60, a12
    v_accvgpr_read_b32 v61, a13
    v_mfma_f32_16x16x32_bf16 a[184:187], v[248:251], v[52:55], a[184:187]
    v_accvgpr_read_b32 v62, a14
    v_accvgpr_read_b32 v63, a15
    v_mfma_f32_16x16x32_bf16 a[188:191], v[252:255], v[52:55], a[188:191]
    v_mul_f32 v56, v22, v56
    v_mul_f32 v57, v22, v57
    v_mul_f32 v58, v22, v58
    v_mul_f32 v59, v22, v59
    v_mul_f32 v60, v22, v60
    v_mul_f32 v61, v22, v61
    v_mul_f32 v62, v22, v62
    v_mul_f32 v63, v22, v63
    s_add_u32 s36, s34, 196608
    v_cvt_pk_bf16_f32 v24, v56, v57
    v_cvt_pk_bf16_f32 v25, v58, v59
    v_cvt_pk_bf16_f32 v26, v60, v61
    v_cvt_pk_bf16_f32 v27, v62, v63
    buffer_store_dwordx4 v[24:27], v4, s[24:27], s36 offen offset:0 sc1
    s_nop 3
    s_nop 0
    v_accvgpr_read_b32 v56, a16
    v_accvgpr_read_b32 v57, a17
    v_accvgpr_read_b32 v58, a18
    v_accvgpr_read_b32 v59, a19
    v_accvgpr_read_b32 v60, a20
    v_accvgpr_read_b32 v61, a21
    v_accvgpr_read_b32 v62, a22
    v_accvgpr_read_b32 v63, a23
    v_pk_mul_f32 v[56:57], v[56:57], v[22:23] op_sel_hi:[1,0]
    v_pk_mul_f32 v[58:59], v[58:59], v[22:23] op_sel_hi:[1,0]
    v_pk_mul_f32 v[60:61], v[60:61], v[22:23] op_sel_hi:[1,0]
    v_pk_mul_f32 v[62:63], v[62:63], v[22:23] op_sel_hi:[1,0]
    s_add_u32 s36, s34, 393216
    v_cvt_pk_bf16_f32 v24, v56, v57
    v_cvt_pk_bf16_f32 v25, v58, v59
    v_cvt_pk_bf16_f32 v26, v60, v61
    v_cvt_pk_bf16_f32 v27, v62, v63
    buffer_store_dwordx4 v[24:27], v4, s[24:27], s36 offen offset:0 sc1
    ds_read_b128 v[32:35], v6 offset:0
    ds_read_b128 v[36:39], v6 offset:128
    v_accvgpr_read_b32 v56, a24
    v_accvgpr_read_b32 v57, a25
    v_accvgpr_read_b32 v58, a26
    v_accvgpr_read_b32 v59, a27
    v_accvgpr_read_b32 v60, a28
    v_accvgpr_read_b32 v61, a29
    v_accvgpr_read_b32 v62, a30
    v_accvgpr_read_b32 v63, a31
    v_pk_mul_f32 v[56:57], v[56:57], v[22:23] op_sel_hi:[1,0]
    v_pk_mul_f32 v[58:59], v[58:59], v[22:23] op_sel_hi:[1,0]
    v_pk_mul_f32 v[60:61], v[60:61], v[22:23] op_sel_hi:[1,0]
    v_pk_mul_f32 v[62:63], v[62:63], v[22:23] op_sel_hi:[1,0]
    s_add_u32 s36, s34, 589824
    v_cvt_pk_bf16_f32 v24, v56, v57
    v_cvt_pk_bf16_f32 v25, v58, v59
    v_cvt_pk_bf16_f32 v26, v60, v61
    v_cvt_pk_bf16_f32 v27, v62, v63
    buffer_store_dwordx4 v[24:27], v4, s[24:27], s36 offen offset:0 sc1
    ds_read_b128 v[40:43], v6 offset:512
    ds_read_b128 v[44:47], v6 offset:640
    v_accvgpr_read_b32 v22, a194
    v_accvgpr_read_b32 v23, a195
    v_add_f32 v22, v22, v23
    v_subrev_u32 v23, s46, v22
    v_rcp_f32 v22, v22
    v_max_u32 v28, v28, v23
    v_accvgpr_read_b32 v56, a32
    v_accvgpr_read_b32 v57, a33
    v_accvgpr_read_b32 v58, a34
    v_accvgpr_read_b32 v59, a35
    v_accvgpr_read_b32 v60, a36
    v_accvgpr_read_b32 v61, a37
    v_accvgpr_read_b32 v62, a38
    v_accvgpr_read_b32 v63, a39
    v_pk_mul_f32 v[56:57], v[56:57], v[22:23] op_sel_hi:[1,0]
    v_pk_mul_f32 v[58:59], v[58:59], v[22:23] op_sel_hi:[1,0]
    v_pk_mul_f32 v[60:61], v[60:61], v[22:23] op_sel_hi:[1,0]
    v_pk_mul_f32 v[62:63], v[62:63], v[22:23] op_sel_hi:[1,0]
    s_add_u32 s36, s34, 0
    s_nop 0
    v_cvt_pk_bf16_f32 v24, v56, v57
    v_cvt_pk_bf16_f32 v25, v58, v59
    v_cvt_pk_bf16_f32 v26, v60, v61
    v_cvt_pk_bf16_f32 v27, v62, v63
    buffer_store_dwordx4 v[24:27], v4, s[24:27], s36 offen offset:1024 sc1
    ds_read_b128 v[48:51], v6 offset:1024
    ds_read_b128 v[52:55], v6 offset:1152
    v_accvgpr_read_b32 v56, a40
    v_accvgpr_read_b32 v57, a41
    v_accvgpr_read_b32 v58, a42
    v_accvgpr_read_b32 v59, a43
    v_accvgpr_read_b32 v60, a44
    v_accvgpr_read_b32 v61, a45
    v_accvgpr_read_b32 v62, a46
    v_accvgpr_read_b32 v63, a47
    v_pk_mul_f32 v[56:57], v[56:57], v[22:23] op_sel_hi:[1,0]
    v_pk_mul_f32 v[58:59], v[58:59], v[22:23] op_sel_hi:[1,0]
    v_pk_mul_f32 v[60:61], v[60:61], v[22:23] op_sel_hi:[1,0]
    v_pk_mul_f32 v[62:63], v[62:63], v[22:23] op_sel_hi:[1,0]
    s_add_u32 s36, s34, 196608
    v_cvt_pk_bf16_f32 v24, v56, v57
    v_cvt_pk_bf16_f32 v25, v58, v59
    v_cvt_pk_bf16_f32 v26, v60, v61
    v_cvt_pk_bf16_f32 v27, v62, v63
    buffer_store_dwordx4 v[24:27], v4, s[24:27], s36 offen offset:1024 sc1
    v_accvgpr_read_b32 v56, a48
    v_accvgpr_read_b32 v57, a49
    v_accvgpr_read_b32 v58, a50
    v_accvgpr_read_b32 v59, a51
    v_accvgpr_read_b32 v60, a52
    v_accvgpr_read_b32 v61, a53
    v_accvgpr_read_b32 v62, a54
    v_accvgpr_read_b32 v63, a55
    v_pk_mul_f32 v[56:57], v[56:57], v[22:23] op_sel_hi:[1,0]
    v_pk_mul_f32 v[58:59], v[58:59], v[22:23] op_sel_hi:[1,0]
    v_pk_mul_f32 v[60:61], v[60:61], v[22:23] op_sel_hi:[1,0]
    v_pk_mul_f32 v[62:63], v[62:63], v[22:23] op_sel_hi:[1,0]
    s_add_u32 s36, s34, 393216
    v_cvt_pk_bf16_f32 v24, v56, v57
    v_cvt_pk_bf16_f32 v25, v58, v59
    v_cvt_pk_bf16_f32 v26, v60, v61
    v_cvt_pk_bf16_f32 v27, v62, v63
    buffer_store_dwordx4 v[24:27], v4, s[24:27], s36 offen offset:1024 sc1
    s_mov_b32 s37, 1
    s_xor_b32 s75, s75, 262144
K1_Q1:
    s_waitcnt vmcnt(31) lgkmcnt(0)
    s_barrier
    v_mfma_f32_16x16x32_bf16 v[64:67], a[220:223], v[32:35], 0
    ds_read_b64_tr_b16 a[0:1], v7 offset:17440
    v_accvgpr_read_b32 v56, a56
    v_mfma_f32_16x16x32_bf16 v[68:71], a[224:227], v[32:35], 0
    ds_read_b64_tr_b16 a[2:3], v7 offset:17952
    v_accvgpr_read_b32 v57, a57
    v_mfma_f32_16x16x32_bf16 v[72:75], a[228:231], v[32:35], 0
    s_add_u32 m0, s29, 24832
    s_xor_b32 s35, s61, 1310720
    v_accvgpr_read_b32 v58, a58
    v_mfma_f32_16x16x32_bf16 v[76:79], a[232:235], v[32:35], 0
    buffer_load_dwordx4 v2, s[12:15], s35 offen lds
    v_mfma_f32_16x16x32_bf16 v[80:83], a[236:239], v[32:35], 0
    ds_read_b64_tr_b16 a[4:5], v7 offset:17448
    v_accvgpr_read_b32 v59, a59
    v_mfma_f32_16x16x32_bf16 v[84:87], a[240:243], v[32:35], 0
    v_accvgpr_read_b32 v60, a60
    v_accvgpr_read_b32 v61, a61
    v_mfma_f32_16x16x32_bf16 v[88:91], a[244:247], v[32:35], 0
    ds_read_b64_tr_b16 a[6:7], v7 offset:17960
    v_accvgpr_read_b32 v62, a62
    v_mfma_f32_16x16x32_bf16 v[92:95], a[248:251], v[32:35], 0
    ds_read_b64_tr_b16 a[8:9], v7 offset:17504
    v_accvgpr_read_b32 v63, a63
    v_mfma_f32_16x16x32_bf16 v[124:127], a[248:251], v[36:39], 0
    v_mul_f32 v56, v22, v56
    v_mul_f32 v57, v22, v57
    v_mfma_f32_16x16x32_bf16 v[120:123], a[244:247], v[36:39], 0
    ds_read_b64_tr_b16 a[10:11], v7 offset:18016
    v_mul_f32 v58, v22, v58
    v_mfma_f32_16x16x32_bf16 v[116:119], a[240:243], v[36:39], 0
    s_add_u32 m0, s29, 25920
    s_xor_b32 s35, s61, 1318912
    v_mul_f32 v59, v22, v59
    v_mfma_f32_16x16x32_bf16 v[112:115], a[236:239], v[36:39], 0
    buffer_load_dwordx4 v2, s[12:15], s35 offen lds
    v_mfma_f32_16x16x32_bf16 v[108:111], a[232:235], v[36:39], 0
    ds_read_b64_tr_b16 a[12:13], v7 offset:17512
    v_mul_f32 v60, v22, v60
    v_mfma_f32_16x16x32_bf16 v[104:107], a[228:231], v[36:39], 0
    ds_read_b64_tr_b16 a[14:15], v7 offset:18024
    v_mul_f32 v61, v22, v61
    v_mfma_f32_16x16x32_bf16 v[100:103], a[224:227], v[36:39], 0
    v_mul_f32 v62, v22, v62
    v_mul_f32 v63, v22, v63
    v_mfma_f32_16x16x32_bf16 v[96:99], a[220:223], v[36:39], 0
    s_add_u32 s36, s34, 589824
    ds_read_b64_tr_b16 a[16:17], v7 offset:17568
    v_cvt_pk_bf16_f32 v24, v56, v57
    v_mfma_f32_16x16x32_bf16 v[128:131], a[220:223], v[40:43], 0
    v_cvt_pk_bf16_f32 v25, v58, v59
    v_cvt_pk_bf16_f32 v26, v60, v61
    v_mfma_f32_16x16x32_bf16 v[132:135], a[224:227], v[40:43], 0
    ds_read_b64_tr_b16 a[18:19], v7 offset:18080
    v_cvt_pk_bf16_f32 v27, v62, v63
    v_mfma_f32_16x16x32_bf16 v[136:139], a[228:231], v[40:43], 0
    s_add_u32 m0, s29, 27008
    s_xor_b32 s35, s61, 1327104
    ds_read_b64_tr_b16 a[20:21], v7 offset:17576
    v_mfma_f32_16x16x32_bf16 v[140:143], a[232:235], v[40:43], 0
    buffer_load_dwordx4 v2, s[12:15], s35 offen lds
    v_mfma_f32_16x16x32_bf16 v[144:147], a[236:239], v[40:43], 0
    v_accvgpr_read_b32 v22, a198
    v_accvgpr_read_b32 v23, a199
    v_mfma_f32_16x16x32_bf16 v[148:151], a[240:243], v[40:43], 0
    ds_read_b64_tr_b16 a[22:23], v7 offset:18088
    v_add_f32 v22, v22, v23
    v_mfma_f32_16x16x32_bf16 v[152:155], a[244:247], v[40:43], 0
    buffer_store_dwordx4 v[24:27], v4, s[24:27], s36 offen offset:1024 sc1
    v_mfma_f32_16x16x32_bf16 v[156:159], a[248:251], v[40:43], 0
    ds_read_b64_tr_b16 a[24:25], v7 offset:17632
    v_subrev_u32 v23, s46, v22
    v_mfma_f32_16x16x32_bf16 v[188:191], a[248:251], v[44:47], 0
    ds_read_b64_tr_b16 a[26:27], v7 offset:18144
    v_mfma_f32_16x16x32_bf16 v[184:187], a[244:247], v[44:47], 0
    v_rcp_f32 v22, v22
    v_mfma_f32_16x16x32_bf16 v[180:183], a[240:243], v[44:47], 0
    s_add_u32 m0, s29, 28096
    s_xor_b32 s35, s61, 1335296
    ds_read_b64_tr_b16 a[28:29], v7 offset:17640
    v_mfma_f32_16x16x32_bf16 v[176:179], a[236:239], v[44:47], 0
    buffer_load_dwordx4 v2, s[12:15], s35 offen lds
    v_mfma_f32_16x16x32_bf16 v[172:175], a[232:235], v[44:47], 0
    v_max_u32 v28, v28, v23
    v_accvgpr_read_b32 v56, a96
    v_mfma_f32_16x16x32_bf16 v[168:171], a[228:231], v[44:47], 0
    ds_read_b64_tr_b16 a[30:31], v7 offset:18152
    v_accvgpr_read_b32 v57, a97
    v_mfma_f32_16x16x32_bf16 v[164:167], a[224:227], v[44:47], 0
    ds_read_b128 a[32:35], v6 offset:64
    v_accvgpr_read_b32 v58, a98
    v_mfma_f32_16x16x32_bf16 v[160:163], a[220:223], v[44:47], 0
    v_accvgpr_read_b32 v59, a99
    v_accvgpr_read_b32 v60, a100
    v_mfma_f32_16x16x32_bf16 v[192:195], a[220:223], v[48:51], 0
    ds_read_b128 a[36:39], v6 offset:192
    v_accvgpr_read_b32 v61, a101
    v_mfma_f32_16x16x32_bf16 v[196:199], a[224:227], v[48:51], 0
    v_accvgpr_read_b32 v62, a102
    v_accvgpr_read_b32 v63, a103
    v_mfma_f32_16x16x32_bf16 v[200:203], a[228:231], v[48:51], 0
    ds_read_b128 a[40:43], v6 offset:576
    v_mul_f32 v56, v22, v56
    v_mfma_f32_16x16x32_bf16 v[204:207], a[232:235], v[48:51], 0
    ds_read_b128 a[44:47], v6 offset:704
    v_mul_f32 v57, v22, v57
    v_mfma_f32_16x16x32_bf16 v[208:211], a[236:239], v[48:51], 0
    v_mul_f32 v58, v22, v58
    v_mul_f32 v59, v22, v59
    v_mfma_f32_16x16x32_bf16 v[212:215], a[240:243], v[48:51], 0
    ds_read_b128 a[48:51], v6 offset:1088
    v_mul_f32 v60, v22, v60
    v_mfma_f32_16x16x32_bf16 v[216:219], a[244:247], v[48:51], 0
    v_mul_f32 v61, v22, v61
    v_mul_f32 v62, v22, v62
    v_mfma_f32_16x16x32_bf16 v[220:223], a[248:251], v[48:51], 0
    ds_read_b128 a[52:55], v6 offset:1216
    v_mul_f32 v63, v22, v63
    v_mfma_f32_16x16x32_bf16 v[252:255], a[248:251], v[52:55], 0
    s_add_u32 s36, s34, 0
    v_cvt_pk_bf16_f32 v24, v56, v57
    v_cvt_pk_bf16_f32 v25, v58, v59
    v_mfma_f32_16x16x32_bf16 v[248:251], a[244:247], v[52:55], 0
    v_cvt_pk_bf16_f32 v26, v60, v61
    v_cvt_pk_bf16_f32 v27, v62, v63
    v_mfma_f32_16x16x32_bf16 v[244:247], a[240:243], v[52:55], 0
    buffer_store_dwordx4 v[24:27], v4, s[24:27], s36 offen offset:3072 sc1
    v_mfma_f32_16x16x32_bf16 v[240:243], a[236:239], v[52:55], 0
    v_mfma_f32_16x16x32_bf16 v[236:239], a[232:235], v[52:55], 0
    v_accvgpr_read_b32 v56, a104
    v_accvgpr_read_b32 v57, a105
    v_mfma_f32_16x16x32_bf16 v[232:235], a[228:231], v[52:55], 0
    v_accvgpr_read_b32 v58, a106
    v_accvgpr_read_b32 v59, a107
    v_mfma_f32_16x16x32_bf16 v[228:231], a[224:227], v[52:55], 0
    v_accvgpr_read_b32 v60, a108
    v_accvgpr_read_b32 v61, a109
    v_mfma_f32_16x16x32_bf16 v[224:227], a[220:223], v[52:55], 0
    s_waitcnt vmcnt(27) lgkmcnt(0)
    s_barrier
    v_mfma_f32_16x16x32_bf16 v[64:67], a[0:3], a[32:35], v[64:67]
    ds_read_b64_tr_b16 a[220:221], v7 offset:59712
    v_accvgpr_read_b32 v62, a110
    v_mfma_f32_16x16x32_bf16 v[68:71], a[4:7], a[32:35], v[68:71]
    ds_read_b64_tr_b16 a[222:223], v7 offset:60224
    v_accvgpr_read_b32 v63, a111
    v_mfma_f32_16x16x32_bf16 v[72:75], a[8:11], a[32:35], v[72:75]
    s_add_u32 m0, s28, 136864
    s_xor_b32 s35, s60, 384
    ds_read_b64_tr_b16 a[224:225], v7 offset:59720
    v_mfma_f32_16x16x32_bf16 v[76:79], a[12:15], a[32:35], v[76:79]
    buffer_load_dwordx4 v1, s[8:11], s35 offen offset:0 lds
    v_mfma_f32_16x16x32_bf16 v[80:83], a[16:19], a[32:35], v[80:83]
    v_mul_f32 v56, v22, v56
    v_mul_f32 v57, v22, v57
    v_mfma_f32_16x16x32_bf16 v[84:87], a[20:23], a[32:35], v[84:87]
    ds_read_b64_tr_b16 a[226:227], v7 offset:60232
    v_mul_f32 v58, v22, v58
    v_mfma_f32_16x16x32_bf16 v[88:91], a[24:27], a[32:35], v[88:91]
    s_add_u32 m0, s28, 138688
    ds_read_b64_tr_b16 a[228:229], v7 offset:59776
    v_mul_f32 v59, v22, v59
    v_mfma_f32_16x16x32_bf16 v[92:95], a[28:31], a[32:35], v[92:95]
    buffer_load_dwordx4 v1, s[8:11], s35 offen offset:1280 lds
    v_mfma_f32_16x16x32_bf16 v[124:127], a[28:31], a[36:39], v[124:127]
    v_mul_f32 v60, v22, v60
    v_mul_f32 v61, v22, v61
    v_mfma_f32_16x16x32_bf16 v[120:123], a[24:27], a[36:39], v[120:123]
    ds_read_b64_tr_b16 a[230:231], v7 offset:60288
    v_mul_f32 v62, v22, v62
    v_mfma_f32_16x16x32_bf16 v[116:119], a[20:23], a[36:39], v[116:119]
    s_add_u32 m0, s28, 137888
    s_xor_b32 s35, s60, 82304
    ds_read_b64_tr_b16 a[232:233], v7 offset:59784
    v_mfma_f32_16x16x32_bf16 v[112:115], a[16:19], a[36:39], v[112:115]
    buffer_load_dwordx4 v1, s[8:11], s35 offen offset:0 lds
    v_mfma_f32_16x16x32_bf16 v[108:111], a[12:15], a[36:39], v[108:111]
    ds_read_b64_tr_b16 a[234:235], v7 offset:60296
    v_mul_f32 v63, v22, v63
    v_mfma_f32_16x16x32_bf16 v[104:107], a[8:11], a[36:39], v[104:107]
    s_add_u32 s36, s34, 196608
    v_cvt_pk_bf16_f32 v24, v56, v57
    v_cvt_pk_bf16_f32 v25, v58, v59
    v_mfma_f32_16x16x32_bf16 v[100:103], a[4:7], a[36:39], v[100:103]
    s_add_u32 m0, s28, 139712
    ds_read_b64_tr_b16 a[236:237], v7 offset:59840
    v_cvt_pk_bf16_f32 v26, v60, v61
    v_mfma_f32_16x16x32_bf16 v[96:99], a[0:3], a[36:39], v[96:99]
    buffer_load_dwordx4 v1, s[8:11], s35 offen offset:1280 lds
    v_mfma_f32_16x16x32_bf16 v[128:131], a[0:3], a[40:43], v[128:131]
    ds_read_b64_tr_b16 a[238:239], v7 offset:60352
    v_cvt_pk_bf16_f32 v27, v62, v63
    v_mfma_f32_16x16x32_bf16 v[132:135], a[4:7], a[40:43], v[132:135]
    buffer_store_dwordx4 v[24:27], v4, s[24:27], s36 offen offset:3072 sc1
    v_mfma_f32_16x16x32_bf16 v[136:139], a[8:11], a[40:43], v[136:139]
    s_add_u32 m0, s28, 138912
    s_xor_b32 s35, s60, 164224
    ds_read_b64_tr_b16 a[240:241], v7 offset:59848
    v_mfma_f32_16x16x32_bf16 v[140:143], a[12:15], a[40:43], v[140:143]
    buffer_load_dwordx4 v1, s[8:11], s35 offen offset:0 lds
    v_mfma_f32_16x16x32_bf16 v[144:147], a[16:19], a[40:43], v[144:147]
    ds_read_b64_tr_b16 a[242:243], v7 offset:60360
    v_accvgpr_read_b32 v56, a112
    v_mfma_f32_16x16x32_bf16 v[148:151], a[20:23], a[40:43], v[148:151]
    ds_read_b64_tr_b16 a[244:245], v7 offset:59904
    v_accvgpr_read_b32 v57, a113
    v_mfma_f32_16x16x32_bf16 v[152:155], a[24:27], a[40:43], v[152:155]
    s_add_u32 m0, s28, 140736
    v_accvgpr_read_b32 v58, a114
    v_accvgpr_read_b32 v59, a115
    v_mfma_f32_16x16x32_bf16 v[156:159], a[28:31], a[40:43], v[156:159]
    buffer_load_dwordx4 v1, s[8:11], s35 offen offset:1280 lds
    v_mfma_f32_16x16x32_bf16 v[188:191], a[28:31], a[44:47], v[188:191]
    ds_read_b64_tr_b16 a[246:247], v7 offset:60416
    v_accvgpr_read_b32 v60, a116
    v_mfma_f32_16x16x32_bf16 v[184:187], a[24:27], a[44:47], v[184:187]
    ds_read_b64_tr_b16 a[248:249], v7 offset:59912
    v_accvgpr_read_b32 v61, a117
    v_mfma_f32_16x16x32_bf16 v[180:183], a[20:23], a[44:47], v[180:183]
    s_add_u32 m0, s29, 42272
    s_xor_b32 s35, s61, 1572864
    v_accvgpr_read_b32 v62, a118
    v_mfma_f32_16x16x32_bf16 v[176:179], a[16:19], a[44:47], v[176:179]
    buffer_load_dwordx4 v2, s[12:15], s35 offen lds
    v_mfma_f32_16x16x32_bf16 v[172:175], a[12:15], a[44:47], v[172:175]
    ds_read_b64_tr_b16 a[250:251], v7 offset:60424
    v_accvgpr_read_b32 v63, a119
    v_mfma_f32_16x16x32_bf16 v[168:171], a[8:11], a[44:47], v[168:171]
    ds_read_b128 v[32:35], v5 offset:0
    v_mul_f32 v56, v22, v56
    v_mfma_f32_16x16x32_bf16 v[164:167], a[4:7], a[44:47], v[164:167]
    s_add_u32 m0, s29, 43360
    s_xor_b32 s35, s61, 1581056
    ds_read_b128 v[36:39], v5 offset:128
    v_mfma_f32_16x16x32_bf16 v[160:163], a[0:3], a[44:47], v[160:163]
    buffer_load_dwordx4 v2, s[12:15], s35 offen lds
    v_mfma_f32_16x16x32_bf16 v[192:195], a[0:3], a[48:51], v[192:195]
    v_mul_f32 v57, v22, v57
    v_mul_f32 v58, v22, v58
    v_mfma_f32_16x16x32_bf16 v[196:199], a[4:7], a[48:51], v[196:199]
    ds_read_b128 v[40:43], v5 offset:512
    v_mul_f32 v59, v22, v59
    v_mfma_f32_16x16x32_bf16 v[200:203], a[8:11], a[48:51], v[200:203]
    s_add_u32 m0, s29, 44448
    s_xor_b32 s35, s61, 1589248
    ds_read_b128 v[44:47], v5 offset:640
    v_mfma_f32_16x16x32_bf16 v[204:207], a[12:15], a[48:51], v[204:207]
    buffer_load_dwordx4 v2, s[12:15], s35 offen lds
    v_mfma_f32_16x16x32_bf16 v[208:211], a[16:19], a[48:51], v[208:211]
    v_mul_f32 v60, v22, v60
    v_mul_f32 v61, v22, v61
    v_mfma_f32_16x16x32_bf16 v[212:215], a[20:23], a[48:51], v[212:215]
    ds_read_b128 v[48:51], v5 offset:1024
    v_mul_f32 v62, v22, v62
    v_mfma_f32_16x16x32_bf16 v[216:219], a[24:27], a[48:51], v[216:219]
    s_add_u32 m0, s29, 45536
    s_xor_b32 s35, s61, 1597440
    ds_read_b128 v[52:55], v5 offset:1152
    v_mfma_f32_16x16x32_bf16 v[220:223], a[28:31], a[48:51], v[220:223]
    buffer_load_dwordx4 v2, s[12:15], s35 offen lds
    v_mfma_f32_16x16x32_bf16 v[252:255], a[28:31], a[52:55], v[252:255]
    v_mul_f32 v63, v22, v63
    v_mfma_f32_16x16x32_bf16 v[248:251], a[24:27], a[52:55], v[248:251]
    s_add_u32 s36, s34, 393216
    v_cvt_pk_bf16_f32 v24, v56, v57
    v_cvt_pk_bf16_f32 v25, v58, v59
    v_mfma_f32_16x16x32_bf16 v[244:247], a[20:23], a[52:55], v[244:247]
    v_cvt_pk_bf16_f32 v26, v60, v61
    v_cvt_pk_bf16_f32 v27, v62, v63
    v_mfma_f32_16x16x32_bf16 v[240:243], a[16:19], a[52:55], v[240:243]
    buffer_store_dwordx4 v[24:27], v4, s[24:27], s36 offen offset:3072 sc1
    v_mfma_f32_16x16x32_bf16 v[236:239], a[12:15], a[52:55], v[236:239]
    v_mfma_f32_16x16x32_bf16 v[232:235], a[8:11], a[52:55], v[232:235]
    v_accvgpr_read_b32 v56, a120
    v_accvgpr_read_b32 v57, a121
    v_mfma_f32_16x16x32_bf16 v[228:231], a[4:7], a[52:55], v[228:231]
    v_accvgpr_read_b32 v58, a122
    v_accvgpr_read_b32 v59, a123
    v_mfma_f32_16x16x32_bf16 v[224:227], a[0:3], a[52:55], v[224:227]
    s_waitcnt vmcnt(29) lgkmcnt(0)
    s_barrier
    v_mfma_f32_16x16x32_bf16 v[64:67], a[220:223], v[32:35], v[64:67]
    ds_read_b64_tr_b16 a[0:1], v8 offset:0
    v_accvgpr_read_b32 v60, a124
    v_mfma_f32_16x16x32_bf16 v[68:71], a[224:227], v[32:35], v[68:71]
    ds_read_b64_tr_b16 a[2:3], v8 offset:512
    v_accvgpr_read_b32 v61, a125
    v_mfma_f32_16x16x32_bf16 v[72:75], a[228:231], v[32:35], v[72:75]
    s_add_u32 m0, s29, 84544
    s_xor_b32 s35, s61, 1835008
    v_accvgpr_read_b32 v62, a126
    v_mfma_f32_16x16x32_bf16 v[76:79], a[232:235], v[32:35], v[76:79]
    buffer_load_dwordx4 v2, s[12:15], s35 offen lds
    v_mfma_f32_16x16x32_bf16 v[80:83], a[236:239], v[32:35], v[80:83]
    ds_read_b64_tr_b16 a[4:5], v8 offset:8
    v_accvgpr_read_b32 v63, a127
    v_mfma_f32_16x16x32_bf16 v[84:87], a[240:243], v[32:35], v[84:87]
    v_mul_f32 v56, v22, v56
    v_mul_f32 v57, v22, v57
    v_mfma_f32_16x16x32_bf16 v[88:91], a[244:247], v[32:35], v[88:91]
    ds_read_b64_tr_b16 a[6:7], v8 offset:520
    v_mul_f32 v58, v22, v58
    v_mfma_f32_16x16x32_bf16 v[92:95], a[248:251], v[32:35], v[92:95]
    ds_read_b64_tr_b16 a[8:9], v8 offset:64
    v_mul_f32 v59, v22, v59
    v_mfma_f32_16x16x32_bf16 v[124:127], a[248:251], v[36:39], v[124:127]
    v_mul_f32 v60, v22, v60
    v_mul_f32 v61, v22, v61
    v_mfma_f32_16x16x32_bf16 v[120:123], a[244:247], v[36:39], v[120:123]
    ds_read_b64_tr_b16 a[10:11], v8 offset:576
    v_mul_f32 v62, v22, v62
    v_mfma_f32_16x16x32_bf16 v[116:119], a[240:243], v[36:39], v[116:119]
    s_add_u32 m0, s29, 85632
    s_xor_b32 s35, s61, 1843200
    v_mul_f32 v63, v22, v63
    v_mfma_f32_16x16x32_bf16 v[112:115], a[236:239], v[36:39], v[112:115]
    s_add_u32 s36, s34, 589824
    buffer_load_dwordx4 v2, s[12:15], s35 offen lds
    v_mfma_f32_16x16x32_bf16 v[108:111], a[232:235], v[36:39], v[108:111]
    ds_read_b64_tr_b16 a[12:13], v8 offset:72
    v_cvt_pk_bf16_f32 v24, v56, v57
    v_mfma_f32_16x16x32_bf16 v[104:107], a[228:231], v[36:39], v[104:107]
    ds_read_b64_tr_b16 a[14:15], v8 offset:584
    v_cvt_pk_bf16_f32 v25, v58, v59
    v_mfma_f32_16x16x32_bf16 v[100:103], a[224:227], v[36:39], v[100:103]
    v_cvt_pk_bf16_f32 v26, v60, v61
    v_cvt_pk_bf16_f32 v27, v62, v63
    v_mfma_f32_16x16x32_bf16 v[96:99], a[220:223], v[36:39], v[96:99]
    ds_read_b64_tr_b16 a[16:17], v8 offset:128
    v_mfma_f32_16x16x32_bf16 v[128:131], a[220:223], v[40:43], v[128:131]
    buffer_store_dwordx4 v[24:27], v4, s[24:27], s36 offen offset:3072 sc1
    v_mfma_f32_16x16x32_bf16 v[132:135], a[224:227], v[40:43], v[132:135]
    ds_read_b64_tr_b16 a[18:19], v8 offset:640
    v_accvgpr_read_b32 v22, a196
    v_mfma_f32_16x16x32_bf16 v[136:139], a[228:231], v[40:43], v[136:139]
    s_add_u32 m0, s29, 86720
    s_xor_b32 s35, s61, 1851392
    ds_read_b64_tr_b16 a[20:21], v8 offset:136
    v_mfma_f32_16x16x32_bf16 v[140:143], a[232:235], v[40:43], v[140:143]
    buffer_load_dwordx4 v2, s[12:15], s35 offen lds
    v_mfma_f32_16x16x32_bf16 v[144:147], a[236:239], v[40:43], v[144:147]
    v_accvgpr_read_b32 v23, a197
    v_add_f32 v22, v22, v23
    v_mfma_f32_16x16x32_bf16 v[148:151], a[240:243], v[40:43], v[148:151]
    ds_read_b64_tr_b16 a[22:23], v8 offset:648
    v_subrev_u32 v23, s46, v22
    v_mfma_f32_16x16x32_bf16 v[152:155], a[244:247], v[40:43], v[152:155]
    v_rcp_f32 v22, v22
    v_mfma_f32_16x16x32_bf16 v[156:159], a[248:251], v[40:43], v[156:159]
    ds_read_b64_tr_b16 a[24:25], v8 offset:192
    v_max_u32 v28, v28, v23
    v_mfma_f32_16x16x32_bf16 v[188:191], a[248:251], v[44:47], v[188:191]
    ds_read_b64_tr_b16 a[26:27], v8 offset:704
    v_accvgpr_read_b32 v56, a64
    v_mfma_f32_16x16x32_bf16 v[184:187], a[244:247], v[44:47], v[184:187]
    v_accvgpr_read_b32 v57, a65
    v_accvgpr_read_b32 v58, a66
    v_mfma_f32_16x16x32_bf16 v[180:183], a[240:243], v[44:47], v[180:183]
    s_add_u32 m0, s29, 87808
    s_xor_b32 s35, s61, 1859584
    ds_read_b64_tr_b16 a[28:29], v8 offset:200
    v_mfma_f32_16x16x32_bf16 v[176:179], a[236:239], v[44:47], v[176:179]
    buffer_load_dwordx4 v2, s[12:15], s35 offen lds
    v_mfma_f32_16x16x32_bf16 v[172:175], a[232:235], v[44:47], v[172:175]
    v_accvgpr_read_b32 v59, a67
    v_accvgpr_read_b32 v60, a68
    v_mfma_f32_16x16x32_bf16 v[168:171], a[228:231], v[44:47], v[168:171]
    ds_read_b64_tr_b16 a[30:31], v8 offset:712
    v_accvgpr_read_b32 v61, a69
    v_mfma_f32_16x16x32_bf16 v[164:167], a[224:227], v[44:47], v[164:167]
    ds_read_b128 a[32:35], v5 offset:64
    v_accvgpr_read_b32 v62, a70
    v_mfma_f32_16x16x32_bf16 v[160:163], a[220:223], v[44:47], v[160:163]
    v_accvgpr_read_b32 v63, a71
    v_mul_f32 v56, v22, v56
    v_mfma_f32_16x16x32_bf16 v[192:195], a[220:223], v[48:51], v[192:195]
    ds_read_b128 a[36:39], v5 offset:192
    v_mul_f32 v57, v22, v57
    v_mfma_f32_16x16x32_bf16 v[196:199], a[224:227], v[48:51], v[196:199]
    v_mul_f32 v58, v22, v58
    v_mul_f32 v59, v22, v59
    v_mfma_f32_16x16x32_bf16 v[200:203], a[228:231], v[48:51], v[200:203]
    ds_read_b128 a[40:43], v5 offset:576
    v_mul_f32 v60, v22, v60
    v_mfma_f32_16x16x32_bf16 v[204:207], a[232:235], v[48:51], v[204:207]
    ds_read_b128 a[44:47], v5 offset:704
    v_mul_f32 v61, v22, v61
    v_mfma_f32_16x16x32_bf16 v[208:211], a[236:239], v[48:51], v[208:211]
    v_mul_f32 v62, v22, v62
    v_mul_f32 v63, v22, v63
    v_mfma_f32_16x16x32_bf16 v[212:215], a[240:243], v[48:51], v[212:215]
    s_add_u32 s36, s34, 0
    ds_read_b128 a[48:51], v5 offset:1088
    v_cvt_pk_bf16_f32 v24, v56, v57
    v_mfma_f32_16x16x32_bf16 v[216:219], a[244:247], v[48:51], v[216:219]
    v_cvt_pk_bf16_f32 v25, v58, v59
    v_cvt_pk_bf16_f32 v26, v60, v61
    v_mfma_f32_16x16x32_bf16 v[220:223], a[248:251], v[48:51], v[220:223]
    ds_read_b128 a[52:55], v5 offset:1216
    v_cvt_pk_bf16_f32 v27, v62, v63
    v_mfma_f32_16x16x32_bf16 v[252:255], a[248:251], v[52:55], v[252:255]
    buffer_store_dwordx4 v[24:27], v4, s[24:27], s36 offen offset:2048 sc1
    v_mfma_f32_16x16x32_bf16 v[248:251], a[244:247], v[52:55], v[248:251]
    v_mfma_f32_16x16x32_bf16 v[244:247], a[240:243], v[52:55], v[244:247]
    v_accvgpr_read_b32 v56, a72
    v_accvgpr_read_b32 v57, a73
    v_mfma_f32_16x16x32_bf16 v[240:243], a[236:239], v[52:55], v[240:243]
    v_accvgpr_read_b32 v58, a74
    v_accvgpr_read_b32 v59, a75
    v_mfma_f32_16x16x32_bf16 v[236:239], a[232:235], v[52:55], v[236:239]
    v_accvgpr_read_b32 v60, a76
    v_accvgpr_read_b32 v61, a77
    v_mfma_f32_16x16x32_bf16 v[232:235], a[228:231], v[52:55], v[232:235]
    v_accvgpr_read_b32 v62, a78
    v_accvgpr_read_b32 v63, a79
    v_mfma_f32_16x16x32_bf16 v[228:231], a[224:227], v[52:55], v[228:231]
    v_mul_f32 v56, v22, v56
    v_mul_f32 v57, v22, v57
    v_mfma_f32_16x16x32_bf16 v[224:227], a[220:223], v[52:55], v[224:227]
    s_waitcnt vmcnt(31) lgkmcnt(0)
    s_barrier
    v_mfma_f32_16x16x32_bf16 v[64:67], a[0:3], a[32:35], v[64:67]
    ds_read_b64_tr_b16 a[220:221], v8 offset:17440
    v_mul_f32 v58, v22, v58
    v_mfma_f32_16x16x32_bf16 v[68:71], a[4:7], a[32:35], v[68:71]
    ds_read_b64_tr_b16 a[222:223], v8 offset:17952
    v_mul_f32 v59, v22, v59
    v_mfma_f32_16x16x32_bf16 v[72:75], a[8:11], a[32:35], v[72:75]
    s_add_u32 m0, s28, 0
    s_xor_b32 s35, s60, 512
    ds_read_b64_tr_b16 a[224:225], v8 offset:17448
    v_mfma_f32_16x16x32_bf16 v[76:79], a[12:15], a[32:35], v[76:79]
    buffer_load_dwordx4 v1, s[8:11], s35 offen offset:0 lds
    v_mfma_f32_16x16x32_bf16 v[80:83], a[16:19], a[32:35], v[80:83]
    v_mul_f32 v60, v22, v60
    v_mul_f32 v61, v22, v61
    v_mfma_f32_16x16x32_bf16 v[84:87], a[20:23], a[32:35], v[84:87]
    ds_read_b64_tr_b16 a[226:227], v8 offset:17960
    v_mul_f32 v62, v22, v62
    v_mfma_f32_16x16x32_bf16 v[88:91], a[24:27], a[32:35], v[88:91]
    s_add_u32 m0, s28, 1824
    ds_read_b64_tr_b16 a[228:229], v8 offset:17504
    v_mul_f32 v63, v22, v63
    v_mfma_f32_16x16x32_bf16 v[92:95], a[28:31], a[32:35], v[92:95]
    s_add_u32 s36, s34, 196608
    buffer_load_dwordx4 v1, s[8:11], s35 offen offset:1280 lds
    v_mfma_f32_16x16x32_bf16 v[124:127], a[28:31], a[36:39], v[124:127]
    v_cvt_pk_bf16_f32 v24, v56, v57
    v_cvt_pk_bf16_f32 v25, v58, v59
    v_mfma_f32_16x16x32_bf16 v[120:123], a[24:27], a[36:39], v[120:123]
    ds_read_b64_tr_b16 a[230:231], v8 offset:18016
    v_cvt_pk_bf16_f32 v26, v60, v61
    v_mfma_f32_16x16x32_bf16 v[116:119], a[20:23], a[36:39], v[116:119]
    s_add_u32 m0, s28, 1024
    s_xor_b32 s35, s60, 82432
    ds_read_b64_tr_b16 a[232:233], v8 offset:17512
    v_mfma_f32_16x16x32_bf16 v[112:115], a[16:19], a[36:39], v[112:115]
    buffer_load_dwordx4 v1, s[8:11], s35 offen offset:0 lds
    v_mfma_f32_16x16x32_bf16 v[108:111], a[12:15], a[36:39], v[108:111]
    ds_read_b64_tr_b16 a[234:235], v8 offset:18024
    v_cvt_pk_bf16_f32 v27, v62, v63
    v_mfma_f32_16x16x32_bf16 v[104:107], a[8:11], a[36:39], v[104:107]
    buffer_store_dwordx4 v[24:27], v4, s[24:27], s36 offen offset:2048 sc1
    v_mfma_f32_16x16x32_bf16 v[100:103], a[4:7], a[36:39], v[100:103]
    s_add_u32 m0, s28, 2848
    ds_read_b64_tr_b16 a[236:237], v8 offset:17568
    v_mfma_f32_16x16x32_bf16 v[96:99], a[0:3], a[36:39], v[96:99]
    buffer_load_dwordx4 v1, s[8:11], s35 offen offset:1280 lds
    v_mfma_f32_16x16x32_bf16 v[128:131], a[0:3], a[40:43], v[128:131]
    ds_read_b64_tr_b16 a[238:239], v8 offset:18080
    v_accvgpr_read_b32 v56, a80
    v_mfma_f32_16x16x32_bf16 v[132:135], a[4:7], a[40:43], v[132:135]
    v_accvgpr_read_b32 v57, a81
    v_accvgpr_read_b32 v58, a82
    v_mfma_f32_16x16x32_bf16 v[136:139], a[8:11], a[40:43], v[136:139]
    s_add_u32 m0, s28, 2048
    s_xor_b32 s35, s60, 164352
    ds_read_b64_tr_b16 a[240:241], v8 offset:17576
    v_mfma_f32_16x16x32_bf16 v[140:143], a[12:15], a[40:43], v[140:143]
    buffer_load_dwordx4 v1, s[8:11], s35 offen offset:0 lds
    v_mfma_f32_16x16x32_bf16 v[144:147], a[16:19], a[40:43], v[144:147]
    ds_read_b64_tr_b16 a[242:243], v8 offset:18088
    v_accvgpr_read_b32 v59, a83
    v_mfma_f32_16x16x32_bf16 v[148:151], a[20:23], a[40:43], v[148:151]
    ds_read_b64_tr_b16 a[244:245], v8 offset:17632
    v_accvgpr_read_b32 v60, a84
    v_mfma_f32_16x16x32_bf16 v[152:155], a[24:27], a[40:43], v[152:155]
    s_add_u32 m0, s28, 3872
    v_accvgpr_read_b32 v61, a85
    v_accvgpr_read_b32 v62, a86
    v_mfma_f32_16x16x32_bf16 v[156:159], a[28:31], a[40:43], v[156:159]
    buffer_load_dwordx4 v1, s[8:11], s35 offen offset:1280 lds
    v_mfma_f32_16x16x32_bf16 v[188:191], a[28:31], a[44:47], v[188:191]
    ds_read_b64_tr_b16 a[246:247], v8 offset:18144
    v_accvgpr_read_b32 v63, a87
    v_mfma_f32_16x16x32_bf16 v[184:187], a[24:27], a[44:47], v[184:187]
    ds_read_b64_tr_b16 a[248:249], v8 offset:17640
    v_mul_f32 v56, v22, v56
    v_mfma_f32_16x16x32_bf16 v[180:183], a[20:23], a[44:47], v[180:183]
    s_add_u32 m0, s29, 101984
    s_xor_b32 s35, s61, 2097152
    v_mul_f32 v57, v22, v57
    v_mfma_f32_16x16x32_bf16 v[176:179], a[16:19], a[44:47], v[176:179]
    buffer_load_dwordx4 v2, s[12:15], s35 offen lds
    v_mfma_f32_16x16x32_bf16 v[172:175], a[12:15], a[44:47], v[172:175]
    ds_read_b64_tr_b16 a[250:251], v8 offset:18152
    v_mul_f32 v58, v22, v58
    v_mfma_f32_16x16x32_bf16 v[168:171], a[8:11], a[44:47], v[168:171]
    ds_read_b128 v[32:35], v5 offset:59712
    v_mul_f32 v59, v22, v59
    v_mfma_f32_16x16x32_bf16 v[164:167], a[4:7], a[44:47], v[164:167]
    s_add_u32 m0, s29, 103072
    s_xor_b32 s35, s61, 2105344
    ds_read_b128 v[36:39], v5 offset:59840
    v_mfma_f32_16x16x32_bf16 v[160:163], a[0:3], a[44:47], v[160:163]
    buffer_load_dwordx4 v2, s[12:15], s35 offen lds
    v_mfma_f32_16x16x32_bf16 v[192:195], a[0:3], a[48:51], v[192:195]
    v_mul_f32 v60, v22, v60
    v_mul_f32 v61, v22, v61
    v_mfma_f32_16x16x32_bf16 v[196:199], a[4:7], a[48:51], v[196:199]
    ds_read_b128 v[40:43], v5 offset:60224
    v_mul_f32 v62, v22, v62
    v_mfma_f32_16x16x32_bf16 v[200:203], a[8:11], a[48:51], v[200:203]
    s_add_u32 m0, s29, 104160
    s_xor_b32 s35, s61, 2113536
    ds_read_b128 v[44:47], v5 offset:60352
    v_mfma_f32_16x16x32_bf16 v[204:207], a[12:15], a[48:51], v[204:207]
    buffer_load_dwordx4 v2, s[12:15], s35 offen lds
    v_mfma_f32_16x16x32_bf16 v[208:211], a[16:19], a[48:51], v[208:211]
    v_mul_f32 v63, v22, v63
    v_mfma_f32_16x16x32_bf16 v[212:215], a[20:23], a[48:51], v[212:215]
    s_add_u32 s36, s34, 393216
    ds_read_b128 v[48:51], v5 offset:60736
    v_cvt_pk_bf16_f32 v24, v56, v57
    v_mfma_f32_16x16x32_bf16 v[216:219], a[24:27], a[48:51], v[216:219]
    s_add_u32 m0, s29, 105248
    s_xor_b32 s35, s61, 2121728
    ds_read_b128 v[52:55], v5 offset:60864
    v_mfma_f32_16x16x32_bf16 v[220:223], a[28:31], a[48:51], v[220:223]
    buffer_load_dwordx4 v2, s[12:15], s35 offen lds
    v_mfma_f32_16x16x32_bf16 v[252:255], a[28:31], a[52:55], v[252:255]
    v_cvt_pk_bf16_f32 v25, v58, v59
    v_cvt_pk_bf16_f32 v26, v60, v61
    v_mfma_f32_16x16x32_bf16 v[248:251], a[24:27], a[52:55], v[248:251]
    v_cvt_pk_bf16_f32 v27, v62, v63
    v_mfma_f32_16x16x32_bf16 v[244:247], a[20:23], a[52:55], v[244:247]
    buffer_store_dwordx4 v[24:27], v4, s[24:27], s36 offen offset:2048 sc1
    v_mfma_f32_16x16x32_bf16 v[240:243], a[16:19], a[52:55], v[240:243]
    v_mfma_f32_16x16x32_bf16 v[236:239], a[12:15], a[52:55], v[236:239]
    v_accvgpr_read_b32 v56, a88
    v_accvgpr_read_b32 v57, a89
    v_mfma_f32_16x16x32_bf16 v[232:235], a[8:11], a[52:55], v[232:235]
    v_accvgpr_read_b32 v58, a90
    v_accvgpr_read_b32 v59, a91
    v_mfma_f32_16x16x32_bf16 v[228:231], a[4:7], a[52:55], v[228:231]
    v_accvgpr_read_b32 v60, a92
    v_accvgpr_read_b32 v61, a93
    v_mfma_f32_16x16x32_bf16 v[224:227], a[0:3], a[52:55], v[224:227]
    s_waitcnt vmcnt(23) lgkmcnt(0)
    s_barrier
    v_mfma_f32_16x16x32_bf16 v[64:67], a[220:223], v[32:35], v[64:67]
    ds_read_b64_tr_b16 a[0:1], v7 offset:0
    v_accvgpr_read_b32 v62, a94
    v_mfma_f32_16x16x32_bf16 v[68:71], a[224:227], v[32:35], v[68:71]
    ds_read_b64_tr_b16 a[2:3], v7 offset:512
    v_accvgpr_read_b32 v63, a95
    v_mfma_f32_16x16x32_bf16 v[72:75], a[228:231], v[32:35], v[72:75]
    s_add_u32 m0, s29, 119424
    s_xor_b32 s35, s61, 2359296
    ds_read_b64_tr_b16 a[4:5], v7 offset:8
    v_mfma_f32_16x16x32_bf16 v[76:79], a[232:235], v[32:35], v[76:79]
    buffer_load_dwordx4 v2, s[12:15], s35 offen lds
    v_mfma_f32_16x16x32_bf16 v[80:83], a[236:239], v[32:35], v[80:83]
    ds_read_b64_tr_b16 a[6:7], v7 offset:520
    v_mul_f32 v56, v22, v56
    v_mfma_f32_16x16x32_bf16 v[84:87], a[240:243], v[32:35], v[84:87]
    v_mul_f32 v57, v22, v57
    v_mul_f32 v58, v22, v58
    v_mfma_f32_16x16x32_bf16 v[88:91], a[244:247], v[32:35], v[88:91]
    ds_read_b64_tr_b16 a[8:9], v7 offset:64
    v_mul_f32 v59, v22, v59
    v_mfma_f32_16x16x32_bf16 v[92:95], a[248:251], v[32:35], v[92:95]
    ds_read_b64_tr_b16 a[10:11], v7 offset:576
    v_mul_f32 v60, v22, v60
    v_mfma_f32_16x16x32_bf16 v[124:127], a[248:251], v[36:39], v[124:127]
    ds_read_b64_tr_b16 a[12:13], v7 offset:72
    v_mul_f32 v61, v22, v61
    v_mfma_f32_16x16x32_bf16 v[120:123], a[244:247], v[36:39], v[120:123]
    v_mul_f32 v62, v22, v62
    v_mul_f32 v63, v22, v63
    v_mfma_f32_16x16x32_bf16 v[116:119], a[240:243], v[36:39], v[116:119]
    s_add_u32 m0, s29, 120512
    s_xor_b32 s35, s61, 2367488
    ds_read_b64_tr_b16 a[14:15], v7 offset:584
    v_mfma_f32_16x16x32_bf16 v[112:115], a[236:239], v[36:39], v[112:115]
    s_add_u32 s36, s34, 589824
    buffer_load_dwordx4 v2, s[12:15], s35 offen lds
    v_mfma_f32_16x16x32_bf16 v[108:111], a[232:235], v[36:39], v[108:111]
    ds_read_b64_tr_b16 a[16:17], v7 offset:128
    v_cvt_pk_bf16_f32 v24, v56, v57
    v_mfma_f32_16x16x32_bf16 v[104:107], a[228:231], v[36:39], v[104:107]
    ds_read_b64_tr_b16 a[18:19], v7 offset:640
    v_cvt_pk_bf16_f32 v25, v58, v59
    v_mfma_f32_16x16x32_bf16 v[100:103], a[224:227], v[36:39], v[100:103]
    v_cvt_pk_bf16_f32 v26, v60, v61
    v_cvt_pk_bf16_f32 v27, v62, v63
    v_mfma_f32_16x16x32_bf16 v[96:99], a[220:223], v[36:39], v[96:99]
    ds_read_b64_tr_b16 a[20:21], v7 offset:136
    v_mfma_f32_16x16x32_bf16 v[128:131], a[220:223], v[40:43], v[128:131]
    ds_read_b64_tr_b16 a[22:23], v7 offset:648
    v_mfma_f32_16x16x32_bf16 v[132:135], a[224:227], v[40:43], v[132:135]
    ds_read_b64_tr_b16 a[24:25], v7 offset:192
    v_accvgpr_read_b32 v22, a202
    v_mfma_f32_16x16x32_bf16 v[136:139], a[228:231], v[40:43], v[136:139]
    s_add_u32 m0, s29, 121600
    s_xor_b32 s35, s61, 2375680
    v_accvgpr_read_b32 v23, a203
    v_mfma_f32_16x16x32_bf16 v[140:143], a[232:235], v[40:43], v[140:143]
    buffer_load_dwordx4 v2, s[12:15], s35 offen lds
    v_mfma_f32_16x16x32_bf16 v[144:147], a[236:239], v[40:43], v[144:147]
    ds_read_b64_tr_b16 a[26:27], v7 offset:704
    v_add_f32 v22, v22, v23
    v_mfma_f32_16x16x32_bf16 v[148:151], a[240:243], v[40:43], v[148:151]
    ds_read_b64_tr_b16 a[28:29], v7 offset:200
    v_subrev_u32 v23, s46, v22
    v_mfma_f32_16x16x32_bf16 v[152:155], a[244:247], v[40:43], v[152:155]
    ds_read_b64_tr_b16 a[30:31], v7 offset:712
    v_mfma_f32_16x16x32_bf16 v[156:159], a[248:251], v[40:43], v[156:159]
    buffer_store_dwordx4 v[24:27], v4, s[24:27], s36 offen offset:2048 sc1
    v_mfma_f32_16x16x32_bf16 v[188:191], a[248:251], v[44:47], v[188:191]
    ds_read_b128 a[32:35], v5 offset:59776
    v_mfma_f32_16x16x32_bf16 v[184:187], a[244:247], v[44:47], v[184:187]
    ds_read_b128 a[36:39], v5 offset:59904
    v_mfma_f32_16x16x32_bf16 v[180:183], a[240:243], v[44:47], v[180:183]
    s_add_u32 m0, s29, 122688
    s_xor_b32 s35, s61, 2383872
    ds_read_b128 a[40:43], v5 offset:60288
    v_mfma_f32_16x16x32_bf16 v[176:179], a[236:239], v[44:47], v[176:179]
    buffer_load_dwordx4 v2, s[12:15], s35 offen lds
    v_mfma_f32_16x16x32_bf16 v[172:175], a[232:235], v[44:47], v[172:175]
    v_rcp_f32 v22, v22
    v_mfma_f32_16x16x32_bf16 v[168:171], a[228:231], v[44:47], v[168:171]
    ds_read_b128 a[44:47], v5 offset:60416
    v_max_u32 v28, v28, v23
    v_mfma_f32_16x16x32_bf16 v[164:167], a[224:227], v[44:47], v[164:167]
    ds_read_b128 a[48:51], v5 offset:60800
    v_accvgpr_read_b32 v56, a160
    v_mfma_f32_16x16x32_bf16 v[160:163], a[220:223], v[44:47], v[160:163]
    ds_read_b128 a[52:55], v5 offset:60928
    v_accvgpr_read_b32 v57, a161
    v_mfma_f32_16x16x32_bf16 v[192:195], a[220:223], v[48:51], v[192:195]
    v_accvgpr_read_b32 v58, a162
    v_accvgpr_read_b32 v59, a163
    v_mfma_f32_16x16x32_bf16 v[196:199], a[224:227], v[48:51], v[196:199]
    ds_read_b128 a[96:99], v6 offset:0
    v_accvgpr_read_b32 v60, a164
    v_mfma_f32_16x16x32_bf16 v[200:203], a[228:231], v[48:51], v[200:203]
    ds_read_b128 a[100:103], v6 offset:128
    v_accvgpr_read_b32 v61, a165
    v_mfma_f32_16x16x32_bf16 v[204:207], a[232:235], v[48:51], v[204:207]
    ds_read_b128 a[104:107], v6 offset:512
    v_accvgpr_read_b32 v62, a166
    v_mfma_f32_16x16x32_bf16 v[208:211], a[236:239], v[48:51], v[208:211]
    v_accvgpr_read_b32 v63, a167
    v_mul_f32 v56, v22, v56
    v_mfma_f32_16x16x32_bf16 v[212:215], a[240:243], v[48:51], v[212:215]
    ds_read_b128 a[108:111], v6 offset:640
    v_mul_f32 v57, v22, v57
    v_mfma_f32_16x16x32_bf16 v[216:219], a[244:247], v[48:51], v[216:219]
    ds_read_b128 a[112:115], v6 offset:1024
    v_mul_f32 v58, v22, v58
    v_mfma_f32_16x16x32_bf16 v[220:223], a[248:251], v[48:51], v[220:223]
    ds_read_b128 a[116:119], v6 offset:1152
    v_mul_f32 v59, v22, v59
    v_mfma_f32_16x16x32_bf16 v[252:255], a[248:251], v[52:55], v[252:255]
    v_mul_f32 v60, v22, v60
    v_mul_f32 v61, v22, v61
    v_mfma_f32_16x16x32_bf16 v[248:251], a[244:247], v[52:55], v[248:251]
    v_mul_f32 v62, v22, v62
    v_mul_f32 v63, v22, v63
    v_mfma_f32_16x16x32_bf16 v[244:247], a[240:243], v[52:55], v[244:247]
    s_add_u32 s36, s34, 4096
    v_cvt_pk_bf16_f32 v24, v56, v57
    v_cvt_pk_bf16_f32 v25, v58, v59
    v_mfma_f32_16x16x32_bf16 v[240:243], a[236:239], v[52:55], v[240:243]
    v_cvt_pk_bf16_f32 v26, v60, v61
    v_cvt_pk_bf16_f32 v27, v62, v63
    v_mfma_f32_16x16x32_bf16 v[236:239], a[232:235], v[52:55], v[236:239]
    buffer_store_dwordx4 v[24:27], v4, s[24:27], s36 offen offset:1024 sc1
    v_mfma_f32_16x16x32_bf16 v[232:235], a[228:231], v[52:55], v[232:235]
    v_mfma_f32_16x16x32_bf16 v[228:231], a[224:227], v[52:55], v[228:231]
    v_accvgpr_read_b32 v56, a168
    v_accvgpr_read_b32 v57, a169
    v_mfma_f32_16x16x32_bf16 v[224:227], a[220:223], v[52:55], v[224:227]
    s_waitcnt vmcnt(19) lgkmcnt(0)
    s_barrier
    v_mfma_f32_16x16x32_bf16 v[64:67], a[0:3], a[32:35], v[64:67]
    ds_read_b64_tr_b16 a[220:221], v7 offset:17440
    v_accvgpr_read_b32 v58, a170
    v_mfma_f32_16x16x32_bf16 v[68:71], a[4:7], a[32:35], v[68:71]
    ds_read_b64_tr_b16 a[222:223], v7 offset:17952
    v_accvgpr_read_b32 v59, a171
    v_mfma_f32_16x16x32_bf16 v[72:75], a[8:11], a[32:35], v[72:75]
    s_add_u32 m0, s28, 59712
    s_xor_b32 s35, s60, 640
    ds_read_b64_tr_b16 a[224:225], v7 offset:17448
    v_mfma_f32_16x16x32_bf16 v[76:79], a[12:15], a[32:35], v[76:79]
    buffer_load_dwordx4 v1, s[8:11], s35 offen offset:0 lds
    v_mfma_f32_16x16x32_bf16 v[80:83], a[16:19], a[32:35], v[80:83]
    ds_read_b64_tr_b16 a[226:227], v7 offset:17960
    v_accvgpr_read_b32 v60, a172
    v_mfma_f32_16x16x32_bf16 v[84:87], a[20:23], a[32:35], v[84:87]
    ds_read_b64_tr_b16 a[228:229], v7 offset:17504
    v_accvgpr_read_b32 v61, a173
    v_mfma_f32_16x16x32_bf16 v[88:91], a[24:27], a[32:35], v[88:91]
    s_add_u32 m0, s28, 61536
    ds_read_b64_tr_b16 a[230:231], v7 offset:18016
    v_accvgpr_read_b32 v62, a174
    v_mfma_f32_16x16x32_bf16 v[92:95], a[28:31], a[32:35], v[92:95]
    buffer_load_dwordx4 v1, s[8:11], s35 offen offset:1280 lds
    v_mfma_f32_16x16x32_bf16 v[124:127], a[28:31], a[36:39], v[124:127]
    v_accvgpr_read_b32 v63, a175
    v_mul_f32 v56, v22, v56
    v_mfma_f32_16x16x32_bf16 v[120:123], a[24:27], a[36:39], v[120:123]
    ds_read_b64_tr_b16 a[232:233], v7 offset:17512
    v_mul_f32 v57, v22, v57
    v_mfma_f32_16x16x32_bf16 v[116:119], a[20:23], a[36:39], v[116:119]
    s_add_u32 m0, s28, 60736
    s_xor_b32 s35, s60, 82560
    ds_read_b64_tr_b16 a[234:235], v7 offset:18024
    v_mfma_f32_16x16x32_bf16 v[112:115], a[16:19], a[36:39], v[112:115]
    buffer_load_dwordx4 v1, s[8:11], s35 offen offset:0 lds
    v_mfma_f32_16x16x32_bf16 v[108:111], a[12:15], a[36:39], v[108:111]
    ds_read_b64_tr_b16 a[236:237], v7 offset:17568
    v_mul_f32 v58, v22, v58
    v_mfma_f32_16x16x32_bf16 v[104:107], a[8:11], a[36:39], v[104:107]
    ds_read_b64_tr_b16 a[238:239], v7 offset:18080
    v_mul_f32 v59, v22, v59
    v_mfma_f32_16x16x32_bf16 v[100:103], a[4:7], a[36:39], v[100:103]
    s_add_u32 m0, s28, 62560
    ds_read_b64_tr_b16 a[240:241], v7 offset:17576
    v_mul_f32 v60, v22, v60
    v_mfma_f32_16x16x32_bf16 v[96:99], a[0:3], a[36:39], v[96:99]
    buffer_load_dwordx4 v1, s[8:11], s35 offen offset:1280 lds
    v_mfma_f32_16x16x32_bf16 v[128:131], a[0:3], a[40:43], v[128:131]
    v_mul_f32 v61, v22, v61
    v_mul_f32 v62, v22, v62
    v_mfma_f32_16x16x32_bf16 v[132:135], a[4:7], a[40:43], v[132:135]
    ds_read_b64_tr_b16 a[242:243], v7 offset:18088
    v_mul_f32 v63, v22, v63
    v_mfma_f32_16x16x32_bf16 v[136:139], a[8:11], a[40:43], v[136:139]
    s_add_u32 m0, s28, 61760
    s_xor_b32 s35, s60, 164480
    ds_read_b64_tr_b16 a[244:245], v7 offset:17632
    v_mfma_f32_16x16x32_bf16 v[140:143], a[12:15], a[40:43], v[140:143]
    s_add_u32 s36, s34, 200704
    buffer_load_dwordx4 v1, s[8:11], s35 offen offset:0 lds
    v_mfma_f32_16x16x32_bf16 v[144:147], a[16:19], a[40:43], v[144:147]
    ds_read_b64_tr_b16 a[246:247], v7 offset:18144
    v_cvt_pk_bf16_f32 v24, v56, v57
    v_mfma_f32_16x16x32_bf16 v[148:151], a[20:23], a[40:43], v[148:151]
    ds_read_b64_tr_b16 a[248:249], v7 offset:17640
    v_cvt_pk_bf16_f32 v25, v58, v59
    v_mfma_f32_16x16x32_bf16 v[152:155], a[24:27], a[40:43], v[152:155]
    s_add_u32 m0, s28, 63584
    ds_read_b64_tr_b16 a[250:251], v7 offset:18152
    v_cvt_pk_bf16_f32 v26, v60, v61
    v_mfma_f32_16x16x32_bf16 v[156:159], a[28:31], a[40:43], v[156:159]
    buffer_load_dwordx4 v1, s[8:11], s35 offen offset:1280 lds
    v_mfma_f32_16x16x32_bf16 v[188:191], a[28:31], a[44:47], v[188:191]
    v_cvt_pk_bf16_f32 v27, v62, v63
    v_mfma_f32_16x16x32_bf16 v[184:187], a[24:27], a[44:47], v[184:187]
    ds_read_b128 v[32:35], v6 offset:64
    v_mfma_f32_16x16x32_bf16 v[180:183], a[20:23], a[44:47], v[180:183]
    s_add_u32 m0, s29, 24832
    s_xor_b32 s35, s61, 2621440
    ds_read_b128 v[36:39], v6 offset:192
    v_mfma_f32_16x16x32_bf16 v[176:179], a[16:19], a[44:47], v[176:179]
    buffer_load_dwordx4 v2, s[12:15], s35 offen lds
    v_mfma_f32_16x16x32_bf16 v[172:175], a[12:15], a[44:47], v[172:175]
    ds_read_b128 v[40:43], v6 offset:576
    v_accvgpr_read_b32 v56, a176
    v_mfma_f32_16x16x32_bf16 v[168:171], a[8:11], a[44:47], v[168:171]
    ds_read_b128 v[44:47], v6 offset:704
    v_accvgpr_read_b32 v57, a177
    v_mfma_f32_16x16x32_bf16 v[164:167], a[4:7], a[44:47], v[164:167]
    s_add_u32 m0, s29, 25920
    s_xor_b32 s35, s61, 2629632
    ds_read_b128 v[48:51], v6 offset:1088
    v_mfma_f32_16x16x32_bf16 v[160:163], a[0:3], a[44:47], v[160:163]
    buffer_load_dwordx4 v2, s[12:15], s35 offen lds
    v_mfma_f32_16x16x32_bf16 v[192:195], a[0:3], a[48:51], v[192:195]
    v_accvgpr_read_b32 v58, a178
    v_accvgpr_read_b32 v59, a179
    v_mfma_f32_16x16x32_bf16 v[196:199], a[4:7], a[48:51], v[196:199]
    ds_read_b128 v[52:55], v6 offset:1216
    v_accvgpr_read_b32 v60, a180
    v_mfma_f32_16x16x32_bf16 v[200:203], a[8:11], a[48:51], v[200:203]
    s_add_u32 m0, s29, 27008
    s_xor_b32 s35, s61, 2637824
    ds_read_b64_tr_b16 a[64:65], v7 offset:59712
    v_mfma_f32_16x16x32_bf16 v[204:207], a[12:15], a[48:51], v[204:207]
    buffer_load_dwordx4 v2, s[12:15], s35 offen lds
    v_mfma_f32_16x16x32_bf16 v[208:211], a[16:19], a[48:51], v[208:211]
    ds_read_b64_tr_b16 a[66:67], v7 offset:60224
    v_accvgpr_read_b32 v61, a181
    v_mfma_f32_16x16x32_bf16 v[212:215], a[20:23], a[48:51], v[212:215]
    ds_read_b64_tr_b16 a[68:69], v7 offset:59720
    v_accvgpr_read_b32 v62, a182
    v_mfma_f32_16x16x32_bf16 v[216:219], a[24:27], a[48:51], v[216:219]
    s_add_u32 m0, s29, 28096
    s_xor_b32 s35, s61, 2646016
    ds_read_b64_tr_b16 a[70:71], v7 offset:60232
    v_mfma_f32_16x16x32_bf16 v[220:223], a[28:31], a[48:51], v[220:223]
    buffer_load_dwordx4 v2, s[12:15], s35 offen lds
    v_mfma_f32_16x16x32_bf16 v[252:255], a[28:31], a[52:55], v[252:255]
    v_accvgpr_read_b32 v63, a183
    v_mul_f32 v56, v22, v56
    v_mfma_f32_16x16x32_bf16 v[248:251], a[24:27], a[52:55], v[248:251]
    buffer_store_dwordx4 v[24:27], v4, s[24:27], s36 offen offset:1024 sc1
    v_mfma_f32_16x16x32_bf16 v[244:247], a[20:23], a[52:55], v[244:247]
    v_mul_f32 v57, v22, v57
    v_mul_f32 v58, v22, v58
    v_mfma_f32_16x16x32_bf16 v[240:243], a[16:19], a[52:55], v[240:243]
    v_mul_f32 v59, v22, v59
    v_mul_f32 v60, v22, v60
    v_mfma_f32_16x16x32_bf16 v[236:239], a[12:15], a[52:55], v[236:239]
    v_mul_f32 v61, v22, v61
    v_mul_f32 v62, v22, v62
    v_mfma_f32_16x16x32_bf16 v[232:235], a[8:11], a[52:55], v[232:235]
    v_mul_f32 v63, v22, v63
    v_mfma_f32_16x16x32_bf16 v[228:231], a[4:7], a[52:55], v[228:231]
    s_add_u32 s36, s34, 397312
    v_cvt_pk_bf16_f32 v24, v56, v57
    v_cvt_pk_bf16_f32 v25, v58, v59
    v_mfma_f32_16x16x32_bf16 v[224:227], a[0:3], a[52:55], v[224:227]
    s_waitcnt vmcnt(18) lgkmcnt(0)
    s_barrier
    v_mfma_f32_16x16x32_bf16 v[64:67], a[220:223], a[96:99], v[64:67]
    ds_read_b64_tr_b16 a[72:73], v7 offset:59776
    v_cvt_pk_bf16_f32 v26, v60, v61
    v_mfma_f32_16x16x32_bf16 v[68:71], a[224:227], a[96:99], v[68:71]
    ds_read_b64_tr_b16 a[74:75], v7 offset:60288
    v_cvt_pk_bf16_f32 v27, v62, v63
    v_mfma_f32_16x16x32_bf16 v[72:75], a[228:231], a[96:99], v[72:75]
    s_add_u32 m0, s29, 42272
    s_xor_b32 s35, s61, 2883584
    ds_read_b64_tr_b16 a[76:77], v7 offset:59784
    v_mfma_f32_16x16x32_bf16 v[76:79], a[232:235], a[96:99], v[76:79]
    buffer_load_dwordx4 v2, s[12:15], s35 offen lds
    v_mfma_f32_16x16x32_bf16 v[80:83], a[236:239], a[96:99], v[80:83]
    ds_read_b64_tr_b16 a[78:79], v7 offset:60296
    v_accvgpr_read_b32 v56, a184
    v_mfma_f32_16x16x32_bf16 v[84:87], a[240:243], a[96:99], v[84:87]
    ds_read_b64_tr_b16 a[80:81], v7 offset:59840
    v_accvgpr_read_b32 v57, a185
    v_mfma_f32_16x16x32_bf16 v[88:91], a[244:247], a[96:99], v[88:91]
    s_add_u32 m0, s29, 43360
    s_xor_b32 s35, s61, 2891776
    ds_read_b64_tr_b16 a[82:83], v7 offset:60352
    v_mfma_f32_16x16x32_bf16 v[92:95], a[248:251], a[96:99], v[92:95]
    buffer_load_dwordx4 v2, s[12:15], s35 offen lds
    v_mfma_f32_16x16x32_bf16 v[124:127], a[248:251], a[100:103], v[124:127]
    v_accvgpr_read_b32 v58, a186
    v_accvgpr_read_b32 v59, a187
    v_mfma_f32_16x16x32_bf16 v[120:123], a[244:247], a[100:103], v[120:123]
    ds_read_b64_tr_b16 a[84:85], v7 offset:59848
    v_accvgpr_read_b32 v60, a188
    v_mfma_f32_16x16x32_bf16 v[116:119], a[240:243], a[100:103], v[116:119]
    s_add_u32 m0, s29, 44448
    s_xor_b32 s35, s61, 2899968
    ds_read_b64_tr_b16 a[86:87], v7 offset:60360
    v_mfma_f32_16x16x32_bf16 v[112:115], a[236:239], a[100:103], v[112:115]
    buffer_load_dwordx4 v2, s[12:15], s35 offen lds
    v_mfma_f32_16x16x32_bf16 v[108:111], a[232:235], a[100:103], v[108:111]
    ds_read_b64_tr_b16 a[88:89], v7 offset:59904
    v_accvgpr_read_b32 v61, a189
    v_mfma_f32_16x16x32_bf16 v[104:107], a[228:231], a[100:103], v[104:107]
    ds_read_b64_tr_b16 a[90:91], v7 offset:60416
    v_accvgpr_read_b32 v62, a190
    v_mfma_f32_16x16x32_bf16 v[100:103], a[224:227], a[100:103], v[100:103]
    s_add_u32 m0, s29, 45536
    s_xor_b32 s35, s61, 2908160
    ds_read_b64_tr_b16 a[92:93], v7 offset:59912
    v_mfma_f32_16x16x32_bf16 v[96:99], a[220:223], a[100:103], v[96:99]
    buffer_load_dwordx4 v2, s[12:15], s35 offen lds
    v_mfma_f32_16x16x32_bf16 v[128:131], a[220:223], a[104:107], v[128:131]
    v_accvgpr_read_b32 v63, a191
    v_mul_f32 v56, v22, v56
    v_mfma_f32_16x16x32_bf16 v[132:135], a[224:227], a[104:107], v[132:135]
    ds_read_b64_tr_b16 a[94:95], v7 offset:60424
    v_mul_f32 v57, v22, v57
    v_mfma_f32_16x16x32_bf16 v[136:139], a[228:231], a[104:107], v[136:139]
    s_add_u32 m0, s28, 136864
    s_xor_b32 s35, s60, 768
    ds_read_b128 a[32:35], v5 offset:0
    v_mfma_f32_16x16x32_bf16 v[140:143], a[232:235], a[104:107], v[140:143]
    buffer_load_dwordx4 v1, s[8:11], s35 offen offset:0 lds
    v_mfma_f32_16x16x32_bf16 v[144:147], a[236:239], a[104:107], v[144:147]
    ds_read_b128 a[36:39], v5 offset:128
    v_mul_f32 v58, v22, v58
    v_mfma_f32_16x16x32_bf16 v[148:151], a[240:243], a[104:107], v[148:151]
    ds_read_b128 a[40:43], v5 offset:512
    v_mul_f32 v59, v22, v59
    v_mfma_f32_16x16x32_bf16 v[152:155], a[244:247], a[104:107], v[152:155]
    s_add_u32 m0, s28, 138688
    ds_read_b128 a[44:47], v5 offset:640
    v_mul_f32 v60, v22, v60
    v_mfma_f32_16x16x32_bf16 v[156:159], a[248:251], a[104:107], v[156:159]
    buffer_load_dwordx4 v1, s[8:11], s35 offen offset:1280 lds
    v_mfma_f32_16x16x32_bf16 v[188:191], a[248:251], a[108:111], v[188:191]
    v_mul_f32 v61, v22, v61
    v_mul_f32 v62, v22, v62
    v_mfma_f32_16x16x32_bf16 v[184:187], a[244:247], a[108:111], v[184:187]
    ds_read_b128 a[48:51], v5 offset:1024
    v_mul_f32 v63, v22, v63
    v_mfma_f32_16x16x32_bf16 v[180:183], a[240:243], a[108:111], v[180:183]
    s_add_u32 m0, s28, 137888
    s_xor_b32 s35, s60, 82688
    ds_read_b128 a[52:55], v5 offset:1152
    v_mfma_f32_16x16x32_bf16 v[176:179], a[236:239], a[108:111], v[176:179]
    buffer_load_dwordx4 v1, s[8:11], s35 offen offset:0 lds
    v_mfma_f32_16x16x32_bf16 v[172:175], a[232:235], a[108:111], v[172:175]
    ds_read_b64_tr_b16 a[0:1], v8 offset:0
    v_mfma_f32_16x16x32_bf16 v[168:171], a[228:231], a[108:111], v[168:171]
    ds_read_b64_tr_b16 a[2:3], v8 offset:512
    v_mfma_f32_16x16x32_bf16 v[164:167], a[224:227], a[108:111], v[164:167]
    s_add_u32 m0, s28, 139712
    ds_read_b64_tr_b16 a[4:5], v8 offset:8
    v_mfma_f32_16x16x32_bf16 v[160:163], a[220:223], a[108:111], v[160:163]
    buffer_load_dwordx4 v1, s[8:11], s35 offen offset:1280 lds
    v_mfma_f32_16x16x32_bf16 v[192:195], a[220:223], a[112:115], v[192:195]
    v_mfma_f32_16x16x32_bf16 v[196:199], a[224:227], a[112:115], v[196:199]
    ds_read_b64_tr_b16 a[6:7], v8 offset:520
    v_mfma_f32_16x16x32_bf16 v[200:203], a[228:231], a[112:115], v[200:203]
    s_add_u32 m0, s28, 138912
    s_xor_b32 s35, s60, 164608
    ds_read_b64_tr_b16 a[8:9], v8 offset:64
    v_mfma_f32_16x16x32_bf16 v[204:207], a[232:235], a[112:115], v[204:207]
    buffer_load_dwordx4 v1, s[8:11], s35 offen offset:0 lds
    v_mfma_f32_16x16x32_bf16 v[208:211], a[236:239], a[112:115], v[208:211]
    ds_read_b64_tr_b16 a[10:11], v8 offset:576
    v_mfma_f32_16x16x32_bf16 v[212:215], a[240:243], a[112:115], v[212:215]
    ds_read_b64_tr_b16 a[12:13], v8 offset:72
    v_mfma_f32_16x16x32_bf16 v[216:219], a[244:247], a[112:115], v[216:219]
    s_add_u32 m0, s28, 140736
    ds_read_b64_tr_b16 a[14:15], v8 offset:584
    v_mfma_f32_16x16x32_bf16 v[220:223], a[248:251], a[112:115], v[220:223]
    buffer_load_dwordx4 v1, s[8:11], s35 offen offset:1280 lds
    v_mfma_f32_16x16x32_bf16 v[252:255], a[248:251], a[116:119], v[252:255]
    v_mfma_f32_16x16x32_bf16 v[248:251], a[244:247], a[116:119], v[248:251]
    buffer_store_dwordx4 v[24:27], v4, s[24:27], s36 offen offset:1024 sc1
    v_mfma_f32_16x16x32_bf16 v[244:247], a[240:243], a[116:119], v[244:247]
    v_mfma_f32_16x16x32_bf16 v[240:243], a[236:239], a[116:119], v[240:243]
    s_add_u32 s36, s34, 593920
    v_cvt_pk_bf16_f32 v24, v56, v57
    v_cvt_pk_bf16_f32 v25, v58, v59
    v_mfma_f32_16x16x32_bf16 v[236:239], a[232:235], a[116:119], v[236:239]
    v_cvt_pk_bf16_f32 v26, v60, v61
    v_cvt_pk_bf16_f32 v27, v62, v63
    v_mfma_f32_16x16x32_bf16 v[232:235], a[228:231], a[116:119], v[232:235]
    buffer_store_dwordx4 v[24:27], v4, s[24:27], s36 offen offset:1024 sc1
    v_mfma_f32_16x16x32_bf16 v[228:231], a[224:227], a[116:119], v[228:231]
    v_mfma_f32_16x16x32_bf16 v[224:227], a[220:223], a[116:119], v[224:227]
    s_waitcnt vmcnt(17) lgkmcnt(0)
    s_barrier
    v_mfma_f32_16x16x32_bf16 v[64:67], a[64:67], v[32:35], v[64:67]
    ds_read_b64_tr_b16 a[16:17], v8 offset:128
    v_accvgpr_read_b32 v22, a200
    v_mfma_f32_16x16x32_bf16 v[68:71], a[68:71], v[32:35], v[68:71]
    ds_read_b64_tr_b16 a[18:19], v8 offset:640
    v_accvgpr_read_b32 v23, a201
    v_mfma_f32_16x16x32_bf16 v[72:75], a[72:75], v[32:35], v[72:75]
    s_add_u32 m0, s29, 84544
    s_xor_b32 s35, s61, 3145728
    ds_read_b64_tr_b16 a[20:21], v8 offset:136
    v_mfma_f32_16x16x32_bf16 v[76:79], a[76:79], v[32:35], v[76:79]
    buffer_load_dwordx4 v2, s[12:15], s35 offen lds
    v_mfma_f32_16x16x32_bf16 v[80:83], a[80:83], v[32:35], v[80:83]
    ds_read_b64_tr_b16 a[22:23], v8 offset:648
    v_add_f32 v22, v22, v23
    v_mfma_f32_16x16x32_bf16 v[84:87], a[84:87], v[32:35], v[84:87]
    v_subrev_u32 v23, s46, v22
    v_mfma_f32_16x16x32_bf16 v[88:91], a[88:91], v[32:35], v[88:91]
    ds_read_b64_tr_b16 a[24:25], v8 offset:192
    v_mfma_f32_16x16x32_bf16 v[92:95], a[92:95], v[32:35], v[92:95]
    ds_read_b64_tr_b16 a[26:27], v8 offset:704
    v_mfma_f32_16x16x32_bf16 v[124:127], a[92:95], v[36:39], v[124:127]
    ds_read_b64_tr_b16 a[28:29], v8 offset:200
    v_mfma_f32_16x16x32_bf16 v[120:123], a[88:91], v[36:39], v[120:123]
    v_rcp_f32 v22, v22
    v_mfma_f32_16x16x32_bf16 v[116:119], a[84:87], v[36:39], v[116:119]
    s_add_u32 m0, s29, 85632
    s_xor_b32 s35, s61, 3153920
    ds_read_b64_tr_b16 a[30:31], v8 offset:712
    v_mfma_f32_16x16x32_bf16 v[112:115], a[80:83], v[36:39], v[112:115]
    buffer_load_dwordx4 v2, s[12:15], s35 offen lds
    v_mfma_f32_16x16x32_bf16 v[108:111], a[76:79], v[36:39], v[108:111]
    ds_read_b128 a[96:99], v5 offset:64
    v_max_u32 v28, v28, v23
    v_mfma_f32_16x16x32_bf16 v[104:107], a[72:75], v[36:39], v[104:107]
    ds_read_b128 a[100:103], v5 offset:192
    v_accvgpr_read_b32 v56, a128
    v_mfma_f32_16x16x32_bf16 v[100:103], a[68:71], v[36:39], v[100:103]
    v_accvgpr_read_b32 v57, a129
    v_accvgpr_read_b32 v58, a130
    v_mfma_f32_16x16x32_bf16 v[96:99], a[64:67], v[36:39], v[96:99]
    ds_read_b128 a[104:107], v5 offset:576
    v_accvgpr_read_b32 v59, a131
    v_mfma_f32_16x16x32_bf16 v[128:131], a[64:67], v[40:43], v[128:131]
    ds_read_b128 a[108:111], v5 offset:704
    v_accvgpr_read_b32 v60, a132
    v_mfma_f32_16x16x32_bf16 v[132:135], a[68:71], v[40:43], v[132:135]
    ds_read_b128 a[112:115], v5 offset:1088
    v_accvgpr_read_b32 v61, a133
    v_mfma_f32_16x16x32_bf16 v[136:139], a[72:75], v[40:43], v[136:139]
    s_add_u32 m0, s29, 86720
    s_xor_b32 s35, s61, 3162112
    v_accvgpr_read_b32 v62, a134
    v_mfma_f32_16x16x32_bf16 v[140:143], a[76:79], v[40:43], v[140:143]
    buffer_load_dwordx4 v2, s[12:15], s35 offen lds
    v_mfma_f32_16x16x32_bf16 v[144:147], a[80:83], v[40:43], v[144:147]
    ds_read_b128 a[116:119], v5 offset:1216
    v_accvgpr_read_b32 v63, a135
    v_mfma_f32_16x16x32_bf16 v[148:151], a[84:87], v[40:43], v[148:151]
    ds_read_b64_tr_b16 a[220:221], v8 offset:17440
    v_mul_f32 v56, v22, v56
    v_mfma_f32_16x16x32_bf16 v[152:155], a[88:91], v[40:43], v[152:155]
    ds_read_b64_tr_b16 a[222:223], v8 offset:17952
    v_mul_f32 v57, v22, v57
    v_mfma_f32_16x16x32_bf16 v[156:159], a[92:95], v[40:43], v[156:159]
    v_mul_f32 v58, v22, v58
    v_mul_f32 v59, v22, v59
    v_mfma_f32_16x16x32_bf16 v[188:191], a[92:95], v[44:47], v[188:191]
    ds_read_b64_tr_b16 a[224:225], v8 offset:17448
    v_mul_f32 v60, v22, v60
    v_mfma_f32_16x16x32_bf16 v[184:187], a[88:91], v[44:47], v[184:187]
    ds_read_b64_tr_b16 a[226:227], v8 offset:17960
    v_mul_f32 v61, v22, v61
    v_mfma_f32_16x16x32_bf16 v[180:183], a[84:87], v[44:47], v[180:183]
    s_add_u32 m0, s29, 87808
    s_xor_b32 s35, s61, 3170304
    ds_read_b128 a[160:163], v5 offset:59712
    v_mfma_f32_16x16x32_bf16 v[176:179], a[80:83], v[44:47], v[176:179]
    buffer_load_dwordx4 v2, s[12:15], s35 offen lds
    v_mfma_f32_16x16x32_bf16 v[172:175], a[76:79], v[44:47], v[172:175]
    v_mul_f32 v62, v22, v62
    v_mul_f32 v63, v22, v63
    v_mfma_f32_16x16x32_bf16 v[168:171], a[72:75], v[44:47], v[168:171]
    s_add_u32 s36, s34, 4096
    ds_read_b128 a[164:167], v5 offset:59840
    v_cvt_pk_bf16_f32 v24, v56, v57
    v_mfma_f32_16x16x32_bf16 v[164:167], a[68:71], v[44:47], v[164:167]
    ds_read_b128 a[168:171], v5 offset:60224
    v_cvt_pk_bf16_f32 v25, v58, v59
    v_mfma_f32_16x16x32_bf16 v[160:163], a[64:67], v[44:47], v[160:163]
    ds_read_b128 a[172:175], v5 offset:60352
    v_cvt_pk_bf16_f32 v26, v60, v61
    v_mfma_f32_16x16x32_bf16 v[192:195], a[64:67], v[48:51], v[192:195]
    v_cvt_pk_bf16_f32 v27, v62, v63
    v_mfma_f32_16x16x32_bf16 v[196:199], a[68:71], v[48:51], v[196:199]
    ds_read_b128 a[176:179], v5 offset:60736
    v_mfma_f32_16x16x32_bf16 v[200:203], a[72:75], v[48:51], v[200:203]
    ds_read_b128 a[180:183], v5 offset:60864
    v_mfma_f32_16x16x32_bf16 v[204:207], a[76:79], v[48:51], v[204:207]
    ds_read_b64_tr_b16 a[228:229], v8 offset:17504
    v_accvgpr_read_b32 v56, a136
    v_mfma_f32_16x16x32_bf16 v[208:211], a[80:83], v[48:51], v[208:211]
    buffer_store_dwordx4 v[24:27], v4, s[24:27], s36 offen offset:0 sc1
    v_mfma_f32_16x16x32_bf16 v[212:215], a[84:87], v[48:51], v[212:215]
    ds_read_b64_tr_b16 a[230:231], v8 offset:18016
    v_accvgpr_read_b32 v57, a137
    v_mfma_f32_16x16x32_bf16 v[216:219], a[88:91], v[48:51], v[216:219]
    ds_read_b64_tr_b16 a[232:233], v8 offset:17512
    v_accvgpr_read_b32 v58, a138
    v_mfma_f32_16x16x32_bf16 v[220:223], a[92:95], v[48:51], v[220:223]
    ds_read_b64_tr_b16 a[234:235], v8 offset:18024
    v_accvgpr_read_b32 v59, a139
    v_mfma_f32_16x16x32_bf16 v[252:255], a[92:95], v[52:55], v[252:255]
    v_accvgpr_read_b32 v60, a140
    v_accvgpr_read_b32 v61, a141
    v_mfma_f32_16x16x32_bf16 v[248:251], a[88:91], v[52:55], v[248:251]
    v_accvgpr_read_b32 v62, a142
    v_accvgpr_read_b32 v63, a143
    v_mfma_f32_16x16x32_bf16 v[244:247], a[84:87], v[52:55], v[244:247]
    v_mul_f32 v56, v22, v56
    v_mul_f32 v57, v22, v57
    v_mfma_f32_16x16x32_bf16 v[240:243], a[80:83], v[52:55], v[240:243]
    v_mul_f32 v58, v22, v58
    v_mul_f32 v59, v22, v59
    v_mfma_f32_16x16x32_bf16 v[236:239], a[76:79], v[52:55], v[236:239]
    v_mul_f32 v60, v22, v60
    v_mul_f32 v61, v22, v61
    v_mfma_f32_16x16x32_bf16 v[232:235], a[72:75], v[52:55], v[232:235]
    v_mul_f32 v62, v22, v62
    v_mul_f32 v63, v22, v63
    v_mfma_f32_16x16x32_bf16 v[228:231], a[68:71], v[52:55], v[228:231]
    s_add_u32 s36, s34, 200704
    v_cvt_pk_bf16_f32 v24, v56, v57
    v_cvt_pk_bf16_f32 v25, v58, v59
    v_mfma_f32_16x16x32_bf16 v[224:227], a[64:67], v[52:55], v[224:227]
    s_waitcnt vmcnt(18) lgkmcnt(0)
    s_barrier
    v_mfma_f32_16x16x32_bf16 v[64:67], a[0:3], a[32:35], v[64:67]
    ds_read_b64_tr_b16 a[236:237], v8 offset:17568
    v_cvt_pk_bf16_f32 v26, v60, v61
    v_mfma_f32_16x16x32_bf16 v[68:71], a[4:7], a[32:35], v[68:71]
    ds_read_b64_tr_b16 a[238:239], v8 offset:18080
    v_cvt_pk_bf16_f32 v27, v62, v63
    v_mfma_f32_16x16x32_bf16 v[72:75], a[8:11], a[32:35], v[72:75]
    s_add_u32 m0, s29, 101984
    s_xor_b32 s35, s61, 3407872
    ds_read_b64_tr_b16 a[240:241], v8 offset:17576
    v_mfma_f32_16x16x32_bf16 v[76:79], a[12:15], a[32:35], v[76:79]
    buffer_load_dwordx4 v2, s[12:15], s35 offen lds
    v_mfma_f32_16x16x32_bf16 v[80:83], a[16:19], a[32:35], v[80:83]
    ds_read_b64_tr_b16 a[242:243], v8 offset:18088
    v_accvgpr_read_b32 v56, a144
    v_mfma_f32_16x16x32_bf16 v[84:87], a[20:23], a[32:35], v[84:87]
    ds_read_b64_tr_b16 a[244:245], v8 offset:17632
    v_accvgpr_read_b32 v57, a145
    v_mfma_f32_16x16x32_bf16 v[88:91], a[24:27], a[32:35], v[88:91]
    s_add_u32 m0, s29, 103072
    s_xor_b32 s35, s61, 3416064
    ds_read_b64_tr_b16 a[246:247], v8 offset:18144
    v_mfma_f32_16x16x32_bf16 v[92:95], a[28:31], a[32:35], v[92:95]
    buffer_load_dwordx4 v2, s[12:15], s35 offen lds
    v_mfma_f32_16x16x32_bf16 v[124:127], a[28:31], a[36:39], v[124:127]
    v_accvgpr_read_b32 v58, a146
    v_accvgpr_read_b32 v59, a147
    v_mfma_f32_16x16x32_bf16 v[120:123], a[24:27], a[36:39], v[120:123]
    ds_read_b64_tr_b16 a[248:249], v8 offset:17640
    v_accvgpr_read_b32 v60, a148
    v_mfma_f32_16x16x32_bf16 v[116:119], a[20:23], a[36:39], v[116:119]
    s_add_u32 m0, s29, 104160
    s_xor_b32 s35, s61, 3424256
    ds_read_b64_tr_b16 a[250:251], v8 offset:18152
    v_mfma_f32_16x16x32_bf16 v[112:115], a[16:19], a[36:39], v[112:115]
    buffer_load_dwordx4 v2, s[12:15], s35 offen lds
    v_mfma_f32_16x16x32_bf16 v[108:111], a[12:15], a[36:39], v[108:111]
    ds_read_b128 v[32:35], v5 offset:59776
    v_accvgpr_read_b32 v61, a149
    v_mfma_f32_16x16x32_bf16 v[104:107], a[8:11], a[36:39], v[104:107]
    ds_read_b128 v[36:39], v5 offset:59904
    v_accvgpr_read_b32 v62, a150
    v_mfma_f32_16x16x32_bf16 v[100:103], a[4:7], a[36:39], v[100:103]
    s_add_u32 m0, s29, 105248
    s_xor_b32 s35, s61, 3432448
    ds_read_b128 v[40:43], v5 offset:60288
    v_mfma_f32_16x16x32_bf16 v[96:99], a[0:3], a[36:39], v[96:99]
    buffer_load_dwordx4 v2, s[12:15], s35 offen lds
    v_mfma_f32_16x16x32_bf16 v[128:131], a[0:3], a[40:43], v[128:131]
    v_accvgpr_read_b32 v63, a151
    v_mul_f32 v56, v22, v56
    v_mfma_f32_16x16x32_bf16 v[132:135], a[4:7], a[40:43], v[132:135]
    ds_read_b128 v[44:47], v5 offset:60416
    v_mul_f32 v57, v22, v57
    v_mfma_f32_16x16x32_bf16 v[136:139], a[8:11], a[40:43], v[136:139]
    s_add_u32 m0, s28, 0
    s_xor_b32 s35, s60, 896
    ds_read_b128 v[48:51], v5 offset:60800
    v_mfma_f32_16x16x32_bf16 v[140:143], a[12:15], a[40:43], v[140:143]
    buffer_load_dwordx4 v1, s[8:11], s35 offen offset:0 lds
    v_mfma_f32_16x16x32_bf16 v[144:147], a[16:19], a[40:43], v[144:147]
    ds_read_b128 v[52:55], v5 offset:60928
    v_mul_f32 v58, v22, v58
    v_mfma_f32_16x16x32_bf16 v[148:151], a[20:23], a[40:43], v[148:151]
    ds_read_b64_tr_b16 a[64:65], v7 offset:0
    v_mul_f32 v59, v22, v59
    v_mfma_f32_16x16x32_bf16 v[152:155], a[24:27], a[40:43], v[152:155]
    s_add_u32 m0, s28, 1824
    ds_read_b64_tr_b16 a[66:67], v7 offset:512
    v_mul_f32 v60, v22, v60
    v_mfma_f32_16x16x32_bf16 v[156:159], a[28:31], a[40:43], v[156:159]
    buffer_load_dwordx4 v1, s[8:11], s35 offen offset:1280 lds
    v_mfma_f32_16x16x32_bf16 v[188:191], a[28:31], a[44:47], v[188:191]
    v_mul_f32 v61, v22, v61
    v_mul_f32 v62, v22, v62
    v_mfma_f32_16x16x32_bf16 v[184:187], a[24:27], a[44:47], v[184:187]
    ds_read_b64_tr_b16 a[68:69], v7 offset:8
    v_mul_f32 v63, v22, v63
    v_mfma_f32_16x16x32_bf16 v[180:183], a[20:23], a[44:47], v[180:183]
    s_add_u32 m0, s28, 1024
    s_xor_b32 s35, s60, 82816
    ds_read_b64_tr_b16 a[70:71], v7 offset:520
    v_mfma_f32_16x16x32_bf16 v[176:179], a[16:19], a[44:47], v[176:179]
    buffer_load_dwordx4 v1, s[8:11], s35 offen offset:0 lds
    v_mfma_f32_16x16x32_bf16 v[172:175], a[12:15], a[44:47], v[172:175]
    ds_read_b64_tr_b16 a[72:73], v7 offset:64
    v_mfma_f32_16x16x32_bf16 v[168:171], a[8:11], a[44:47], v[168:171]
    ds_read_b64_tr_b16 a[74:75], v7 offset:576
    v_mfma_f32_16x16x32_bf16 v[164:167], a[4:7], a[44:47], v[164:167]
    s_add_u32 m0, s28, 2848
    ds_read_b64_tr_b16 a[76:77], v7 offset:72
    v_mfma_f32_16x16x32_bf16 v[160:163], a[0:3], a[44:47], v[160:163]
    buffer_load_dwordx4 v1, s[8:11], s35 offen offset:1280 lds
    v_mfma_f32_16x16x32_bf16 v[192:195], a[0:3], a[48:51], v[192:195]
    v_mfma_f32_16x16x32_bf16 v[196:199], a[4:7], a[48:51], v[196:199]
    ds_read_b64_tr_b16 a[78:79], v7 offset:584
    v_mfma_f32_16x16x32_bf16 v[200:203], a[8:11], a[48:51], v[200:203]
    s_add_u32 m0, s28, 2048
    s_xor_b32 s35, s60, 164736
    ds_read_b64_tr_b16 a[80:81], v7 offset:128
    v_mfma_f32_16x16x32_bf16 v[204:207], a[12:15], a[48:51], v[204:207]
    buffer_load_dwordx4 v1, s[8:11], s35 offen offset:0 lds
    v_mfma_f32_16x16x32_bf16 v[208:211], a[16:19], a[48:51], v[208:211]
    ds_read_b64_tr_b16 a[82:83], v7 offset:640
    v_mfma_f32_16x16x32_bf16 v[212:215], a[20:23], a[48:51], v[212:215]
    ds_read_b64_tr_b16 a[84:85], v7 offset:136
    v_mfma_f32_16x16x32_bf16 v[216:219], a[24:27], a[48:51], v[216:219]
    s_add_u32 m0, s28, 3872
    ds_read_b64_tr_b16 a[86:87], v7 offset:648
    v_mfma_f32_16x16x32_bf16 v[220:223], a[28:31], a[48:51], v[220:223]
    buffer_load_dwordx4 v1, s[8:11], s35 offen offset:1280 lds
    v_mfma_f32_16x16x32_bf16 v[252:255], a[28:31], a[52:55], v[252:255]
    v_mfma_f32_16x16x32_bf16 v[248:251], a[24:27], a[52:55], v[248:251]
    buffer_store_dwordx4 v[24:27], v4, s[24:27], s36 offen offset:0 sc1
    v_mfma_f32_16x16x32_bf16 v[244:247], a[20:23], a[52:55], v[244:247]
    v_mfma_f32_16x16x32_bf16 v[240:243], a[16:19], a[52:55], v[240:243]
    s_add_u32 s36, s34, 397312
    v_cvt_pk_bf16_f32 v24, v56, v57
    v_cvt_pk_bf16_f32 v25, v58, v59
    v_mfma_f32_16x16x32_bf16 v[236:239], a[12:15], a[52:55], v[236:239]
    v_cvt_pk_bf16_f32 v26, v60, v61
    v_cvt_pk_bf16_f32 v27, v62, v63
    v_mfma_f32_16x16x32_bf16 v[232:235], a[8:11], a[52:55], v[232:235]
    buffer_store_dwordx4 v[24:27], v4, s[24:27], s36 offen offset:0 sc1
    v_mfma_f32_16x16x32_bf16 v[228:231], a[4:7], a[52:55], v[228:231]
    v_mfma_f32_16x16x32_bf16 v[224:227], a[0:3], a[52:55], v[224:227]
    s_waitcnt vmcnt(19) lgkmcnt(0)
    s_barrier
    v_mfma_f32_16x16x32_bf16 v[64:67], a[220:223], a[96:99], v[64:67]
    ds_read_b64_tr_b16 a[88:89], v7 offset:192
    v_accvgpr_read_b32 v56, a152
    v_mfma_f32_16x16x32_bf16 v[68:71], a[224:227], a[96:99], v[68:71]
    ds_read_b64_tr_b16 a[90:91], v7 offset:704
    v_accvgpr_read_b32 v57, a153
    v_mfma_f32_16x16x32_bf16 v[72:75], a[228:231], a[96:99], v[72:75]
    s_add_u32 m0, s29, 119424
    s_xor_b32 s35, s61, 3670016
    ds_read_b64_tr_b16 a[92:93], v7 offset:200
    v_mfma_f32_16x16x32_bf16 v[76:79], a[232:235], a[96:99], v[76:79]
    buffer_load_dwordx4 v2, s[12:15], s35 offen lds
    v_mfma_f32_16x16x32_bf16 v[80:83], a[236:239], a[96:99], v[80:83]
    ds_read_b64_tr_b16 a[94:95], v7 offset:712
    v_accvgpr_read_b32 v58, a154
    v_mfma_f32_16x16x32_bf16 v[84:87], a[240:243], a[96:99], v[84:87]
    ds_read_b64_tr_b16 a[0:1], v7 offset:17440
    v_accvgpr_read_b32 v59, a155
    v_mfma_f32_16x16x32_bf16 v[88:91], a[244:247], a[96:99], v[88:91]
    s_add_u32 m0, s29, 120512
    s_xor_b32 s35, s61, 3678208
    ds_read_b64_tr_b16 a[2:3], v7 offset:17952
    v_mfma_f32_16x16x32_bf16 v[92:95], a[248:251], a[96:99], v[92:95]
    buffer_load_dwordx4 v2, s[12:15], s35 offen lds
    v_mfma_f32_16x16x32_bf16 v[124:127], a[248:251], a[100:103], v[124:127]
    v_accvgpr_read_b32 v60, a156
    v_accvgpr_read_b32 v61, a157
    v_mfma_f32_16x16x32_bf16 v[120:123], a[244:247], a[100:103], v[120:123]
    ds_read_b64_tr_b16 a[4:5], v7 offset:17448
    v_accvgpr_read_b32 v62, a158
    v_mfma_f32_16x16x32_bf16 v[116:119], a[240:243], a[100:103], v[116:119]
    s_add_u32 m0, s29, 121600
    s_xor_b32 s35, s61, 3686400
    ds_read_b64_tr_b16 a[6:7], v7 offset:17960
    v_mfma_f32_16x16x32_bf16 v[112:115], a[236:239], a[100:103], v[112:115]
    buffer_load_dwordx4 v2, s[12:15], s35 offen lds
    v_mfma_f32_16x16x32_bf16 v[108:111], a[232:235], a[100:103], v[108:111]
    ds_read_b128 a[32:35], v6 offset:0
    v_accvgpr_read_b32 v63, a159
    v_mfma_f32_16x16x32_bf16 v[104:107], a[228:231], a[100:103], v[104:107]
    ds_read_b128 a[36:39], v6 offset:128
    v_mul_f32 v56, v22, v56
    v_mfma_f32_16x16x32_bf16 v[100:103], a[224:227], a[100:103], v[100:103]
    s_add_u32 m0, s29, 122688
    s_xor_b32 s35, s61, 3694592
    ds_read_b128 a[40:43], v6 offset:512
    v_mfma_f32_16x16x32_bf16 v[96:99], a[220:223], a[100:103], v[96:99]
    buffer_load_dwordx4 v2, s[12:15], s35 offen lds
    v_mfma_f32_16x16x32_bf16 v[128:131], a[220:223], a[104:107], v[128:131]
    v_mul_f32 v57, v22, v57
    v_mul_f32 v58, v22, v58
    v_mfma_f32_16x16x32_bf16 v[132:135], a[224:227], a[104:107], v[132:135]
    ds_read_b128 a[44:47], v6 offset:640
    v_mul_f32 v59, v22, v59
    v_mfma_f32_16x16x32_bf16 v[136:139], a[228:231], a[104:107], v[136:139]
    s_add_u32 m0, s28, 59712
    s_xor_b32 s35, s60, 1024
    ds_read_b128 a[48:51], v6 offset:1024
    v_mfma_f32_16x16x32_bf16 v[140:143], a[232:235], a[104:107], v[140:143]
    buffer_load_dwordx4 v1, s[8:11], s35 offen offset:0 lds
    v_mfma_f32_16x16x32_bf16 v[144:147], a[236:239], a[104:107], v[144:147]
    ds_read_b128 a[52:55], v6 offset:1152
    v_mul_f32 v60, v22, v60
    v_mfma_f32_16x16x32_bf16 v[148:151], a[240:243], a[104:107], v[148:151]
    ds_read_b64_tr_b16 a[8:9], v7 offset:17504
    v_mul_f32 v61, v22, v61
    v_mfma_f32_16x16x32_bf16 v[152:155], a[244:247], a[104:107], v[152:155]
    s_add_u32 m0, s28, 61536
    ds_read_b64_tr_b16 a[10:11], v7 offset:18016
    v_mul_f32 v62, v22, v62
    v_mfma_f32_16x16x32_bf16 v[156:159], a[248:251], a[104:107], v[156:159]
    buffer_load_dwordx4 v1, s[8:11], s35 offen offset:1280 lds
    v_mfma_f32_16x16x32_bf16 v[188:191], a[248:251], a[108:111], v[188:191]
    v_mul_f32 v63, v22, v63
    v_mfma_f32_16x16x32_bf16 v[184:187], a[244:247], a[108:111], v[184:187]
    s_add_u32 s36, s34, 593920
    ds_read_b64_tr_b16 a[12:13], v7 offset:17512
    v_cvt_pk_bf16_f32 v24, v56, v57
    v_mfma_f32_16x16x32_bf16 v[180:183], a[240:243], a[108:111], v[180:183]
    s_add_u32 m0, s28, 60736
    s_xor_b32 s35, s60, 82944
    ds_read_b64_tr_b16 a[14:15], v7 offset:18024
    v_mfma_f32_16x16x32_bf16 v[176:179], a[236:239], a[108:111], v[176:179]
    buffer_load_dwordx4 v1, s[8:11], s35 offen offset:0 lds
    v_mfma_f32_16x16x32_bf16 v[172:175], a[232:235], a[108:111], v[172:175]
    ds_read_b64_tr_b16 a[16:17], v7 offset:17568
    v_cvt_pk_bf16_f32 v25, v58, v59
    v_mfma_f32_16x16x32_bf16 v[168:171], a[228:231], a[108:111], v[168:171]
    ds_read_b64_tr_b16 a[18:19], v7 offset:18080
    v_cvt_pk_bf16_f32 v26, v60, v61
    v_mfma_f32_16x16x32_bf16 v[164:167], a[224:227], a[108:111], v[164:167]
    s_add_u32 m0, s28, 62560
    ds_read_b64_tr_b16 a[20:21], v7 offset:17576
    v_cvt_pk_bf16_f32 v27, v62, v63
    v_mfma_f32_16x16x32_bf16 v[160:163], a[220:223], a[108:111], v[160:163]
    buffer_load_dwordx4 v1, s[8:11], s35 offen offset:1280 lds
    v_mfma_f32_16x16x32_bf16 v[192:195], a[220:223], a[112:115], v[192:195]
    v_mfma_f32_16x16x32_bf16 v[196:199], a[224:227], a[112:115], v[196:199]
    ds_read_b64_tr_b16 a[22:23], v7 offset:18088
    v_cmp_le_u32 s[40:41], s47, v28
    v_mfma_f32_16x16x32_bf16 v[200:203], a[228:231], a[112:115], v[200:203]
    s_add_u32 m0, s28, 61760
    s_xor_b32 s35, s60, 164864
    ds_read_b64_tr_b16 a[24:25], v7 offset:17632
    v_mfma_f32_16x16x32_bf16 v[204:207], a[232:235], a[112:115], v[204:207]
    buffer_load_dwordx4 v1, s[8:11], s35 offen offset:0 lds
    v_mfma_f32_16x16x32_bf16 v[208:211], a[236:239], a[112:115], v[208:211]
    ds_read_b64_tr_b16 a[26:27], v7 offset:18144
    v_mov_b32 v57, 163776
    v_mfma_f32_16x16x32_bf16 v[212:215], a[240:243], a[112:115], v[212:215]
    s_cmp_lg_u64 s[40:41], 0
    s_cselect_b32 s85, 1, 0
    ds_read_b64_tr_b16 a[28:29], v7 offset:17640
    v_mfma_f32_16x16x32_bf16 v[216:219], a[244:247], a[112:115], v[216:219]
    s_add_u32 m0, s28, 63584
    s_or_b32 s42, s42, s85
    ds_read_b64_tr_b16 a[30:31], v7 offset:18152
    v_mfma_f32_16x16x32_bf16 v[220:223], a[248:251], a[112:115], v[220:223]
    s_lshl_b32 s85, s43, 2
    buffer_load_dwordx4 v1, s[8:11], s35 offen offset:1280 lds
    v_mfma_f32_16x16x32_bf16 v[252:255], a[248:251], a[116:119], v[252:255]
    v_mov_b32 v56, s42
    v_add_u32 v58, s85, v57
    v_mfma_f32_16x16x32_bf16 v[248:251], a[244:247], a[116:119], v[248:251]
    buffer_store_dwordx4 v[24:27], v4, s[24:27], s36 offen offset:0 sc1
    v_mfma_f32_16x16x32_bf16 v[244:247], a[240:243], a[116:119], v[244:247]
    ds_write_b32 v58, v56
    v_mfma_f32_16x16x32_bf16 v[240:243], a[236:239], a[116:119], v[240:243]
    v_mfma_f32_16x16x32_bf16 v[236:239], a[232:235], a[116:119], v[236:239]
    v_mfma_f32_16x16x32_bf16 v[232:235], a[228:231], a[116:119], v[232:235]
    v_mfma_f32_16x16x32_bf16 v[228:231], a[224:227], a[116:119], v[228:231]
    v_mfma_f32_16x16x32_bf16 v[224:227], a[220:223], a[116:119], v[224:227]
    s_waitcnt vmcnt(19) lgkmcnt(0)
    s_barrier
    v_mfma_f32_16x16x32_bf16 v[64:67], a[64:67], a[160:163], v[64:67]
    ds_read_b128 a[96:99], v6 offset:64
    v_mfma_f32_16x16x32_bf16 v[68:71], a[68:71], a[160:163], v[68:71]
    ds_read_b128 a[100:103], v6 offset:192
    v_mfma_f32_16x16x32_bf16 v[72:75], a[72:75], a[160:163], v[72:75]
    s_add_u32 m0, s29, 24832
    s_xor_b32 s35, s61, 3932160
    ds_read_b128 a[104:107], v6 offset:576
    v_mfma_f32_16x16x32_bf16 v[76:79], a[76:79], a[160:163], v[76:79]
    buffer_load_dwordx4 v2, s[12:15], s35 offen lds
    v_mfma_f32_16x16x32_bf16 v[80:83], a[80:83], a[160:163], v[80:83]
    ds_read_b128 a[108:111], v6 offset:704
    v_mfma_f32_16x16x32_bf16 v[84:87], a[84:87], a[160:163], v[84:87]
    ds_read_b128 v[60:63], v57
    v_mfma_f32_16x16x32_bf16 v[88:91], a[88:91], a[160:163], v[88:91]
    ds_read_b128 a[112:115], v6 offset:1088
    v_mfma_f32_16x16x32_bf16 v[92:95], a[92:95], a[160:163], v[92:95]
    s_add_u32 m0, s29, 25920
    s_xor_b32 s35, s61, 3940352
    ds_read_b128 a[116:119], v6 offset:1216
    v_mfma_f32_16x16x32_bf16 v[124:127], a[92:95], a[164:167], v[124:127]
    buffer_load_dwordx4 v2, s[12:15], s35 offen lds
    v_mfma_f32_16x16x32_bf16 v[120:123], a[88:91], a[164:167], v[120:123]
    ds_read_b64_tr_b16 a[220:221], v7 offset:59712
    v_mfma_f32_16x16x32_bf16 v[116:119], a[84:87], a[164:167], v[116:119]
    ds_read_b64_tr_b16 a[222:223], v7 offset:60224
    v_mfma_f32_16x16x32_bf16 v[112:115], a[80:83], a[164:167], v[112:115]
    v_mfma_f32_16x16x32_bf16 v[108:111], a[76:79], a[164:167], v[108:111]
    s_add_u32 m0, s29, 27008
    s_xor_b32 s35, s61, 3948544
    ds_read_b64_tr_b16 a[224:225], v7 offset:59720
    v_mfma_f32_16x16x32_bf16 v[104:107], a[72:75], a[164:167], v[104:107]
    buffer_load_dwordx4 v2, s[12:15], s35 offen lds
    v_mfma_f32_16x16x32_bf16 v[100:103], a[68:71], a[164:167], v[100:103]
    ds_read_b64_tr_b16 a[226:227], v7 offset:60232
    v_mfma_f32_16x16x32_bf16 v[96:99], a[64:67], a[164:167], v[96:99]
    ds_read_b64_tr_b16 a[228:229], v7 offset:59776
    v_mfma_f32_16x16x32_bf16 v[128:131], a[64:67], a[168:171], v[128:131]
    ds_read_b64_tr_b16 a[230:231], v7 offset:60288
    v_mfma_f32_16x16x32_bf16 v[132:135], a[68:71], a[168:171], v[132:135]
    s_add_u32 m0, s29, 28096
    s_xor_b32 s35, s61, 3956736
    v_mfma_f32_16x16x32_bf16 v[136:139], a[72:75], a[168:171], v[136:139]
    buffer_load_dwordx4 v2, s[12:15], s35 offen lds
    v_mfma_f32_16x16x32_bf16 v[140:143], a[76:79], a[168:171], v[140:143]
    ds_read_b64_tr_b16 a[232:233], v7 offset:59784
    v_mfma_f32_16x16x32_bf16 v[144:147], a[80:83], a[168:171], v[144:147]
    ds_read_b64_tr_b16 a[234:235], v7 offset:60296
    v_mfma_f32_16x16x32_bf16 v[148:151], a[84:87], a[168:171], v[148:151]
    ds_read_b64_tr_b16 a[236:237], v7 offset:59840
    v_mfma_f32_16x16x32_bf16 v[152:155], a[88:91], a[168:171], v[152:155]
    s_add_u32 m0, s29, 42272
    s_xor_b32 s35, s61, 4194304
    v_mfma_f32_16x16x32_bf16 v[156:159], a[92:95], a[168:171], v[156:159]
    buffer_load_dwordx4 v2, s[12:15], s35 offen lds
    v_mfma_f32_16x16x32_bf16 v[188:191], a[92:95], a[172:175], v[188:191]
    ds_read_b64_tr_b16 a[238:239], v7 offset:60352
    v_mfma_f32_16x16x32_bf16 v[184:187], a[88:91], a[172:175], v[184:187]
    ds_read_b64_tr_b16 a[240:241], v7 offset:59848
    v_mfma_f32_16x16x32_bf16 v[180:183], a[84:87], a[172:175], v[180:183]
    ds_read_b64_tr_b16 a[242:243], v7 offset:60360
    v_mfma_f32_16x16x32_bf16 v[176:179], a[80:83], a[172:175], v[176:179]
    s_add_u32 m0, s29, 43360
    s_xor_b32 s35, s61, 4202496
    ds_read_b64_tr_b16 a[244:245], v7 offset:59904
    v_mfma_f32_16x16x32_bf16 v[172:175], a[76:79], a[172:175], v[172:175]
    buffer_load_dwordx4 v2, s[12:15], s35 offen lds
    v_mfma_f32_16x16x32_bf16 v[168:171], a[72:75], a[172:175], v[168:171]
    v_mfma_f32_16x16x32_bf16 v[164:167], a[68:71], a[172:175], v[164:167]
    ds_read_b64_tr_b16 a[246:247], v7 offset:60416
    v_mfma_f32_16x16x32_bf16 v[160:163], a[64:67], a[172:175], v[160:163]
    ds_read_b64_tr_b16 a[248:249], v7 offset:59912
    v_mfma_f32_16x16x32_bf16 v[192:195], a[64:67], a[176:179], v[192:195]
    s_add_u32 m0, s29, 44448
    s_xor_b32 s35, s61, 4210688
    ds_read_b64_tr_b16 a[250:251], v7 offset:60424
    v_mfma_f32_16x16x32_bf16 v[196:199], a[68:71], a[176:179], v[196:199]
    buffer_load_dwordx4 v2, s[12:15], s35 offen lds
    v_mfma_f32_16x16x32_bf16 v[200:203], a[72:75], a[176:179], v[200:203]
    ds_read_b64_tr_b16 a[128:129], v8 offset:0
    v_mfma_f32_16x16x32_bf16 v[204:207], a[76:79], a[176:179], v[204:207]
    v_mfma_f32_16x16x32_bf16 v[208:211], a[80:83], a[176:179], v[208:211]
    ds_read_b64_tr_b16 a[130:131], v8 offset:512
    v_mfma_f32_16x16x32_bf16 v[212:215], a[84:87], a[176:179], v[212:215]
    s_add_u32 m0, s29, 45536
    s_xor_b32 s35, s61, 4218880
    ds_read_b64_tr_b16 a[132:133], v8 offset:8
    v_mfma_f32_16x16x32_bf16 v[216:219], a[88:91], a[176:179], v[216:219]
    buffer_load_dwordx4 v2, s[12:15], s35 offen lds
    v_mfma_f32_16x16x32_bf16 v[220:223], a[92:95], a[176:179], v[220:223]
    ds_read_b64_tr_b16 a[134:135], v8 offset:520
    v_mfma_f32_16x16x32_bf16 v[252:255], a[92:95], a[180:183], v[252:255]
    v_mfma_f32_16x16x32_bf16 v[248:251], a[88:91], a[180:183], v[248:251]
    v_mfma_f32_16x16x32_bf16 v[244:247], a[84:87], a[180:183], v[244:247]
    v_mfma_f32_16x16x32_bf16 v[240:243], a[80:83], a[180:183], v[240:243]
    v_mfma_f32_16x16x32_bf16 v[236:239], a[76:79], a[180:183], v[236:239]
    v_mfma_f32_16x16x32_bf16 v[232:235], a[72:75], a[180:183], v[232:235]
    v_mfma_f32_16x16x32_bf16 v[228:231], a[68:71], a[180:183], v[228:231]
    v_mfma_f32_16x16x32_bf16 v[224:227], a[64:67], a[180:183], v[224:227]
    s_waitcnt vmcnt(15) lgkmcnt(0)
    s_barrier
    v_mfma_f32_16x16x32_bf16 v[64:67], a[0:3], v[32:35], v[64:67]
    ds_read_b128 a[160:163], v5 offset:0
    v_or3_b32 v56, v60, v61, v62
    v_mfma_f32_16x16x32_bf16 v[68:71], a[4:7], v[32:35], v[68:71]
    ds_read_b128 a[164:167], v5 offset:128
    v_or_b32 v56, v56, v63
    v_mfma_f32_16x16x32_bf16 v[72:75], a[8:11], v[32:35], v[72:75]
    s_add_u32 m0, s29, 84544
    s_xor_b32 s35, s61, 4456448
    ds_read_b128 a[168:171], v5 offset:512
    v_mfma_f32_16x16x32_bf16 v[76:79], a[12:15], v[32:35], v[76:79]
    buffer_load_dwordx4 v2, s[12:15], s35 offen lds
    v_mfma_f32_16x16x32_bf16 v[80:83], a[16:19], v[32:35], v[80:83]
    ds_read_b128 a[172:175], v5 offset:640
    v_readfirstlane_b32 s87, v56
    v_mfma_f32_16x16x32_bf16 v[84:87], a[20:23], v[32:35], v[84:87]
    s_cmp_eq_u32 s87, 0
    s_cselect_b32 s70, s86, 0
    ds_read_b128 a[176:179], v5 offset:1024
    v_mfma_f32_16x16x32_bf16 v[88:91], a[24:27], v[32:35], v[88:91]
    s_add_u32 m0, s29, 85632
    s_xor_b32 s35, s61, 4464640
    ds_read_b128 a[180:183], v5 offset:1152
    v_mfma_f32_16x16x32_bf16 v[92:95], a[28:31], v[32:35], v[92:95]
    buffer_load_dwordx4 v2, s[12:15], s35 offen lds
    v_mfma_f32_16x16x32_bf16 v[124:127], a[28:31], v[36:39], v[124:127]
    v_accvgpr_write_b32 a192, 0
    v_accvgpr_write_b32 a193, 0
    v_mfma_f32_16x16x32_bf16 v[120:123], a[24:27], v[36:39], v[120:123]
    ds_read_b64_tr_b16 a[136:137], v8 offset:64
    v_accvgpr_write_b32 a194, 0
    v_mfma_f32_16x16x32_bf16 v[116:119], a[20:23], v[36:39], v[116:119]
    s_add_u32 m0, s29, 86720
    s_xor_b32 s35, s61, 4472832
    ds_read_b64_tr_b16 a[138:139], v8 offset:576
    v_mfma_f32_16x16x32_bf16 v[112:115], a[16:19], v[36:39], v[112:115]
    buffer_load_dwordx4 v2, s[12:15], s35 offen lds
    v_mfma_f32_16x16x32_bf16 v[108:111], a[12:15], v[36:39], v[108:111]
    ds_read_b64_tr_b16 a[140:141], v8 offset:72
    v_accvgpr_write_b32 a195, 0
    v_mfma_f32_16x16x32_bf16 v[104:107], a[8:11], v[36:39], v[104:107]
    ds_read_b64_tr_b16 a[142:143], v8 offset:584
    v_accvgpr_write_b32 a196, 0
    v_mfma_f32_16x16x32_bf16 v[100:103], a[4:7], v[36:39], v[100:103]
    s_add_u32 m0, s29, 87808
    s_xor_b32 s35, s61, 4481024
    ds_read_b64_tr_b16 a[144:145], v8 offset:128
    v_mfma_f32_16x16x32_bf16 v[96:99], a[0:3], v[36:39], v[96:99]
    buffer_load_dwordx4 v2, s[12:15], s35 offen lds
    v_mfma_f32_16x16x32_bf16 v[128:131], a[0:3], v[40:43], v[128:131]
    v_accvgpr_write_b32 a197, 0
    v_accvgpr_write_b32 a198, 0
    v_mfma_f32_16x16x32_bf16 v[132:135], a[4:7], v[40:43], v[132:135]
    ds_read_b64_tr_b16 a[146:147], v8 offset:640
    v_accvgpr_write_b32 a199, 0
    v_mfma_f32_16x16x32_bf16 v[136:139], a[8:11], v[40:43], v[136:139]
    s_add_u32 m0, s28, 136864
    s_xor_b32 s35, s60, 1152
    ds_read_b64_tr_b16 a[148:149], v8 offset:136
    v_mfma_f32_16x16x32_bf16 v[140:143], a[12:15], v[40:43], v[140:143]
    buffer_load_dwordx4 v1, s[8:11], s35 offen offset:0 lds
    v_mfma_f32_16x16x32_bf16 v[144:147], a[16:19], v[40:43], v[144:147]
    ds_read_b64_tr_b16 a[150:151], v8 offset:648
    v_accvgpr_write_b32 a200, 0
    v_mfma_f32_16x16x32_bf16 v[148:151], a[20:23], v[40:43], v[148:151]
    ds_read_b64_tr_b16 a[152:153], v8 offset:192
    v_accvgpr_write_b32 a201, 0
    v_mfma_f32_16x16x32_bf16 v[152:155], a[24:27], v[40:43], v[152:155]
    s_add_u32 m0, s28, 138688
    ds_read_b64_tr_b16 a[154:155], v8 offset:704
    v_accvgpr_write_b32 a202, 0
    v_mfma_f32_16x16x32_bf16 v[156:159], a[28:31], v[40:43], v[156:159]
    buffer_load_dwordx4 v1, s[8:11], s35 offen offset:1280 lds
    v_mfma_f32_16x16x32_bf16 v[188:191], a[28:31], v[44:47], v[188:191]
    v_accvgpr_write_b32 a203, 0
    v_mfma_f32_16x16x32_bf16 v[184:187], a[24:27], v[44:47], v[184:187]
    ds_read_b64_tr_b16 a[156:157], v8 offset:200
    v_mfma_f32_16x16x32_bf16 v[180:183], a[20:23], v[44:47], v[180:183]
    s_add_u32 m0, s28, 137888
    s_xor_b32 s35, s60, 83072
    ds_read_b64_tr_b16 a[158:159], v8 offset:712
    v_mfma_f32_16x16x32_bf16 v[176:179], a[16:19], v[44:47], v[176:179]
    buffer_load_dwordx4 v1, s[8:11], s35 offen offset:0 lds
    v_mfma_f32_16x16x32_bf16 v[172:175], a[12:15], v[44:47], v[172:175]
    ds_read_b64_tr_b16 a[64:65], v8 offset:17440
    v_mfma_f32_16x16x32_bf16 v[168:171], a[8:11], v[44:47], v[168:171]
    ds_read_b64_tr_b16 a[66:67], v8 offset:17952
    v_mfma_f32_16x16x32_bf16 v[164:167], a[4:7], v[44:47], v[164:167]
    s_add_u32 m0, s28, 139712
    ds_read_b64_tr_b16 a[68:69], v8 offset:17448
    v_mfma_f32_16x16x32_bf16 v[160:163], a[0:3], v[44:47], v[160:163]
    buffer_load_dwordx4 v1, s[8:11], s35 offen offset:1280 lds
    v_mfma_f32_16x16x32_bf16 v[192:195], a[0:3], v[48:51], v[192:195]
    v_mfma_f32_16x16x32_bf16 v[196:199], a[4:7], v[48:51], v[196:199]
    ds_read_b64_tr_b16 a[70:71], v8 offset:17960
    v_mfma_f32_16x16x32_bf16 v[200:203], a[8:11], v[48:51], v[200:203]
    s_add_u32 m0, s28, 138912
    s_xor_b32 s35, s60, 164992
    ds_read_b64_tr_b16 a[72:73], v8 offset:17504
    v_mfma_f32_16x16x32_bf16 v[204:207], a[12:15], v[48:51], v[204:207]
    buffer_load_dwordx4 v1, s[8:11], s35 offen offset:0 lds
    v_mfma_f32_16x16x32_bf16 v[208:211], a[16:19], v[48:51], v[208:211]
    ds_read_b64_tr_b16 a[74:75], v8 offset:18016
    v_mfma_f32_16x16x32_bf16 v[212:215], a[20:23], v[48:51], v[212:215]
    ds_read_b64_tr_b16 a[76:77], v8 offset:17512
    v_mfma_f32_16x16x32_bf16 v[216:219], a[24:27], v[48:51], v[216:219]
    s_add_u32 m0, s28, 140736
    ds_read_b64_tr_b16 a[78:79], v8 offset:18024
    v_mfma_f32_16x16x32_bf16 v[220:223], a[28:31], v[48:51], v[220:223]
    buffer_load_dwordx4 v1, s[8:11], s35 offen offset:1280 lds
    v_mfma_f32_16x16x32_bf16 v[252:255], a[28:31], v[52:55], v[252:255]
    v_mfma_f32_16x16x32_bf16 v[248:251], a[24:27], v[52:55], v[248:251]
    v_mfma_f32_16x16x32_bf16 v[244:247], a[20:23], v[52:55], v[244:247]
    v_mfma_f32_16x16x32_bf16 v[240:243], a[16:19], v[52:55], v[240:243]
    v_mfma_f32_16x16x32_bf16 v[236:239], a[12:15], v[52:55], v[236:239]
    v_mfma_f32_16x16x32_bf16 v[232:235], a[8:11], v[52:55], v[232:235]
    v_mfma_f32_16x16x32_bf16 v[228:231], a[4:7], v[52:55], v[228:231]
    v_mfma_f32_16x16x32_bf16 v[224:227], a[0:3], v[52:55], v[224:227]
    s_waitcnt vmcnt(14) lgkmcnt(0)
    s_barrier
    v_mfma_f32_16x16x32_bf16 v[64:67], a[220:223], a[32:35], v[64:67]
    ds_read_b128 v[32:35], v5 offset:64
    v_mfma_f32_16x16x32_bf16 v[68:71], a[224:227], a[32:35], v[68:71]
    ds_read_b128 v[36:39], v5 offset:192
    v_mfma_f32_16x16x32_bf16 v[72:75], a[228:231], a[32:35], v[72:75]
    s_add_u32 m0, s29, 101984
    s_xor_b32 s35, s61, 4718592
    ds_read_b128 v[40:43], v5 offset:576
    v_mfma_f32_16x16x32_bf16 v[76:79], a[232:235], a[32:35], v[76:79]
    buffer_load_dwordx4 v2, s[12:15], s35 offen lds
    v_mfma_f32_16x16x32_bf16 v[80:83], a[236:239], a[32:35], v[80:83]
    v_mfma_f32_16x16x32_bf16 v[84:87], a[240:243], a[32:35], v[84:87]
    ds_read_b128 v[44:47], v5 offset:704
    v_mfma_f32_16x16x32_bf16 v[88:91], a[244:247], a[32:35], v[88:91]
    ds_read_b128 v[48:51], v5 offset:1088
    v_mfma_f32_16x16x32_bf16 v[92:95], a[248:251], a[32:35], v[92:95]
    v_mfma_f32_16x16x32_bf16 v[124:127], a[248:251], a[36:39], v[124:127]
    ds_read_b128 v[52:55], v5 offset:1216
    v_mfma_f32_16x16x32_bf16 v[120:123], a[244:247], a[36:39], v[120:123]
    ds_read_b64_tr_b16 a[80:81], v8 offset:17568
    v_mfma_f32_16x16x32_bf16 v[116:119], a[240:243], a[36:39], v[116:119]
    s_add_u32 m0, s29, 103072
    s_xor_b32 s35, s61, 4726784
    ds_read_b64_tr_b16 a[82:83], v8 offset:18080
    v_mfma_f32_16x16x32_bf16 v[112:115], a[236:239], a[36:39], v[112:115]
    buffer_load_dwordx4 v2, s[12:15], s35 offen lds
    v_mfma_f32_16x16x32_bf16 v[108:111], a[232:235], a[36:39], v[108:111]
    v_mfma_f32_16x16x32_bf16 v[104:107], a[228:231], a[36:39], v[104:107]
    ds_read_b64_tr_b16 a[84:85], v8 offset:17576
    v_mfma_f32_16x16x32_bf16 v[100:103], a[224:227], a[36:39], v[100:103]
    ds_read_b64_tr_b16 a[86:87], v8 offset:18088
    v_mfma_f32_16x16x32_bf16 v[96:99], a[220:223], a[36:39], v[96:99]
    v_mfma_f32_16x16x32_bf16 v[128:131], a[220:223], a[40:43], v[128:131]
    ds_read_b64_tr_b16 a[88:89], v8 offset:17632
    v_mfma_f32_16x16x32_bf16 v[132:135], a[224:227], a[40:43], v[132:135]
    ds_read_b64_tr_b16 a[90:91], v8 offset:18144
    v_mfma_f32_16x16x32_bf16 v[136:139], a[228:231], a[40:43], v[136:139]
    s_add_u32 m0, s29, 104160
    s_xor_b32 s35, s61, 4734976
    v_mfma_f32_16x16x32_bf16 v[140:143], a[232:235], a[40:43], v[140:143]
    buffer_load_dwordx4 v2, s[12:15], s35 offen lds
    v_mfma_f32_16x16x32_bf16 v[144:147], a[236:239], a[40:43], v[144:147]
    ds_read_b64_tr_b16 a[92:93], v8 offset:17640
    v_mfma_f32_16x16x32_bf16 v[148:151], a[240:243], a[40:43], v[148:151]
    ds_read_b64_tr_b16 a[94:95], v8 offset:18152
    v_mfma_f32_16x16x32_bf16 v[152:155], a[244:247], a[40:43], v[152:155]
    ds_read_b64_tr_b16 a[0:1], v7 offset:0
    v_mfma_f32_16x16x32_bf16 v[156:159], a[248:251], a[40:43], v[156:159]
    v_mfma_f32_16x16x32_bf16 v[188:191], a[248:251], a[44:47], v[188:191]
    ds_read_b64_tr_b16 a[2:3], v7 offset:512
    v_mfma_f32_16x16x32_bf16 v[184:187], a[244:247], a[44:47], v[184:187]
    ds_read_b64_tr_b16 a[4:5], v7 offset:8
    v_mfma_f32_16x16x32_bf16 v[180:183], a[240:243], a[44:47], v[180:183]
    s_add_u32 m0, s29, 105248
    s_xor_b32 s35, s61, 4743168
    v_mfma_f32_16x16x32_bf16 v[176:179], a[236:239], a[44:47], v[176:179]
    buffer_load_dwordx4 v2, s[12:15], s35 offen lds
    v_mfma_f32_16x16x32_bf16 v[172:175], a[232:235], a[44:47], v[172:175]
    ds_read_b64_tr_b16 a[6:7], v7 offset:520
    v_mfma_f32_16x16x32_bf16 v[168:171], a[228:231], a[44:47], v[168:171]
    ds_read_b64_tr_b16 a[8:9], v7 offset:64
    v_mfma_f32_16x16x32_bf16 v[164:167], a[224:227], a[44:47], v[164:167]
    v_mfma_f32_16x16x32_bf16 v[160:163], a[220:223], a[44:47], v[160:163]
    ds_read_b64_tr_b16 a[10:11], v7 offset:576
    v_mfma_f32_16x16x32_bf16 v[192:195], a[220:223], a[48:51], v[192:195]
    ds_read_b64_tr_b16 a[12:13], v7 offset:72
    v_mfma_f32_16x16x32_bf16 v[196:199], a[224:227], a[48:51], v[196:199]
    ds_read_b64_tr_b16 a[14:15], v7 offset:584
    v_mfma_f32_16x16x32_bf16 v[200:203], a[228:231], a[48:51], v[200:203]
    v_mfma_f32_16x16x32_bf16 v[204:207], a[232:235], a[48:51], v[204:207]
    ds_read_b64_tr_b16 a[16:17], v7 offset:128
    v_mfma_f32_16x16x32_bf16 v[208:211], a[236:239], a[48:51], v[208:211]
    ds_read_b64_tr_b16 a[18:19], v7 offset:640
    v_mfma_f32_16x16x32_bf16 v[212:215], a[240:243], a[48:51], v[212:215]
    v_mfma_f32_16x16x32_bf16 v[216:219], a[244:247], a[48:51], v[216:219]
    ds_read_b64_tr_b16 a[20:21], v7 offset:136
    v_mfma_f32_16x16x32_bf16 v[220:223], a[248:251], a[48:51], v[220:223]
    ds_read_b64_tr_b16 a[22:23], v7 offset:648
    v_mfma_f32_16x16x32_bf16 v[252:255], a[248:251], a[52:55], v[252:255]
    v_mfma_f32_16x16x32_bf16 v[248:251], a[244:247], a[52:55], v[248:251]
    v_mfma_f32_16x16x32_bf16 v[244:247], a[240:243], a[52:55], v[244:247]
    v_mfma_f32_16x16x32_bf16 v[240:243], a[236:239], a[52:55], v[240:243]
    v_mfma_f32_16x16x32_bf16 v[236:239], a[232:235], a[52:55], v[236:239]
    v_mfma_f32_16x16x32_bf16 v[232:235], a[228:231], a[52:55], v[232:235]
    v_mfma_f32_16x16x32_bf16 v[228:231], a[224:227], a[52:55], v[228:231]
    v_mfma_f32_16x16x32_bf16 v[224:227], a[220:223], a[52:55], v[224:227]
    s_waitcnt vmcnt(14) lgkmcnt(0)
    s_barrier
    v_mfma_f32_16x16x32_bf16 v[64:67], a[128:131], a[96:99], v[64:67]
    ds_read_b128 a[32:35], v5 offset:59712
    v_mfma_f32_16x16x32_bf16 v[68:71], a[132:135], a[96:99], v[68:71]
    ds_read_b128 a[36:39], v5 offset:59840
    v_mfma_f32_16x16x32_bf16 v[72:75], a[136:139], a[96:99], v[72:75]
    s_add_u32 m0, s29, 119424
    s_xor_b32 s35, s61, 4980736
    ds_read_b128 a[40:43], v5 offset:60224
    v_mfma_f32_16x16x32_bf16 v[76:79], a[140:143], a[96:99], v[76:79]
    buffer_load_dwordx4 v2, s[12:15], s35 offen lds
    v_mfma_f32_16x16x32_bf16 v[80:83], a[144:147], a[96:99], v[80:83]
    ds_read_b128 a[44:47], v5 offset:60352
    v_mfma_f32_16x16x32_bf16 v[84:87], a[148:151], a[96:99], v[84:87]
    v_mfma_f32_16x16x32_bf16 v[88:91], a[152:155], a[96:99], v[88:91]
    ds_read_b128 a[48:51], v5 offset:60736
    v_mfma_f32_16x16x32_bf16 v[92:95], a[156:159], a[96:99], v[92:95]
    s_add_u32 m0, s29, 120512
    s_xor_b32 s35, s61, 4988928
    ds_read_b128 a[52:55], v5 offset:60864
    v_mfma_f32_16x16x32_bf16 v[124:127], a[156:159], a[100:103], v[124:127]
    buffer_load_dwordx4 v2, s[12:15], s35 offen lds
    v_mfma_f32_16x16x32_bf16 v[120:123], a[152:155], a[100:103], v[120:123]
    ds_read_b64_tr_b16 a[24:25], v7 offset:192
    v_mfma_f32_16x16x32_bf16 v[116:119], a[148:151], a[100:103], v[116:119]
    ds_read_b64_tr_b16 a[26:27], v7 offset:704
    v_mfma_f32_16x16x32_bf16 v[112:115], a[144:147], a[100:103], v[112:115]
    v_mfma_f32_16x16x32_bf16 v[108:111], a[140:143], a[100:103], v[108:111]
    s_add_u32 m0, s29, 121600
    s_xor_b32 s35, s61, 4997120
    ds_read_b64_tr_b16 a[28:29], v7 offset:200
    v_mfma_f32_16x16x32_bf16 v[104:107], a[136:139], a[100:103], v[104:107]
    buffer_load_dwordx4 v2, s[12:15], s35 offen lds
    v_mfma_f32_16x16x32_bf16 v[100:103], a[132:135], a[100:103], v[100:103]
    ds_read_b64_tr_b16 a[30:31], v7 offset:712
    v_mfma_f32_16x16x32_bf16 v[96:99], a[128:131], a[100:103], v[96:99]
    ds_read_b64_tr_b16 a[220:221], v7 offset:17440
    v_mfma_f32_16x16x32_bf16 v[128:131], a[128:131], a[104:107], v[128:131]
    ds_read_b64_tr_b16 a[222:223], v7 offset:17952
    v_mfma_f32_16x16x32_bf16 v[132:135], a[132:135], a[104:107], v[132:135]
    s_add_u32 m0, s29, 122688
    s_xor_b32 s35, s61, 5005312
    v_mfma_f32_16x16x32_bf16 v[136:139], a[136:139], a[104:107], v[136:139]
    buffer_load_dwordx4 v2, s[12:15], s35 offen lds
    v_mfma_f32_16x16x32_bf16 v[140:143], a[140:143], a[104:107], v[140:143]
    ds_read_b64_tr_b16 a[224:225], v7 offset:17448
    v_mfma_f32_16x16x32_bf16 v[144:147], a[144:147], a[104:107], v[144:147]
    ds_read_b64_tr_b16 a[226:227], v7 offset:17960
    v_mfma_f32_16x16x32_bf16 v[148:151], a[148:151], a[104:107], v[148:151]
    s_add_u32 m0, s30, 0
    s_mul_i32 s35, s80, 0
    ds_read_b64_tr_b16 a[228:229], v7 offset:17504
    v_mfma_f32_16x16x32_bf16 v[152:155], a[152:155], a[104:107], v[152:155]
    s_add_u32 s35, s35, s101
    s_and_b32 s35, s35, 0x1e000
    s_or_b32 s35, s35, s75
    v_mfma_f32_16x16x32_bf16 v[156:159], a[156:159], a[104:107], v[156:159]
    buffer_load_dwordx4 v3, s[16:19], s35 offen offset:0 nt lds
    v_mfma_f32_16x16x32_bf16 v[188:191], a[156:159], a[108:111], v[188:191]
    ds_read_b64_tr_b16 a[230:231], v7 offset:18016
    v_mfma_f32_16x16x32_bf16 v[184:187], a[152:155], a[108:111], v[184:187]
    ds_read_b64_tr_b16 a[232:233], v7 offset:17512
    v_mfma_f32_16x16x32_bf16 v[180:183], a[148:151], a[108:111], v[180:183]
    ds_read_b64_tr_b16 a[234:235], v7 offset:18024
    v_mfma_f32_16x16x32_bf16 v[176:179], a[144:147], a[108:111], v[176:179]
    s_add_u32 m0, s30, 800
    ds_read_b64_tr_b16 a[236:237], v7 offset:17568
    v_mfma_f32_16x16x32_bf16 v[172:175], a[140:143], a[108:111], v[172:175]
    buffer_load_dwordx4 v3, s[16:19], s35 offen offset:256 nt lds
    v_mfma_f32_16x16x32_bf16 v[168:171], a[136:139], a[108:111], v[168:171]
    v_mfma_f32_16x16x32_bf16 v[164:167], a[132:135], a[108:111], v[164:167]
    ds_read_b64_tr_b16 a[238:239], v7 offset:18080
    v_mfma_f32_16x16x32_bf16 v[160:163], a[128:131], a[108:111], v[160:163]
    ds_read_b64_tr_b16 a[240:241], v7 offset:17576
    v_mfma_f32_16x16x32_bf16 v[192:195], a[128:131], a[112:115], v[192:195]
    s_add_u32 m0, s30, 1600
    ds_read_b64_tr_b16 a[242:243], v7 offset:18088
    v_mfma_f32_16x16x32_bf16 v[196:199], a[132:135], a[112:115], v[196:199]
    buffer_load_dwordx4 v3, s[16:19], s35 offen offset:512 nt lds
    v_mfma_f32_16x16x32_bf16 v[200:203], a[136:139], a[112:115], v[200:203]
    ds_read_b64_tr_b16 a[244:245], v7 offset:17632
    v_mfma_f32_16x16x32_bf16 v[204:207], a[140:143], a[112:115], v[204:207]
    v_mfma_f32_16x16x32_bf16 v[208:211], a[144:147], a[112:115], v[208:211]
    ds_read_b64_tr_b16 a[246:247], v7 offset:18144
    v_mfma_f32_16x16x32_bf16 v[212:215], a[148:151], a[112:115], v[212:215]
    s_add_u32 m0, s30, 2400
    ds_read_b64_tr_b16 a[248:249], v7 offset:17640
    v_mfma_f32_16x16x32_bf16 v[216:219], a[152:155], a[112:115], v[216:219]
    buffer_load_dwordx4 v3, s[16:19], s35 offen offset:768 nt lds
    v_mfma_f32_16x16x32_bf16 v[220:223], a[156:159], a[112:115], v[220:223]
    ds_read_b64_tr_b16 a[250:251], v7 offset:18152
    v_mfma_f32_16x16x32_bf16 v[252:255], a[156:159], a[116:119], v[252:255]
    v_mfma_f32_16x16x32_bf16 v[248:251], a[152:155], a[116:119], v[248:251]
    v_mfma_f32_16x16x32_bf16 v[244:247], a[148:151], a[116:119], v[244:247]
    v_mfma_f32_16x16x32_bf16 v[240:243], a[144:147], a[116:119], v[240:243]
    v_mfma_f32_16x16x32_bf16 v[236:239], a[140:143], a[116:119], v[236:239]
    v_mfma_f32_16x16x32_bf16 v[232:235], a[136:139], a[116:119], v[232:235]
    v_mfma_f32_16x16x32_bf16 v[228:231], a[132:135], a[116:119], v[228:231]
    v_mfma_f32_16x16x32_bf16 v[224:227], a[128:131], a[116:119], v[224:227]
    s_waitcnt vmcnt(18) lgkmcnt(0)
    s_barrier
    v_mfma_f32_16x16x32_bf16 v[64:67], a[64:67], a[160:163], v[64:67]
    ds_read_b128 a[96:99], v5 offset:59776
    v_mfma_f32_16x16x32_bf16 v[68:71], a[68:71], a[160:163], v[68:71]
    s_add_u32 m0, s30, 16896
    s_mul_i32 s35, s80, 0
    ds_read_b128 a[100:103], v5 offset:59904
    v_mfma_f32_16x16x32_bf16 v[72:75], a[72:75], a[160:163], v[72:75]
    s_add_u32 s35, s35, s101
    s_and_b32 s35, s35, 0x1e000
    s_or_b32 s35, s35, s75
    v_mfma_f32_16x16x32_bf16 v[76:79], a[76:79], a[160:163], v[76:79]
    buffer_load_dwordx4 v3, s[20:23], s35 offen offset:0 nt lds
    v_mfma_f32_16x16x32_bf16 v[80:83], a[80:83], a[160:163], v[80:83]
    ds_read_b128 a[104:107], v5 offset:60288
    v_mfma_f32_16x16x32_bf16 v[84:87], a[84:87], a[160:163], v[84:87]
    ds_read_b128 a[108:111], v5 offset:60416
    v_mfma_f32_16x16x32_bf16 v[88:91], a[88:91], a[160:163], v[88:91]
    v_mfma_f32_16x16x32_bf16 v[92:95], a[92:95], a[160:163], v[92:95]
    s_add_u32 m0, s30, 17696
    ds_read_b128 a[112:115], v5 offset:60800
    v_mfma_f32_16x16x32_bf16 v[124:127], a[92:95], a[164:167], v[124:127]
    buffer_load_dwordx4 v3, s[20:23], s35 offen offset:256 nt lds
    v_mfma_f32_16x16x32_bf16 v[120:123], a[88:91], a[164:167], v[120:123]
    ds_read_b128 a[116:119], v5 offset:60928
    v_mfma_f32_16x16x32_bf16 v[116:119], a[84:87], a[164:167], v[116:119]
    v_mfma_f32_16x16x32_bf16 v[112:115], a[80:83], a[164:167], v[112:115]
    ds_read_b64_tr_b16 a[128:129], v7 offset:59712
    v_mfma_f32_16x16x32_bf16 v[108:111], a[76:79], a[164:167], v[108:111]
    s_add_u32 m0, s30, 18496
    ds_read_b64_tr_b16 a[130:131], v7 offset:60224
    v_mfma_f32_16x16x32_bf16 v[104:107], a[72:75], a[164:167], v[104:107]
    buffer_load_dwordx4 v3, s[20:23], s35 offen offset:512 nt lds
    v_mfma_f32_16x16x32_bf16 v[100:103], a[68:71], a[164:167], v[100:103]
    v_mfma_f32_16x16x32_bf16 v[96:99], a[64:67], a[164:167], v[96:99]
    ds_read_b64_tr_b16 a[132:133], v7 offset:59720
    v_mfma_f32_16x16x32_bf16 v[128:131], a[64:67], a[168:171], v[128:131]
    ds_read_b64_tr_b16 a[134:135], v7 offset:60232
    v_mfma_f32_16x16x32_bf16 v[132:135], a[68:71], a[168:171], v[132:135]
    s_add_u32 m0, s30, 19296
    v_mfma_f32_16x16x32_bf16 v[136:139], a[72:75], a[168:171], v[136:139]
    buffer_load_dwordx4 v3, s[20:23], s35 offen offset:768 nt lds
    v_mfma_f32_16x16x32_bf16 v[140:143], a[76:79], a[168:171], v[140:143]
    ds_read_b64_tr_b16 a[136:137], v7 offset:59776
    v_mfma_f32_16x16x32_bf16 v[144:147], a[80:83], a[168:171], v[144:147]
    ds_read_b64_tr_b16 a[138:139], v7 offset:60288
    v_mfma_f32_16x16x32_bf16 v[148:151], a[84:87], a[168:171], v[148:151]
    s_add_u32 m0, s30, 33792
    s_mul_i32 s35, s80, 1
    s_add_u32 s35, s35, s101
    v_mfma_f32_16x16x32_bf16 v[152:155], a[88:91], a[168:171], v[152:155]
    s_and_b32 s35, s35, 0x1e000
    s_or_b32 s35, s35, s75
    ds_read_b64_tr_b16 a[140:141], v7 offset:59784
    v_mfma_f32_16x16x32_bf16 v[156:159], a[92:95], a[168:171], v[156:159]
    buffer_load_dwordx4 v3, s[16:19], s35 offen offset:0 nt lds
    v_mfma_f32_16x16x32_bf16 v[188:191], a[92:95], a[172:175], v[188:191]
    ds_read_b64_tr_b16 a[142:143], v7 offset:60296
    v_mfma_f32_16x16x32_bf16 v[184:187], a[88:91], a[172:175], v[184:187]
    v_mfma_f32_16x16x32_bf16 v[180:183], a[84:87], a[172:175], v[180:183]
    ds_read_b64_tr_b16 a[144:145], v7 offset:59840
    v_mfma_f32_16x16x32_bf16 v[176:179], a[80:83], a[172:175], v[176:179]
    s_add_u32 m0, s30, 34592
    ds_read_b64_tr_b16 a[146:147], v7 offset:60352
    v_mfma_f32_16x16x32_bf16 v[172:175], a[76:79], a[172:175], v[172:175]
    buffer_load_dwordx4 v3, s[16:19], s35 offen offset:256 nt lds
    v_mfma_f32_16x16x32_bf16 v[168:171], a[72:75], a[172:175], v[168:171]
    v_mfma_f32_16x16x32_bf16 v[164:167], a[68:71], a[172:175], v[164:167]
    ds_read_b64_tr_b16 a[148:149], v7 offset:59848
    v_mfma_f32_16x16x32_bf16 v[160:163], a[64:67], a[172:175], v[160:163]
    ds_read_b64_tr_b16 a[150:151], v7 offset:60360
    v_mfma_f32_16x16x32_bf16 v[192:195], a[64:67], a[176:179], v[192:195]
    s_add_u32 m0, s30, 35392
    v_mfma_f32_16x16x32_bf16 v[196:199], a[68:71], a[176:179], v[196:199]
    buffer_load_dwordx4 v3, s[16:19], s35 offen offset:512 nt lds
    v_mfma_f32_16x16x32_bf16 v[200:203], a[72:75], a[176:179], v[200:203]
    ds_read_b64_tr_b16 a[152:153], v7 offset:59904
    v_mfma_f32_16x16x32_bf16 v[204:207], a[76:79], a[176:179], v[204:207]
    ds_read_b64_tr_b16 a[154:155], v7 offset:60416
    v_mfma_f32_16x16x32_bf16 v[208:211], a[80:83], a[176:179], v[208:211]
    v_mfma_f32_16x16x32_bf16 v[212:215], a[84:87], a[176:179], v[212:215]
    s_add_u32 m0, s30, 36192
    ds_read_b64_tr_b16 a[156:157], v7 offset:59912
    v_mfma_f32_16x16x32_bf16 v[216:219], a[88:91], a[176:179], v[216:219]
    buffer_load_dwordx4 v3, s[16:19], s35 offen offset:768 nt lds
    v_mfma_f32_16x16x32_bf16 v[220:223], a[92:95], a[176:179], v[220:223]
    ds_read_b64_tr_b16 a[158:159], v7 offset:60424
    v_mfma_f32_16x16x32_bf16 v[252:255], a[92:95], a[180:183], v[252:255]
    v_mfma_f32_16x16x32_bf16 v[248:251], a[88:91], a[180:183], v[248:251]
    v_mfma_f32_16x16x32_bf16 v[244:247], a[84:87], a[180:183], v[244:247]
    v_mfma_f32_16x16x32_bf16 v[240:243], a[80:83], a[180:183], v[240:243]
    v_mfma_f32_16x16x32_bf16 v[236:239], a[76:79], a[180:183], v[236:239]
    v_mfma_f32_16x16x32_bf16 v[232:235], a[72:75], a[180:183], v[232:235]
    v_mfma_f32_16x16x32_bf16 v[228:231], a[68:71], a[180:183], v[228:231]
    v_mfma_f32_16x16x32_bf16 v[224:227], a[64:67], a[180:183], v[224:227]
    s_waitcnt vmcnt(16) lgkmcnt(0)
    s_barrier
    v_mfma_f32_16x16x32_bf16 v[64:67], a[0:3], v[32:35], v[64:67]
    ds_read_b128 a[160:163], v6 offset:0
    v_mfma_f32_16x16x32_bf16 v[68:71], a[4:7], v[32:35], v[68:71]
    s_add_u32 m0, s30, 50688
    s_mul_i32 s35, s80, 1
    ds_read_b128 a[164:167], v6 offset:128
    v_mfma_f32_16x16x32_bf16 v[72:75], a[8:11], v[32:35], v[72:75]
    s_add_u32 s35, s35, s101
    s_and_b32 s35, s35, 0x1e000
    s_or_b32 s35, s35, s75
    v_mfma_f32_16x16x32_bf16 v[76:79], a[12:15], v[32:35], v[76:79]
    buffer_load_dwordx4 v3, s[20:23], s35 offen offset:0 nt lds
    v_mfma_f32_16x16x32_bf16 v[80:83], a[16:19], v[32:35], v[80:83]
    ds_read_b128 a[168:171], v6 offset:512
    v_mfma_f32_16x16x32_bf16 v[84:87], a[20:23], v[32:35], v[84:87]
    v_mfma_f32_16x16x32_bf16 v[88:91], a[24:27], v[32:35], v[88:91]
    ds_read_b128 a[172:175], v6 offset:640
    v_mfma_f32_16x16x32_bf16 v[92:95], a[28:31], v[32:35], v[92:95]
    ds_read_b128 a[176:179], v6 offset:1024
    v_mfma_f32_16x16x32_bf16 v[124:127], a[28:31], v[36:39], v[124:127]
    v_mfma_f32_16x16x32_bf16 v[120:123], a[24:27], v[36:39], v[120:123]
    ds_read_b128 a[180:183], v6 offset:1152
    v_mfma_f32_16x16x32_bf16 v[116:119], a[20:23], v[36:39], v[116:119]
    v_mfma_f32_16x16x32_bf16 v[112:115], a[16:19], v[36:39], v[112:115]
    ds_read_b64_tr_b16 a[64:65], v8 offset:0
    v_mfma_f32_16x16x32_bf16 v[108:111], a[12:15], v[36:39], v[108:111]
    ds_read_b64_tr_b16 a[66:67], v8 offset:512
    v_mfma_f32_16x16x32_bf16 v[104:107], a[8:11], v[36:39], v[104:107]
    s_add_u32 m0, s30, 51488
    v_mfma_f32_16x16x32_bf16 v[100:103], a[4:7], v[36:39], v[100:103]
    buffer_load_dwordx4 v3, s[20:23], s35 offen offset:256 nt lds
    v_mfma_f32_16x16x32_bf16 v[96:99], a[0:3], v[36:39], v[96:99]
    ds_read_b64_tr_b16 a[68:69], v8 offset:8
    v_mfma_f32_16x16x32_bf16 v[128:131], a[0:3], v[40:43], v[128:131]
    v_mfma_f32_16x16x32_bf16 v[132:135], a[4:7], v[40:43], v[132:135]
    ds_read_b64_tr_b16 a[70:71], v8 offset:520
    v_mfma_f32_16x16x32_bf16 v[136:139], a[8:11], v[40:43], v[136:139]
    ds_read_b64_tr_b16 a[72:73], v8 offset:64
    v_mfma_f32_16x16x32_bf16 v[140:143], a[12:15], v[40:43], v[140:143]
    v_mfma_f32_16x16x32_bf16 v[144:147], a[16:19], v[40:43], v[144:147]
    ds_read_b64_tr_b16 a[74:75], v8 offset:576
    v_mfma_f32_16x16x32_bf16 v[148:151], a[20:23], v[40:43], v[148:151]
    v_mfma_f32_16x16x32_bf16 v[152:155], a[24:27], v[40:43], v[152:155]
    ds_read_b64_tr_b16 a[76:77], v8 offset:72
    v_mfma_f32_16x16x32_bf16 v[156:159], a[28:31], v[40:43], v[156:159]
    ds_read_b64_tr_b16 a[78:79], v8 offset:584
    v_mfma_f32_16x16x32_bf16 v[188:191], a[28:31], v[44:47], v[188:191]
    s_add_u32 m0, s30, 52288
    v_mfma_f32_16x16x32_bf16 v[184:187], a[24:27], v[44:47], v[184:187]
    buffer_load_dwordx4 v3, s[20:23], s35 offen offset:512 nt lds
    v_mfma_f32_16x16x32_bf16 v[180:183], a[20:23], v[44:47], v[180:183]
    ds_read_b64_tr_b16 a[80:81], v8 offset:128
    v_mfma_f32_16x16x32_bf16 v[176:179], a[16:19], v[44:47], v[176:179]
    v_mfma_f32_16x16x32_bf16 v[172:175], a[12:15], v[44:47], v[172:175]
    ds_read_b64_tr_b16 a[82:83], v8 offset:640
    v_mfma_f32_16x16x32_bf16 v[168:171], a[8:11], v[44:47], v[168:171]
    ds_read_b64_tr_b16 a[84:85], v8 offset:136
    v_mfma_f32_16x16x32_bf16 v[164:167], a[4:7], v[44:47], v[164:167]
    v_mfma_f32_16x16x32_bf16 v[160:163], a[0:3], v[44:47], v[160:163]
    ds_read_b64_tr_b16 a[86:87], v8 offset:648
    v_mfma_f32_16x16x32_bf16 v[192:195], a[0:3], v[48:51], v[192:195]
    v_mfma_f32_16x16x32_bf16 v[196:199], a[4:7], v[48:51], v[196:199]
    ds_read_b64_tr_b16 a[88:89], v8 offset:192
    v_mfma_f32_16x16x32_bf16 v[200:203], a[8:11], v[48:51], v[200:203]
    ds_read_b64_tr_b16 a[90:91], v8 offset:704
    v_mfma_f32_16x16x32_bf16 v[204:207], a[12:15], v[48:51], v[204:207]
    s_add_u32 m0, s30, 53088
    v_mfma_f32_16x16x32_bf16 v[208:211], a[16:19], v[48:51], v[208:211]
    buffer_load_dwordx4 v3, s[20:23], s35 offen offset:768 nt lds
    v_mfma_f32_16x16x32_bf16 v[212:215], a[20:23], v[48:51], v[212:215]
    ds_read_b64_tr_b16 a[92:93], v8 offset:200
    v_mfma_f32_16x16x32_bf16 v[216:219], a[24:27], v[48:51], v[216:219]
    v_mfma_f32_16x16x32_bf16 v[220:223], a[28:31], v[48:51], v[220:223]
    ds_read_b64_tr_b16 a[94:95], v8 offset:712
    v_mfma_f32_16x16x32_bf16 v[252:255], a[28:31], v[52:55], v[252:255]
    v_mfma_f32_16x16x32_bf16 v[248:251], a[24:27], v[52:55], v[248:251]
    v_mfma_f32_16x16x32_bf16 v[244:247], a[20:23], v[52:55], v[244:247]
    v_mfma_f32_16x16x32_bf16 v[240:243], a[16:19], v[52:55], v[240:243]
    v_mfma_f32_16x16x32_bf16 v[236:239], a[12:15], v[52:55], v[236:239]
    v_mfma_f32_16x16x32_bf16 v[232:235], a[8:11], v[52:55], v[232:235]
    v_mfma_f32_16x16x32_bf16 v[228:231], a[4:7], v[52:55], v[228:231]
    v_mfma_f32_16x16x32_bf16 v[224:227], a[0:3], v[52:55], v[224:227]
    s_waitcnt vmcnt(16) lgkmcnt(0)
    s_barrier
    v_mfma_f32_16x16x32_bf16 v[64:67], a[220:223], a[32:35], v[64:67]
    ds_read_b128 v[32:35], v6 offset:64
    v_mfma_f32_16x16x32_bf16 v[68:71], a[224:227], a[32:35], v[68:71]
    s_add_u32 m0, s30, 67584
    s_mul_i32 s35, s80, 2
    ds_read_b128 v[36:39], v6 offset:192
    v_mfma_f32_16x16x32_bf16 v[72:75], a[228:231], a[32:35], v[72:75]
    s_add_u32 s35, s35, s101
    s_and_b32 s35, s35, 0x1e000
    s_or_b32 s35, s35, s75
    v_mfma_f32_16x16x32_bf16 v[76:79], a[232:235], a[32:35], v[76:79]
    buffer_load_dwordx4 v3, s[16:19], s35 offen offset:0 nt lds
    v_mfma_f32_16x16x32_bf16 v[80:83], a[236:239], a[32:35], v[80:83]
    ds_read_b128 v[40:43], v6 offset:576
    v_mfma_f32_16x16x32_bf16 v[84:87], a[240:243], a[32:35], v[84:87]
    v_mfma_f32_16x16x32_bf16 v[88:91], a[244:247], a[32:35], v[88:91]
    ds_read_b128 v[44:47], v6 offset:704
    v_mfma_f32_16x16x32_bf16 v[92:95], a[248:251], a[32:35], v[92:95]
    ds_read_b128 v[48:51], v6 offset:1088
    v_mfma_f32_16x16x32_bf16 v[124:127], a[248:251], a[36:39], v[124:127]
    v_mfma_f32_16x16x32_bf16 v[120:123], a[244:247], a[36:39], v[120:123]
    ds_read_b128 v[52:55], v6 offset:1216
    v_mfma_f32_16x16x32_bf16 v[116:119], a[240:243], a[36:39], v[116:119]
    v_mfma_f32_16x16x32_bf16 v[112:115], a[236:239], a[36:39], v[112:115]
    ds_read_b64_tr_b16 a[0:1], v8 offset:17440
    v_mfma_f32_16x16x32_bf16 v[108:111], a[232:235], a[36:39], v[108:111]
    ds_read_b64_tr_b16 a[2:3], v8 offset:17952
    v_mfma_f32_16x16x32_bf16 v[104:107], a[228:231], a[36:39], v[104:107]
    s_add_u32 m0, s30, 68384
    v_mfma_f32_16x16x32_bf16 v[100:103], a[224:227], a[36:39], v[100:103]
    buffer_load_dwordx4 v3, s[16:19], s35 offen offset:256 nt lds
    v_mfma_f32_16x16x32_bf16 v[96:99], a[220:223], a[36:39], v[96:99]
    ds_read_b64_tr_b16 a[4:5], v8 offset:17448
    v_mfma_f32_16x16x32_bf16 v[128:131], a[220:223], a[40:43], v[128:131]
    v_mfma_f32_16x16x32_bf16 v[132:135], a[224:227], a[40:43], v[132:135]
    ds_read_b64_tr_b16 a[6:7], v8 offset:17960
    v_mfma_f32_16x16x32_bf16 v[136:139], a[228:231], a[40:43], v[136:139]
    ds_read_b64_tr_b16 a[8:9], v8 offset:17504
    v_mfma_f32_16x16x32_bf16 v[140:143], a[232:235], a[40:43], v[140:143]
    v_mfma_f32_16x16x32_bf16 v[144:147], a[236:239], a[40:43], v[144:147]
    ds_read_b64_tr_b16 a[10:11], v8 offset:18016
    v_mfma_f32_16x16x32_bf16 v[148:151], a[240:243], a[40:43], v[148:151]
    v_mfma_f32_16x16x32_bf16 v[152:155], a[244:247], a[40:43], v[152:155]
    ds_read_b64_tr_b16 a[12:13], v8 offset:17512
    v_mfma_f32_16x16x32_bf16 v[156:159], a[248:251], a[40:43], v[156:159]
    ds_read_b64_tr_b16 a[14:15], v8 offset:18024
    v_mfma_f32_16x16x32_bf16 v[188:191], a[248:251], a[44:47], v[188:191]
    s_add_u32 m0, s30, 69184
    v_mfma_f32_16x16x32_bf16 v[184:187], a[244:247], a[44:47], v[184:187]
    buffer_load_dwordx4 v3, s[16:19], s35 offen offset:512 nt lds
    v_mfma_f32_16x16x32_bf16 v[180:183], a[240:243], a[44:47], v[180:183]
    ds_read_b64_tr_b16 a[16:17], v8 offset:17568
    v_mfma_f32_16x16x32_bf16 v[176:179], a[236:239], a[44:47], v[176:179]
    v_mfma_f32_16x16x32_bf16 v[172:175], a[232:235], a[44:47], v[172:175]
    ds_read_b64_tr_b16 a[18:19], v8 offset:18080
    v_mfma_f32_16x16x32_bf16 v[168:171], a[228:231], a[44:47], v[168:171]
    ds_read_b64_tr_b16 a[20:21], v8 offset:17576
    v_mfma_f32_16x16x32_bf16 v[164:167], a[224:227], a[44:47], v[164:167]
    v_mfma_f32_16x16x32_bf16 v[160:163], a[220:223], a[44:47], v[160:163]
    ds_read_b64_tr_b16 a[22:23], v8 offset:18088
    v_mfma_f32_16x16x32_bf16 v[192:195], a[220:223], a[48:51], v[192:195]
    v_mfma_f32_16x16x32_bf16 v[196:199], a[224:227], a[48:51], v[196:199]
    ds_read_b64_tr_b16 a[24:25], v8 offset:17632
    v_mfma_f32_16x16x32_bf16 v[200:203], a[228:231], a[48:51], v[200:203]
    ds_read_b64_tr_b16 a[26:27], v8 offset:18144
    v_mfma_f32_16x16x32_bf16 v[204:207], a[232:235], a[48:51], v[204:207]
    s_add_u32 m0, s30, 69984
    v_mfma_f32_16x16x32_bf16 v[208:211], a[236:239], a[48:51], v[208:211]
    buffer_load_dwordx4 v3, s[16:19], s35 offen offset:768 nt lds
    v_mfma_f32_16x16x32_bf16 v[212:215], a[240:243], a[48:51], v[212:215]
    ds_read_b64_tr_b16 a[28:29], v8 offset:17640
    v_mfma_f32_16x16x32_bf16 v[216:219], a[244:247], a[48:51], v[216:219]
    v_mfma_f32_16x16x32_bf16 v[220:223], a[248:251], a[48:51], v[220:223]
    ds_read_b64_tr_b16 a[30:31], v8 offset:18152
    v_mfma_f32_16x16x32_bf16 v[252:255], a[248:251], a[52:55], v[252:255]
    v_mfma_f32_16x16x32_bf16 v[248:251], a[244:247], a[52:55], v[248:251]
    v_mfma_f32_16x16x32_bf16 v[244:247], a[240:243], a[52:55], v[244:247]
    v_mfma_f32_16x16x32_bf16 v[240:243], a[236:239], a[52:55], v[240:243]
    v_mfma_f32_16x16x32_bf16 v[236:239], a[232:235], a[52:55], v[236:239]
    v_mfma_f32_16x16x32_bf16 v[232:235], a[228:231], a[52:55], v[232:235]
    v_mfma_f32_16x16x32_bf16 v[228:231], a[224:227], a[52:55], v[228:231]
    v_mfma_f32_16x16x32_bf16 v[224:227], a[220:223], a[52:55], v[224:227]
    s_waitcnt vmcnt(63) lgkmcnt(0)
    s_barrier
    v_mfma_f32_16x16x32_bf16 v[64:67], a[128:131], a[96:99], v[64:67]
    v_mfma_f32_16x16x32_bf16 v[68:71], a[132:135], a[96:99], v[68:71]
    s_add_u32 m0, s30, 84480
    s_mul_i32 s35, s80, 2
    v_mfma_f32_16x16x32_bf16 v[72:75], a[136:139], a[96:99], v[72:75]
    s_add_u32 s35, s35, s101
    s_and_b32 s35, s35, 0x1e000
    s_or_b32 s35, s35, s75
    v_mfma_f32_16x16x32_bf16 v[76:79], a[140:143], a[96:99], v[76:79]
    buffer_load_dwordx4 v3, s[20:23], s35 offen offset:0 nt lds
    v_mfma_f32_16x16x32_bf16 v[80:83], a[144:147], a[96:99], v[80:83]
    v_lshlrev_b32 v56, 14, v0
    v_mfma_f32_16x16x32_bf16 v[84:87], a[148:151], a[96:99], v[84:87]
    s_getpc_b64 s[76:77]
CT_Z:
    s_add_u32 s76, s76, K1_AEXIT-CT_Z
    s_addc_u32 s77, s77, -1
    v_mfma_f32_16x16x32_bf16 v[88:91], a[152:155], a[96:99], v[88:91]
    s_mov_b32 s78, K1_TAILA-K1_AEXIT
    s_lshl_b32 s36, s3, 2
    s_add_u32 s36, s36, s43
    v_mfma_f32_16x16x32_bf16 v[92:95], a[156:159], a[96:99], v[92:95]
    s_lshl_b32 s36, s36, 7
    v_mfma_f32_16x16x32_bf16 v[124:127], a[156:159], a[100:103], v[124:127]
    buffer_load_dword v13, v56, s[76:79], s36 offen
    v_mfma_f32_16x16x32_bf16 v[120:123], a[152:155], a[100:103], v[120:123]
    v_mfma_f32_16x16x32_bf16 v[116:119], a[148:151], a[100:103], v[116:119]
    v_mfma_f32_16x16x32_bf16 v[112:115], a[144:147], a[100:103], v[112:115]
    v_mfma_f32_16x16x32_bf16 v[108:111], a[140:143], a[100:103], v[108:111]
    v_mfma_f32_16x16x32_bf16 v[104:107], a[136:139], a[100:103], v[104:107]
    s_add_u32 m0, s30, 85280
    v_mfma_f32_16x16x32_bf16 v[100:103], a[132:135], a[100:103], v[100:103]
    buffer_load_dwordx4 v3, s[20:23], s35 offen offset:256 nt lds
    v_mfma_f32_16x16x32_bf16 v[96:99], a[128:131], a[100:103], v[96:99]
    v_mfma_f32_16x16x32_bf16 v[128:131], a[128:131], a[104:107], v[128:131]
    v_mfma_f32_16x16x32_bf16 v[132:135], a[132:135], a[104:107], v[132:135]
    v_mfma_f32_16x16x32_bf16 v[136:139], a[136:139], a[104:107], v[136:139]
    v_mfma_f32_16x16x32_bf16 v[140:143], a[140:143], a[104:107], v[140:143]
    v_mfma_f32_16x16x32_bf16 v[144:147], a[144:147], a[104:107], v[144:147]
    v_mfma_f32_16x16x32_bf16 v[148:151], a[148:151], a[104:107], v[148:151]
    v_mfma_f32_16x16x32_bf16 v[152:155], a[152:155], a[104:107], v[152:155]
    v_mfma_f32_16x16x32_bf16 v[156:159], a[156:159], a[104:107], v[156:159]
    v_mfma_f32_16x16x32_bf16 v[188:191], a[156:159], a[108:111], v[188:191]
    s_add_u32 m0, s30, 86080
    v_mfma_f32_16x16x32_bf16 v[184:187], a[152:155], a[108:111], v[184:187]
    buffer_load_dwordx4 v3, s[20:23], s35 offen offset:512 nt lds
    v_mfma_f32_16x16x32_bf16 v[180:183], a[148:151], a[108:111], v[180:183]
    v_mfma_f32_16x16x32_bf16 v[176:179], a[144:147], a[108:111], v[176:179]
    v_mfma_f32_16x16x32_bf16 v[172:175], a[140:143], a[108:111], v[172:175]
    v_mfma_f32_16x16x32_bf16 v[168:171], a[136:139], a[108:111], v[168:171]
    v_mfma_f32_16x16x32_bf16 v[164:167], a[132:135], a[108:111], v[164:167]
    v_mfma_f32_16x16x32_bf16 v[160:163], a[128:131], a[108:111], v[160:163]
    v_mfma_f32_16x16x32_bf16 v[192:195], a[128:131], a[112:115], v[192:195]
    v_mfma_f32_16x16x32_bf16 v[196:199], a[132:135], a[112:115], v[196:199]
    v_mfma_f32_16x16x32_bf16 v[200:203], a[136:139], a[112:115], v[200:203]
    v_mfma_f32_16x16x32_bf16 v[204:207], a[140:143], a[112:115], v[204:207]
    s_add_u32 m0, s30, 86880
    v_mfma_f32_16x16x32_bf16 v[208:211], a[144:147], a[112:115], v[208:211]
    buffer_load_dwordx4 v3, s[20:23], s35 offen offset:768 nt lds
    v_mfma_f32_16x16x32_bf16 v[212:215], a[148:151], a[112:115], v[212:215]
    v_mfma_f32_16x16x32_bf16 v[216:219], a[152:155], a[112:115], v[216:219]
    v_mfma_f32_16x16x32_bf16 v[220:223], a[156:159], a[112:115], v[220:223]
    v_mfma_f32_16x16x32_bf16 v[252:255], a[156:159], a[116:119], v[252:255]
    v_mfma_f32_16x16x32_bf16 v[248:251], a[152:155], a[116:119], v[248:251]
    v_mfma_f32_16x16x32_bf16 v[244:247], a[148:151], a[116:119], v[244:247]
    v_mfma_f32_16x16x32_bf16 v[240:243], a[144:147], a[116:119], v[240:243]
    v_mfma_f32_16x16x32_bf16 v[236:239], a[140:143], a[116:119], v[236:239]
    v_mfma_f32_16x16x32_bf16 v[232:235], a[136:139], a[116:119], v[232:235]
    v_mfma_f32_16x16x32_bf16 v[228:231], a[132:135], a[116:119], v[228:231]
    v_mfma_f32_16x16x32_bf16 v[224:227], a[128:131], a[116:119], v[224:227]
    s_waitcnt vmcnt(63) lgkmcnt(0)
    s_barrier
    v_mfma_f32_16x16x32_bf16 v[64:67], a[64:67], a[160:163], v[64:67]
    v_mfma_f32_16x16x32_bf16 v[68:71], a[68:71], a[160:163], v[68:71]
    s_add_u32 m0, s30, 101376
    s_mul_i32 s35, s80, 3
    v_mfma_f32_16x16x32_bf16 v[72:75], a[72:75], a[160:163], v[72:75]
    s_add_u32 s35, s35, s101
    s_and_b32 s35, s35, 0x1e000
    s_or_b32 s35, s35, s75
    v_mfma_f32_16x16x32_bf16 v[76:79], a[76:79], a[160:163], v[76:79]
    buffer_load_dwordx4 v3, s[16:19], s35 offen offset:0 nt lds
    v_mfma_f32_16x16x32_bf16 v[80:83], a[80:83], a[160:163], v[80:83]
    v_mfma_f32_16x16x32_bf16 v[84:87], a[84:87], a[160:163], v[84:87]
    v_mfma_f32_16x16x32_bf16 v[88:91], a[88:91], a[160:163], v[88:91]
    v_mfma_f32_16x16x32_bf16 v[92:95], a[92:95], a[160:163], v[92:95]
    v_mfma_f32_16x16x32_bf16 v[124:127], a[92:95], a[164:167], v[124:127]
    v_mfma_f32_16x16x32_bf16 v[120:123], a[88:91], a[164:167], v[120:123]
    v_mfma_f32_16x16x32_bf16 v[116:119], a[84:87], a[164:167], v[116:119]
    v_mfma_f32_16x16x32_bf16 v[112:115], a[80:83], a[164:167], v[112:115]
    v_mfma_f32_16x16x32_bf16 v[108:111], a[76:79], a[164:167], v[108:111]
    v_mfma_f32_16x16x32_bf16 v[104:107], a[72:75], a[164:167], v[104:107]
    s_add_u32 m0, s30, 102176
    v_mfma_f32_16x16x32_bf16 v[100:103], a[68:71], a[164:167], v[100:103]
    buffer_load_dwordx4 v3, s[16:19], s35 offen offset:256 nt lds
    v_mfma_f32_16x16x32_bf16 v[96:99], a[64:67], a[164:167], v[96:99]
    v_mfma_f32_16x16x32_bf16 v[128:131], a[64:67], a[168:171], v[128:131]
    v_mfma_f32_16x16x32_bf16 v[132:135], a[68:71], a[168:171], v[132:135]
    v_mfma_f32_16x16x32_bf16 v[136:139], a[72:75], a[168:171], v[136:139]
    v_mfma_f32_16x16x32_bf16 v[140:143], a[76:79], a[168:171], v[140:143]
    v_mfma_f32_16x16x32_bf16 v[144:147], a[80:83], a[168:171], v[144:147]
    v_mfma_f32_16x16x32_bf16 v[148:151], a[84:87], a[168:171], v[148:151]
    v_mfma_f32_16x16x32_bf16 v[152:155], a[88:91], a[168:171], v[152:155]
    v_mfma_f32_16x16x32_bf16 v[156:159], a[92:95], a[168:171], v[156:159]
    v_mfma_f32_16x16x32_bf16 v[188:191], a[92:95], a[172:175], v[188:191]
    s_add_u32 m0, s30, 102976
    v_mfma_f32_16x16x32_bf16 v[184:187], a[88:91], a[172:175], v[184:187]
    buffer_load_dwordx4 v3, s[16:19], s35 offen offset:512 nt lds
    v_mfma_f32_16x16x32_bf16 v[180:183], a[84:87], a[172:175], v[180:183]
    v_mfma_f32_16x16x32_bf16 v[176:179], a[80:83], a[172:175], v[176:179]
    v_mfma_f32_16x16x32_bf16 v[172:175], a[76:79], a[172:175], v[172:175]
    v_mfma_f32_16x16x32_bf16 v[168:171], a[72:75], a[172:175], v[168:171]
    v_mfma_f32_16x16x32_bf16 v[164:167], a[68:71], a[172:175], v[164:167]
    v_mfma_f32_16x16x32_bf16 v[160:163], a[64:67], a[172:175], v[160:163]
    v_mfma_f32_16x16x32_bf16 v[192:195], a[64:67], a[176:179], v[192:195]
    v_mfma_f32_16x16x32_bf16 v[196:199], a[68:71], a[176:179], v[196:199]
    v_mfma_f32_16x16x32_bf16 v[200:203], a[72:75], a[176:179], v[200:203]
    v_mfma_f32_16x16x32_bf16 v[204:207], a[76:79], a[176:179], v[204:207]
    s_add_u32 m0, s30, 103776
    v_mfma_f32_16x16x32_bf16 v[208:211], a[80:83], a[176:179], v[208:211]
    buffer_load_dwordx4 v3, s[16:19], s35 offen offset:768 nt lds
    v_mfma_f32_16x16x32_bf16 v[212:215], a[84:87], a[176:179], v[212:215]
    v_mfma_f32_16x16x32_bf16 v[216:219], a[88:91], a[176:179], v[216:219]
    v_mfma_f32_16x16x32_bf16 v[220:223], a[92:95], a[176:179], v[220:223]
    v_mfma_f32_16x16x32_bf16 v[252:255], a[92:95], a[180:183], v[252:255]
    v_mfma_f32_16x16x32_bf16 v[248:251], a[88:91], a[180:183], v[248:251]
    v_mfma_f32_16x16x32_bf16 v[244:247], a[84:87], a[180:183], v[244:247]
    v_mfma_f32_16x16x32_bf16 v[240:243], a[80:83], a[180:183], v[240:243]
    v_mfma_f32_16x16x32_bf16 v[236:239], a[76:79], a[180:183], v[236:239]
    v_mfma_f32_16x16x32_bf16 v[232:235], a[72:75], a[180:183], v[232:235]
    v_mfma_f32_16x16x32_bf16 v[228:231], a[68:71], a[180:183], v[228:231]
    v_mfma_f32_16x16x32_bf16 v[224:227], a[64:67], a[180:183], v[224:227]
    s_waitcnt vmcnt(21) lgkmcnt(0)
    s_barrier
    v_mfma_f32_16x16x32_bf16 v[128:131], a[0:3], v[40:43], v[128:131]
    ds_read_b128 a[220:223], v9 offset:0
    v_mfma_f32_16x16x32_bf16 v[132:135], a[4:7], v[40:43], v[132:135]
    ds_read_b128 a[224:227], v9 offset:64
    v_mfma_f32_16x16x32_bf16 v[136:139], a[8:11], v[40:43], v[136:139]
    ds_read_b128 a[228:231], v9 offset:128
    v_mfma_f32_16x16x32_bf16 v[140:143], a[12:15], v[40:43], v[140:143]
    buffer_store_dword v21, v20, s[68:71], 0 offen offset:0 sc1
    v_mfma_f32_16x16x32_bf16 v[144:147], a[16:19], v[40:43], v[144:147]
    ds_read_b128 a[232:235], v9 offset:192
    v_mfma_f32_16x16x32_bf16 v[148:151], a[20:23], v[40:43], v[148:151]
    v_mfma_f32_16x16x32_bf16 v[152:155], a[24:27], v[40:43], v[152:155]
    ds_read_b128 a[236:239], v9 offset:512
    v_mfma_f32_16x16x32_bf16 v[156:159], a[28:31], v[40:43], v[156:159]
    ds_read_b128 a[240:243], v9 offset:576
    v_mfma_f32_16x16x32_bf16 v[188:191], a[28:31], v[44:47], v[188:191]
    ds_read_b128 a[244:247], v9 offset:640
    v_mfma_f32_16x16x32_bf16 v[184:187], a[24:27], v[44:47], v[184:187]
    s_add_u32 m0, s30, 118272
    s_mul_i32 s35, s80, 3
    ds_read_b128 a[248:251], v9 offset:704
    v_mfma_f32_16x16x32_bf16 v[180:183], a[20:23], v[44:47], v[180:183]
    s_add_u32 s35, s35, s101
    s_and_b32 s35, s35, 0x1e000
    s_or_b32 s35, s35, s75
    v_mfma_f32_16x16x32_bf16 v[176:179], a[16:19], v[44:47], v[176:179]
    buffer_load_dwordx4 v3, s[20:23], s35 offen offset:0 nt lds
    v_mfma_f32_16x16x32_bf16 v[172:175], a[12:15], v[44:47], v[172:175]
    v_mfma_f32_16x16x32_bf16 v[168:171], a[8:11], v[44:47], v[168:171]
    v_mul_f32 v128, s38, v128
    v_mul_f32 v129, s38, v129
    v_mfma_f32_16x16x32_bf16 v[164:167], a[4:7], v[44:47], v[164:167]
    v_cvt_pk_bf16_f32 v128, v128, v129
    v_mul_f32 v130, s38, v130
    v_mfma_f32_16x16x32_bf16 v[160:163], a[0:3], v[44:47], v[160:163]
    v_mul_f32 v131, s38, v131
    v_cvt_pk_bf16_f32 v129, v130, v131
    v_mfma_f32_16x16x32_bf16 v[64:67], a[0:3], v[32:35], v[64:67]
    v_mul_f32 v132, s38, v132
    v_mul_f32 v133, s38, v133
    v_mfma_f32_16x16x32_bf16 v[68:71], a[4:7], v[32:35], v[68:71]
    v_cvt_pk_bf16_f32 v130, v132, v133
    v_mul_f32 v134, s38, v134
    v_mfma_f32_16x16x32_bf16 v[72:75], a[8:11], v[32:35], v[72:75]
    s_add_u32 m0, s30, 119072
    v_mul_f32 v135, s38, v135
    v_cvt_pk_bf16_f32 v131, v134, v135
    v_mfma_f32_16x16x32_bf16 v[76:79], a[12:15], v[32:35], v[76:79]
    buffer_load_dwordx4 v3, s[20:23], s35 offen offset:256 nt lds
    v_mfma_f32_16x16x32_bf16 v[80:83], a[16:19], v[32:35], v[80:83]
    v_mul_f32 v136, s38, v136
    v_mul_f32 v137, s38, v137
    v_mfma_f32_16x16x32_bf16 v[84:87], a[20:23], v[32:35], v[84:87]
    v_cvt_pk_bf16_f32 v132, v136, v137
    v_mul_f32 v138, s38, v138
    v_mfma_f32_16x16x32_bf16 v[88:91], a[24:27], v[32:35], v[88:91]
    v_mul_f32 v139, s38, v139
    v_cvt_pk_bf16_f32 v133, v138, v139
    v_mfma_f32_16x16x32_bf16 v[92:95], a[28:31], v[32:35], v[92:95]
    v_mul_f32 v140, s38, v140
    v_mul_f32 v141, s38, v141
    v_mfma_f32_16x16x32_bf16 v[124:127], a[28:31], v[36:39], v[124:127]
    v_cvt_pk_bf16_f32 v134, v140, v141
    v_mul_f32 v142, s38, v142
    v_mfma_f32_16x16x32_bf16 v[120:123], a[24:27], v[36:39], v[120:123]
    v_mul_f32 v143, s38, v143
    v_cvt_pk_bf16_f32 v135, v142, v143
    v_mfma_f32_16x16x32_bf16 v[116:119], a[20:23], v[36:39], v[116:119]
    s_add_u32 m0, s30, 119872
    v_mul_f32 v144, s38, v144
    v_mul_f32 v145, s38, v145
    v_mfma_f32_16x16x32_bf16 v[112:115], a[16:19], v[36:39], v[112:115]
    buffer_load_dwordx4 v3, s[20:23], s35 offen offset:512 nt lds
    v_mfma_f32_16x16x32_bf16 v[108:111], a[12:15], v[36:39], v[108:111]
    v_cvt_pk_bf16_f32 v136, v144, v145
    v_mul_f32 v146, s38, v146
    v_mfma_f32_16x16x32_bf16 v[104:107], a[8:11], v[36:39], v[104:107]
    v_mul_f32 v147, s38, v147
    v_cvt_pk_bf16_f32 v137, v146, v147
    v_mfma_f32_16x16x32_bf16 v[100:103], a[4:7], v[36:39], v[100:103]
    v_mul_f32 v148, s38, v148
    v_mul_f32 v149, s38, v149
    v_mfma_f32_16x16x32_bf16 v[96:99], a[0:3], v[36:39], v[96:99]
    v_cvt_pk_bf16_f32 v138, v148, v149
    v_mul_f32 v150, s38, v150
    v_mfma_f32_16x16x32_bf16 v[192:195], a[0:3], v[48:51], v[192:195]
    v_mul_f32 v151, s38, v151
    v_cvt_pk_bf16_f32 v139, v150, v151
    v_mfma_f32_16x16x32_bf16 v[196:199], a[4:7], v[48:51], v[196:199]
    v_mul_f32 v152, s38, v152
    v_mul_f32 v153, s38, v153
    v_mfma_f32_16x16x32_bf16 v[200:203], a[8:11], v[48:51], v[200:203]
    s_add_u32 m0, s30, 120672
    v_cvt_pk_bf16_f32 v140, v152, v153
    v_mul_f32 v154, s38, v154
    v_mfma_f32_16x16x32_bf16 v[204:207], a[12:15], v[48:51], v[204:207]
    buffer_load_dwordx4 v3, s[20:23], s35 offen offset:768 nt lds
    v_mfma_f32_16x16x32_bf16 v[208:211], a[16:19], v[48:51], v[208:211]
    v_mul_f32 v155, s38, v155
    v_cvt_pk_bf16_f32 v141, v154, v155
    v_mfma_f32_16x16x32_bf16 v[212:215], a[20:23], v[48:51], v[212:215]
    v_mul_f32 v156, s38, v156
    v_mul_f32 v157, s38, v157
    v_mfma_f32_16x16x32_bf16 v[216:219], a[24:27], v[48:51], v[216:219]
    v_cvt_pk_bf16_f32 v142, v156, v157
    v_mul_f32 v158, s38, v158
    v_mfma_f32_16x16x32_bf16 v[220:223], a[28:31], v[48:51], v[220:223]
    v_mul_f32 v159, s38, v159
    v_cvt_pk_bf16_f32 v143, v158, v159
    v_mfma_f32_16x16x32_bf16 v[252:255], a[28:31], v[52:55], v[252:255]
    v_mul_f32 v160, s38, v160
    v_mul_f32 v161, s38, v161
    v_mfma_f32_16x16x32_bf16 v[248:251], a[24:27], v[52:55], v[248:251]
    v_cvt_pk_bf16_f32 v160, v160, v161
    v_mul_f32 v162, s38, v162
    v_mfma_f32_16x16x32_bf16 v[244:247], a[20:23], v[52:55], v[244:247]
    v_mul_f32 v163, s38, v163
    v_cvt_pk_bf16_f32 v161, v162, v163
    v_mfma_f32_16x16x32_bf16 v[240:243], a[16:19], v[52:55], v[240:243]
    v_mul_f32 v164, s38, v164
    v_mul_f32 v165, s38, v165
    v_mfma_f32_16x16x32_bf16 v[236:239], a[12:15], v[52:55], v[236:239]
    v_cvt_pk_bf16_f32 v162, v164, v165
    v_mul_f32 v166, s38, v166
    v_mfma_f32_16x16x32_bf16 v[232:235], a[8:11], v[52:55], v[232:235]
    v_mul_f32 v167, s38, v167
    v_cvt_pk_bf16_f32 v163, v166, v167
    v_mfma_f32_16x16x32_bf16 v[228:231], a[4:7], v[52:55], v[228:231]
    v_mul_f32 v168, s38, v168
    v_mul_f32 v169, s38, v169
    v_mfma_f32_16x16x32_bf16 v[224:227], a[0:3], v[52:55], v[224:227]
    v_cvt_pk_bf16_f32 v164, v168, v169
    v_mul_f32 v170, s38, v170
    v_mul_f32 v171, s38, v171
    v_cvt_pk_bf16_f32 v165, v170, v171
    s_lshl_b32 s32, s80, 2
    s_add_u32 s32, s32, s101
    s_add_u32 s32, s32, 512
    s_sub_u32 s62, s80, 512
    s_add_u32 s33, s30, 19008
    s_mov_b32 s88, 3
    s_mov_b32 s84, 33792
    v_add_u32 v11, 33792, v9
    s_xor_b32 s61, s61, 512
    s_mov_b32 s7, 0
    s_mov_b32 s26, 2168832
    s_mul_i32 s34, s75, 6
    s_mov_b32 s86, 16384
    s_cmp_eq_u32 s37, 0
    s_cselect_b32 s83, 5, 1
    s_nop 0
    v_pk_mul_f32 v[172:173], v[172:173], s[38:39]
    v_cvt_pk_bf16_f32 v166, v172, v173
    v_pk_mul_f32 v[174:175], v[174:175], s[38:39]
    v_cvt_pk_bf16_f32 v167, v174, v175
    v_pk_mul_f32 v[176:177], v[176:177], s[38:39]
    v_cvt_pk_bf16_f32 v168, v176, v177
    v_pk_mul_f32 v[178:179], v[178:179], s[38:39]
    v_cvt_pk_bf16_f32 v169, v178, v179
    v_pk_mul_f32 v[180:181], v[180:181], s[38:39]
    v_cvt_pk_bf16_f32 v170, v180, v181
    v_pk_mul_f32 v[182:183], v[182:183], s[38:39]
    v_cvt_pk_bf16_f32 v171, v182, v183
    v_pk_mul_f32 v[184:185], v[184:185], s[38:39]
    v_cvt_pk_bf16_f32 v172, v184, v185
    v_pk_mul_f32 v[186:187], v[186:187], s[38:39]
    v_cvt_pk_bf16_f32 v173, v186, v187
    v_pk_mul_f32 v[188:189], v[188:189], s[38:39]
    v_cvt_pk_bf16_f32 v174, v188, v189
    v_pk_mul_f32 v[190:191], v[190:191], s[38:39]
    v_cvt_pk_bf16_f32 v175, v190, v191
    ds_read_b64_tr_b16 v[144:145], v10 offset:16896
    ds_read_b64_tr_b16 v[146:147], v10 offset:17408
    v_pk_mul_f32 v[64:65], v[64:65], s[38:39]
    v_cvt_pk_bf16_f32 v64, v64, v65
    v_pk_mul_f32 v[66:67], v[66:67], s[38:39]
    v_cvt_pk_bf16_f32 v65, v66, v67
    v_pk_mul_f32 v[68:69], v[68:69], s[38:39]
    v_cvt_pk_bf16_f32 v66, v68, v69
    v_pk_mul_f32 v[70:71], v[70:71], s[38:39]
    v_cvt_pk_bf16_f32 v67, v70, v71
    v_pk_mul_f32 v[72:73], v[72:73], s[38:39]
    v_cvt_pk_bf16_f32 v68, v72, v73
    v_pk_mul_f32 v[74:75], v[74:75], s[38:39]
    v_cvt_pk_bf16_f32 v69, v74, v75
    ds_read_b64_tr_b16 v[148:149], v10 offset:16928
    ds_read_b64_tr_b16 v[150:151], v10 offset:17440
    v_pk_mul_f32 v[76:77], v[76:77], s[38:39]
    v_cvt_pk_bf16_f32 v70, v76, v77
    v_pk_mul_f32 v[78:79], v[78:79], s[38:39]
    v_cvt_pk_bf16_f32 v71, v78, v79
    v_pk_mul_f32 v[80:81], v[80:81], s[38:39]
    v_cvt_pk_bf16_f32 v72, v80, v81
    v_pk_mul_f32 v[82:83], v[82:83], s[38:39]
    v_cvt_pk_bf16_f32 v73, v82, v83
    v_pk_mul_f32 v[84:85], v[84:85], s[38:39]
    v_cvt_pk_bf16_f32 v74, v84, v85
    v_pk_mul_f32 v[86:87], v[86:87], s[38:39]
    v_cvt_pk_bf16_f32 v75, v86, v87
    ds_read_b64_tr_b16 v[152:153], v10 offset:16960
    ds_read_b64_tr_b16 v[154:155], v10 offset:17472
    v_pk_mul_f32 v[88:89], v[88:89], s[38:39]
    v_cvt_pk_bf16_f32 v76, v88, v89
    v_pk_mul_f32 v[90:91], v[90:91], s[38:39]
    v_cvt_pk_bf16_f32 v77, v90, v91
    v_pk_mul_f32 v[92:93], v[92:93], s[38:39]
    v_cvt_pk_bf16_f32 v78, v92, v93
    v_pk_mul_f32 v[94:95], v[94:95], s[38:39]
    v_cvt_pk_bf16_f32 v79, v94, v95
    v_pk_mul_f32 v[96:97], v[96:97], s[38:39]
    v_cvt_pk_bf16_f32 v96, v96, v97
    v_pk_mul_f32 v[98:99], v[98:99], s[38:39]
    v_cvt_pk_bf16_f32 v97, v98, v99
    ds_read_b64_tr_b16 v[156:157], v10 offset:16992
    ds_read_b64_tr_b16 v[158:159], v10 offset:17504
    v_pk_mul_f32 v[100:101], v[100:101], s[38:39]
    v_cvt_pk_bf16_f32 v98, v100, v101
    v_pk_mul_f32 v[102:103], v[102:103], s[38:39]
    v_cvt_pk_bf16_f32 v99, v102, v103
    v_pk_mul_f32 v[104:105], v[104:105], s[38:39]
    v_cvt_pk_bf16_f32 v100, v104, v105
    v_pk_mul_f32 v[106:107], v[106:107], s[38:39]
    v_cvt_pk_bf16_f32 v101, v106, v107
    v_pk_mul_f32 v[108:109], v[108:109], s[38:39]
    v_cvt_pk_bf16_f32 v102, v108, v109
    v_pk_mul_f32 v[110:111], v[110:111], s[38:39]
    v_cvt_pk_bf16_f32 v103, v110, v111
    ds_read_b64_tr_b16 v[176:177], v10 offset:17024
    ds_read_b64_tr_b16 v[178:179], v10 offset:17536
    v_pk_mul_f32 v[112:113], v[112:113], s[38:39]
    v_cvt_pk_bf16_f32 v104, v112, v113
    v_pk_mul_f32 v[114:115], v[114:115], s[38:39]
    v_cvt_pk_bf16_f32 v105, v114, v115
    v_pk_mul_f32 v[116:117], v[116:117], s[38:39]
    v_cvt_pk_bf16_f32 v106, v116, v117
    v_pk_mul_f32 v[118:119], v[118:119], s[38:39]
    v_cvt_pk_bf16_f32 v107, v118, v119
    v_pk_mul_f32 v[120:121], v[120:121], s[38:39]
    v_cvt_pk_bf16_f32 v108, v120, v121
    v_pk_mul_f32 v[122:123], v[122:123], s[38:39]
    v_cvt_pk_bf16_f32 v109, v122, v123
    ds_read_b64_tr_b16 v[180:181], v10 offset:17056
    ds_read_b64_tr_b16 v[182:183], v10 offset:17568
    v_pk_mul_f32 v[124:125], v[124:125], s[38:39]
    v_cvt_pk_bf16_f32 v110, v124, v125
    v_pk_mul_f32 v[126:127], v[126:127], s[38:39]
    v_cvt_pk_bf16_f32 v111, v126, v127
    v_pk_mul_f32 v[192:193], v[192:193], s[38:39]
    v_cvt_pk_bf16_f32 v192, v192, v193
    v_pk_mul_f32 v[194:195], v[194:195], s[38:39]
    v_cvt_pk_bf16_f32 v193, v194, v195
    v_pk_mul_f32 v[196:197], v[196:197], s[38:39]
    v_cvt_pk_bf16_f32 v194, v196, v197
    v_pk_mul_f32 v[198:199], v[198:199], s[38:39]
    v_cvt_pk_bf16_f32 v195, v198, v199
    v_pk_mul_f32 v[200:201], v[200:201], s[38:39]
    v_cvt_pk_bf16_f32 v196, v200, v201
    v_pk_mul_f32 v[202:203], v[202:203], s[38:39]
    v_cvt_pk_bf16_f32 v197, v202, v203
    v_pk_mul_f32 v[204:205], v[204:205], s[38:39]
    v_cvt_pk_bf16_f32 v198, v204, v205
    v_pk_mul_f32 v[206:207], v[206:207], s[38:39]
    v_cvt_pk_bf16_f32 v199, v206, v207
    v_pk_mul_f32 v[208:209], v[208:209], s[38:39]
    v_cvt_pk_bf16_f32 v200, v208, v209
    v_pk_mul_f32 v[210:211], v[210:211], s[38:39]
    v_cvt_pk_bf16_f32 v201, v210, v211
    v_pk_mul_f32 v[212:213], v[212:213], s[38:39]
    v_cvt_pk_bf16_f32 v202, v212, v213
    v_pk_mul_f32 v[214:215], v[214:215], s[38:39]
    v_cvt_pk_bf16_f32 v203, v214, v215
    v_pk_mul_f32 v[216:217], v[216:217], s[38:39]
    v_cvt_pk_bf16_f32 v204, v216, v217
    v_pk_mul_f32 v[218:219], v[218:219], s[38:39]
    v_cvt_pk_bf16_f32 v205, v218, v219
    v_pk_mul_f32 v[220:221], v[220:221], s[38:39]
    v_cvt_pk_bf16_f32 v206, v220, v221
    v_pk_mul_f32 v[222:223], v[222:223], s[38:39]
    v_cvt_pk_bf16_f32 v207, v222, v223
    v_pk_mul_f32 v[224:225], v[224:225], s[38:39]
    v_cvt_pk_bf16_f32 v224, v224, v225
    v_pk_mul_f32 v[226:227], v[226:227], s[38:39]
    v_cvt_pk_bf16_f32 v225, v226, v227
    v_pk_mul_f32 v[228:229], v[228:229], s[38:39]
    v_cvt_pk_bf16_f32 v226, v228, v229
    v_pk_mul_f32 v[230:231], v[230:231], s[38:39]
    v_cvt_pk_bf16_f32 v227, v230, v231
    v_pk_mul_f32 v[232:233], v[232:233], s[38:39]
    v_cvt_pk_bf16_f32 v228, v232, v233
    v_pk_mul_f32 v[234:235], v[234:235], s[38:39]
    v_cvt_pk_bf16_f32 v229, v234, v235
    v_pk_mul_f32 v[236:237], v[236:237], s[38:39]
    v_cvt_pk_bf16_f32 v230, v236, v237
    v_pk_mul_f32 v[238:239], v[238:239], s[38:39]
    v_cvt_pk_bf16_f32 v231, v238, v239
    v_pk_mul_f32 v[240:241], v[240:241], s[38:39]
    v_cvt_pk_bf16_f32 v232, v240, v241
    v_pk_mul_f32 v[242:243], v[242:243], s[38:39]
    v_cvt_pk_bf16_f32 v233, v242, v243
    v_pk_mul_f32 v[244:245], v[244:245], s[38:39]
    v_cvt_pk_bf16_f32 v234, v244, v245
    v_pk_mul_f32 v[246:247], v[246:247], s[38:39]
    v_cvt_pk_bf16_f32 v235, v246, v247
    v_pk_mul_f32 v[248:249], v[248:249], s[38:39]
    v_cvt_pk_bf16_f32 v236, v248, v249
    v_pk_mul_f32 v[250:251], v[250:251], s[38:39]
    v_cvt_pk_bf16_f32 v237, v250, v251
    v_pk_mul_f32 v[252:253], v[252:253], s[38:39]
    v_cvt_pk_bf16_f32 v238, v252, v253
    v_pk_mul_f32 v[254:255], v[254:255], s[38:39]
    v_cvt_pk_bf16_f32 v239, v254, v255
    s_branch K1_ATT
NOTILE:
    s_waitcnt vmcnt(0) lgkmcnt(0)
    s_barrier
    s_mov_b32 s70, 16384
    buffer_store_dword v21, v20, s[68:71], 0 offen offset:128 sc1
    s_waitcnt vmcnt(0)
K_END:
    s_endpgm
TEXT_END:
P_SPIN0:
    s_mov_b32 s37, 0x40000
P_SPIN0_L:
    s_sleep 8
    buffer_load_dword v18, v17, s[64:67], 0 offen offset:0 sc1
    s_waitcnt vmcnt(0)
    v_cmp_ne_u32 s[40:41], v18, v21
    s_sub_u32 s37, s37, 1
    s_cmp_eq_u32 s37, 0
    s_cbranch_scc1 P_BACK0
    s_cmp_lg_u32 s40, 0
    s_cbranch_scc1 P_SPIN0_L
    s_branch P_BACK0
P_SPIN1:
    s_mov_b32 s37, 0x40000
P_SPIN1_L:
    s_sleep 8
    buffer_load_dword v18, v17, s[64:67], 0 offen offset:128 sc1
    s_waitcnt vmcnt(0)
    v_cmp_ne_u32 s[40:41], v18, v21
    s_sub_u32 s37, s37, 1
    s_cmp_eq_u32 s37, 0
    s_cbranch_scc1 P_BACK1
    s_cmp_lg_u32 s40, 0
    s_cbranch_scc1 P_SPIN1_L
    s_branch P_BACK1
P_SPIN2:
    s_mov_b32 s37, 0x40000
P_SPIN2_L:
    s_sleep 8
    buffer_load_dword v18, v17, s[64:67], 0 offen offset:0 sc1
    s_waitcnt vmcnt(0)
    v_cmp_ne_u32 s[40:41], v18, v21
    s_sub_u32 s37, s37, 1
    s_cmp_eq_u32 s37, 0
    s_cbranch_scc1 P_BACK2
    s_cmp_lg_u32 s40, 0
    s_cbranch_scc1 P_SPIN2_L
    s_branch P_BACK2
T_SPIN:
    s_mov_b32 s37, 0x40000
T_SPIN_L:
    s_sleep 8
    buffer_load_dword v21, off, s[64:67], 0 sc1
    s_waitcnt vmcnt(0)
    v_cmp_eq_u32 s[40:41], 0, v21
    s_sub_u32 s37, s37, 1
    s_cmp_eq_u32 s37, 0
    s_cbranch_scc1 T_BACK
    s_cmp_lg_u32 s40, 0
    s_cbranch_scc1 T_SPIN_L
    s_branch T_BACK
SLOW:
    s_waitcnt vmcnt(0) lgkmcnt(0)
    s_barrier
    s_mul_i32 s60, s43, 40960
    v_and_b32 v32, 15, v0
    v_lshrrev_b32 v33, 4, v0
    s_mul_i32 s35, s45, 96
    v_add_u32 v34, s35, v32
    v_mul_u32_u24 v34, 1280, v34
    v_lshl_add_u32 v1, v33, 4, v34
    v_lshlrev_b32 v34, 13, v33
    v_lshl_add_u32 v2, v32, 4, v34
    v_lshlrev_b32 v34, 8, v32
    v_lshl_add_u32 v3, v33, 4, v34
    v_bfe_u32 v34, v0, 2, 2
    v_and_b32 v35, 3, v0
    v_lshl_add_u32 v36, v33, 3, v34
    v_lshlrev_b32 v36, 8, v36
    v_lshl_add_u32 v36, v35, 4, v36
    v_add_u32 v5, s60, v36
    v_lshl_add_u32 v36, v33, 2, v34
    v_lshlrev_b32 v36, 8, v36
    v_lshl_add_u32 v36, v35, 3, v36
    v_add_u32_e64 v6, s60, v36
    v_mov_b32 v32, 0x3f803f80
    v_accvgpr_write_b32 a216, v32
    v_accvgpr_write_b32 a217, v32
    v_accvgpr_write_b32 a218, v32
    v_accvgpr_write_b32 a219, v32
    s_mov_b32 s37, 0
SLOW_U:
    s_lshr_b32 s35, s42, s37
    s_and_b32 s35, s35, 1
    s_cmp_eq_u32 s35, 0
    s_cbranch_scc1 SLOW_NEXT
    v_mov_b64 v[64:65], 0
    v_mov_b64 v[66:67], 0
    v_mov_b64 v[68:69], 0
    v_mov_b64 v[70:71], 0
    v_mov_b64 v[72:73], 0
    v_mov_b64 v[74:75], 0
    v_mov_b64 v[76:77], 0
    v_mov_b64 v[78:79], 0
    v_mov_b64 v[80:81], 0
    v_mov_b64 v[82:83], 0
    v_mov_b64 v[84:85], 0
    v_mov_b64 v[86:87], 0
    v_mov_b64 v[88:89], 0
    v_mov_b64 v[90:91], 0
    v_mov_b64 v[92:93], 0
    v_mov_b64 v[94:95], 0
    v_mov_b64 v[96:97], 0
    v_mov_b64 v[98:99], 0
    v_mov_b64 v[100:101], 0
    v_mov_b64 v[102:103], 0
    v_mov_b64 v[104:105], 0
    v_mov_b64 v[106:107], 0
    v_mov_b64 v[108:109], 0
    v_mov_b64 v[110:111], 0
    v_mov_b64 v[112:113], 0
    v_mov_b64 v[114:115], 0
    v_mov_b64 v[116:117], 0
    v_mov_b64 v[118:119], 0
    v_mov_b64 v[120:121], 0
    v_mov_b64 v[122:123], 0
    v_mov_b64 v[124:125], 0
    v_mov_b64 v[126:127], 0
    v_mov_b64 v[128:129], 0
    v_mov_b64 v[130:131], 0
    v_mov_b64 v[132:133], 0
    v_mov_b64 v[134:135], 0
    v_mov_b64 v[136:137], 0
    v_mov_b64 v[138:139], 0
    v_mov_b64 v[140:141], 0
    v_mov_b64 v[142:143], 0
    v_mov_b64 v[144:145], 0
    v_mov_b64 v[146:147], 0
    v_mov_b64 v[148:149], 0
    v_mov_b64 v[150:151], 0
    v_mov_b64 v[152:153], 0
    v_mov_b64 v[154:155], 0
    v_mov_b64 v[156:157], 0
    v_mov_b64 v[158:159], 0
    v_mov_b64 v[160:161], 0
    v_mov_b64 v[162:163], 0
    v_mov_b64 v[164:165], 0
    v_mov_b64 v[166:167], 0
    v_mov_b64 v[168:169], 0
    v_mov_b64 v[170:171], 0
    v_mov_b64 v[172:173], 0
    v_mov_b64 v[174:175], 0
    v_mov_b64 v[176:177], 0
    v_mov_b64 v[178:179], 0
    v_mov_b64 v[180:181], 0
    v_mov_b64 v[182:183], 0
    v_mov_b64 v[184:185], 0
    v_mov_b64 v[186:187], 0
    v_mov_b64 v[188:189], 0
    v_mov_b64 v[190:191], 0
    v_mov_b64 v[192:193], 0
    v_mov_b64 v[194:195], 0
    v_mov_b64 v[196:197], 0
    v_mov_b64 v[198:199], 0
    v_mov_b64 v[200:201], 0
    v_mov_b64 v[202:203], 0
    v_mov_b64 v[204:205], 0
    v_mov_b64 v[206:207], 0
    v_mov_b64 v[208:209], 0
    v_mov_b64 v[210:211], 0
    v_mov_b64 v[212:213], 0
    v_mov_b64 v[214:215], 0
    v_mov_b64 v[216:217], 0
    v_mov_b64 v[218:219], 0
    v_mov_b64 v[220:221], 0
    v_mov_b64 v[222:223], 0
    v_mov_b64 v[224:225], 0
    v_mov_b64 v[226:227], 0
    v_mov_b64 v[228:229], 0
    v_mov_b64 v[230:231], 0
    v_mov_b64 v[232:233], 0
    v_mov_b64 v[234:235], 0
    v_mov_b64 v[236:237], 0
    v_mov_b64 v[238:239], 0
    v_mov_b64 v[240:241], 0
    v_mov_b64 v[242:243], 0
    v_mov_b64 v[244:245], 0
    v_mov_b64 v[246:247], 0
    v_mov_b64 v[248:249], 0
    v_mov_b64 v[250:251], 0
    v_mov_b64 v[252:253], 0
    v_mov_b64 v[254:255], 0
    s_xor_b32 s75, s37, s31
    s_lshl_b32 s61, s75, 9
    s_lshl_b32 s35, s44, 8
    s_add_u32 s61, s61, s35
    s_mov_b32 s7, 0
SLOW_Q:
    s_add_u32 s35, s7, 0
    s_nop 0
    buffer_load_dwordx4 a[128:131], v1, s[8:11], s35 offen
    s_add_u32 s35, s7, 20480
    buffer_load_dwordx4 a[132:135], v1, s[8:11], s35 offen
    s_add_u32 s35, s7, 40960
    buffer_load_dwordx4 a[136:139], v1, s[8:11], s35 offen
    s_add_u32 s35, s7, 61440
    buffer_load_dwordx4 a[140:143], v1, s[8:11], s35 offen
    s_add_u32 s35, s7, 81920
    buffer_load_dwordx4 a[144:147], v1, s[8:11], s35 offen
    s_add_u32 s35, s7, 102400
    buffer_load_dwordx4 a[148:151], v1, s[8:11], s35 offen
    s_add_u32 m0, s60, 0
    s_add_u32 s35, s61, 0
    buffer_load_dwordx4 v2, s[12:15], s35 offen lds
    s_add_u32 m0, s60, 1024
    s_add_u32 s35, s61, 32768
    buffer_load_dwordx4 v2, s[12:15], s35 offen lds
    s_add_u32 m0, s60, 2048
    s_add_u32 s35, s61, 65536
    buffer_load_dwordx4 v2, s[12:15], s35 offen lds
    s_add_u32 m0, s60, 3072
    s_add_u32 s35, s61, 98304
    buffer_load_dwordx4 v2, s[12:15], s35 offen lds
    s_add_u32 m0, s60, 4096
    s_add_u32 s35, s61, 131072
    buffer_load_dwordx4 v2, s[12:15], s35 offen lds
    s_add_u32 m0, s60, 5120
    s_add_u32 s35, s61, 163840
    buffer_load_dwordx4 v2, s[12:15], s35 offen lds
    s_add_u32 m0, s60, 6144
    s_add_u32 s35, s61, 196608
    buffer_load_dwordx4 v2, s[12:15], s35 offen lds
    s_add_u32 m0, s60, 7168
    s_add_u32 s35, s61, 229376
    buffer_load_dwordx4 v2, s[12:15], s35 offen lds
    s_waitcnt vmcnt(0)
    s_nop 0
    ds_read_b64_tr_b16 a[96:97], v5 offset:0
    ds_read_b64_tr_b16 a[98:99], v5 offset:1024
    ds_read_b64_tr_b16 a[100:101], v5 offset:8
    ds_read_b64_tr_b16 a[102:103], v5 offset:1032
    ds_read_b64_tr_b16 a[104:105], v5 offset:64
    ds_read_b64_tr_b16 a[106:107], v5 offset:1088
    ds_read_b64_tr_b16 a[108:109], v5 offset:72
    ds_read_b64_tr_b16 a[110:111], v5 offset:1096
    s_waitcnt lgkmcnt(0)
    s_nop 0
    ds_read_b64_tr_b16 a[112:113], v5 offset:128
    ds_read_b64_tr_b16 a[114:115], v5 offset:1152
    ds_read_b64_tr_b16 a[116:117], v5 offset:136
    ds_read_b64_tr_b16 a[118:119], v5 offset:1160
    ds_read_b64_tr_b16 a[120:121], v5 offset:192
    ds_read_b64_tr_b16 a[122:123], v5 offset:1216
    ds_read_b64_tr_b16 a[124:125], v5 offset:200
    ds_read_b64_tr_b16 a[126:127], v5 offset:1224
    s_waitcnt lgkmcnt(0)
    s_nop 0
    v_mfma_f32_16x16x32_bf16 v[64:67], a[96:99], a[128:131], v[64:67]
    v_mfma_f32_16x16x32_bf16 v[68:71], a[100:103], a[128:131], v[68:71]
    v_mfma_f32_16x16x32_bf16 v[72:75], a[104:107], a[128:131], v[72:75]
    v_mfma_f32_16x16x32_bf16 v[76:79], a[108:111], a[128:131], v[76:79]
    v_mfma_f32_16x16x32_bf16 v[80:83], a[112:115], a[128:131], v[80:83]
    v_mfma_f32_16x16x32_bf16 v[84:87], a[116:119], a[128:131], v[84:87]
    v_mfma_f32_16x16x32_bf16 v[88:91], a[120:123], a[128:131], v[88:91]
    v_mfma_f32_16x16x32_bf16 v[92:95], a[124:127], a[128:131], v[92:95]
    v_mfma_f32_16x16x32_bf16 v[96:99], a[96:99], a[132:135], v[96:99]
    v_mfma_f32_16x16x32_bf16 v[100:103], a[100:103], a[132:135], v[100:103]
    v_mfma_f32_16x16x32_bf16 v[104:107], a[104:107], a[132:135], v[104:107]
    v_mfma_f32_16x16x32_bf16 v[108:111], a[108:111], a[132:135], v[108:111]
    v_mfma_f32_16x16x32_bf16 v[112:115], a[112:115], a[132:135], v[112:115]
    v_mfma_f32_16x16x32_bf16 v[116:119], a[116:119], a[132:135], v[116:119]
    v_mfma_f32_16x16x32_bf16 v[120:123], a[120:123], a[132:135], v[120:123]
    v_mfma_f32_16x16x32_bf16 v[124:127], a[124:127], a[132:135], v[124:127]
    v_mfma_f32_16x16x32_bf16 v[128:131], a[96:99], a[136:139], v[128:131]
    v_mfma_f32_16x16x32_bf16 v[132:135], a[100:103], a[136:139], v[132:135]
    v_mfma_f32_16x16x32_bf16 v[136:139], a[104:107], a[136:139], v[136:139]
    v_mfma_f32_16x16x32_bf16 v[140:143], a[108:111], a[136:139], v[140:143]
    v_mfma_f32_16x16x32_bf16 v[144:147], a[112:115], a[136:139], v[144:147]
    v_mfma_f32_16x16x32_bf16 v[148:151], a[116:119], a[136:139], v[148:151]
    v_mfma_f32_16x16x32_bf16 v[152:155], a[120:123], a[136:139], v[152:155]
    v_mfma_f32_16x16x32_bf16 v[156:159], a[124:127], a[136:139], v[156:159]
    v_mfma_f32_16x16x32_bf16 v[160:163], a[96:99], a[140:143], v[160:163]
    v_mfma_f32_16x16x32_bf16 v[164:167], a[100:103], a[140:143], v[164:167]
    v_mfma_f32_16x16x32_bf16 v[168:171], a[104:107], a[140:143], v[168:171]
    v_mfma_f32_16x16x32_bf16 v[172:175], a[108:111], a[140:143], v[172:175]
    v_mfma_f32_16x16x32_bf16 v[176:179], a[112:115], a[140:143], v[176:179]
    v_mfma_f32_16x16x32_bf16 v[180:183], a[116:119], a[140:143], v[180:183]
    v_mfma_f32_16x16x32_bf16 v[184:187], a[120:123], a[140:143], v[184:187]
    v_mfma_f32_16x16x32_bf16 v[188:191], a[124:127], a[140:143], v[188:191]
    v_mfma_f32_16x16x32_bf16 v[192:195], a[96:99], a[144:147], v[192:195]
    v_mfma_f32_16x16x32_bf16 v[196:199], a[100:103], a[144:147], v[196:199]
    v_mfma_f32_16x16x32_bf16 v[200:203], a[104:107], a[144:147], v[200:203]
    v_mfma_f32_16x16x32_bf16 v[204:207], a[108:111], a[144:147], v[204:207]
    v_mfma_f32_16x16x32_bf16 v[208:211], a[112:115], a[144:147], v[208:211]
    v_mfma_f32_16x16x32_bf16 v[212:215], a[116:119], a[144:147], v[212:215]
    v_mfma_f32_16x16x32_bf16 v[216:219], a[120:123], a[144:147], v[216:219]
    v_mfma_f32_16x16x32_bf16 v[220:223], a[124:127], a[144:147], v[220:223]
    v_mfma_f32_16x16x32_bf16 v[224:227], a[96:99], a[148:151], v[224:227]
    v_mfma_f32_16x16x32_bf16 v[228:231], a[100:103], a[148:151], v[228:231]
    v_mfma_f32_16x16x32_bf16 v[232:235], a[104:107], a[148:151], v[232:235]
    v_mfma_f32_16x16x32_bf16 v[236:239], a[108:111], a[148:151], v[236:239]
    v_mfma_f32_16x16x32_bf16 v[240:243], a[112:115], a[148:151], v[240:243]
    v_mfma_f32_16x16x32_bf16 v[244:247], a[116:119], a[148:151], v[244:247]
    v_mfma_f32_16x16x32_bf16 v[248:251], a[120:123], a[148:151], v[248:251]
    v_mfma_f32_16x16x32_bf16 v[252:255], a[124:127], a[148:151], v[252:255]
    s_add_u32 s61, s61, 262144
    s_add_u32 s7, s7, 64
    s_cmp_lt_u32 s7, 1280
    s_cbranch_scc1 SLOW_Q
    s_nop 7
    s_nop 0
    v_pk_mul_f32 v[64:65], v[64:65], s[38:39]
    v_cvt_pk_bf16_f32 v64, v64, v65
    v_accvgpr_write_b32 a0, v64
    v_pk_mul_f32 v[66:67], v[66:67], s[38:39]
    v_cvt_pk_bf16_f32 v66, v66, v67
    v_accvgpr_write_b32 a1, v66
    v_pk_mul_f32 v[68:69], v[68:69], s[38:39]
    v_cvt_pk_bf16_f32 v68, v68, v69
    v_accvgpr_write_b32 a2, v68
    v_pk_mul_f32 v[70:71], v[70:71], s[38:39]
    v_cvt_pk_bf16_f32 v70, v70, v71
    v_accvgpr_write_b32 a3, v70
    v_pk_mul_f32 v[72:73], v[72:73], s[38:39]
    v_cvt_pk_bf16_f32 v72, v72, v73
    v_accvgpr_write_b32 a4, v72
    v_pk_mul_f32 v[74:75], v[74:75], s[38:39]
    v_cvt_pk_bf16_f32 v74, v74, v75
    v_accvgpr_write_b32 a5, v74
    v_pk_mul_f32 v[76:77], v[76:77], s[38:39]
    v_cvt_pk_bf16_f32 v76, v76, v77
    v_accvgpr_write_b32 a6, v76
    v_pk_mul_f32 v[78:79], v[78:79], s[38:39]
    v_cvt_pk_bf16_f32 v78, v78, v79
    v_accvgpr_write_b32 a7, v78
    v_pk_mul_f32 v[80:81], v[80:81], s[38:39]
    v_cvt_pk_bf16_f32 v80, v80, v81
    v_accvgpr_write_b32 a8, v80
    v_pk_mul_f32 v[82:83], v[82:83], s[38:39]
    v_cvt_pk_bf16_f32 v82, v82, v83
    v_accvgpr_write_b32 a9, v82
    v_pk_mul_f32 v[84:85], v[84:85], s[38:39]
    v_cvt_pk_bf16_f32 v84, v84, v85
    v_accvgpr_write_b32 a10, v84
    v_pk_mul_f32 v[86:87], v[86:87], s[38:39]
    v_cvt_pk_bf16_f32 v86, v86, v87
    v_accvgpr_write_b32 a11, v86
    v_pk_mul_f32 v[88:89], v[88:89], s[38:39]
    v_cvt_pk_bf16_f32 v88, v88, v89
    v_accvgpr_write_b32 a12, v88
    v_pk_mul_f32 v[90:91], v[90:91], s[38:39]
    v_cvt_pk_bf16_f32 v90, v90, v91
    v_accvgpr_write_b32 a13, v90
    v_pk_mul_f32 v[92:93], v[92:93], s[38:39]
    v_cvt_pk_bf16_f32 v92, v92, v93
    v_accvgpr_write_b32 a14, v92
    v_pk_mul_f32 v[94:95], v[94:95], s[38:39]
    v_cvt_pk_bf16_f32 v94, v94, v95
    v_accvgpr_write_b32 a15, v94
    v_pk_mul_f32 v[96:97], v[96:97], s[38:39]
    v_cvt_pk_bf16_f32 v96, v96, v97
    v_accvgpr_write_b32 a16, v96
    v_pk_mul_f32 v[98:99], v[98:99], s[38:39]
    v_cvt_pk_bf16_f32 v98, v98, v99
    v_accvgpr_write_b32 a17, v98
    v_pk_mul_f32 v[100:101], v[100:101], s[38:39]
    v_cvt_pk_bf16_f32 v100, v100, v101
    v_accvgpr_write_b32 a18, v100
    v_pk_mul_f32 v[102:103], v[102:103], s[38:39]
    v_cvt_pk_bf16_f32 v102, v102, v103
    v_accvgpr_write_b32 a19, v102
    v_pk_mul_f32 v[104:105], v[104:105], s[38:39]
    v_cvt_pk_bf16_f32 v104, v104, v105
    v_accvgpr_write_b32 a20, v104
    v_pk_mul_f32 v[106:107], v[106:107], s[38:39]
    v_cvt_pk_bf16_f32 v106, v106, v107
    v_accvgpr_write_b32 a21, v106
    v_pk_mul_f32 v[108:109], v[108:109], s[38:39]
    v_cvt_pk_bf16_f32 v108, v108, v109
    v_accvgpr_write_b32 a22, v108
    v_pk_mul_f32 v[110:111], v[110:111], s[38:39]
    v_cvt_pk_bf16_f32 v110, v110, v111
    v_accvgpr_write_b32 a23, v110
    v_pk_mul_f32 v[112:113], v[112:113], s[38:39]
    v_cvt_pk_bf16_f32 v112, v112, v113
    v_accvgpr_write_b32 a24, v112
    v_pk_mul_f32 v[114:115], v[114:115], s[38:39]
    v_cvt_pk_bf16_f32 v114, v114, v115
    v_accvgpr_write_b32 a25, v114
    v_pk_mul_f32 v[116:117], v[116:117], s[38:39]
    v_cvt_pk_bf16_f32 v116, v116, v117
    v_accvgpr_write_b32 a26, v116
    v_pk_mul_f32 v[118:119], v[118:119], s[38:39]
    v_cvt_pk_bf16_f32 v118, v118, v119
    v_accvgpr_write_b32 a27, v118
    v_pk_mul_f32 v[120:121], v[120:121], s[38:39]
    v_cvt_pk_bf16_f32 v120, v120, v121
    v_accvgpr_write_b32 a28, v120
    v_pk_mul_f32 v[122:123], v[122:123], s[38:39]
    v_cvt_pk_bf16_f32 v122, v122, v123
    v_accvgpr_write_b32 a29, v122
    v_pk_mul_f32 v[124:125], v[124:125], s[38:39]
    v_cvt_pk_bf16_f32 v124, v124, v125
    v_accvgpr_write_b32 a30, v124
    v_pk_mul_f32 v[126:127], v[126:127], s[38:39]
    v_cvt_pk_bf16_f32 v126, v126, v127
    v_accvgpr_write_b32 a31, v126
    v_pk_mul_f32 v[128:129], v[128:129], s[38:39]
    v_cvt_pk_bf16_f32 v128, v128, v129
    v_accvgpr_write_b32 a32, v128
    v_pk_mul_f32 v[130:131], v[130:131], s[38:39]
    v_cvt_pk_bf16_f32 v130, v130, v131
    v_accvgpr_write_b32 a33, v130
    v_pk_mul_f32 v[132:133], v[132:133], s[38:39]
    v_cvt_pk_bf16_f32 v132, v132, v133
    v_accvgpr_write_b32 a34, v132
    v_pk_mul_f32 v[134:135], v[134:135], s[38:39]
    v_cvt_pk_bf16_f32 v134, v134, v135
    v_accvgpr_write_b32 a35, v134
    v_pk_mul_f32 v[136:137], v[136:137], s[38:39]
    v_cvt_pk_bf16_f32 v136, v136, v137
    v_accvgpr_write_b32 a36, v136
    v_pk_mul_f32 v[138:139], v[138:139], s[38:39]
    v_cvt_pk_bf16_f32 v138, v138, v139
    v_accvgpr_write_b32 a37, v138
    v_pk_mul_f32 v[140:141], v[140:141], s[38:39]
    v_cvt_pk_bf16_f32 v140, v140, v141
    v_accvgpr_write_b32 a38, v140
    v_pk_mul_f32 v[142:143], v[142:143], s[38:39]
    v_cvt_pk_bf16_f32 v142, v142, v143
    v_accvgpr_write_b32 a39, v142
    v_pk_mul_f32 v[144:145], v[144:145], s[38:39]
    v_cvt_pk_bf16_f32 v144, v144, v145
    v_accvgpr_write_b32 a40, v144
    v_pk_mul_f32 v[146:147], v[146:147], s[38:39]
    v_cvt_pk_bf16_f32 v146, v146, v147
    v_accvgpr_write_b32 a41, v146
    v_pk_mul_f32 v[148:149], v[148:149], s[38:39]
    v_cvt_pk_bf16_f32 v148, v148, v149
    v_accvgpr_write_b32 a42, v148
    v_pk_mul_f32 v[150:151], v[150:151], s[38:39]
    v_cvt_pk_bf16_f32 v150, v150, v151
    v_accvgpr_write_b32 a43, v150
    v_pk_mul_f32 v[152:153], v[152:153], s[38:39]
    v_cvt_pk_bf16_f32 v152, v152, v153
    v_accvgpr_write_b32 a44, v152
    v_pk_mul_f32 v[154:155], v[154:155], s[38:39]
    v_cvt_pk_bf16_f32 v154, v154, v155
    v_accvgpr_write_b32 a45, v154
    v_pk_mul_f32 v[156:157], v[156:157], s[38:39]
    v_cvt_pk_bf16_f32 v156, v156, v157
    v_accvgpr_write_b32 a46, v156
    v_pk_mul_f32 v[158:159], v[158:159], s[38:39]
    v_cvt_pk_bf16_f32 v158, v158, v159
    v_accvgpr_write_b32 a47, v158
    v_pk_mul_f32 v[160:161], v[160:161], s[38:39]
    v_cvt_pk_bf16_f32 v160, v160, v161
    v_accvgpr_write_b32 a48, v160
    v_pk_mul_f32 v[162:163], v[162:163], s[38:39]
    v_cvt_pk_bf16_f32 v162, v162, v163
    v_accvgpr_write_b32 a49, v162
    v_pk_mul_f32 v[164:165], v[164:165], s[38:39]
    v_cvt_pk_bf16_f32 v164, v164, v165
    v_accvgpr_write_b32 a50, v164
    v_pk_mul_f32 v[166:167], v[166:167], s[38:39]
    v_cvt_pk_bf16_f32 v166, v166, v167
    v_accvgpr_write_b32 a51, v166
    v_pk_mul_f32 v[168:169], v[168:169], s[38:39]
    v_cvt_pk_bf16_f32 v168, v168, v169
    v_accvgpr_write_b32 a52, v168
    v_pk_mul_f32 v[170:171], v[170:171], s[38:39]
    v_cvt_pk_bf16_f32 v170, v170, v171
    v_accvgpr_write_b32 a53, v170
    v_pk_mul_f32 v[172:173], v[172:173], s[38:39]
    v_cvt_pk_bf16_f32 v172, v172, v173
    v_accvgpr_write_b32 a54, v172
    v_pk_mul_f32 v[174:175], v[174:175], s[38:39]
    v_cvt_pk_bf16_f32 v174, v174, v175
    v_accvgpr_write_b32 a55, v174
    v_pk_mul_f32 v[176:177], v[176:177], s[38:39]
    v_cvt_pk_bf16_f32 v176, v176, v177
    v_accvgpr_write_b32 a56, v176
    v_pk_mul_f32 v[178:179], v[178:179], s[38:39]
    v_cvt_pk_bf16_f32 v178, v178, v179
    v_accvgpr_write_b32 a57, v178
    v_pk_mul_f32 v[180:181], v[180:181], s[38:39]
    v_cvt_pk_bf16_f32 v180, v180, v181
    v_accvgpr_write_b32 a58, v180
    v_pk_mul_f32 v[182:183], v[182:183], s[38:39]
    v_cvt_pk_bf16_f32 v182, v182, v183
    v_accvgpr_write_b32 a59, v182
    v_pk_mul_f32 v[184:185], v[184:185], s[38:39]
    v_cvt_pk_bf16_f32 v184, v184, v185
    v_accvgpr_write_b32 a60, v184
    v_pk_mul_f32 v[186:187], v[186:187], s[38:39]
    v_cvt_pk_bf16_f32 v186, v186, v187
    v_accvgpr_write_b32 a61, v186
    v_pk_mul_f32 v[188:189], v[188:189], s[38:39]
    v_cvt_pk_bf16_f32 v188, v188, v189
    v_accvgpr_write_b32 a62, v188
    v_pk_mul_f32 v[190:191], v[190:191], s[38:39]
    v_cvt_pk_bf16_f32 v190, v190, v191
    v_accvgpr_write_b32 a63, v190
    v_pk_mul_f32 v[192:193], v[192:193], s[38:39]
    v_cvt_pk_bf16_f32 v192, v192, v193
    v_accvgpr_write_b32 a64, v192
    v_pk_mul_f32 v[194:195], v[194:195], s[38:39]
    v_cvt_pk_bf16_f32 v194, v194, v195
    v_accvgpr_write_b32 a65, v194
    v_pk_mul_f32 v[196:197], v[196:197], s[38:39]
    v_cvt_pk_bf16_f32 v196, v196, v197
    v_accvgpr_write_b32 a66, v196
    v_pk_mul_f32 v[198:199], v[198:199], s[38:39]
    v_cvt_pk_bf16_f32 v198, v198, v199
    v_accvgpr_write_b32 a67, v198
    v_pk_mul_f32 v[200:201], v[200:201], s[38:39]
    v_cvt_pk_bf16_f32 v200, v200, v201
    v_accvgpr_write_b32 a68, v200
    v_pk_mul_f32 v[202:203], v[202:203], s[38:39]
    v_cvt_pk_bf16_f32 v202, v202, v203
    v_accvgpr_write_b32 a69, v202
    v_pk_mul_f32 v[204:205], v[204:205], s[38:39]
    v_cvt_pk_bf16_f32 v204, v204, v205
    v_accvgpr_write_b32 a70, v204
    v_pk_mul_f32 v[206:207], v[206:207], s[38:39]
    v_cvt_pk_bf16_f32 v206, v206, v207
    v_accvgpr_write_b32 a71, v206
    v_pk_mul_f32 v[208:209], v[208:209], s[38:39]
    v_cvt_pk_bf16_f32 v208, v208, v209
    v_accvgpr_write_b32 a72, v208
    v_pk_mul_f32 v[210:211], v[210:211], s[38:39]
    v_cvt_pk_bf16_f32 v210, v210, v211
    v_accvgpr_write_b32 a73, v210
    v_pk_mul_f32 v[212:213], v[212:213], s[38:39]
    v_cvt_pk_bf16_f32 v212, v212, v213
    v_accvgpr_write_b32 a74, v212
    v_pk_mul_f32 v[214:215], v[214:215], s[38:39]
    v_cvt_pk_bf16_f32 v214, v214, v215
    v_accvgpr_write_b32 a75, v214
    v_pk_mul_f32 v[216:217], v[216:217], s[38:39]
    v_cvt_pk_bf16_f32 v216, v216, v217
    v_accvgpr_write_b32 a76, v216
    v_pk_mul_f32 v[218:219], v[218:219], s[38:39]
    v_cvt_pk_bf16_f32 v218, v218, v219
    v_accvgpr_write_b32 a77, v218
    v_pk_mul_f32 v[220:221], v[220:221], s[38:39]
    v_cvt_pk_bf16_f32 v220, v220, v221
    v_accvgpr_write_b32 a78, v220
    v_pk_mul_f32 v[222:223], v[222:223], s[38:39]
    v_cvt_pk_bf16_f32 v222, v222, v223
    v_accvgpr_write_b32 a79, v222
    v_pk_mul_f32 v[224:225], v[224:225], s[38:39]
    v_cvt_pk_bf16_f32 v224, v224, v225
    v_accvgpr_write_b32 a80, v224
    v_pk_mul_f32 v[226:227], v[226:227], s[38:39]
    v_cvt_pk_bf16_f32 v226, v226, v227
    v_accvgpr_write_b32 a81, v226
    v_pk_mul_f32 v[228:229], v[228:229], s[38:39]
    v_cvt_pk_bf16_f32 v228, v228, v229
    v_accvgpr_write_b32 a82, v228
    v_pk_mul_f32 v[230:231], v[230:231], s[38:39]
    v_cvt_pk_bf16_f32 v230, v230, v231
    v_accvgpr_write_b32 a83, v230
    v_pk_mul_f32 v[232:233], v[232:233], s[38:39]
    v_cvt_pk_bf16_f32 v232, v232, v233
    v_accvgpr_write_b32 a84, v232
    v_pk_mul_f32 v[234:235], v[234:235], s[38:39]
    v_cvt_pk_bf16_f32 v234, v234, v235
    v_accvgpr_write_b32 a85, v234
    v_pk_mul_f32 v[236:237], v[236:237], s[38:39]
    v_cvt_pk_bf16_f32 v236, v236, v237
    v_accvgpr_write_b32 a86, v236
    v_pk_mul_f32 v[238:239], v[238:239], s[38:39]
    v_cvt_pk_bf16_f32 v238, v238, v239
    v_accvgpr_write_b32 a87, v238
    v_pk_mul_f32 v[240:241], v[240:241], s[38:39]
    v_cvt_pk_bf16_f32 v240, v240, v241
    v_accvgpr_write_b32 a88, v240
    v_pk_mul_f32 v[242:243], v[242:243], s[38:39]
    v_cvt_pk_bf16_f32 v242, v242, v243
    v_accvgpr_write_b32 a89, v242
    v_pk_mul_f32 v[244:245], v[244:245], s[38:39]
    v_cvt_pk_bf16_f32 v244, v244, v245
    v_accvgpr_write_b32 a90, v244
    v_pk_mul_f32 v[246:247], v[246:247], s[38:39]
    v_cvt_pk_bf16_f32 v246, v246, v247
    v_accvgpr_write_b32 a91, v246
    v_pk_mul_f32 v[248:249], v[248:249], s[38:39]
    v_cvt_pk_bf16_f32 v248, v248, v249
    v_accvgpr_write_b32 a92, v248
    v_pk_mul_f32 v[250:251], v[250:251], s[38:39]
    v_cvt_pk_bf16_f32 v250, v250, v251
    v_accvgpr_write_b32 a93, v250
    v_pk_mul_f32 v[252:253], v[252:253], s[38:39]
    v_cvt_pk_bf16_f32 v252, v252, v253
    v_accvgpr_write_b32 a94, v252
    v_pk_mul_f32 v[254:255], v[254:255], s[38:39]
    v_cvt_pk_bf16_f32 v254, v254, v255
    v_accvgpr_write_b32 a95, v254
    v_mov_b32 v56, 0xff800000
    v_mov_b32 v57, 0xff800000
    v_mov_b32 v58, 0xff800000
    v_mov_b32 v59, 0xff800000
    v_mov_b32 v60, 0xff800000
    v_mov_b32 v61, 0xff800000
    s_lshl_b32 s84, s75, 18
    s_mov_b32 s7, 0
SLOW_M:
    s_add_u32 s35, s84, 0
    s_nop 0
    buffer_load_dwordx4 a[96:99], v3, s[16:19], s35 offen offset:0
    buffer_load_dwordx4 a[100:103], v3, s[16:19], s35 offen offset:64
    buffer_load_dwordx4 a[104:107], v3, s[16:19], s35 offen offset:128
    buffer_load_dwordx4 a[108:111], v3, s[16:19], s35 offen offset:192
    s_add_u32 s35, s84, 4096
    buffer_load_dwordx4 a[112:115], v3, s[16:19], s35 offen offset:0
    buffer_load_dwordx4 a[116:119], v3, s[16:19], s35 offen offset:64
    buffer_load_dwordx4 a[120:123], v3, s[16:19], s35 offen offset:128
    buffer_load_dwordx4 a[124:127], v3, s[16:19], s35 offen offset:192
    s_waitcnt vmcnt(0)
    s_nop 0
    v_mfma_f32_16x16x32_bf16 v[32:35], a[96:99], a[0:3], 0
    v_mfma_f32_16x16x32_bf16 v[32:35], a[100:103], a[4:7], v[32:35]
    v_mfma_f32_16x16x32_bf16 v[32:35], a[104:107], a[8:11], v[32:35]
    v_mfma_f32_16x16x32_bf16 v[32:35], a[108:111], a[12:15], v[32:35]
    v_mfma_f32_16x16x32_bf16 v[36:39], a[112:115], a[0:3], 0
    v_mfma_f32_16x16x32_bf16 v[36:39], a[116:119], a[4:7], v[36:39]
    v_mfma_f32_16x16x32_bf16 v[36:39], a[120:123], a[8:11], v[36:39]
    v_mfma_f32_16x16x32_bf16 v[36:39], a[124:127], a[12:15], v[36:39]
    s_nop 7
    s_nop 0
    v_max3_f32 v56, v32, v33, v56
    v_max3_f32 v56, v34, v35, v56
    v_max3_f32 v56, v36, v37, v56
    v_max3_f32 v56, v38, v39, v56
    v_mfma_f32_16x16x32_bf16 v[32:35], a[96:99], a[16:19], 0
    v_mfma_f32_16x16x32_bf16 v[32:35], a[100:103], a[20:23], v[32:35]
    v_mfma_f32_16x16x32_bf16 v[32:35], a[104:107], a[24:27], v[32:35]
    v_mfma_f32_16x16x32_bf16 v[32:35], a[108:111], a[28:31], v[32:35]
    v_mfma_f32_16x16x32_bf16 v[36:39], a[112:115], a[16:19], 0
    v_mfma_f32_16x16x32_bf16 v[36:39], a[116:119], a[20:23], v[36:39]
    v_mfma_f32_16x16x32_bf16 v[36:39], a[120:123], a[24:27], v[36:39]
    v_mfma_f32_16x16x32_bf16 v[36:39], a[124:127], a[28:31], v[36:39]
    s_nop 7
    s_nop 0
    v_max3_f32 v57, v32, v33, v57
    v_max3_f32 v57, v34, v35, v57
    v_max3_f32 v57, v36, v37, v57
    v_max3_f32 v57, v38, v39, v57
    v_mfma_f32_16x16x32_bf16 v[32:35], a[96:99], a[32:35], 0
    v_mfma_f32_16x16x32_bf16 v[32:35], a[100:103], a[36:39], v[32:35]
    v_mfma_f32_16x16x32_bf16 v[32:35], a[104:107], a[40:43], v[32:35]
    v_mfma_f32_16x16x32_bf16 v[32:35], a[108:111], a[44:47], v[32:35]
    v_mfma_f32_16x16x32_bf16 v[36:39], a[112:115], a[32:35], 0
    v_mfma_f32_16x16x32_bf16 v[36:39], a[116:119], a[36:39], v[36:39]
    v_mfma_f32_16x16x32_bf16 v[36:39], a[120:123], a[40:43], v[36:39]
    v_mfma_f32_16x16x32_bf16 v[36:39], a[124:127], a[44:47], v[36:39]
    s_nop 7
    s_nop 0
    v_max3_f32 v58, v32, v33, v58
    v_max3_f32 v58, v34, v35, v58
    v_max3_f32 v58, v36, v37, v58
    v_max3_f32 v58, v38, v39, v58
    v_mfma_f32_16x16x32_bf16 v[32:35], a[96:99], a[48:51], 0
    v_mfma_f32_16x16x32_bf16 v[32:35], a[100:103], a[52:55], v[32:35]
    v_mfma_f32_16x16x32_bf16 v[32:35], a[104:107], a[56:59], v[32:35]
    v_mfma_f32_16x16x32_bf16 v[32:35], a[108:111], a[60:63], v[32:35]
    v_mfma_f32_16x16x32_bf16 v[36:39], a[112:115], a[48:51], 0
    v_mfma_f32_16x16x32_bf16 v[36:39], a[116:119], a[52:55], v[36:39]
    v_mfma_f32_16x16x32_bf16 v[36:39], a[120:123], a[56:59], v[36:39]
    v_mfma_f32_16x16x32_bf16 v[36:39], a[124:127], a[60:63], v[36:39]
    s_nop 7
    s_nop 0
    v_max3_f32 v59, v32, v33, v59
    v_max3_f32 v59, v34, v35, v59
    v_max3_f32 v59, v36, v37, v59
    v_max3_f32 v59, v38, v39, v59
    v_mfma_f32_16x16x32_bf16 v[32:35], a[96:99], a[64:67], 0
    v_mfma_f32_16x16x32_bf16 v[32:35], a[100:103], a[68:71], v[32:35]
    v_mfma_f32_16x16x32_bf16 v[32:35], a[104:107], a[72:75], v[32:35]
    v_mfma_f32_16x16x32_bf16 v[32:35], a[108:111], a[76:79], v[32:35]
    v_mfma_f32_16x16x32_bf16 v[36:39], a[112:115], a[64:67], 0
    v_mfma_f32_16x16x32_bf16 v[36:39], a[116:119], a[68:71], v[36:39]
    v_mfma_f32_16x16x32_bf16 v[36:39], a[120:123], a[72:75], v[36:39]
    v_mfma_f32_16x16x32_bf16 v[36:39], a[124:127], a[76:79], v[36:39]
    s_nop 7
    s_nop 0
    v_max3_f32 v60, v32, v33, v60
    v_max3_f32 v60, v34, v35, v60
    v_max3_f32 v60, v36, v37, v60
    v_max3_f32 v60, v38, v39, v60
    v_mfma_f32_16x16x32_bf16 v[32:35], a[96:99], a[80:83], 0
    v_mfma_f32_16x16x32_bf16 v[32:35], a[100:103], a[84:87], v[32:35]
    v_mfma_f32_16x16x32_bf16 v[32:35], a[104:107], a[88:91], v[32:35]
    v_mfma_f32_16x16x32_bf16 v[32:35], a[108:111], a[92:95], v[32:35]
    v_mfma_f32_16x16x32_bf16 v[36:39], a[112:115], a[80:83], 0
    v_mfma_f32_16x16x32_bf16 v[36:39], a[116:119], a[84:87], v[36:39]
    v_mfma_f32_16x16x32_bf16 v[36:39], a[120:123], a[88:91], v[36:39]
    v_mfma_f32_16x16x32_bf16 v[36:39], a[124:127], a[92:95], v[36:39]
    s_nop 7
    v_max3_f32 v61, v32, v33, v61
    v_max3_f32 v61, v34, v35, v61
    v_max3_f32 v61, v36, v37, v61
    v_max3_f32 v61, v38, v39, v61
    s_add_u32 s84, s84, 8192
    s_add_u32 s7, s7, 1
    s_cmp_lt_u32 s7, 16
    s_cbranch_scc1 SLOW_M
    v_mov_b32 v62, v56
    s_nop 1
    v_permlane16_swap_b32 v56, v62
    v_max_f32 v56, v56, v62
    v_mov_b32 v62, v56
    s_nop 1
    v_permlane32_swap_b32 v56, v62
    v_max_f32 v56, v56, v62
    v_mov_b32 v62, v57
    s_nop 1
    v_permlane16_swap_b32 v57, v62
    v_max_f32 v57, v57, v62
    v_mov_b32 v62, v57
    s_nop 1
    v_permlane32_swap_b32 v57, v62
    v_max_f32 v57, v57, v62
    v_mov_b32 v62, v58
    s_nop 1
    v_permlane16_swap_b32 v58, v62
    v_max_f32 v58, v58, v62
    v_mov_b32 v62, v58
    s_nop 1
    v_permlane32_swap_b32 v58, v62
    v_max_f32 v58, v58, v62
    v_mov_b32 v62, v59
    s_nop 1
    v_permlane16_swap_b32 v59, v62
    v_max_f32 v59, v59, v62
    v_mov_b32 v62, v59
    s_nop 1
    v_permlane32_swap_b32 v59, v62
    v_max_f32 v59, v59, v62
    v_mov_b32 v62, v60
    s_nop 1
    v_permlane16_swap_b32 v60, v62
    v_max_f32 v60, v60, v62
    v_mov_b32 v62, v60
    s_nop 1
    v_permlane32_swap_b32 v60, v62
    v_max_f32 v60, v60, v62
    v_mov_b32 v62, v61
    s_nop 1
    v_permlane16_swap_b32 v61, v62
    v_max_f32 v61, v61, v62
    v_mov_b32 v62, v61
    s_nop 1
    v_permlane32_swap_b32 v61, v62
    v_max_f32 v61, v61, v62
    v_mov_b64 v[64:65], 0
    v_mov_b64 v[66:67], 0
    v_mov_b64 v[68:69], 0
    v_mov_b64 v[70:71], 0
    v_mov_b64 v[72:73], 0
    v_mov_b64 v[74:75], 0
    v_mov_b64 v[76:77], 0
    v_mov_b64 v[78:79], 0
    v_mov_b64 v[80:81], 0
    v_mov_b64 v[82:83], 0
    v_mov_b64 v[84:85], 0
    v_mov_b64 v[86:87], 0
    v_mov_b64 v[88:89], 0
    v_mov_b64 v[90:91], 0
    v_mov_b64 v[92:93], 0
    v_mov_b64 v[94:95], 0
    v_mov_b64 v[96:97], 0
    v_mov_b64 v[98:99], 0
    v_mov_b64 v[100:101], 0
    v_mov_b64 v[102:103], 0
    v_mov_b64 v[104:105], 0
    v_mov_b64 v[106:107], 0
    v_mov_b64 v[108:109], 0
    v_mov_b64 v[110:111], 0
    v_mov_b64 v[112:113], 0
    v_mov_b64 v[114:115], 0
    v_mov_b64 v[116:117], 0
    v_mov_b64 v[118:119], 0
    v_mov_b64 v[120:121], 0
    v_mov_b64 v[122:123], 0
    v_mov_b64 v[124:125], 0
    v_mov_b64 v[126:127], 0
    v_mov_b64 v[128:129], 0
    v_mov_b64 v[130:131], 0
    v_mov_b64 v[132:133], 0
    v_mov_b64 v[134:135], 0
    v_mov_b64 v[136:137], 0
    v_mov_b64 v[138:139], 0
    v_mov_b64 v[140:141], 0
    v_mov_b64 v[142:143], 0
    v_mov_b64 v[144:145], 0
    v_mov_b64 v[146:147], 0
    v_mov_b64 v[148:149], 0
    v_mov_b64 v[150:151], 0
    v_mov_b64 v[152:153], 0
    v_mov_b64 v[154:155], 0
    v_mov_b64 v[156:157], 0
    v_mov_b64 v[158:159], 0
    v_mov_b64 v[160:161], 0
    v_mov_b64 v[162:163], 0
    v_mov_b64 v[164:165], 0
    v_mov_b64 v[166:167], 0
    v_mov_b64 v[168:169], 0
    v_mov_b64 v[170:171], 0
    v_mov_b64 v[172:173], 0
    v_mov_b64 v[174:175], 0
    v_mov_b64 v[176:177], 0
    v_mov_b64 v[178:179], 0
    v_mov_b64 v[180:181], 0
    v_mov_b64 v[182:183], 0
    v_mov_b64 v[184:185], 0
    v_mov_b64 v[186:187], 0
    v_mov_b64 v[188:189], 0
    v_mov_b64 v[190:191], 0
    v_mov_b64 v[192:193], 0
    v_mov_b64 v[194:195], 0
    v_mov_b64 v[196:197], 0
    v_mov_b64 v[198:199], 0
    v_mov_b64 v[200:201], 0
    v_mov_b64 v[202:203], 0
    v_mov_b64 v[204:205], 0
    v_mov_b64 v[206:207], 0
    v_mov_b64 v[208:209], 0
    v_mov_b64 v[210:211], 0
    v_mov_b64 v[212:213], 0
    v_mov_b64 v[214:215], 0
    v_mov_b64 v[216:217], 0
    v_mov_b64 v[218:219], 0
    v_mov_b64 v[220:221], 0
    v_mov_b64 v[222:223], 0
    v_mov_b64 v[224:225], 0
    v_mov_b64 v[226:227], 0
    v_mov_b64 v[228:229], 0
    v_mov_b64 v[230:231], 0
    v_mov_b64 v[232:233], 0
    v_mov_b64 v[234:235], 0
    v_mov_b64 v[236:237], 0
    v_mov_b64 v[238:239], 0
    v_mov_b64 v[240:241], 0
    v_mov_b64 v[242:243], 0
    v_mov_b64 v[244:245], 0
    v_mov_b64 v[246:247], 0
    v_mov_b64 v[248:249], 0
    v_mov_b64 v[250:251], 0
    v_mov_b64 v[252:253], 0
    v_mov_b64 v[254:255], 0
    v_accvgpr_write_b32 a192, 0
    v_accvgpr_write_b32 a193, 0
    v_accvgpr_write_b32 a194, 0
    v_accvgpr_write_b32 a195, 0
    v_accvgpr_write_b32 a196, 0
    v_accvgpr_write_b32 a197, 0
    v_accvgpr_write_b32 a198, 0
    v_accvgpr_write_b32 a199, 0
    v_accvgpr_write_b32 a200, 0
    v_accvgpr_write_b32 a201, 0
    v_accvgpr_write_b32 a202, 0
    v_accvgpr_write_b32 a203, 0
    v_accvgpr_write_b32 a204, 0
    v_accvgpr_write_b32 a205, 0
    v_accvgpr_write_b32 a206, 0
    v_accvgpr_write_b32 a207, 0
    v_accvgpr_write_b32 a208, 0
    v_accvgpr_write_b32 a209, 0
    v_accvgpr_write_b32 a210, 0
    v_accvgpr_write_b32 a211, 0
    v_accvgpr_write_b32 a212, 0
    v_accvgpr_write_b32 a213, 0
    v_accvgpr_write_b32 a214, 0
    v_accvgpr_write_b32 a215, 0
    s_lshl_b32 s84, s75, 18
    s_mov_b32 s7, 0
SLOW_A:
    s_add_u32 s35, s84, 0
    s_nop 0
    buffer_load_dwordx4 a[96:99], v3, s[16:19], s35 offen offset:0
    buffer_load_dwordx4 a[100:103], v3, s[16:19], s35 offen offset:64
    buffer_load_dwordx4 a[104:107], v3, s[16:19], s35 offen offset:128
    buffer_load_dwordx4 a[108:111], v3, s[16:19], s35 offen offset:192
    s_add_u32 s35, s84, 4096
    buffer_load_dwordx4 a[112:115], v3, s[16:19], s35 offen offset:0
    buffer_load_dwordx4 a[116:119], v3, s[16:19], s35 offen offset:64
    buffer_load_dwordx4 a[120:123], v3, s[16:19], s35 offen offset:128
    buffer_load_dwordx4 a[124:127], v3, s[16:19], s35 offen offset:192
    s_add_u32 m0, s60, 0
    s_add_u32 s35, s84, 0
    buffer_load_dwordx4 v4, s[20:23], s35 offen lds
    s_add_u32 m0, s60, 1024
    s_add_u32 s35, s84, 1024
    buffer_load_dwordx4 v4, s[20:23], s35 offen lds
    s_add_u32 m0, s60, 2048
    s_add_u32 s35, s84, 2048
    buffer_load_dwordx4 v4, s[20:23], s35 offen lds
    s_add_u32 m0, s60, 3072
    s_add_u32 s35, s84, 3072
    buffer_load_dwordx4 v4, s[20:23], s35 offen lds
    s_add_u32 m0, s60, 4096
    s_add_u32 s35, s84, 4096
    buffer_load_dwordx4 v4, s[20:23], s35 offen lds
    s_add_u32 m0, s60, 5120
    s_add_u32 s35, s84, 5120
    buffer_load_dwordx4 v4, s[20:23], s35 offen lds
    s_add_u32 m0, s60, 6144
    s_add_u32 s35, s84, 6144
    buffer_load_dwordx4 v4, s[20:23], s35 offen lds
    s_add_u32 m0, s60, 7168
    s_add_u32 s35, s84, 7168
    buffer_load_dwordx4 v4, s[20:23], s35 offen lds
    s_waitcnt vmcnt(0)
    s_nop 0
    ds_read_b64_tr_b16 a[128:129], v6 offset:0
    ds_read_b64_tr_b16 a[130:131], v6 offset:4096
    ds_read_b64_tr_b16 a[132:133], v6 offset:32
    ds_read_b64_tr_b16 a[134:135], v6 offset:4128
    ds_read_b64_tr_b16 a[136:137], v6 offset:64
    ds_read_b64_tr_b16 a[138:139], v6 offset:4160
    ds_read_b64_tr_b16 a[140:141], v6 offset:96
    ds_read_b64_tr_b16 a[142:143], v6 offset:4192
    s_waitcnt lgkmcnt(0)
    s_nop 0
    ds_read_b64_tr_b16 a[144:145], v6 offset:128
    ds_read_b64_tr_b16 a[146:147], v6 offset:4224
    ds_read_b64_tr_b16 a[148:149], v6 offset:160
    ds_read_b64_tr_b16 a[150:151], v6 offset:4256
    ds_read_b64_tr_b16 a[152:153], v6 offset:192
    ds_read_b64_tr_b16 a[154:155], v6 offset:4288
    ds_read_b64_tr_b16 a[156:157], v6 offset:224
    ds_read_b64_tr_b16 a[158:159], v6 offset:4320
    s_waitcnt lgkmcnt(0)
    s_nop 0
    v_mfma_f32_16x16x32_bf16 v[32:35], a[96:99], a[0:3], 0
    v_mfma_f32_16x16x32_bf16 v[32:35], a[100:103], a[4:7], v[32:35]
    v_mfma_f32_16x16x32_bf16 v[32:35], a[104:107], a[8:11], v[32:35]
    v_mfma_f32_16x16x32_bf16 v[32:35], a[108:111], a[12:15], v[32:35]
    v_mfma_f32_16x16x32_bf16 v[36:39], a[112:115], a[0:3], 0
    v_mfma_f32_16x16x32_bf16 v[36:39], a[116:119], a[4:7], v[36:39]
    v_mfma_f32_16x16x32_bf16 v[36:39], a[120:123], a[8:11], v[36:39]
    v_mfma_f32_16x16x32_bf16 v[36:39], a[124:127], a[12:15], v[36:39]
    s_nop 7
    v_sub_f32 v32, v32, v56
    v_sub_f32 v33, v33, v56
    v_sub_f32 v34, v34, v56
    v_sub_f32 v35, v35, v56
    v_sub_f32 v36, v36, v56
    v_sub_f32 v37, v37, v56
    v_sub_f32 v38, v38, v56
    v_sub_f32 v39, v39, v56
    v_exp_f32 v32, v32
    v_exp_f32 v33, v33
    v_exp_f32 v34, v34
    v_exp_f32 v35, v35
    v_exp_f32 v36, v36
    v_exp_f32 v37, v37
    v_exp_f32 v38, v38
    v_exp_f32_e64 v39, v39
    v_cvt_pk_bf16_f32 v48, v32, v33
    v_cvt_pk_bf16_f32 v49, v34, v35
    v_cvt_pk_bf16_f32 v50, v36, v37
    v_cvt_pk_bf16_f32 v51, v38, v39
    s_nop 1
    s_nop 0
    v_mfma_f32_16x16x32_bf16 v[64:67], a[128:131], v[48:51], v[64:67]
    v_mfma_f32_16x16x32_bf16 v[68:71], a[132:135], v[48:51], v[68:71]
    v_mfma_f32_16x16x32_bf16 v[72:75], a[136:139], v[48:51], v[72:75]
    v_mfma_f32_16x16x32_bf16 v[76:79], a[140:143], v[48:51], v[76:79]
    v_mfma_f32_16x16x32_bf16 v[80:83], a[144:147], v[48:51], v[80:83]
    v_mfma_f32_16x16x32_bf16 v[84:87], a[148:151], v[48:51], v[84:87]
    v_mfma_f32_16x16x32_bf16 v[88:91], a[152:155], v[48:51], v[88:91]
    v_mfma_f32_16x16x32_bf16 v[92:95], a[156:159], v[48:51], v[92:95]
    v_mfma_f32_16x16x32_bf16 a[192:195], a[216:219], v[48:51], a[192:195]
    v_mfma_f32_16x16x32_bf16 v[32:35], a[96:99], a[16:19], 0
    v_mfma_f32_16x16x32_bf16 v[32:35], a[100:103], a[20:23], v[32:35]
    v_mfma_f32_16x16x32_bf16 v[32:35], a[104:107], a[24:27], v[32:35]
    v_mfma_f32_16x16x32_bf16 v[32:35], a[108:111], a[28:31], v[32:35]
    v_mfma_f32_16x16x32_bf16 v[36:39], a[112:115], a[16:19], 0
    v_mfma_f32_16x16x32_bf16 v[36:39], a[116:119], a[20:23], v[36:39]
    v_mfma_f32_16x16x32_bf16 v[36:39], a[120:123], a[24:27], v[36:39]
    v_mfma_f32_16x16x32_bf16 v[36:39], a[124:127], a[28:31], v[36:39]
    s_nop 7
    v_sub_f32 v32, v32, v57
    v_sub_f32 v33, v33, v57
    v_sub_f32 v34, v34, v57
    v_sub_f32 v35, v35, v57
    v_sub_f32 v36, v36, v57
    v_sub_f32 v37, v37, v57
    v_sub_f32 v38, v38, v57
    v_sub_f32 v39, v39, v57
    v_exp_f32 v32, v32
    v_exp_f32 v33, v33
    v_exp_f32 v34, v34
    v_exp_f32 v35, v35
    v_exp_f32 v36, v36
    v_exp_f32 v37, v37
    v_exp_f32 v38, v38
    v_exp_f32_e64 v39, v39
    v_cvt_pk_bf16_f32 v48, v32, v33
    v_cvt_pk_bf16_f32 v49, v34, v35
    v_cvt_pk_bf16_f32 v50, v36, v37
    v_cvt_pk_bf16_f32 v51, v38, v39
    s_nop 1
    s_nop 0
    v_mfma_f32_16x16x32_bf16 v[96:99], a[128:131], v[48:51], v[96:99]
    v_mfma_f32_16x16x32_bf16 v[100:103], a[132:135], v[48:51], v[100:103]
    v_mfma_f32_16x16x32_bf16 v[104:107], a[136:139], v[48:51], v[104:107]
    v_mfma_f32_16x16x32_bf16 v[108:111], a[140:143], v[48:51], v[108:111]
    v_mfma_f32_16x16x32_bf16 v[112:115], a[144:147], v[48:51], v[112:115]
    v_mfma_f32_16x16x32_bf16 v[116:119], a[148:151], v[48:51], v[116:119]
    v_mfma_f32_16x16x32_bf16 v[120:123], a[152:155], v[48:51], v[120:123]
    v_mfma_f32_16x16x32_bf16 v[124:127], a[156:159], v[48:51], v[124:127]
    v_mfma_f32_16x16x32_bf16 a[196:199], a[216:219], v[48:51], a[196:199]
    v_mfma_f32_16x16x32_bf16 v[32:35], a[96:99], a[32:35], 0
    v_mfma_f32_16x16x32_bf16 v[32:35], a[100:103], a[36:39], v[32:35]
    v_mfma_f32_16x16x32_bf16 v[32:35], a[104:107], a[40:43], v[32:35]
    v_mfma_f32_16x16x32_bf16 v[32:35], a[108:111], a[44:47], v[32:35]
    v_mfma_f32_16x16x32_bf16 v[36:39], a[112:115], a[32:35], 0
    v_mfma_f32_16x16x32_bf16 v[36:39], a[116:119], a[36:39], v[36:39]
    v_mfma_f32_16x16x32_bf16 v[36:39], a[120:123], a[40:43], v[36:39]
    v_mfma_f32_16x16x32_bf16 v[36:39], a[124:127], a[44:47], v[36:39]
    s_nop 7
    v_sub_f32 v32, v32, v58
    v_sub_f32 v33, v33, v58
    v_sub_f32 v34, v34, v58
    v_sub_f32 v35, v35, v58
    v_sub_f32 v36, v36, v58
    v_sub_f32 v37, v37, v58
    v_sub_f32 v38, v38, v58
    v_sub_f32 v39, v39, v58
    v_exp_f32 v32, v32
    v_exp_f32 v33, v33
    v_exp_f32 v34, v34
    v_exp_f32 v35, v35
    v_exp_f32 v36, v36
    v_exp_f32 v37, v37
    v_exp_f32 v38, v38
    v_exp_f32_e64 v39, v39
    v_cvt_pk_bf16_f32 v48, v32, v33
    v_cvt_pk_bf16_f32 v49, v34, v35
    v_cvt_pk_bf16_f32 v50, v36, v37
    v_cvt_pk_bf16_f32 v51, v38, v39
    s_nop 1
    s_nop 0
    v_mfma_f32_16x16x32_bf16 v[128:131], a[128:131], v[48:51], v[128:131]
    v_mfma_f32_16x16x32_bf16 v[132:135], a[132:135], v[48:51], v[132:135]
    v_mfma_f32_16x16x32_bf16 v[136:139], a[136:139], v[48:51], v[136:139]
    v_mfma_f32_16x16x32_bf16 v[140:143], a[140:143], v[48:51], v[140:143]
    v_mfma_f32_16x16x32_bf16 v[144:147], a[144:147], v[48:51], v[144:147]
    v_mfma_f32_16x16x32_bf16 v[148:151], a[148:151], v[48:51], v[148:151]
    v_mfma_f32_16x16x32_bf16 v[152:155], a[152:155], v[48:51], v[152:155]
    v_mfma_f32_16x16x32_bf16 v[156:159], a[156:159], v[48:51], v[156:159]
    v_mfma_f32_16x16x32_bf16 a[200:203], a[216:219], v[48:51], a[200:203]
    v_mfma_f32_16x16x32_bf16 v[32:35], a[96:99], a[48:51], 0
    v_mfma_f32_16x16x32_bf16 v[32:35], a[100:103], a[52:55], v[32:35]
    v_mfma_f32_16x16x32_bf16 v[32:35], a[104:107], a[56:59], v[32:35]
    v_mfma_f32_16x16x32_bf16 v[32:35], a[108:111], a[60:63], v[32:35]
    v_mfma_f32_16x16x32_bf16 v[36:39], a[112:115], a[48:51], 0
    v_mfma_f32_16x16x32_bf16 v[36:39], a[116:119], a[52:55], v[36:39]
    v_mfma_f32_16x16x32_bf16 v[36:39], a[120:123], a[56:59], v[36:39]
    v_mfma_f32_16x16x32_bf16 v[36:39], a[124:127], a[60:63], v[36:39]
    s_nop 7
    v_sub_f32 v32, v32, v59
    v_sub_f32 v33, v33, v59
    v_sub_f32 v34, v34, v59
    v_sub_f32 v35, v35, v59
    v_sub_f32 v36, v36, v59
    v_sub_f32 v37, v37, v59
    v_sub_f32 v38, v38, v59
    v_sub_f32 v39, v39, v59
    v_exp_f32 v32, v32
    v_exp_f32 v33, v33
    v_exp_f32 v34, v34
    v_exp_f32 v35, v35
    v_exp_f32 v36, v36
    v_exp_f32 v37, v37
    v_exp_f32 v38, v38
    v_exp_f32_e64 v39, v39
    v_cvt_pk_bf16_f32 v48, v32, v33
    v_cvt_pk_bf16_f32 v49, v34, v35
    v_cvt_pk_bf16_f32 v50, v36, v37
    v_cvt_pk_bf16_f32 v51, v38, v39
    s_nop 1
    s_nop 0
    v_mfma_f32_16x16x32_bf16 v[160:163], a[128:131], v[48:51], v[160:163]
    v_mfma_f32_16x16x32_bf16 v[164:167], a[132:135], v[48:51], v[164:167]
    v_mfma_f32_16x16x32_bf16 v[168:171], a[136:139], v[48:51], v[168:171]
    v_mfma_f32_16x16x32_bf16 v[172:175], a[140:143], v[48:51], v[172:175]
    v_mfma_f32_16x16x32_bf16 v[176:179], a[144:147], v[48:51], v[176:179]
    v_mfma_f32_16x16x32_bf16 v[180:183], a[148:151], v[48:51], v[180:183]
    v_mfma_f32_16x16x32_bf16 v[184:187], a[152:155], v[48:51], v[184:187]
    v_mfma_f32_16x16x32_bf16 v[188:191], a[156:159], v[48:51], v[188:191]
    v_mfma_f32_16x16x32_bf16 a[204:207], a[216:219], v[48:51], a[204:207]
    v_mfma_f32_16x16x32_bf16 v[32:35], a[96:99], a[64:67], 0
    v_mfma_f32_16x16x32_bf16 v[32:35], a[100:103], a[68:71], v[32:35]
    v_mfma_f32_16x16x32_bf16 v[32:35], a[104:107], a[72:75], v[32:35]
    v_mfma_f32_16x16x32_bf16 v[32:35], a[108:111], a[76:79], v[32:35]
    v_mfma_f32_16x16x32_bf16 v[36:39], a[112:115], a[64:67], 0
    v_mfma_f32_16x16x32_bf16 v[36:39], a[116:119], a[68:71], v[36:39]
    v_mfma_f32_16x16x32_bf16 v[36:39], a[120:123], a[72:75], v[36:39]
    v_mfma_f32_16x16x32_bf16 v[36:39], a[124:127], a[76:79], v[36:39]
    s_nop 7
    v_sub_f32 v32, v32, v60
    v_sub_f32 v33, v33, v60
    v_sub_f32 v34, v34, v60
    v_sub_f32 v35, v35, v60
    v_sub_f32 v36, v36, v60
    v_sub_f32 v37, v37, v60
    v_sub_f32 v38, v38, v60
    v_sub_f32 v39, v39, v60
    v_exp_f32 v32, v32
    v_exp_f32 v33, v33
    v_exp_f32 v34, v34
    v_exp_f32 v35, v35
    v_exp_f32 v36, v36
    v_exp_f32 v37, v37
    v_exp_f32 v38, v38
    v_exp_f32_e64 v39, v39
    v_cvt_pk_bf16_f32 v48, v32, v33
    v_cvt_pk_bf16_f32 v49, v34, v35
    v_cvt_pk_bf16_f32 v50, v36, v37
    v_cvt_pk_bf16_f32 v51, v38, v39
    s_nop 1
    s_nop 0
    v_mfma_f32_16x16x32_bf16 v[192:195], a[128:131], v[48:51], v[192:195]
    v_mfma_f32_16x16x32_bf16 v[196:199], a[132:135], v[48:51], v[196:199]
    v_mfma_f32_16x16x32_bf16 v[200:203], a[136:139], v[48:51], v[200:203]
    v_mfma_f32_16x16x32_bf16 v[204:207], a[140:143], v[48:51], v[204:207]
    v_mfma_f32_16x16x32_bf16 v[208:211], a[144:147], v[48:51], v[208:211]
    v_mfma_f32_16x16x32_bf16 v[212:215], a[148:151], v[48:51], v[212:215]
    v_mfma_f32_16x16x32_bf16 v[216:219], a[152:155], v[48:51], v[216:219]
    v_mfma_f32_16x16x32_bf16 v[220:223], a[156:159], v[48:51], v[220:223]
    v_mfma_f32_16x16x32_bf16 a[208:211], a[216:219], v[48:51], a[208:211]
    v_mfma_f32_16x16x32_bf16 v[32:35], a[96:99], a[80:83], 0
    v_mfma_f32_16x16x32_bf16 v[32:35], a[100:103], a[84:87], v[32:35]
    v_mfma_f32_16x16x32_bf16 v[32:35], a[104:107], a[88:91], v[32:35]
    v_mfma_f32_16x16x32_bf16 v[32:35], a[108:111], a[92:95], v[32:35]
    v_mfma_f32_16x16x32_bf16 v[36:39], a[112:115], a[80:83], 0
    v_mfma_f32_16x16x32_bf16 v[36:39], a[116:119], a[84:87], v[36:39]
    v_mfma_f32_16x16x32_bf16 v[36:39], a[120:123], a[88:91], v[36:39]
    v_mfma_f32_16x16x32_bf16 v[36:39], a[124:127], a[92:95], v[36:39]
    s_nop 7
    v_sub_f32 v32, v32, v61
    v_sub_f32 v33, v33, v61
    v_sub_f32 v34, v34, v61
    v_sub_f32 v35, v35, v61
    v_sub_f32 v36, v36, v61
    v_sub_f32 v37, v37, v61
    v_sub_f32 v38, v38, v61
    v_sub_f32 v39, v39, v61
    v_exp_f32 v32, v32
    v_exp_f32 v33, v33
    v_exp_f32 v34, v34
    v_exp_f32 v35, v35
    v_exp_f32 v36, v36
    v_exp_f32 v37, v37
    v_exp_f32 v38, v38
    v_exp_f32_e64 v39, v39
    v_cvt_pk_bf16_f32 v48, v32, v33
    v_cvt_pk_bf16_f32 v49, v34, v35
    v_cvt_pk_bf16_f32 v50, v36, v37
    v_cvt_pk_bf16_f32 v51, v38, v39
    s_nop 1
    s_nop 0
    v_mfma_f32_16x16x32_bf16 v[224:227], a[128:131], v[48:51], v[224:227]
    v_mfma_f32_16x16x32_bf16 v[228:231], a[132:135], v[48:51], v[228:231]
    v_mfma_f32_16x16x32_bf16 v[232:235], a[136:139], v[48:51], v[232:235]
    v_mfma_f32_16x16x32_bf16 v[236:239], a[140:143], v[48:51], v[236:239]
    v_mfma_f32_16x16x32_bf16 v[240:243], a[144:147], v[48:51], v[240:243]
    v_mfma_f32_16x16x32_bf16 v[244:247], a[148:151], v[48:51], v[244:247]
    v_mfma_f32_16x16x32_bf16 v[248:251], a[152:155], v[48:51], v[248:251]
    v_mfma_f32_16x16x32_bf16 v[252:255], a[156:159], v[48:51], v[252:255]
    v_mfma_f32_16x16x32_bf16 a[212:215], a[216:219], v[48:51], a[212:215]
    s_add_u32 s84, s84, 8192
    s_add_u32 s7, s7, 1
    s_cmp_lt_u32 s7, 16
    s_cbranch_scc1 SLOW_A
    s_nop 7
    s_mul_i32 s34, s75, 1572864
    v_accvgpr_read_b32 v32, a192
    v_rcp_f32 v32, v32
    s_nop 0
    v_pk_mul_f32 v[64:65], v[64:65], v[32:33] op_sel_hi:[1,0]
    v_cvt_pk_bf16_f32 v64, v64, v65
    v_accvgpr_write_b32 a0, v64
    v_pk_mul_f32 v[66:67], v[66:67], v[32:33] op_sel_hi:[1,0]
    v_cvt_pk_bf16_f32 v66, v66, v67
    v_accvgpr_write_b32 a1, v66
    v_pk_mul_f32 v[68:69], v[68:69], v[32:33] op_sel_hi:[1,0]
    v_cvt_pk_bf16_f32 v68, v68, v69
    v_accvgpr_write_b32 a2, v68
    v_pk_mul_f32 v[70:71], v[70:71], v[32:33] op_sel_hi:[1,0]
    v_cvt_pk_bf16_f32 v70, v70, v71
    v_accvgpr_write_b32 a3, v70
    v_pk_mul_f32 v[72:73], v[72:73], v[32:33] op_sel_hi:[1,0]
    v_cvt_pk_bf16_f32 v72, v72, v73
    v_accvgpr_write_b32 a4, v72
    v_pk_mul_f32 v[74:75], v[74:75], v[32:33] op_sel_hi:[1,0]
    v_cvt_pk_bf16_f32 v74, v74, v75
    v_accvgpr_write_b32 a5, v74
    v_pk_mul_f32 v[76:77], v[76:77], v[32:33] op_sel_hi:[1,0]
    v_cvt_pk_bf16_f32 v76, v76, v77
    v_accvgpr_write_b32 a6, v76
    v_pk_mul_f32 v[78:79], v[78:79], v[32:33] op_sel_hi:[1,0]
    v_cvt_pk_bf16_f32 v78, v78, v79
    v_accvgpr_write_b32 a7, v78
    v_pk_mul_f32 v[80:81], v[80:81], v[32:33] op_sel_hi:[1,0]
    v_cvt_pk_bf16_f32 v80, v80, v81
    v_accvgpr_write_b32 a8, v80
    v_pk_mul_f32 v[82:83], v[82:83], v[32:33] op_sel_hi:[1,0]
    v_cvt_pk_bf16_f32 v82, v82, v83
    v_accvgpr_write_b32 a9, v82
    v_pk_mul_f32 v[84:85], v[84:85], v[32:33] op_sel_hi:[1,0]
    v_cvt_pk_bf16_f32 v84, v84, v85
    v_accvgpr_write_b32 a10, v84
    v_pk_mul_f32 v[86:87], v[86:87], v[32:33] op_sel_hi:[1,0]
    v_cvt_pk_bf16_f32 v86, v86, v87
    v_accvgpr_write_b32 a11, v86
    v_pk_mul_f32 v[88:89], v[88:89], v[32:33] op_sel_hi:[1,0]
    v_cvt_pk_bf16_f32 v88, v88, v89
    v_accvgpr_write_b32 a12, v88
    v_pk_mul_f32 v[90:91], v[90:91], v[32:33] op_sel_hi:[1,0]
    v_cvt_pk_bf16_f32 v90, v90, v91
    v_accvgpr_write_b32 a13, v90
    v_pk_mul_f32 v[92:93], v[92:93], v[32:33] op_sel_hi:[1,0]
    v_cvt_pk_bf16_f32 v92, v92, v93
    v_accvgpr_write_b32 a14, v92
    v_pk_mul_f32 v[94:95], v[94:95], v[32:33] op_sel_hi:[1,0]
    v_cvt_pk_bf16_f32 v94, v94, v95
    v_accvgpr_write_b32 a15, v94
    s_add_u32 s36, s34, 0
    s_nop 0
    buffer_store_dwordx4 a[0:3], v4, s[24:27], s36 offen offset:0 sc1
    s_add_u32 s36, s34, 196608
    buffer_store_dwordx4 a[4:7], v4, s[24:27], s36 offen offset:0 sc1
    s_add_u32 s36, s34, 393216
    buffer_store_dwordx4 a[8:11], v4, s[24:27], s36 offen offset:0 sc1
    s_add_u32 s36, s34, 589824
    buffer_store_dwordx4 a[12:15], v4, s[24:27], s36 offen offset:0 sc1
    v_accvgpr_read_b32 v32, a196
    v_rcp_f32 v32, v32
    s_nop 0
    v_pk_mul_f32 v[96:97], v[96:97], v[32:33] op_sel_hi:[1,0]
    v_cvt_pk_bf16_f32 v96, v96, v97
    v_accvgpr_write_b32 a16, v96
    v_pk_mul_f32 v[98:99], v[98:99], v[32:33] op_sel_hi:[1,0]
    v_cvt_pk_bf16_f32 v98, v98, v99
    v_accvgpr_write_b32 a17, v98
    v_pk_mul_f32 v[100:101], v[100:101], v[32:33] op_sel_hi:[1,0]
    v_cvt_pk_bf16_f32 v100, v100, v101
    v_accvgpr_write_b32 a18, v100
    v_pk_mul_f32 v[102:103], v[102:103], v[32:33] op_sel_hi:[1,0]
    v_cvt_pk_bf16_f32 v102, v102, v103
    v_accvgpr_write_b32 a19, v102
    v_pk_mul_f32 v[104:105], v[104:105], v[32:33] op_sel_hi:[1,0]
    v_cvt_pk_bf16_f32 v104, v104, v105
    v_accvgpr_write_b32 a20, v104
    v_pk_mul_f32 v[106:107], v[106:107], v[32:33] op_sel_hi:[1,0]
    v_cvt_pk_bf16_f32 v106, v106, v107
    v_accvgpr_write_b32 a21, v106
    v_pk_mul_f32 v[108:109], v[108:109], v[32:33] op_sel_hi:[1,0]
    v_cvt_pk_bf16_f32 v108, v108, v109
    v_accvgpr_write_b32 a22, v108
    v_pk_mul_f32 v[110:111], v[110:111], v[32:33] op_sel_hi:[1,0]
    v_cvt_pk_bf16_f32 v110, v110, v111
    v_accvgpr_write_b32 a23, v110
    v_pk_mul_f32 v[112:113], v[112:113], v[32:33] op_sel_hi:[1,0]
    v_cvt_pk_bf16_f32 v112, v112, v113
    v_accvgpr_write_b32 a24, v112
    v_pk_mul_f32 v[114:115], v[114:115], v[32:33] op_sel_hi:[1,0]
    v_cvt_pk_bf16_f32 v114, v114, v115
    v_accvgpr_write_b32 a25, v114
    v_pk_mul_f32 v[116:117], v[116:117], v[32:33] op_sel_hi:[1,0]
    v_cvt_pk_bf16_f32 v116, v116, v117
    v_accvgpr_write_b32 a26, v116
    v_pk_mul_f32 v[118:119], v[118:119], v[32:33] op_sel_hi:[1,0]
    v_cvt_pk_bf16_f32 v118, v118, v119
    v_accvgpr_write_b32 a27, v118
    v_pk_mul_f32 v[120:121], v[120:121], v[32:33] op_sel_hi:[1,0]
    v_cvt_pk_bf16_f32 v120, v120, v121
    v_accvgpr_write_b32 a28, v120
    v_pk_mul_f32 v[122:123], v[122:123], v[32:33] op_sel_hi:[1,0]
    v_cvt_pk_bf16_f32 v122, v122, v123
    v_accvgpr_write_b32 a29, v122
    v_pk_mul_f32 v[124:125], v[124:125], v[32:33] op_sel_hi:[1,0]
    v_cvt_pk_bf16_f32 v124, v124, v125
    v_accvgpr_write_b32 a30, v124
    v_pk_mul_f32 v[126:127], v[126:127], v[32:33] op_sel_hi:[1,0]
    v_cvt_pk_bf16_f32 v126, v126, v127
    v_accvgpr_write_b32 a31, v126
    s_add_u32 s36, s34, 0
    s_nop 0
    buffer_store_dwordx4 a[16:19], v4, s[24:27], s36 offen offset:1024 sc1
    s_add_u32 s36, s34, 196608
    buffer_store_dwordx4 a[20:23], v4, s[24:27], s36 offen offset:1024 sc1
    s_add_u32 s36, s34, 393216
    buffer_store_dwordx4 a[24:27], v4, s[24:27], s36 offen offset:1024 sc1
    s_add_u32 s36, s34, 589824
    buffer_store_dwordx4 a[28:31], v4, s[24:27], s36 offen offset:1024 sc1
    v_accvgpr_read_b32 v32, a200
    v_rcp_f32 v32, v32
    s_nop 0
    v_pk_mul_f32 v[128:129], v[128:129], v[32:33] op_sel_hi:[1,0]
    v_cvt_pk_bf16_f32 v128, v128, v129
    v_accvgpr_write_b32 a32, v128
    v_pk_mul_f32 v[130:131], v[130:131], v[32:33] op_sel_hi:[1,0]
    v_cvt_pk_bf16_f32 v130, v130, v131
    v_accvgpr_write_b32 a33, v130
    v_pk_mul_f32 v[132:133], v[132:133], v[32:33] op_sel_hi:[1,0]
    v_cvt_pk_bf16_f32 v132, v132, v133
    v_accvgpr_write_b32 a34, v132
    v_pk_mul_f32 v[134:135], v[134:135], v[32:33] op_sel_hi:[1,0]
    v_cvt_pk_bf16_f32 v134, v134, v135
    v_accvgpr_write_b32 a35, v134
    v_pk_mul_f32 v[136:137], v[136:137], v[32:33] op_sel_hi:[1,0]
    v_cvt_pk_bf16_f32 v136, v136, v137
    v_accvgpr_write_b32 a36, v136
    v_pk_mul_f32 v[138:139], v[138:139], v[32:33] op_sel_hi:[1,0]
    v_cvt_pk_bf16_f32 v138, v138, v139
    v_accvgpr_write_b32 a37, v138
    v_pk_mul_f32 v[140:141], v[140:141], v[32:33] op_sel_hi:[1,0]
    v_cvt_pk_bf16_f32 v140, v140, v141
    v_accvgpr_write_b32 a38, v140
    v_pk_mul_f32 v[142:143], v[142:143], v[32:33] op_sel_hi:[1,0]
    v_cvt_pk_bf16_f32 v142, v142, v143
    v_accvgpr_write_b32 a39, v142
    v_pk_mul_f32 v[144:145], v[144:145], v[32:33] op_sel_hi:[1,0]
    v_cvt_pk_bf16_f32 v144, v144, v145
    v_accvgpr_write_b32 a40, v144
    v_pk_mul_f32 v[146:147], v[146:147], v[32:33] op_sel_hi:[1,0]
    v_cvt_pk_bf16_f32 v146, v146, v147
    v_accvgpr_write_b32 a41, v146
    v_pk_mul_f32 v[148:149], v[148:149], v[32:33] op_sel_hi:[1,0]
    v_cvt_pk_bf16_f32 v148, v148, v149
    v_accvgpr_write_b32 a42, v148
    v_pk_mul_f32 v[150:151], v[150:151], v[32:33] op_sel_hi:[1,0]
    v_cvt_pk_bf16_f32 v150, v150, v151
    v_accvgpr_write_b32 a43, v150
    v_pk_mul_f32 v[152:153], v[152:153], v[32:33] op_sel_hi:[1,0]
    v_cvt_pk_bf16_f32 v152, v152, v153
    v_accvgpr_write_b32 a44, v152
    v_pk_mul_f32 v[154:155], v[154:155], v[32:33] op_sel_hi:[1,0]
    v_cvt_pk_bf16_f32 v154, v154, v155
    v_accvgpr_write_b32 a45, v154
    v_pk_mul_f32 v[156:157], v[156:157], v[32:33] op_sel_hi:[1,0]
    v_cvt_pk_bf16_f32 v156, v156, v157
    v_accvgpr_write_b32 a46, v156
    v_pk_mul_f32 v[158:159], v[158:159], v[32:33] op_sel_hi:[1,0]
    v_cvt_pk_bf16_f32 v158, v158, v159
    v_accvgpr_write_b32 a47, v158
    s_add_u32 s36, s34, 0
    s_nop 0
    buffer_store_dwordx4 a[32:35], v4, s[24:27], s36 offen offset:2048 sc1
    s_add_u32 s36, s34, 196608
    buffer_store_dwordx4 a[36:39], v4, s[24:27], s36 offen offset:2048 sc1
    s_add_u32 s36, s34, 393216
    buffer_store_dwordx4 a[40:43], v4, s[24:27], s36 offen offset:2048 sc1
    s_add_u32 s36, s34, 589824
    buffer_store_dwordx4 a[44:47], v4, s[24:27], s36 offen offset:2048 sc1
    v_accvgpr_read_b32 v32, a204
    v_rcp_f32 v32, v32
    s_nop 0
    v_pk_mul_f32 v[160:161], v[160:161], v[32:33] op_sel_hi:[1,0]
    v_cvt_pk_bf16_f32 v160, v160, v161
    v_accvgpr_write_b32 a48, v160
    v_pk_mul_f32 v[162:163], v[162:163], v[32:33] op_sel_hi:[1,0]
    v_cvt_pk_bf16_f32 v162, v162, v163
    v_accvgpr_write_b32 a49, v162
    v_pk_mul_f32 v[164:165], v[164:165], v[32:33] op_sel_hi:[1,0]
    v_cvt_pk_bf16_f32 v164, v164, v165
    v_accvgpr_write_b32 a50, v164
    v_pk_mul_f32 v[166:167], v[166:167], v[32:33] op_sel_hi:[1,0]
    v_cvt_pk_bf16_f32 v166, v166, v167
    v_accvgpr_write_b32 a51, v166
    v_pk_mul_f32 v[168:169], v[168:169], v[32:33] op_sel_hi:[1,0]
    v_cvt_pk_bf16_f32 v168, v168, v169
    v_accvgpr_write_b32 a52, v168
    v_pk_mul_f32 v[170:171], v[170:171], v[32:33] op_sel_hi:[1,0]
    v_cvt_pk_bf16_f32 v170, v170, v171
    v_accvgpr_write_b32 a53, v170
    v_pk_mul_f32 v[172:173], v[172:173], v[32:33] op_sel_hi:[1,0]
    v_cvt_pk_bf16_f32 v172, v172, v173
    v_accvgpr_write_b32 a54, v172
    v_pk_mul_f32 v[174:175], v[174:175], v[32:33] op_sel_hi:[1,0]
    v_cvt_pk_bf16_f32 v174, v174, v175
    v_accvgpr_write_b32 a55, v174
    v_pk_mul_f32 v[176:177], v[176:177], v[32:33] op_sel_hi:[1,0]
    v_cvt_pk_bf16_f32 v176, v176, v177
    v_accvgpr_write_b32 a56, v176
    v_pk_mul_f32 v[178:179], v[178:179], v[32:33] op_sel_hi:[1,0]
    v_cvt_pk_bf16_f32 v178, v178, v179
    v_accvgpr_write_b32 a57, v178
    v_pk_mul_f32 v[180:181], v[180:181], v[32:33] op_sel_hi:[1,0]
    v_cvt_pk_bf16_f32 v180, v180, v181
    v_accvgpr_write_b32 a58, v180
    v_pk_mul_f32 v[182:183], v[182:183], v[32:33] op_sel_hi:[1,0]
    v_cvt_pk_bf16_f32 v182, v182, v183
    v_accvgpr_write_b32 a59, v182
    v_pk_mul_f32 v[184:185], v[184:185], v[32:33] op_sel_hi:[1,0]
    v_cvt_pk_bf16_f32 v184, v184, v185
    v_accvgpr_write_b32 a60, v184
    v_pk_mul_f32 v[186:187], v[186:187], v[32:33] op_sel_hi:[1,0]
    v_cvt_pk_bf16_f32 v186, v186, v187
    v_accvgpr_write_b32 a61, v186
    v_pk_mul_f32 v[188:189], v[188:189], v[32:33] op_sel_hi:[1,0]
    v_cvt_pk_bf16_f32 v188, v188, v189
    v_accvgpr_write_b32 a62, v188
    v_pk_mul_f32 v[190:191], v[190:191], v[32:33] op_sel_hi:[1,0]
    v_cvt_pk_bf16_f32 v190, v190, v191
    v_accvgpr_write_b32 a63, v190
    s_add_u32 s36, s34, 0
    s_nop 0
    buffer_store_dwordx4 a[48:51], v4, s[24:27], s36 offen offset:3072 sc1
    s_add_u32 s36, s34, 196608
    buffer_store_dwordx4 a[52:55], v4, s[24:27], s36 offen offset:3072 sc1
    s_add_u32 s36, s34, 393216
    buffer_store_dwordx4 a[56:59], v4, s[24:27], s36 offen offset:3072 sc1
    s_add_u32 s36, s34, 589824
    buffer_store_dwordx4 a[60:63], v4, s[24:27], s36 offen offset:3072 sc1
    v_accvgpr_read_b32 v32, a208
    v_rcp_f32 v32, v32
    s_nop 0
    v_pk_mul_f32 v[192:193], v[192:193], v[32:33] op_sel_hi:[1,0]
    v_cvt_pk_bf16_f32 v192, v192, v193
    v_accvgpr_write_b32 a64, v192
    v_pk_mul_f32 v[194:195], v[194:195], v[32:33] op_sel_hi:[1,0]
    v_cvt_pk_bf16_f32 v194, v194, v195
    v_accvgpr_write_b32 a65, v194
    v_pk_mul_f32 v[196:197], v[196:197], v[32:33] op_sel_hi:[1,0]
    v_cvt_pk_bf16_f32 v196, v196, v197
    v_accvgpr_write_b32 a66, v196
    v_pk_mul_f32 v[198:199], v[198:199], v[32:33] op_sel_hi:[1,0]
    v_cvt_pk_bf16_f32 v198, v198, v199
    v_accvgpr_write_b32 a67, v198
    v_pk_mul_f32 v[200:201], v[200:201], v[32:33] op_sel_hi:[1,0]
    v_cvt_pk_bf16_f32 v200, v200, v201
    v_accvgpr_write_b32 a68, v200
    v_pk_mul_f32 v[202:203], v[202:203], v[32:33] op_sel_hi:[1,0]
    v_cvt_pk_bf16_f32 v202, v202, v203
    v_accvgpr_write_b32 a69, v202
    v_pk_mul_f32 v[204:205], v[204:205], v[32:33] op_sel_hi:[1,0]
    v_cvt_pk_bf16_f32 v204, v204, v205
    v_accvgpr_write_b32 a70, v204
    v_pk_mul_f32 v[206:207], v[206:207], v[32:33] op_sel_hi:[1,0]
    v_cvt_pk_bf16_f32 v206, v206, v207
    v_accvgpr_write_b32 a71, v206
    v_pk_mul_f32 v[208:209], v[208:209], v[32:33] op_sel_hi:[1,0]
    v_cvt_pk_bf16_f32 v208, v208, v209
    v_accvgpr_write_b32 a72, v208
    v_pk_mul_f32 v[210:211], v[210:211], v[32:33] op_sel_hi:[1,0]
    v_cvt_pk_bf16_f32 v210, v210, v211
    v_accvgpr_write_b32 a73, v210
    v_pk_mul_f32 v[212:213], v[212:213], v[32:33] op_sel_hi:[1,0]
    v_cvt_pk_bf16_f32 v212, v212, v213
    v_accvgpr_write_b32 a74, v212
    v_pk_mul_f32 v[214:215], v[214:215], v[32:33] op_sel_hi:[1,0]
    v_cvt_pk_bf16_f32 v214, v214, v215
    v_accvgpr_write_b32 a75, v214
    v_pk_mul_f32 v[216:217], v[216:217], v[32:33] op_sel_hi:[1,0]
    v_cvt_pk_bf16_f32 v216, v216, v217
    v_accvgpr_write_b32 a76, v216
    v_pk_mul_f32 v[218:219], v[218:219], v[32:33] op_sel_hi:[1,0]
    v_cvt_pk_bf16_f32 v218, v218, v219
    v_accvgpr_write_b32 a77, v218
    v_pk_mul_f32 v[220:221], v[220:221], v[32:33] op_sel_hi:[1,0]
    v_cvt_pk_bf16_f32 v220, v220, v221
    v_accvgpr_write_b32 a78, v220
    v_pk_mul_f32 v[222:223], v[222:223], v[32:33] op_sel_hi:[1,0]
    v_cvt_pk_bf16_f32 v222, v222, v223
    v_accvgpr_write_b32 a79, v222
    s_add_u32 s36, s34, 4096
    buffer_store_dwordx4 a[64:67], v4, s[24:27], s36 offen offset:0 sc1
    s_add_u32 s36, s34, 200704
    buffer_store_dwordx4 a[68:71], v4, s[24:27], s36 offen offset:0 sc1
    s_add_u32 s36, s34, 397312
    buffer_store_dwordx4 a[72:75], v4, s[24:27], s36 offen offset:0 sc1
    s_add_u32 s36, s34, 593920
    buffer_store_dwordx4 a[76:79], v4, s[24:27], s36 offen offset:0 sc1
    v_accvgpr_read_b32 v32, a212
    v_rcp_f32 v32, v32
    s_nop 0
    v_pk_mul_f32 v[224:225], v[224:225], v[32:33] op_sel_hi:[1,0]
    v_cvt_pk_bf16_f32 v224, v224, v225
    v_accvgpr_write_b32 a80, v224
    v_pk_mul_f32 v[226:227], v[226:227], v[32:33] op_sel_hi:[1,0]
    v_cvt_pk_bf16_f32 v226, v226, v227
    v_accvgpr_write_b32 a81, v226
    v_pk_mul_f32 v[228:229], v[228:229], v[32:33] op_sel_hi:[1,0]
    v_cvt_pk_bf16_f32 v228, v228, v229
    v_accvgpr_write_b32 a82, v228
    v_pk_mul_f32 v[230:231], v[230:231], v[32:33] op_sel_hi:[1,0]
    v_cvt_pk_bf16_f32 v230, v230, v231
    v_accvgpr_write_b32 a83, v230
    v_pk_mul_f32 v[232:233], v[232:233], v[32:33] op_sel_hi:[1,0]
    v_cvt_pk_bf16_f32 v232, v232, v233
    v_accvgpr_write_b32 a84, v232
    v_pk_mul_f32 v[234:235], v[234:235], v[32:33] op_sel_hi:[1,0]
    v_cvt_pk_bf16_f32 v234, v234, v235
    v_accvgpr_write_b32 a85, v234
    v_pk_mul_f32 v[236:237], v[236:237], v[32:33] op_sel_hi:[1,0]
    v_cvt_pk_bf16_f32 v236, v236, v237
    v_accvgpr_write_b32 a86, v236
    v_pk_mul_f32 v[238:239], v[238:239], v[32:33] op_sel_hi:[1,0]
    v_cvt_pk_bf16_f32 v238, v238, v239
    v_accvgpr_write_b32 a87, v238
    v_pk_mul_f32 v[240:241], v[240:241], v[32:33] op_sel_hi:[1,0]
    v_cvt_pk_bf16_f32 v240, v240, v241
    v_accvgpr_write_b32 a88, v240
    v_pk_mul_f32 v[242:243], v[242:243], v[32:33] op_sel_hi:[1,0]
    v_cvt_pk_bf16_f32 v242, v242, v243
    v_accvgpr_write_b32 a89, v242
    v_pk_mul_f32 v[244:245], v[244:245], v[32:33] op_sel_hi:[1,0]
    v_cvt_pk_bf16_f32 v244, v244, v245
    v_accvgpr_write_b32 a90, v244
    v_pk_mul_f32 v[246:247], v[246:247], v[32:33] op_sel_hi:[1,0]
    v_cvt_pk_bf16_f32 v246, v246, v247
    v_accvgpr_write_b32 a91, v246
    v_pk_mul_f32 v[248:249], v[248:249], v[32:33] op_sel_hi:[1,0]
    v_cvt_pk_bf16_f32 v248, v248, v249
    v_accvgpr_write_b32 a92, v248
    v_pk_mul_f32 v[250:251], v[250:251], v[32:33] op_sel_hi:[1,0]
    v_cvt_pk_bf16_f32 v250, v250, v251
    v_accvgpr_write_b32 a93, v250
    v_pk_mul_f32 v[252:253], v[252:253], v[32:33] op_sel_hi:[1,0]
    v_cvt_pk_bf16_f32 v252, v252, v253
    v_accvgpr_write_b32 a94, v252
    v_pk_mul_f32 v[254:255], v[254:255], v[32:33] op_sel_hi:[1,0]
    v_cvt_pk_bf16_f32 v254, v254, v255
    v_accvgpr_write_b32 a95, v254
    s_add_u32 s36, s34, 4096
    buffer_store_dwordx4 a[80:83], v4, s[24:27], s36 offen offset:1024 sc1
    s_add_u32 s36, s34, 200704
    buffer_store_dwordx4 a[84:87], v4, s[24:27], s36 offen offset:1024 sc1
    s_add_u32 s36, s34, 397312
    buffer_store_dwordx4 a[88:91], v4, s[24:27], s36 offen offset:1024 sc1
    s_add_u32 s36, s34, 593920
    buffer_store_dwordx4 a[92:95], v4, s[24:27], s36 offen offset:1024 sc1
    s_waitcnt vmcnt(0)
SLOW_NEXT:
    s_add_u32 s37, s37, 1
    s_cmp_lt_u32 s37, 2
    s_cbranch_scc1 SLOW_U
    s_waitcnt vmcnt(0) lgkmcnt(0)
    s_barrier
    s_mov_b32 s70, 16384
    buffer_store_dword v21, v20, s[68:71], 0 offen offset:0 sc1
    buffer_store_dword v21, v20, s[68:71], 0 offen offset:128 sc1
    s_mov_b32 s86, 0
    s_mov_b32 s26, 0
    s_mov_b32 s42, 0
    v_mov_b32 v28, 0
    v_accvgpr_write_b32 a192, 1.0
    v_accvgpr_write_b32 a193, 1.0
    v_accvgpr_write_b32 a194, 1.0
    v_accvgpr_write_b32 a195, 1.0
    v_accvgpr_write_b32 a196, 1.0
    v_accvgpr_write_b32 a197, 1.0
    v_accvgpr_write_b32 a198, 1.0
    v_accvgpr_write_b32 a199, 1.0
    v_accvgpr_write_b32 a200, 1.0
    v_accvgpr_write_b32 a201, 1.0
    v_accvgpr_write_b32 a202, 1.0
    v_accvgpr_write_b32 a203, 1.0
    s_waitcnt vmcnt(0)
    s_cmp_lg_u32 s63, 0
    s_cbranch_scc1 K_END
    s_mov_b32 s50, 12390400
    s_branch P_SPIN2
P_BACK2:
    s_add_u32 m0, s30, 33792
    s_xor_b32 s35, s72, 0
    s_mul_i32 s35, s35, 40960
    buffer_load_dwordx4 v16, s[52:55], s35 offen offset:0 lds
    s_add_u32 m0, s30, 33568
    s_nop 0
    buffer_load_dwordx4 v16, s[52:55], s35 offen offset:1280 lds
    s_add_u32 m0, s30, 33344
    s_nop 0
    buffer_load_dwordx4 v16, s[52:55], s35 offen offset:2560 lds
    s_add_u32 m0, s30, 33120
    s_nop 0
    buffer_load_dwordx4 v16, s[52:55], s35 offen offset:3840 lds
    s_add_u32 m0, s30, 50688
    s_xor_b32 s35, s72, 1
    s_mul_i32 s35, s35, 40960
    buffer_load_dwordx4 v16, s[52:55], s35 offen offset:0 lds
    s_add_u32 m0, s30, 50464
    s_nop 0
    buffer_load_dwordx4 v16, s[52:55], s35 offen offset:1280 lds
    s_add_u32 m0, s30, 50240
    s_nop 0
    buffer_load_dwordx4 v16, s[52:55], s35 offen offset:2560 lds
    s_add_u32 m0, s30, 50016
    s_nop 0
    buffer_load_dwordx4 v16, s[52:55], s35 offen offset:3840 lds
    s_add_u32 m0, s30, 67584
    s_xor_b32 s35, s72, 2
    s_mul_i32 s35, s35, 40960
    buffer_load_dwordx4 v16, s[52:55], s35 offen offset:0 lds
    s_add_u32 m0, s30, 67360
    s_nop 0
    buffer_load_dwordx4 v16, s[52:55], s35 offen offset:1280 lds
    s_add_u32 m0, s30, 67136
    s_nop 0
    buffer_load_dwordx4 v16, s[52:55], s35 offen offset:2560 lds
    s_add_u32 m0, s30, 66912
    s_nop 0
    buffer_load_dwordx4 v16, s[52:55], s35 offen offset:3840 lds
    s_add_u32 m0, s30, 84480
    s_xor_b32 s35, s72, 3
    s_mul_i32 s35, s35, 40960
    buffer_load_dwordx4 v16, s[52:55], s35 offen offset:0 lds
    s_add_u32 m0, s30, 84256
    s_nop 0
    buffer_load_dwordx4 v16, s[52:55], s35 offen offset:1280 lds
    s_add_u32 m0, s30, 84032
    s_nop 0
    buffer_load_dwordx4 v16, s[52:55], s35 offen offset:2560 lds
    s_add_u32 m0, s30, 83808
    s_nop 0
    buffer_load_dwordx4 v16, s[52:55], s35 offen offset:3840 lds
    s_add_u32 m0, s30, 135168
    s_xor_b32 s35, s72, 4
    s_mul_i32 s35, s35, 40960
    buffer_load_dwordx4 v16, s[52:55], s35 offen offset:0 lds
    s_add_u32 m0, s30, 134944
    s_nop 0
    buffer_load_dwordx4 v16, s[52:55], s35 offen offset:1280 lds
    s_add_u32 m0, s30, 134720
    s_nop 0
    buffer_load_dwordx4 v16, s[52:55], s35 offen offset:2560 lds
    s_add_u32 m0, s30, 134496
    s_nop 0
    buffer_load_dwordx4 v16, s[52:55], s35 offen offset:3840 lds
    s_add_u32 m0, s30, 16896
    s_xor_b32 s35, s72, 5
    s_mul_i32 s35, s35, 40960
    buffer_load_dwordx4 v16, s[52:55], s35 offen offset:0 lds
    s_add_u32 m0, s30, 16672
    s_nop 0
    buffer_load_dwordx4 v16, s[52:55], s35 offen offset:1280 lds
    s_add_u32 m0, s30, 16448
    s_nop 0
    buffer_load_dwordx4 v16, s[52:55], s35 offen offset:2560 lds
    s_add_u32 m0, s30, 16224
    s_nop 0
    buffer_load_dwordx4 v16, s[52:55], s35 offen offset:3840 lds
    s_add_u32 m0, s30, 101376
    s_xor_b32 s35, s72, 6
    s_mul_i32 s35, s35, 40960
    buffer_load_dwordx4 v16, s[52:55], s35 offen offset:0 lds
    s_add_u32 m0, s30, 101152
    s_nop 0
    buffer_load_dwordx4 v16, s[52:55], s35 offen offset:1280 lds
    s_add_u32 m0, s30, 100928
    s_nop 0
    buffer_load_dwordx4 v16, s[52:55], s35 offen offset:2560 lds
    s_add_u32 m0, s30, 100704
    s_nop 0
    buffer_load_dwordx4 v16, s[52:55], s35 offen offset:3840 lds
    s_add_u32 m0, s30, 118272
    s_xor_b32 s35, s72, 7
    s_mul_i32 s35, s35, 40960
    buffer_load_dwordx4 v16, s[52:55], s35 offen offset:0 lds
    s_add_u32 m0, s30, 118048
    s_nop 0
    buffer_load_dwordx4 v16, s[52:55], s35 offen offset:1280 lds
    s_add_u32 m0, s30, 117824
    s_nop 0
    buffer_load_dwordx4 v16, s[52:55], s35 offen offset:2560 lds
    s_add_u32 m0, s30, 117600
    s_nop 0
    buffer_load_dwordx4 v16, s[52:55], s35 offen offset:3840 lds
    s_xor_b32 s7, s72, 0
    s_mul_i32 s7, s7, 196608
    buffer_load_dwordx4 v[144:147], v14, s[48:51], s7 offen offset:0 sc1
    buffer_load_dwordx4 v[148:151], v14, s[48:51], s7 offen offset:1024 sc1
    buffer_load_dwordx4 v[152:155], v15, s[48:51], s7 offen offset:0 sc1
    buffer_load_dwordx4 v[156:159], v15, s[48:51], s7 offen offset:1024 sc1
    s_xor_b32 s7, s72, 1
    s_mul_i32 s7, s7, 196608
    buffer_load_dwordx4 v[176:179], v14, s[48:51], s7 offen offset:0 sc1
    buffer_load_dwordx4 v[180:183], v14, s[48:51], s7 offen offset:1024 sc1
    buffer_load_dwordx4 v[184:187], v15, s[48:51], s7 offen offset:0 sc1
    buffer_load_dwordx4 v[188:191], v15, s[48:51], s7 offen offset:1024 sc1
    s_xor_b32 s7, s72, 2
    s_mul_i32 s7, s7, 196608
    buffer_load_dwordx4 v[80:83], v14, s[48:51], s7 offen offset:0 sc1
    buffer_load_dwordx4 v[84:87], v14, s[48:51], s7 offen offset:1024 sc1
    buffer_load_dwordx4 v[88:91], v15, s[48:51], s7 offen offset:0 sc1
    buffer_load_dwordx4 v[92:95], v15, s[48:51], s7 offen offset:1024 sc1
    s_waitcnt vmcnt(0)
    s_barrier
    s_nop 0
    ds_read_b64_tr_b16 a[220:221], v11 offset:0
    ds_read_b64_tr_b16 a[222:223], v11 offset:512
    ds_read_b64_tr_b16 a[224:225], v11 offset:32
    ds_read_b64_tr_b16 a[226:227], v11 offset:544
    ds_read_b64_tr_b16 a[228:229], v11 offset:64
    ds_read_b64_tr_b16 a[230:231], v11 offset:576
    ds_read_b64_tr_b16 a[232:233], v11 offset:96
    ds_read_b64_tr_b16 a[234:235], v11 offset:608
    s_waitcnt lgkmcnt(0)
    s_nop 0
    ds_read_b64_tr_b16 a[236:237], v11 offset:128
    ds_read_b64_tr_b16 a[238:239], v11 offset:640
    ds_read_b64_tr_b16 a[240:241], v11 offset:160
    ds_read_b64_tr_b16 a[242:243], v11 offset:672
    ds_read_b64_tr_b16 a[244:245], v11 offset:192
    ds_read_b64_tr_b16 a[246:247], v11 offset:704
    ds_read_b64_tr_b16 a[248:249], v11 offset:224
    ds_read_b64_tr_b16 a[250:251], v11 offset:736
    s_branch P_START
.section .rodata,"a"
.p2align 6
.amdhsa_kernel concat_heads__mha_block_cached__gqa_block_cached__near_ridge_kernel
  .amdhsa_next_free_vgpr 512
  .amdhsa_next_free_sgpr 102
  .amdhsa_accum_offset 256
  .amdhsa_group_segment_fixed_size 0
  .amdhsa_kernarg_size 104
  .amdhsa_user_sgpr_count 2
  .amdhsa_user_sgpr_kernarg_segment_ptr 1
  .amdhsa_system_sgpr_workgroup_id_x 1
.end_amdhsa_kernel
```
